```python
import torch

def _softmax(x, axis=-1):
    return torch.softmax(x, dim=axis)
def _gelu(x):
    return torch.nn.functional.gelu(x, approximate="tanh")
def _silu(x):
    return torch.nn.functional.silu(x)
def _sigmoid(x):
    return torch.sigmoid(x)
def _layernorm(x, axis=-1, eps=1e-5):
    m = x.mean(dim=axis, keepdim=True)
    v = x.var(dim=axis, keepdim=True, unbiased=False)
    return (x - m) / torch.sqrt(v + eps)
def _scatter_add(tgt, idx, src, axis=0):
    return tgt.clone().index_add_(axis, idx, src)
def _segment_sum(src, seg, n):
    out = torch.zeros((n,) + src.shape[1:], dtype=src.dtype)
    return out.index_add_(0, seg, src)
def _pad(x, pw):
    flat = tuple(v for pair in reversed(pw) for v in pair)
    return torch.nn.functional.pad(x, flat)

kernel_name = 'recurrent_scan__sliding_block_cached__moe_arch_mod__prompt'

def setup_inputs():

    _w = (lambda a: (lambda t: t.to(torch.bfloat16) if t.is_floating_point() else t)(torch.as_tensor(a)))
    def _A_setup():
        B, Sq, D = 1, 2048, 448
        Hq, Hkv, Sk, Dh = 16, 8, 2048, 256
        assert Hq % Hkv == 0, (Hq, Hkv)
        return {
            "x": _w((lambda *s: torch.randn(*s, dtype=torch.bfloat16) * 0.05)(B, Sq, D)),
            "k_cache": _w((lambda *s: torch.randn(*s, dtype=torch.bfloat16) * 0.8)(B, Hkv, Sk, Dh)),
            "v_cache": _w((lambda *s: torch.randn(*s, dtype=torch.bfloat16) * 0.2)(B, Hkv, Sk, Dh)),
            "wq": _w((lambda *s: torch.randn(*s, dtype=torch.bfloat16) * 0.8)(D, Hq * Dh) * (D ** -0.5)),
            "wo": _w((lambda *s: torch.randn(*s, dtype=torch.bfloat16) * 0.2)(Hq * Dh, D) * ((Hq * Dh) ** -0.5)),
        }
    _A_in = _A_setup()

    def _B_setup():
        B, S, D, F, C = 1, 2048, 448, 1792, 2
        return {
            "x": _w((lambda *s: torch.randn(*s, dtype=torch.bfloat16) * 0.05)(B, S, D)),
            "w_r": _w((lambda *s: torch.randn(*s, dtype=torch.bfloat16) * 0.2)(D)),
            "w_gate": _w((lambda *s: torch.randn(*s, dtype=torch.bfloat16) * 0.1)(D, F)),
            "w_up": _w((lambda *s: torch.randn(*s, dtype=torch.bfloat16) * 0.1)(D, F)),
            "w_down": _w((lambda *s: torch.randn(*s, dtype=torch.bfloat16) * 0.1)(F, D)),
        }
    _B_in = _B_setup()

    return {
        "A_x": _A_in["x"],
        "A_k_cache": _A_in["k_cache"],
        "A_v_cache": _A_in["v_cache"],
        "A_wq": _A_in["wq"],
        "A_wo": _A_in["wo"],
        "B_x": _B_in["x"],
        "B_w_r": _B_in["w_r"],
        "B_w_gate": _B_in["w_gate"],
        "B_w_up": _B_in["w_up"],
        "B_w_down": _B_in["w_down"],
    }

def reference(A_x, A_k_cache, A_v_cache, A_wq, A_wo, B_x, B_w_r, B_w_gate, B_w_up, B_w_down):
    def _A_ref(x, k_cache, v_cache, wq, wo):
        B, Sq, D = x.shape
        Hq, Dh = 16, 256
        Hkv, Sk = k_cache.shape[1], k_cache.shape[2]
        W = min(4096, max(256, Sk // 4))
        rep = Hq // Hkv
        q = (lambda x, *d: x.permute(*d))((x @ wq).reshape(B, Sq, Hq, Dh), 0, 2, 1, 3)
        k = (lambda x, n, axis: torch.repeat_interleave(x, n, dim=axis))(k_cache[:, :, Sk - W:, :], rep, axis=1)
        v = (lambda x, n, axis: torch.repeat_interleave(x, n, dim=axis))(v_cache[:, :, Sk - W:, :], rep, axis=1)
        scores = torch.einsum("bhqd,bhkd->bhqk", q, k) * (Dh ** -0.5)
        p = _softmax(scores, axis=-1)
        o = torch.einsum("bhqk,bhkd->bhqd", p, v)
        return (lambda x, *d: x.permute(*d))(o, 0, 2, 1, 3).reshape(B, Sq, Hq * Dh) @ wo

    def _B_ref(x, w_r, w_gate, w_up, w_down):
        B, S, D = x.shape
        C = 2
        r = x @ w_r
        idx = torch.argsort(-r, axis=-1)[:, :C]
        idx_e = (lambda x, n, axis: torch.repeat_interleave(x, n, dim=axis))(idx.reshape(B, C, 1), D, axis=2)
        x_sel = (lambda x, i, axis: torch.take_along_dim(x, i, dim=axis))(x, idx_e, axis=1)
        g = _silu(x_sel @ w_gate)
        u = x_sel @ w_up
        y = (g * u) @ w_down
        r_sel = _sigmoid((lambda x, i, axis: torch.take_along_dim(x, i, dim=axis))(r, idx, axis=1))
        y = y * r_sel.reshape(B, C, 1)
        b_off = (torch.arange(B) * S).reshape(B, 1)
        flat_idx = (idx + b_off).reshape(B * C)
        zero = (x * 0.0).reshape(B * S, D)
        upd = _scatter_add(zero, flat_idx, y.reshape(B * C, D), axis=0)
        return x + upd.reshape(B, S, D)

    x = A_x
    xn = _layernorm(x, axis=-1)
    s = _A_ref(xn, A_k_cache, A_v_cache, A_wq, A_wo)
    g = _silu(_B_ref(xn, B_w_r, B_w_gate, B_w_up, B_w_down))
    return x + s * g
```

```asm
; @launch kernel=main_kernel grid=(256,1,1) block=(256,1,1) lds=163840
.amdgcn_target "amdgcn-amd-amdhsa--gfx950"
.text
.globl main_kernel
.p2align 8
.type main_kernel,@function
main_kernel:
  s_cmp_ge_u32 s2, 256
  s_cbranch_scc1 L_end
  s_load_dwordx16 s[4:19], s[0:1], 0
  s_load_dwordx8 s[20:27], s[0:1], 64
  s_load_dwordx2 s[28:29], s[0:1], 96
  v_lshrrev_b32 v252, 6, v0
  v_and_b32 v251, 63, v0
  v_readfirstlane_b32 s68, v252
  s_and_b32 s70, s2, 3
  s_lshl_b32 s70, s70, 1
  s_bfe_u32 s87, s2, 65539
  s_add_u32 s70, s70, s87
  s_bfe_u32 s71, s2, 65538
  s_lshl_b32 s71, s71, 4
  s_lshr_b32 s87, s2, 4
  s_add_u32 s71, s71, s87
  s_lshl_b32 s3, s71, 2
  s_add_u32 s3, s3, s68
  s_getpc_b64 s[64:65]
L_pc:
  s_lshr_b32 s87, s2, 3
  s_lshl_b32 s87, s87, 2
  s_add_u32 s87, s87, s68
  s_lshl_b32 s87, s87, 9
  v_and_b32 v252, 3, v251
  s_and_b32 s65, s65, 0xffff
  s_mov_b32 s66, L_codeend-L_pc
  s_mov_b32 s67, 0x20000
  v_lshlrev_b32 v252, 7, v252
  buffer_load_dword a253, v252, s[64:67], s87 offen
  s_and_b32 s88, s3, 63
  s_lshl_b32 s88, s88, 4
  v_min_u32 v249, 15, v251
  v_add_u32 v249, s88, v249
  v_lshrrev_b32 v31, 3, v249
  v_lshlrev_b32 v31, 13, v31
  v_and_b32 v253, 7, v249
  v_lshl_add_u32 v31, v253, 7, v31
  v_lshrrev_b32 v244, 4, v251
  v_and_b32 v245, 15, v251
  v_lshrrev_b32 v242, 2, v251
  v_and_b32 v243, 3, v251
  v_xor_b32 v254, v243, v244
  v_mul_u32_u24 v252, 896, v242
  v_lshl_add_u32 v252, v254, 4, v252
  v_add_u32 v4, 3072, v252
  v_add_u32 v5, 2112, v252
  v_add_u32 v6, 1152, v252
  v_add_u32 v7, 192, v252
  v_lshlrev_b32 v250, 4, v251
  s_mul_i32 s72, s3, 14336
  s_lshl_b32 s69, s68, 12
  s_lshl_b32 s89, s68, 13
  s_lshr_b32 s74, s68, 1
  s_and_b32 s75, s68, 1
  s_lshl_b32 s88, s70, 10
  s_mov_b32 m0, 137216
  s_waitcnt lgkmcnt(0)
  s_add_u32 s36, s10, s88
  s_addc_u32 s37, s11, 0
  s_sub_u32 s36, s36, 3072
  s_subb_u32 s37, s37, 0
  s_and_b32 s37, s37, 0xffff
  s_mov_b32 s38, 0
  s_mov_b32 s39, 0x20000
  s_sub_u32 s38, 3673088, s88
  s_mov_b32 s0, 3072
  buffer_load_dword a252, v31, s[36:39], s0 offen
  s_mov_b32 s60, s16
  s_and_b32 s61, s17, 0xffff
  s_mov_b32 s62, 896
  s_mov_b32 s63, 0x20000
  buffer_load_dwordx4 v250, s[60:63], 0 offen lds
  s_sub_u32 s32, s4, 3072
  s_subb_u32 s33, s5, 0
  s_and_b32 s33, s33, 0xffff
  s_mov_b32 s34, 1838080
  s_mov_b32 s35, 0x20000
  s_add_u32 m0, s89, 98304
  s_nop 0
  buffer_load_dwordx4 v4, s[32:35], s72 offen offset:0 lds
  buffer_load_dwordx4 v5, s[32:35], s72 offen offset:1024 lds
  buffer_load_dwordx4 v6, s[32:35], s72 offen offset:2048 lds
  buffer_load_dwordx4 v7, s[32:35], s72 offen offset:3072 lds
  v_and_b32 v252, 2, v244
  v_xor_b32 v252, v252, v243
  v_lshlrev_b32 v253, 13, v242
  v_lshl_add_u32 v253, v252, 4, v253
  s_lshl_b32 s88, s74, 17
  s_lshl_b32 s87, s75, 8
  s_add_u32 s88, s88, s87
  v_add_u32 v253, s88, v253
  s_add_u32 m0, s89, 102400
  s_add_u32 s72, s72, 256
  buffer_load_dwordx4 v4, s[32:35], s72 offen offset:0 lds
  v_add_u32 v0, 3072, v253
  v_add_u32 v1, 2112, v253
  v_add_u32 v2, 1152, v253
  v_add_u32 v3, 192, v253
  s_lshl_b32 s87, s70, 20
  s_add_u32 s87, s87, 786432
  s_add_u32 s40, s6, s87
  s_addc_u32 s41, s7, 0
  s_sub_u32 s40, s40, 3072
  s_subb_u32 s41, s41, 0
  buffer_load_dwordx4 v5, s[32:35], s72 offen offset:1024 lds
  s_and_b32 s41, s41, 0xffff
  s_mov_b32 s42, 265216
  s_mov_b32 s43, 0x20000
  s_add_u32 s44, s8, s87
  s_addc_u32 s45, s9, 0
  s_sub_u32 s44, s44, 3072
  s_subb_u32 s45, s45, 0
  s_and_b32 s45, s45, 0xffff
  s_mov_b32 s46, 265216
  s_mov_b32 s47, 0x20000
  buffer_load_dwordx4 v6, s[32:35], s72 offen offset:2048 lds
  s_mov_b32 s48, s28
  s_and_b32 s49, s29, 0xffff
  s_mov_b32 s50, 268435456
  s_mov_b32 s51, 0x20000
  s_mov_b32 s56, s26
  s_and_b32 s57, s27, 0xffff
  s_mov_b32 s58, 256
  s_mov_b32 s59, 0x20000
  buffer_load_dwordx4 v7, s[32:35], s72 offen offset:3072 lds
  s_mov_b32 s60, s18
  s_and_b32 s61, s19, 0xffff
  s_mov_b32 s62, 1605632
  s_mov_b32 s63, 0x20000
  s_cmp_eq_u32 s70, 7
  s_cselect_b32 s62, 0, s62
  s_mov_b32 s64, s20
  s_and_b32 s65, s21, 0xffff
  s_mov_b32 s66, 1605632
  s_add_u32 m0, s89, 131072
  s_add_u32 s72, s72, 256
  buffer_load_dwordx4 v4, s[32:35], s72 offen offset:0 lds
  s_mov_b32 s67, 0x20000
  s_cmp_eq_u32 s70, 7
  s_cselect_b32 s66, 0, s66
  s_mov_b32 s52, s22
  s_and_b32 s53, s23, 0xffff
  s_mov_b32 s54, 1605632
  s_mov_b32 s55, 0x20000
  s_cmp_eq_u32 s70, 7
  s_cselect_b32 s54, 0, s54
  s_lshl_b32 s14, s70, 5
  buffer_load_dwordx4 v5, s[32:35], s72 offen offset:1024 lds
  s_add_u32 s14, s14, s71
  s_andn2_b32 s87, s14, 15
  s_mul_i32 s1, s87, 7168
  s_lshl_b32 s87, s87, 4
  v_lshrrev_b32 v236, 1, v249
  v_mul_u32_u24 v236, 3584, v236
  v_and_b32 v253, 1, v249
  v_lshl_add_u32 v236, v253, 7, v236
  buffer_load_dwordx4 v6, s[32:35], s72 offen offset:2048 lds
  v_add_u32 v236, s87, v236
  v_lshlrev_b32 v249, 7, v249
  v_mov_b32 v8, 0x3f803f80
  v_mov_b32 v9, 0x3f803f80
  v_mov_b32 v10, 0x3f803f80
  v_mov_b32 v11, 0x3f803f80
  v_add_u32 v252, 138240, v250
  ds_write_b128 v252, v[8:11]
  buffer_load_dwordx4 v7, s[32:35], s72 offen offset:3072 lds
  v_and_b32 v252, 1, v251
  v_lshlrev_b32 v252, 10, v252
  v_sub_u32 v252, 138240, v252
  v_lshl_add_u32 v29, v244, 4, v252
  v_and_b32 v252, 1, v244
  v_lshlrev_b32 v253, 3, v243
  v_lshl_add_u32 v253, v252, 5, v253
  v_lshl_add_u32 v232, v242, 6, v253
  s_add_u32 m0, s89, 135168
  s_add_u32 s72, s72, 256
  buffer_load_dwordx4 v4, s[32:35], s72 offen offset:0 lds
  v_xor_b32 v233, 32, v232
  v_add_u32 v234, 0x10000, v232
  v_add_u32 v235, 0x10000, v233
  v_and_b32 v24, 0xff, v232
  v_lshl_add_u32 v24, v252, 9, v24
  v_lshrrev_b32 v253, 5, v251
  v_lshl_add_u32 v24, v253, 13, v24
  s_lshl_b32 s87, s74, 14
  buffer_load_dwordx4 v5, s[32:35], s72 offen offset:1024 lds
  v_add_u32 v24, s87, v24
  v_xor_b32 v25, 32, v24
  v_add_u32 v26, 0x10000, v24
  v_add_u32 v27, 0x10000, v25
  v_lshl_add_u32 v240, v252, 1, v253
  v_lshrrev_b32 v253, 2, v245
  v_xor_b32 v240, v240, v253
  v_lshlrev_b32 v240, 4, v240
  s_add_u32 m0, s69, 0
  s_mov_b32 s72, 0
  buffer_load_dwordx4 v0, s[36:39], s72 offen offset:0 lds
  v_lshl_add_u32 v240, v245, 6, v240
  v_add_u32 v241, 0x10000, v240
  v_xor_b32 v28, v253, v244
  v_lshlrev_b32 v28, 4, v28
  v_lshl_add_u32 v28, v245, 6, v28
  s_lshl_b32 s87, s75, 14
  s_add_u32 s87, s87, 98304
  v_add_u32 v248, s87, v28
  buffer_load_dwordx4 v1, s[36:39], s72 offen offset:1024 lds
  s_add_u32 s87, s89, 98304
  v_add_u32 v28, s87, v28
  s_lshl_b32 s87, s68, 4
  v_add_u32 v30, s87, v245
  s_mov_b32 s90, 0x100001
  s_mov_b32 s91, 0x10000100
  s_mov_b32 s92, 0x200002
  s_mov_b32 s93, 0x20000200
  buffer_load_dwordx4 v2, s[36:39], s72 offen offset:2048 lds
  s_mov_b32 s94, 0x400004
  s_mov_b32 s95, 0x40000400
  s_mov_b32 s96, 0x800008
  s_mov_b32 s97, 0x80000800
  s_lshl_b32 s87, s74, 13
  s_lshl_b32 s88, s75, 8
  s_add_u32 s87, s87, s88
  v_lshlrev_b32 v253, 9, v242
  buffer_load_dwordx4 v3, s[36:39], s72 offen offset:3072 lds
  v_add_u32 v253, s87, v253
  v_lshl_add_u32 v254, v254, 4, v253
  v_lshlrev_b32 v252, 1, v252
  v_xor_b32 v252, v252, v243
  v_lshl_add_u32 v253, v252, 4, v253
  v_add_u32 v224, 3072, v254
  v_add_u32 v228, 3072, v253
  v_add_u32 v225, 2112, v254
  s_add_u32 m0, s69, 16384
  s_mov_b32 s72, 512
  buffer_load_dwordx4 v0, s[36:39], s72 offen offset:0 lds
  v_add_u32 v229, 2112, v253
  v_add_u32 v226, 1152, v254
  v_add_u32 v230, 1152, v253
  v_add_u32 v227, 192, v254
  v_add_u32 v231, 192, v253
  s_mov_b32 s73, 0x47800000
  s_mul_i32 s87, s75, 14
  s_mul_i32 s88, s74, 7
  buffer_load_dwordx4 v1, s[36:39], s72 offen offset:1024 lds
  s_add_u32 s87, s87, s88
  s_mul_i32 s88, s71, 28
  s_add_u32 s87, s87, s88
  s_lshl_b32 s83, s87, 14
  s_add_u32 s87, s70, 1
  s_cmp_ge_u32 s87, 7
  s_cselect_b32 s88, 7, 0
  s_sub_u32 s87, s87, s88
  s_lshl_b32 s76, s87, 7
  buffer_load_dwordx4 v2, s[36:39], s72 offen offset:2048 lds
  s_lshl_b32 s88, s87, 14
  s_add_u32 s4, s88, s83
  s_cmp_eq_u32 s70, 7
  s_cselect_b32 s88, 6, 0
  s_lshl_b32 s88, s88, 11
  s_add_u32 s4, s4, s88
  s_add_u32 s87, s87, 1
  s_cmp_ge_u32 s87, 7
  s_cselect_b32 s88, 7, 0
  s_sub_u32 s87, s87, s88
  buffer_load_dwordx4 v3, s[36:39], s72 offen offset:3072 lds
  s_lshl_b32 s77, s87, 7
  s_lshl_b32 s88, s87, 14
  s_add_u32 s5, s88, s83
  s_cmp_eq_u32 s70, 7
  s_cselect_b32 s88, 6, 1
  s_lshl_b32 s88, s88, 11
  s_add_u32 s5, s5, s88
  s_add_u32 s87, s87, 1
  s_cmp_ge_u32 s87, 7
  s_cselect_b32 s88, 7, 0
  s_mov_b32 s0, 1051648
  buffer_load_dword a252, v31, s[36:39], s0 offen
  s_sub_u32 s87, s87, s88
  s_lshl_b32 s78, s87, 7
  s_lshl_b32 s88, s87, 14
  s_add_u32 s6, s88, s83
  s_cmp_eq_u32 s70, 7
  s_cselect_b32 s88, 6, 2
  s_lshl_b32 s88, s88, 11
  s_add_u32 s6, s6, s88
  s_add_u32 s87, s87, 1
  s_cmp_ge_u32 s87, 7
  s_cselect_b32 s88, 7, 0
  s_sub_u32 s87, s87, s88
  s_lshl_b32 s79, s87, 7
  s_lshl_b32 s88, s87, 14
  s_add_u32 s7, s88, s83
  s_cmp_eq_u32 s70, 7
  s_cselect_b32 s88, 6, 3
  s_lshl_b32 s88, s88, 11
  s_add_u32 s7, s7, s88
  s_add_u32 s87, s87, 1
  s_cmp_ge_u32 s87, 7
  s_cselect_b32 s88, 7, 0
  s_sub_u32 s87, s87, s88
  s_lshl_b32 s80, s87, 7
  s_lshl_b32 s88, s87, 14
  s_add_u32 s8, s88, s83
  s_cmp_eq_u32 s70, 7
  s_cselect_b32 s88, 6, 4
  s_lshl_b32 s88, s88, 11
  s_add_u32 s8, s8, s88
  s_add_u32 s87, s87, 1
  s_cmp_ge_u32 s87, 7
  s_cselect_b32 s88, 7, 0
  s_sub_u32 s87, s87, s88
  s_lshl_b32 s81, s87, 7
  s_lshl_b32 s88, s87, 14
  s_add_u32 s9, s88, s83
  s_cmp_eq_u32 s70, 7
  s_cselect_b32 s88, 6, 5
  s_lshl_b32 s88, s88, 11
  s_add_u32 s9, s9, s88
  s_add_u32 s87, s87, 1
  s_cmp_ge_u32 s87, 7
  s_cselect_b32 s88, 7, 0
  s_sub_u32 s87, s87, s88
  s_lshl_b32 s82, s87, 7
  s_lshl_b32 s88, s87, 14
  s_add_u32 s10, s88, s83
  s_cmp_eq_u32 s70, 7
  s_cselect_b32 s88, 6, 6
  s_lshl_b32 s88, s88, 11
  s_add_u32 s10, s10, s88
  s_add_u32 s87, s87, 1
  s_sub_u32 s83, s10, 12288
  s_cmp_eq_u32 s70, 7
  s_cselect_b32 s83, 2146435072, s83
  s_cselect_b32 s10, s10, 2146435072
  s_cselect_b32 s84, s68, 1
  s_lshl_b32 s15, s74, 6
  s_add_u32 s15, s15, s82
  v_mov_b32 v253, -1
  v_accvgpr_write_b32 a248, v253
  v_accvgpr_write_b32 a249, v253
  v_accvgpr_write_b32 a250, v253
  v_accvgpr_write_b32 a251, v253
  s_mov_b32 s16, s24
  s_and_b32 s17, s25, 0xffff
  s_mov_b32 s18, 1835008
  s_mov_b32 s19, 0x20000
  v_lshrrev_b32 v220, 1, v244
  v_xor_b32 v220, v220, v244
  v_lshlrev_b32 v220, 4, v220
  v_xor_b32 v220, v220, v248
  v_and_b32 v221, 1, v244
  v_lshl_add_u32 v220, v221, 3, v220
  s_lshr_b32 s87, s15, 9
  s_mul_i32 s87, s87, 24576
  s_lshl_b32 s88, s15, 4
  s_add_u32 s87, s87, s88
  v_add_u32 v220, s87, v220
  v_xor_b32 v221, 32, v220
  s_cmp_eq_u32 s70, 7
  s_cbranch_scc1 L_pub0
L_pub0r:
  s_waitcnt vmcnt(23)
  ds_read_b128 a[168:171], v29 offset:0
  ds_read_b128 a[172:175], v29 offset:64
  ds_read_b128 a[176:179], v29 offset:128
  ds_read_b128 a[180:183], v29 offset:192
  ds_read_b128 a[184:187], v29 offset:256
  ds_read_b128 a[188:191], v29 offset:320
  ds_read_b128 a[192:195], v29 offset:384
  ds_read_b128 a[196:199], v29 offset:448
  ds_read_b128 a[200:203], v29 offset:512
  ds_read_b128 a[204:207], v29 offset:576
  ds_read_b128 a[208:211], v29 offset:640
  ds_read_b128 a[212:215], v29 offset:704
  ds_read_b128 a[216:219], v29 offset:768
  ds_read_b128 a[220:223], v29 offset:832
  s_waitcnt lgkmcnt(13)
  v_mfma_f32_16x16x32_bf16 v[20:23], a[168:171], v[8:11], 0
  s_waitcnt lgkmcnt(12)
  v_mfma_f32_16x16x32_bf16 v[20:23], a[172:175], v[8:11], v[20:23]
  s_waitcnt lgkmcnt(11)
  v_mfma_f32_16x16x32_bf16 v[20:23], a[176:179], v[8:11], v[20:23]
  s_waitcnt lgkmcnt(10)
  v_mfma_f32_16x16x32_bf16 v[20:23], a[180:183], v[8:11], v[20:23]
  s_waitcnt lgkmcnt(9)
  v_mfma_f32_16x16x32_bf16 v[20:23], a[184:187], v[8:11], v[20:23]
  s_waitcnt lgkmcnt(8)
  v_mfma_f32_16x16x32_bf16 v[20:23], a[188:191], v[8:11], v[20:23]
  s_waitcnt lgkmcnt(7)
  v_mfma_f32_16x16x32_bf16 v[20:23], a[192:195], v[8:11], v[20:23]
  s_waitcnt lgkmcnt(6)
  v_mfma_f32_16x16x32_bf16 v[20:23], a[196:199], v[8:11], v[20:23]
  s_waitcnt lgkmcnt(5)
  v_mfma_f32_16x16x32_bf16 v[20:23], a[200:203], v[8:11], v[20:23]
  s_waitcnt lgkmcnt(4)
  v_mfma_f32_16x16x32_bf16 v[20:23], a[204:207], v[8:11], v[20:23]
  s_waitcnt lgkmcnt(3)
  v_mfma_f32_16x16x32_bf16 v[20:23], a[208:211], v[8:11], v[20:23]
  s_waitcnt lgkmcnt(2)
  v_mfma_f32_16x16x32_bf16 v[20:23], a[212:215], v[8:11], v[20:23]
  s_waitcnt lgkmcnt(1)
  v_mfma_f32_16x16x32_bf16 v[20:23], a[216:219], v[8:11], v[20:23]
  s_waitcnt lgkmcnt(0)
  v_mfma_f32_16x16x32_bf16 v[20:23], a[220:223], v[8:11], v[20:23]
  s_waitcnt vmcnt(19)
  ds_read_b128 a[112:115], v28 offset:0
  ds_read_b128 a[116:119], v28 offset:1024
  ds_read_b128 a[120:123], v28 offset:2048
  ds_read_b128 a[124:127], v28 offset:3072
  s_waitcnt vmcnt(15)
  ds_read_b128 a[128:131], v28 offset:4096
  ds_read_b128 a[132:135], v28 offset:5120
  ds_read_b128 a[136:139], v28 offset:6144
  ds_read_b128 a[140:143], v28 offset:7168
  s_waitcnt lgkmcnt(7)
  v_mfma_f32_16x16x32_bf16 v[12:15], a[168:171], a[112:115], 0
  v_mfma_f32_16x16x32_bf16 v[16:19], a[112:115], a[112:115], 0
  s_add_u32 m0, s69, 32768
  s_mov_b32 s72, 262144
  buffer_load_dwordx4 v0, s[36:39], s72 offen offset:0 lds
  s_waitcnt lgkmcnt(6)
  v_mfma_f32_16x16x32_bf16 v[12:15], a[172:175], a[116:119], v[12:15]
  v_mfma_f32_16x16x32_bf16 v[16:19], a[116:119], a[116:119], v[16:19]
  buffer_load_dwordx4 v1, s[36:39], s72 offen offset:1024 lds
  s_waitcnt lgkmcnt(5)
  v_mfma_f32_16x16x32_bf16 v[12:15], a[176:179], a[120:123], v[12:15]
  v_mfma_f32_16x16x32_bf16 v[16:19], a[120:123], a[120:123], v[16:19]
  buffer_load_dwordx4 v2, s[36:39], s72 offen offset:2048 lds
  s_waitcnt lgkmcnt(4)
  v_mfma_f32_16x16x32_bf16 v[12:15], a[180:183], a[124:127], v[12:15]
  v_mfma_f32_16x16x32_bf16 v[16:19], a[124:127], a[124:127], v[16:19]
  buffer_load_dwordx4 v3, s[36:39], s72 offen offset:3072 lds
  s_waitcnt vmcnt(15)
  ds_read_b128 a[144:147], v28 offset:32768
  ds_read_b128 a[148:151], v28 offset:33792
  ds_read_b128 a[152:155], v28 offset:34816
  ds_read_b128 a[156:159], v28 offset:35840
  s_waitcnt lgkmcnt(7)
  v_mfma_f32_16x16x32_bf16 v[12:15], a[184:187], a[128:131], v[12:15]
  v_mfma_f32_16x16x32_bf16 v[16:19], a[128:131], a[128:131], v[16:19]
  s_add_u32 m0, s69, 49152
  s_mov_b32 s72, 262656
  buffer_load_dwordx4 v0, s[36:39], s72 offen offset:0 lds
  s_waitcnt lgkmcnt(6)
  v_mfma_f32_16x16x32_bf16 v[12:15], a[188:191], a[132:135], v[12:15]
  v_mfma_f32_16x16x32_bf16 v[16:19], a[132:135], a[132:135], v[16:19]
  buffer_load_dwordx4 v1, s[36:39], s72 offen offset:1024 lds
  s_waitcnt lgkmcnt(5)
  v_mfma_f32_16x16x32_bf16 v[12:15], a[192:195], a[136:139], v[12:15]
  v_mfma_f32_16x16x32_bf16 v[16:19], a[136:139], a[136:139], v[16:19]
  buffer_load_dwordx4 v2, s[36:39], s72 offen offset:2048 lds
  s_waitcnt lgkmcnt(4)
  v_mfma_f32_16x16x32_bf16 v[12:15], a[196:199], a[140:143], v[12:15]
  v_mfma_f32_16x16x32_bf16 v[16:19], a[140:143], a[140:143], v[16:19]
  buffer_load_dwordx4 v3, s[36:39], s72 offen offset:3072 lds
  s_waitcnt vmcnt(17)
  ds_read_b128 a[160:163], v28 offset:36864
  ds_read_b128 a[164:167], v28 offset:37888
  s_barrier
  s_waitcnt lgkmcnt(5)
  v_mfma_f32_16x16x32_bf16 v[12:15], a[200:203], a[144:147], v[12:15]
  v_mfma_f32_16x16x32_bf16 v[16:19], a[144:147], a[144:147], v[16:19]
  s_add_u32 m0, s69, 65536
  s_mov_b32 s72, 524288
  buffer_load_dwordx4 v0, s[36:39], s72 offen offset:0 lds
  ds_read_b128 v[32:35], v248 offset:0
  ds_read_b128 v[36:39], v248 offset:8192
  s_waitcnt lgkmcnt(6)
  v_mfma_f32_16x16x32_bf16 v[12:15], a[204:207], a[148:151], v[12:15]
  v_mfma_f32_16x16x32_bf16 v[16:19], a[148:151], a[148:151], v[16:19]
  buffer_load_dwordx4 v1, s[36:39], s72 offen offset:1024 lds
  ds_read_b128 v[40:43], v248 offset:1024
  ds_read_b128 v[44:47], v248 offset:9216
  s_waitcnt lgkmcnt(7)
  v_mfma_f32_16x16x32_bf16 v[12:15], a[208:211], a[152:155], v[12:15]
  v_mfma_f32_16x16x32_bf16 v[16:19], a[152:155], a[152:155], v[16:19]
  buffer_load_dwordx4 v2, s[36:39], s72 offen offset:2048 lds
  ds_read_b128 v[48:51], v248 offset:2048
  ds_read_b128 v[52:55], v248 offset:10240
  s_waitcnt lgkmcnt(8)
  v_mfma_f32_16x16x32_bf16 v[12:15], a[212:215], a[156:159], v[12:15]
  v_mfma_f32_16x16x32_bf16 v[16:19], a[156:159], a[156:159], v[16:19]
  buffer_load_dwordx4 v3, s[36:39], s72 offen offset:3072 lds
  ds_read_b128 v[56:59], v248 offset:3072
  ds_read_b128 v[60:63], v248 offset:11264
  s_waitcnt lgkmcnt(9)
  v_mfma_f32_16x16x32_bf16 v[12:15], a[216:219], a[160:163], v[12:15]
  v_mfma_f32_16x16x32_bf16 v[16:19], a[160:163], a[160:163], v[16:19]
  ds_read_b128 v[64:67], v248 offset:4096
  ds_read_b128 v[68:71], v248 offset:12288
  s_waitcnt lgkmcnt(10)
  v_mfma_f32_16x16x32_bf16 v[12:15], a[220:223], a[164:167], v[12:15]
  v_mfma_f32_16x16x32_bf16 v[16:19], a[164:167], a[164:167], v[16:19]
  ds_read_b128 v[72:75], v248 offset:5120
  ds_read_b128 v[76:79], v248 offset:13312
  ds_read_b128 v[80:83], v248 offset:6144
  ds_read_b128 v[84:87], v248 offset:14336
  ds_read_b128 v[88:91], v248 offset:7168
  ds_read_b128 v[92:95], v248 offset:15360
  ds_read_b64 a[224:225], v220 offset:0
  ds_read_b64 a[226:227], v221 offset:0
  ds_read_b64 a[228:229], v220 offset:8192
  ds_read_b64 a[230:231], v221 offset:8192
  v_cndmask_b32_e64 v253, 0, v16, s[90:91]
  v_cndmask_b32_e64 v253, v253, v17, s[92:93]
  v_cndmask_b32_e64 v253, v253, v18, s[94:95]
  v_cndmask_b32_e64 v253, v253, v19, s[96:97]
  v_mov_b32 v254, v253
  s_nop 1
  v_permlane16_swap_b32 v253, v254
  v_add_f32 v253, v253, v254
  v_mov_b32 v254, v253
  s_nop 1
  v_permlane32_swap_b32 v253, v254
  v_add_f32 v253, v253, v254
  v_mul_f32 v14, 0x3b124925, v12
  v_mul_f32 v254, 0x3b124925, v253
  v_fma_f32 v254, -v14, v14, v254
  v_max_f32 v254, 0, v254
  v_cvt_pk_bf16_f32 v254, v14, v254
  v_lshlrev_b32 v14, 16, v254
  v_and_b32 v254, 0xffff0000, v254
  v_add_f32 v254, 0x3727c5ac, v254
  v_cvt_pk_bf16_f32 v254, 0, v254
  v_sqrt_f32 v254, v254
  s_nop 0
  v_cvt_pk_bf16_f32 v15, 0, v254
  v_rcp_f32 v15, v15
  v_fma_f32 v18, -v14, v21, v13
  v_mul_f32 v16, 0x3db8aa3b, v15
  v_lshlrev_b32 v253, 4, v30
  v_mul_f32_e64 v17, -v14, v16
  v_mul_f32 v18, v18, v15
  v_add_u32 v253, 145408, v253
  ds_write_b96 v253, v[16:18]
  s_cmp_eq_u32 s70, 7
  s_cbranch_scc1 L_pub1
L_pub1r:
  s_add_u32 m0, s69, 81920
  s_mov_b32 s72, 524800
  buffer_load_dwordx4 v0, s[36:39], s72 offen offset:0 lds
  buffer_load_dwordx4 v1, s[36:39], s72 offen offset:1024 lds
  buffer_load_dwordx4 v2, s[36:39], s72 offen offset:2048 lds
  buffer_load_dwordx4 v3, s[36:39], s72 offen offset:3072 lds
  v_and_b32 v253, 15, v251
  v_lshlrev_b32 v253, 4, v253
  s_lshl_b32 s87, s75, 9
  s_add_u32 s87, s87, 145408
  v_add_u32 v253, s87, v253
  s_waitcnt vmcnt(17)
  s_waitcnt lgkmcnt(0)
  s_barrier
  ds_read_b64 v[238:239], v253
  ds_read_b64 v[246:247], v253 offset:256
  ds_read_b64_tr_b16 a[0:1], v24 offset:0
  ds_read_b64_tr_b16 a[2:3], v24 offset:256
  ds_read_b64_tr_b16 a[4:5], v25 offset:0
  ds_read_b64_tr_b16 a[6:7], v25 offset:256
  ds_read_b64_tr_b16 a[8:9], v24 offset:1024
  ds_read_b64_tr_b16 a[10:11], v24 offset:1280
  ds_read_b64_tr_b16 a[12:13], v25 offset:1024
  ds_read_b64_tr_b16 a[14:15], v25 offset:1280
  ds_read_b64_tr_b16 a[16:17], v24 offset:2048
  ds_read_b64_tr_b16 a[18:19], v24 offset:2304
  ds_read_b64_tr_b16 a[20:21], v25 offset:2048
  ds_read_b64_tr_b16 a[22:23], v25 offset:2304
  ds_read_b64_tr_b16 a[24:25], v24 offset:3072
  ds_read_b64_tr_b16 a[26:27], v24 offset:3328
  ds_read_b64_tr_b16 a[28:29], v25 offset:3072
  ds_read_b64_tr_b16 a[30:31], v25 offset:3328
  v_lshlrev_b32 v8, 16, v32
  v_and_b32 v9, 0xffff0000, v32
  s_waitcnt lgkmcnt(15)
  v_fma_f32 v8, v8, v238, v239
  v_fma_f32 v9, v9, v238, v239
  v_cvt_pk_bf16_f32 v32, v8, v9
  v_lshlrev_b32 v10, 16, v33
  v_and_b32 v11, 0xffff0000, v33
  v_fma_f32 v10, v10, v238, v239
  v_fma_f32 v11, v11, v238, v239
  v_cvt_pk_bf16_f32 v33, v10, v11
  v_lshlrev_b32 v8, 16, v34
  v_and_b32 v9, 0xffff0000, v34
  v_fma_f32 v8, v8, v238, v239
  v_fma_f32 v9, v9, v238, v239
  v_cvt_pk_bf16_f32 v34, v8, v9
  v_lshlrev_b32 v10, 16, v35
  v_and_b32 v11, 0xffff0000, v35
  v_fma_f32 v10, v10, v238, v239
  v_fma_f32 v11, v11, v238, v239
  v_cvt_pk_bf16_f32 v35, v10, v11
  v_lshlrev_b32 v8, 16, v36
  v_and_b32 v9, 0xffff0000, v36
  s_waitcnt lgkmcnt(15)
  v_fma_f32 v8, v8, v246, v247
  v_fma_f32 v9, v9, v246, v247
  v_cvt_pk_bf16_f32 v36, v8, v9
  v_lshlrev_b32 v10, 16, v37
  v_and_b32 v11, 0xffff0000, v37
  v_fma_f32 v10, v10, v246, v247
  v_fma_f32 v11, v11, v246, v247
  v_cvt_pk_bf16_f32 v37, v10, v11
  v_lshlrev_b32 v8, 16, v38
  v_and_b32 v9, 0xffff0000, v38
  v_fma_f32 v8, v8, v246, v247
  v_fma_f32 v9, v9, v246, v247
  v_cvt_pk_bf16_f32 v38, v8, v9
  v_lshlrev_b32 v10, 16, v39
  v_and_b32 v11, 0xffff0000, v39
  v_fma_f32 v10, v10, v246, v247
  v_fma_f32 v11, v11, v246, v247
  v_cvt_pk_bf16_f32 v39, v10, v11
L_g1:
  s_waitcnt lgkmcnt(8)
  v_mfma_f32_16x16x32_bf16 v[96:99], a[0:3], v[32:35], 0
  ds_read_b64_tr_b16 a[32:33], v24 offset:4096
  ds_read_b64_tr_b16 a[34:35], v24 offset:4352
  ds_read_b64_tr_b16 a[36:37], v25 offset:4096
  ds_read_b64_tr_b16 a[38:39], v25 offset:4352
  v_mfma_f32_16x16x32_bf16 v[104:107], a[0:3], v[36:39], 0
  s_mov_b32 s0, 2100224
  buffer_load_dword a252, v31, s[36:39], s0 offen
  v_mfma_f32_16x16x32_bf16 v[100:103], a[4:7], v[32:35], 0
  s_add_u32 m0, s69, 98304
  s_mov_b32 s72, 786432
  ds_read_b64_tr_b16 a[40:41], v24 offset:5120
  ds_read_b64_tr_b16 a[42:43], v24 offset:5376
  v_mfma_f32_16x16x32_bf16 v[108:111], a[4:7], v[36:39], 0
  buffer_load_dwordx4 v0, s[36:39], s72 offen offset:0 lds
  v_mfma_f32_16x16x32_bf16 v[112:115], a[8:11], v[32:35], 0
  ds_read_b64_tr_b16 a[44:45], v25 offset:5120
  ds_read_b64_tr_b16 a[46:47], v25 offset:5376
  v_lshlrev_b32 v8, 16, v40
  v_mfma_f32_16x16x32_bf16 v[120:123], a[8:11], v[36:39], 0
  ds_read_b64_tr_b16 a[48:49], v24 offset:6144
  ds_read_b64_tr_b16 a[50:51], v24 offset:6400
  v_and_b32 v9, 0xffff0000, v40
  v_mfma_f32_16x16x32_bf16 v[116:119], a[12:15], v[32:35], 0
  ds_read_b64_tr_b16 a[52:53], v25 offset:6144
  ds_read_b64_tr_b16 a[54:55], v25 offset:6400
  v_fma_f32 v8, v8, v238, v239
  v_mfma_f32_16x16x32_bf16 v[124:127], a[12:15], v[36:39], 0
  buffer_load_dwordx4 v1, s[36:39], s72 offen offset:1024 lds
  s_waitcnt lgkmcnt(12)
  v_mfma_f32_16x16x32_bf16 v[128:131], a[16:19], v[32:35], 0
  ds_read_b64_tr_b16 a[56:57], v24 offset:7168
  ds_read_b64_tr_b16 a[58:59], v24 offset:7424
  v_fma_f32 v9, v9, v238, v239
  v_mfma_f32_16x16x32_bf16 v[136:139], a[16:19], v[36:39], 0
  ds_read_b64_tr_b16 a[60:61], v25 offset:7168
  ds_read_b64_tr_b16 a[62:63], v25 offset:7424
  v_cvt_pk_bf16_f32 v40, v8, v9
  v_mfma_f32_16x16x32_bf16 v[132:135], a[20:23], v[32:35], 0
  v_lshlrev_b32 v10, 16, v41
  v_and_b32 v11, 0xffff0000, v41
  v_fma_f32 v10, v10, v238, v239
  v_mfma_f32_16x16x32_bf16 v[140:143], a[20:23], v[36:39], 0
  buffer_load_dwordx4 v2, s[36:39], s72 offen offset:2048 lds
  v_mfma_f32_16x16x32_bf16 v[144:147], a[24:27], v[32:35], 0
  v_fma_f32 v11, v11, v238, v239
  v_cvt_pk_bf16_f32 v41, v10, v11
  v_lshlrev_b32 v8, 16, v42
  v_mfma_f32_16x16x32_bf16 v[152:155], a[24:27], v[36:39], 0
  v_and_b32 v9, 0xffff0000, v42
  v_fma_f32 v8, v8, v238, v239
  v_fma_f32 v9, v9, v238, v239
  v_mfma_f32_16x16x32_bf16 v[148:151], a[28:31], v[32:35], 0
  v_cvt_pk_bf16_f32 v42, v8, v9
  v_lshlrev_b32 v10, 16, v43
  v_and_b32 v11, 0xffff0000, v43
  v_mfma_f32_16x16x32_bf16 v[156:159], a[28:31], v[36:39], 0
  buffer_load_dwordx4 v3, s[36:39], s72 offen offset:3072 lds
  s_waitcnt lgkmcnt(8)
  v_mfma_f32_16x16x32_bf16 v[160:163], a[32:35], v[32:35], 0
  s_waitcnt vmcnt(13)
  s_waitcnt lgkmcnt(0)
  s_barrier
  ds_read_b64_tr_b16 a[0:1], v24 offset:32768
  v_mfma_f32_16x16x32_bf16 v[168:171], a[32:35], v[36:39], 0
  ds_read_b64_tr_b16 a[2:3], v24 offset:33024
  v_fma_f32 v10, v10, v238, v239
  v_fma_f32 v11, v11, v238, v239
  v_mfma_f32_16x16x32_bf16 v[164:167], a[36:39], v[32:35], 0
  s_add_u32 m0, s69, 114688
  s_mov_b32 s72, 786944
  ds_read_b64_tr_b16 a[4:5], v25 offset:32768
  ds_read_b64_tr_b16 a[6:7], v25 offset:33024
  v_mfma_f32_16x16x32_bf16 v[172:175], a[36:39], v[36:39], 0
  buffer_load_dwordx4 v0, s[36:39], s72 offen offset:0 lds
  v_mfma_f32_16x16x32_bf16 v[176:179], a[40:43], v[32:35], 0
  ds_read_b64_tr_b16 a[8:9], v24 offset:33792
  v_cvt_pk_bf16_f32 v43, v10, v11
  v_lshlrev_b32 v8, 16, v44
  v_mfma_f32_16x16x32_bf16 v[184:187], a[40:43], v[36:39], 0
  ds_read_b64_tr_b16 a[10:11], v24 offset:34048
  v_and_b32 v9, 0xffff0000, v44
  v_fma_f32 v8, v8, v246, v247
  v_mfma_f32_16x16x32_bf16 v[180:183], a[44:47], v[32:35], 0
  ds_read_b64_tr_b16 a[12:13], v25 offset:33792
  ds_read_b64_tr_b16 a[14:15], v25 offset:34048
  v_fma_f32 v9, v9, v246, v247
  v_mfma_f32_16x16x32_bf16 v[188:191], a[44:47], v[36:39], 0
  buffer_load_dwordx4 v1, s[36:39], s72 offen offset:1024 lds
  v_mfma_f32_16x16x32_bf16 v[192:195], a[48:51], v[32:35], 0
  ds_read_b64_tr_b16 a[16:17], v24 offset:34816
  v_cvt_pk_bf16_f32 v44, v8, v9
  v_lshlrev_b32 v10, 16, v45
  v_and_b32 v11, 0xffff0000, v45
  v_mfma_f32_16x16x32_bf16 v[200:203], a[48:51], v[36:39], 0
  ds_read_b64_tr_b16 a[18:19], v24 offset:35072
  v_fma_f32 v10, v10, v246, v247
  v_fma_f32 v11, v11, v246, v247
  v_cvt_pk_bf16_f32 v45, v10, v11
  v_mfma_f32_16x16x32_bf16 v[196:199], a[52:55], v[32:35], 0
  ds_read_b64_tr_b16 a[20:21], v25 offset:34816
  ds_read_b64_tr_b16 a[22:23], v25 offset:35072
  v_lshlrev_b32 v8, 16, v46
  v_and_b32 v9, 0xffff0000, v46
  v_mfma_f32_16x16x32_bf16 v[204:207], a[52:55], v[36:39], 0
  buffer_load_dwordx4 v2, s[36:39], s72 offen offset:2048 lds
  v_mfma_f32_16x16x32_bf16 v[208:211], a[56:59], v[32:35], 0
  ds_read_b64_tr_b16 a[24:25], v24 offset:35840
  v_fma_f32 v8, v8, v246, v247
  v_fma_f32 v9, v9, v246, v247
  v_cvt_pk_bf16_f32 v46, v8, v9
  v_mfma_f32_16x16x32_bf16 v[216:219], a[56:59], v[36:39], 0
  ds_read_b64_tr_b16 a[26:27], v24 offset:36096
  v_lshlrev_b32 v10, 16, v47
  v_and_b32 v11, 0xffff0000, v47
  v_fma_f32 v10, v10, v246, v247
  v_mfma_f32_16x16x32_bf16 v[212:215], a[60:63], v[32:35], 0
  ds_read_b64_tr_b16 a[28:29], v25 offset:35840
  ds_read_b64_tr_b16 a[30:31], v25 offset:36096
  v_fma_f32 v11, v11, v246, v247
  v_cvt_pk_bf16_f32 v47, v10, v11
  v_mfma_f32_16x16x32_bf16 v[220:223], a[60:63], v[36:39], 0
  buffer_load_dwordx4 v3, s[36:39], s72 offen offset:3072 lds
  s_waitcnt lgkmcnt(8)
  v_mfma_f32_16x16x32_bf16 v[96:99], a[0:3], v[40:43], v[96:99]
  ds_read_b64_tr_b16 a[32:33], v24 offset:36864
  ds_read_b64_tr_b16 a[34:35], v24 offset:37120
  v_lshlrev_b32 v8, 16, v48
  v_mfma_f32_16x16x32_bf16 v[104:107], a[0:3], v[44:47], v[104:107]
  ds_read_b64_tr_b16 a[36:37], v25 offset:36864
  ds_read_b64_tr_b16 a[38:39], v25 offset:37120
  v_and_b32 v9, 0xffff0000, v48
  v_mfma_f32_16x16x32_bf16 v[100:103], a[4:7], v[40:43], v[100:103]
  s_add_u32 m0, s69, 0
  s_mov_b32 s72, 1048576
  ds_read_b64_tr_b16 a[40:41], v24 offset:37888
  ds_read_b64_tr_b16 a[42:43], v24 offset:38144
  v_mfma_f32_16x16x32_bf16 v[108:111], a[4:7], v[44:47], v[108:111]
  buffer_load_dwordx4 v0, s[36:39], s72 offen offset:0 lds
  v_mfma_f32_16x16x32_bf16 v[112:115], a[8:11], v[40:43], v[112:115]
  ds_read_b64_tr_b16 a[44:45], v25 offset:37888
  ds_read_b64_tr_b16 a[46:47], v25 offset:38144
  v_fma_f32 v8, v8, v238, v239
  v_mfma_f32_16x16x32_bf16 v[120:123], a[8:11], v[44:47], v[120:123]
  ds_read_b64_tr_b16 a[48:49], v24 offset:38912
  ds_read_b64_tr_b16 a[50:51], v24 offset:39168
  v_fma_f32 v9, v9, v238, v239
  v_mfma_f32_16x16x32_bf16 v[116:119], a[12:15], v[40:43], v[116:119]
  ds_read_b64_tr_b16 a[52:53], v25 offset:38912
  ds_read_b64_tr_b16 a[54:55], v25 offset:39168
  v_cvt_pk_bf16_f32 v48, v8, v9
  v_mfma_f32_16x16x32_bf16 v[124:127], a[12:15], v[44:47], v[124:127]
  buffer_load_dwordx4 v1, s[36:39], s72 offen offset:1024 lds
  s_waitcnt lgkmcnt(12)
  v_mfma_f32_16x16x32_bf16 v[128:131], a[16:19], v[40:43], v[128:131]
  ds_read_b64_tr_b16 a[56:57], v24 offset:39936
  ds_read_b64_tr_b16 a[58:59], v24 offset:40192
  v_lshlrev_b32 v10, 16, v49
  v_mfma_f32_16x16x32_bf16 v[136:139], a[16:19], v[44:47], v[136:139]
  ds_read_b64_tr_b16 a[60:61], v25 offset:39936
  ds_read_b64_tr_b16 a[62:63], v25 offset:40192
  v_and_b32 v11, 0xffff0000, v49
  v_mfma_f32_16x16x32_bf16 v[132:135], a[20:23], v[40:43], v[132:135]
  v_fma_f32 v10, v10, v238, v239
  v_fma_f32 v11, v11, v238, v239
  v_cvt_pk_bf16_f32 v49, v10, v11
  v_mfma_f32_16x16x32_bf16 v[140:143], a[20:23], v[44:47], v[140:143]
  buffer_load_dwordx4 v2, s[36:39], s72 offen offset:2048 lds
  v_mfma_f32_16x16x32_bf16 v[144:147], a[24:27], v[40:43], v[144:147]
  v_lshlrev_b32 v8, 16, v50
  v_and_b32 v9, 0xffff0000, v50
  v_fma_f32 v8, v8, v238, v239
  v_mfma_f32_16x16x32_bf16 v[152:155], a[24:27], v[44:47], v[152:155]
  v_fma_f32 v9, v9, v238, v239
  v_cvt_pk_bf16_f32 v50, v8, v9
  v_lshlrev_b32 v10, 16, v51
  v_mfma_f32_16x16x32_bf16 v[148:151], a[28:31], v[40:43], v[148:151]
  v_and_b32 v11, 0xffff0000, v51
  v_fma_f32 v10, v10, v238, v239
  v_fma_f32 v11, v11, v238, v239
  v_mfma_f32_16x16x32_bf16 v[156:159], a[28:31], v[44:47], v[156:159]
  buffer_load_dwordx4 v3, s[36:39], s72 offen offset:3072 lds
  s_waitcnt lgkmcnt(8)
  v_mfma_f32_16x16x32_bf16 v[160:163], a[32:35], v[40:43], v[160:163]
  s_waitcnt vmcnt(13)
  s_waitcnt lgkmcnt(0)
  s_barrier
  ds_read_b64_tr_b16 a[0:1], v26 offset:0
  v_mfma_f32_16x16x32_bf16 v[168:171], a[32:35], v[44:47], v[168:171]
  ds_read_b64_tr_b16 a[2:3], v26 offset:256
  v_cvt_pk_bf16_f32 v51, v10, v11
  v_lshlrev_b32 v8, 16, v52
  v_mfma_f32_16x16x32_bf16 v[164:167], a[36:39], v[40:43], v[164:167]
  s_add_u32 m0, s69, 16384
  s_mov_b32 s72, 1049088
  ds_read_b64_tr_b16 a[4:5], v27 offset:0
  ds_read_b64_tr_b16 a[6:7], v27 offset:256
  v_mfma_f32_16x16x32_bf16 v[172:175], a[36:39], v[44:47], v[172:175]
  buffer_load_dwordx4 v0, s[36:39], s72 offen offset:0 lds
  v_mfma_f32_16x16x32_bf16 v[176:179], a[40:43], v[40:43], v[176:179]
  ds_read_b64_tr_b16 a[8:9], v26 offset:1024
  v_and_b32 v9, 0xffff0000, v52
  v_fma_f32 v8, v8, v246, v247
  v_mfma_f32_16x16x32_bf16 v[184:187], a[40:43], v[44:47], v[184:187]
  ds_read_b64_tr_b16 a[10:11], v26 offset:1280
  v_fma_f32 v9, v9, v246, v247
  v_cvt_pk_bf16_f32 v52, v8, v9
  v_mfma_f32_16x16x32_bf16 v[180:183], a[44:47], v[40:43], v[180:183]
  ds_read_b64_tr_b16 a[12:13], v27 offset:1024
  ds_read_b64_tr_b16 a[14:15], v27 offset:1280
  v_lshlrev_b32 v10, 16, v53
  v_mfma_f32_16x16x32_bf16 v[188:191], a[44:47], v[44:47], v[188:191]
  buffer_load_dwordx4 v1, s[36:39], s72 offen offset:1024 lds
  v_mfma_f32_16x16x32_bf16 v[192:195], a[48:51], v[40:43], v[192:195]
  ds_read_b64_tr_b16 a[16:17], v26 offset:2048
  v_and_b32 v11, 0xffff0000, v53
  v_fma_f32 v10, v10, v246, v247
  v_mfma_f32_16x16x32_bf16 v[200:203], a[48:51], v[44:47], v[200:203]
  ds_read_b64_tr_b16 a[18:19], v26 offset:2304
  v_fma_f32 v11, v11, v246, v247
  v_cvt_pk_bf16_f32 v53, v10, v11
  v_mfma_f32_16x16x32_bf16 v[196:199], a[52:55], v[40:43], v[196:199]
  ds_read_b64_tr_b16 a[20:21], v27 offset:2048
  ds_read_b64_tr_b16 a[22:23], v27 offset:2304
  v_lshlrev_b32 v8, 16, v54
  v_and_b32 v9, 0xffff0000, v54
  v_mfma_f32_16x16x32_bf16 v[204:207], a[52:55], v[44:47], v[204:207]
  buffer_load_dwordx4 v2, s[36:39], s72 offen offset:2048 lds
  v_mfma_f32_16x16x32_bf16 v[208:211], a[56:59], v[40:43], v[208:211]
  ds_read_b64_tr_b16 a[24:25], v26 offset:3072
  v_fma_f32 v8, v8, v246, v247
  v_fma_f32 v9, v9, v246, v247
  v_cvt_pk_bf16_f32 v54, v8, v9
  v_mfma_f32_16x16x32_bf16 v[216:219], a[56:59], v[44:47], v[216:219]
  ds_read_b64_tr_b16 a[26:27], v26 offset:3328
  v_lshlrev_b32 v10, 16, v55
  v_and_b32 v11, 0xffff0000, v55
  v_fma_f32 v10, v10, v246, v247
  v_mfma_f32_16x16x32_bf16 v[212:215], a[60:63], v[40:43], v[212:215]
  ds_read_b64_tr_b16 a[28:29], v27 offset:3072
  ds_read_b64_tr_b16 a[30:31], v27 offset:3328
  v_fma_f32 v11, v11, v246, v247
  v_cvt_pk_bf16_f32 v55, v10, v11
  v_mfma_f32_16x16x32_bf16 v[220:223], a[60:63], v[44:47], v[220:223]
  buffer_load_dwordx4 v3, s[36:39], s72 offen offset:3072 lds
  s_waitcnt lgkmcnt(8)
  v_mfma_f32_16x16x32_bf16 v[96:99], a[0:3], v[48:51], v[96:99]
  ds_read_b64_tr_b16 a[32:33], v26 offset:4096
  ds_read_b64_tr_b16 a[34:35], v26 offset:4352
  ds_read_b64_tr_b16 a[36:37], v27 offset:4096
  ds_read_b64_tr_b16 a[38:39], v27 offset:4352
  v_mfma_f32_16x16x32_bf16 v[104:107], a[0:3], v[52:55], v[104:107]
  s_mov_b32 s0, 3148800
  buffer_load_dword a252, v31, s[36:39], s0 offen
  v_mfma_f32_16x16x32_bf16 v[100:103], a[4:7], v[48:51], v[100:103]
  s_add_u32 m0, s69, 32768
  s_mov_b32 s72, 1310720
  ds_read_b64_tr_b16 a[40:41], v26 offset:5120
  ds_read_b64_tr_b16 a[42:43], v26 offset:5376
  v_mfma_f32_16x16x32_bf16 v[108:111], a[4:7], v[52:55], v[108:111]
  buffer_load_dwordx4 v0, s[36:39], s72 offen offset:0 lds
  v_mfma_f32_16x16x32_bf16 v[112:115], a[8:11], v[48:51], v[112:115]
  ds_read_b64_tr_b16 a[44:45], v27 offset:5120
  ds_read_b64_tr_b16 a[46:47], v27 offset:5376
  v_lshlrev_b32 v8, 16, v56
  v_mfma_f32_16x16x32_bf16 v[120:123], a[8:11], v[52:55], v[120:123]
  ds_read_b64_tr_b16 a[48:49], v26 offset:6144
  ds_read_b64_tr_b16 a[50:51], v26 offset:6400
  v_and_b32 v9, 0xffff0000, v56
  v_mfma_f32_16x16x32_bf16 v[116:119], a[12:15], v[48:51], v[116:119]
  ds_read_b64_tr_b16 a[52:53], v27 offset:6144
  ds_read_b64_tr_b16 a[54:55], v27 offset:6400
  v_fma_f32 v8, v8, v238, v239
  v_mfma_f32_16x16x32_bf16 v[124:127], a[12:15], v[52:55], v[124:127]
  buffer_load_dwordx4 v1, s[36:39], s72 offen offset:1024 lds
  s_waitcnt lgkmcnt(12)
  v_mfma_f32_16x16x32_bf16 v[128:131], a[16:19], v[48:51], v[128:131]
  ds_read_b64_tr_b16 a[56:57], v26 offset:7168
  ds_read_b64_tr_b16 a[58:59], v26 offset:7424
  v_fma_f32 v9, v9, v238, v239
  v_mfma_f32_16x16x32_bf16 v[136:139], a[16:19], v[52:55], v[136:139]
  ds_read_b64_tr_b16 a[60:61], v27 offset:7168
  ds_read_b64_tr_b16 a[62:63], v27 offset:7424
  v_cvt_pk_bf16_f32 v56, v8, v9
  v_mfma_f32_16x16x32_bf16 v[132:135], a[20:23], v[48:51], v[132:135]
  v_lshlrev_b32 v10, 16, v57
  v_and_b32 v11, 0xffff0000, v57
  v_fma_f32 v10, v10, v238, v239
  v_mfma_f32_16x16x32_bf16 v[140:143], a[20:23], v[52:55], v[140:143]
  buffer_load_dwordx4 v2, s[36:39], s72 offen offset:2048 lds
  v_mfma_f32_16x16x32_bf16 v[144:147], a[24:27], v[48:51], v[144:147]
  v_fma_f32 v11, v11, v238, v239
  v_cvt_pk_bf16_f32 v57, v10, v11
  v_lshlrev_b32 v8, 16, v58
  v_mfma_f32_16x16x32_bf16 v[152:155], a[24:27], v[52:55], v[152:155]
  v_and_b32 v9, 0xffff0000, v58
  v_fma_f32 v8, v8, v238, v239
  v_fma_f32 v9, v9, v238, v239
  v_mfma_f32_16x16x32_bf16 v[148:151], a[28:31], v[48:51], v[148:151]
  v_cvt_pk_bf16_f32 v58, v8, v9
  v_lshlrev_b32 v10, 16, v59
  v_and_b32 v11, 0xffff0000, v59
  v_mfma_f32_16x16x32_bf16 v[156:159], a[28:31], v[52:55], v[156:159]
  buffer_load_dwordx4 v3, s[36:39], s72 offen offset:3072 lds
  s_waitcnt lgkmcnt(8)
  v_mfma_f32_16x16x32_bf16 v[160:163], a[32:35], v[48:51], v[160:163]
  s_waitcnt vmcnt(13)
  s_waitcnt lgkmcnt(0)
  s_barrier
  ds_read_b64_tr_b16 a[0:1], v26 offset:32768
  v_mfma_f32_16x16x32_bf16 v[168:171], a[32:35], v[52:55], v[168:171]
  ds_read_b64_tr_b16 a[2:3], v26 offset:33024
  v_fma_f32 v10, v10, v238, v239
  v_fma_f32 v11, v11, v238, v239
  v_mfma_f32_16x16x32_bf16 v[164:167], a[36:39], v[48:51], v[164:167]
  s_add_u32 m0, s69, 49152
  s_mov_b32 s72, 1311232
  ds_read_b64_tr_b16 a[4:5], v27 offset:32768
  ds_read_b64_tr_b16 a[6:7], v27 offset:33024
  v_mfma_f32_16x16x32_bf16 v[172:175], a[36:39], v[52:55], v[172:175]
  buffer_load_dwordx4 v0, s[36:39], s72 offen offset:0 lds
  s_cmp_eq_u32 s84, 0
  s_cbranch_scc1 L_pub2
L_pub2r:
  v_mfma_f32_16x16x32_bf16 v[176:179], a[40:43], v[48:51], v[176:179]
  ds_read_b64_tr_b16 a[8:9], v26 offset:33792
  v_cvt_pk_bf16_f32 v59, v10, v11
  v_lshlrev_b32 v8, 16, v60
  v_mfma_f32_16x16x32_bf16 v[184:187], a[40:43], v[52:55], v[184:187]
  ds_read_b64_tr_b16 a[10:11], v26 offset:34048
  v_and_b32 v9, 0xffff0000, v60
  v_fma_f32 v8, v8, v246, v247
  v_mfma_f32_16x16x32_bf16 v[180:183], a[44:47], v[48:51], v[180:183]
  ds_read_b64_tr_b16 a[12:13], v27 offset:33792
  ds_read_b64_tr_b16 a[14:15], v27 offset:34048
  v_fma_f32 v9, v9, v246, v247
  v_mfma_f32_16x16x32_bf16 v[188:191], a[44:47], v[52:55], v[188:191]
  buffer_load_dwordx4 v1, s[36:39], s72 offen offset:1024 lds
  v_mfma_f32_16x16x32_bf16 v[192:195], a[48:51], v[48:51], v[192:195]
  ds_read_b64_tr_b16 a[16:17], v26 offset:34816
  v_cvt_pk_bf16_f32 v60, v8, v9
  v_lshlrev_b32 v10, 16, v61
  v_and_b32 v11, 0xffff0000, v61
  v_mfma_f32_16x16x32_bf16 v[200:203], a[48:51], v[52:55], v[200:203]
  ds_read_b64_tr_b16 a[18:19], v26 offset:35072
  v_fma_f32 v10, v10, v246, v247
  v_fma_f32 v11, v11, v246, v247
  v_cvt_pk_bf16_f32 v61, v10, v11
  v_mfma_f32_16x16x32_bf16 v[196:199], a[52:55], v[48:51], v[196:199]
  ds_read_b64_tr_b16 a[20:21], v27 offset:34816
  ds_read_b64_tr_b16 a[22:23], v27 offset:35072
  v_lshlrev_b32 v8, 16, v62
  v_and_b32 v9, 0xffff0000, v62
  v_mfma_f32_16x16x32_bf16 v[204:207], a[52:55], v[52:55], v[204:207]
  buffer_load_dwordx4 v2, s[36:39], s72 offen offset:2048 lds
  v_mfma_f32_16x16x32_bf16 v[208:211], a[56:59], v[48:51], v[208:211]
  ds_read_b64_tr_b16 a[24:25], v26 offset:35840
  v_fma_f32 v8, v8, v246, v247
  v_fma_f32 v9, v9, v246, v247
  v_cvt_pk_bf16_f32 v62, v8, v9
  v_mfma_f32_16x16x32_bf16 v[216:219], a[56:59], v[52:55], v[216:219]
  ds_read_b64_tr_b16 a[26:27], v26 offset:36096
  v_lshlrev_b32 v10, 16, v63
  v_and_b32 v11, 0xffff0000, v63
  v_fma_f32 v10, v10, v246, v247
  v_mfma_f32_16x16x32_bf16 v[212:215], a[60:63], v[48:51], v[212:215]
  ds_read_b64_tr_b16 a[28:29], v27 offset:35840
  ds_read_b64_tr_b16 a[30:31], v27 offset:36096
  v_fma_f32 v11, v11, v246, v247
  v_cvt_pk_bf16_f32 v63, v10, v11
  v_mfma_f32_16x16x32_bf16 v[220:223], a[60:63], v[52:55], v[220:223]
  buffer_load_dwordx4 v3, s[36:39], s72 offen offset:3072 lds
  s_waitcnt lgkmcnt(8)
  v_mfma_f32_16x16x32_bf16 v[96:99], a[0:3], v[56:59], v[96:99]
  ds_read_b64_tr_b16 a[32:33], v26 offset:36864
  ds_read_b64_tr_b16 a[34:35], v26 offset:37120
  v_lshlrev_b32 v8, 16, v64
  v_mfma_f32_16x16x32_bf16 v[104:107], a[0:3], v[60:63], v[104:107]
  ds_read_b64_tr_b16 a[36:37], v27 offset:36864
  ds_read_b64_tr_b16 a[38:39], v27 offset:37120
  v_and_b32 v9, 0xffff0000, v64
  v_mfma_f32_16x16x32_bf16 v[100:103], a[4:7], v[56:59], v[100:103]
  s_add_u32 m0, s69, 65536
  s_mov_b32 s72, 1572864
  ds_read_b64_tr_b16 a[40:41], v26 offset:37888
  ds_read_b64_tr_b16 a[42:43], v26 offset:38144
  v_mfma_f32_16x16x32_bf16 v[108:111], a[4:7], v[60:63], v[108:111]
  buffer_load_dwordx4 v0, s[36:39], s72 offen offset:0 lds
  v_mfma_f32_16x16x32_bf16 v[112:115], a[8:11], v[56:59], v[112:115]
  ds_read_b64_tr_b16 a[44:45], v27 offset:37888
  ds_read_b64_tr_b16 a[46:47], v27 offset:38144
  v_fma_f32 v8, v8, v238, v239
  v_mfma_f32_16x16x32_bf16 v[120:123], a[8:11], v[60:63], v[120:123]
  ds_read_b64_tr_b16 a[48:49], v26 offset:38912
  ds_read_b64_tr_b16 a[50:51], v26 offset:39168
  v_fma_f32 v9, v9, v238, v239
  v_mfma_f32_16x16x32_bf16 v[116:119], a[12:15], v[56:59], v[116:119]
  ds_read_b64_tr_b16 a[52:53], v27 offset:38912
  ds_read_b64_tr_b16 a[54:55], v27 offset:39168
  v_cvt_pk_bf16_f32 v64, v8, v9
  v_mfma_f32_16x16x32_bf16 v[124:127], a[12:15], v[60:63], v[124:127]
  buffer_load_dwordx4 v1, s[36:39], s72 offen offset:1024 lds
  s_waitcnt lgkmcnt(12)
  v_mfma_f32_16x16x32_bf16 v[128:131], a[16:19], v[56:59], v[128:131]
  ds_read_b64_tr_b16 a[56:57], v26 offset:39936
  ds_read_b64_tr_b16 a[58:59], v26 offset:40192
  v_lshlrev_b32 v10, 16, v65
  v_mfma_f32_16x16x32_bf16 v[136:139], a[16:19], v[60:63], v[136:139]
  ds_read_b64_tr_b16 a[60:61], v27 offset:39936
  ds_read_b64_tr_b16 a[62:63], v27 offset:40192
  v_and_b32 v11, 0xffff0000, v65
  v_mfma_f32_16x16x32_bf16 v[132:135], a[20:23], v[56:59], v[132:135]
  v_fma_f32 v10, v10, v238, v239
  v_fma_f32 v11, v11, v238, v239
  v_cvt_pk_bf16_f32 v65, v10, v11
  v_mfma_f32_16x16x32_bf16 v[140:143], a[20:23], v[60:63], v[140:143]
  buffer_load_dwordx4 v2, s[36:39], s72 offen offset:2048 lds
  v_mfma_f32_16x16x32_bf16 v[144:147], a[24:27], v[56:59], v[144:147]
  v_lshlrev_b32 v8, 16, v66
  v_and_b32 v9, 0xffff0000, v66
  v_fma_f32 v8, v8, v238, v239
  v_mfma_f32_16x16x32_bf16 v[152:155], a[24:27], v[60:63], v[152:155]
  v_fma_f32 v9, v9, v238, v239
  v_cvt_pk_bf16_f32 v66, v8, v9
  v_lshlrev_b32 v10, 16, v67
  v_mfma_f32_16x16x32_bf16 v[148:151], a[28:31], v[56:59], v[148:151]
  v_and_b32 v11, 0xffff0000, v67
  v_fma_f32 v10, v10, v238, v239
  v_fma_f32 v11, v11, v238, v239
  v_mfma_f32_16x16x32_bf16 v[156:159], a[28:31], v[60:63], v[156:159]
  buffer_load_dwordx4 v3, s[36:39], s72 offen offset:3072 lds
  s_waitcnt lgkmcnt(8)
  v_mfma_f32_16x16x32_bf16 v[160:163], a[32:35], v[56:59], v[160:163]
  s_waitcnt vmcnt(13)
  s_waitcnt lgkmcnt(0)
  s_barrier
  ds_read_b64_tr_b16 a[0:1], v24 offset:0
  v_mfma_f32_16x16x32_bf16 v[168:171], a[32:35], v[60:63], v[168:171]
  ds_read_b64_tr_b16 a[2:3], v24 offset:256
  v_cvt_pk_bf16_f32 v67, v10, v11
  v_lshlrev_b32 v8, 16, v68
  v_mfma_f32_16x16x32_bf16 v[164:167], a[36:39], v[56:59], v[164:167]
  s_add_u32 m0, s69, 81920
  s_mov_b32 s72, 1573376
  ds_read_b64_tr_b16 a[4:5], v25 offset:0
  ds_read_b64_tr_b16 a[6:7], v25 offset:256
  v_mfma_f32_16x16x32_bf16 v[172:175], a[36:39], v[60:63], v[172:175]
  buffer_load_dwordx4 v0, s[36:39], s72 offen offset:0 lds
  v_mfma_f32_16x16x32_bf16 v[176:179], a[40:43], v[56:59], v[176:179]
  ds_read_b64_tr_b16 a[8:9], v24 offset:1024
  v_and_b32 v9, 0xffff0000, v68
  v_fma_f32 v8, v8, v246, v247
  v_mfma_f32_16x16x32_bf16 v[184:187], a[40:43], v[60:63], v[184:187]
  ds_read_b64_tr_b16 a[10:11], v24 offset:1280
  v_fma_f32 v9, v9, v246, v247
  v_cvt_pk_bf16_f32 v68, v8, v9
  v_mfma_f32_16x16x32_bf16 v[180:183], a[44:47], v[56:59], v[180:183]
  ds_read_b64_tr_b16 a[12:13], v25 offset:1024
  ds_read_b64_tr_b16 a[14:15], v25 offset:1280
  v_lshlrev_b32 v10, 16, v69
  v_mfma_f32_16x16x32_bf16 v[188:191], a[44:47], v[60:63], v[188:191]
  buffer_load_dwordx4 v1, s[36:39], s72 offen offset:1024 lds
  v_mfma_f32_16x16x32_bf16 v[192:195], a[48:51], v[56:59], v[192:195]
  ds_read_b64_tr_b16 a[16:17], v24 offset:2048
  v_and_b32 v11, 0xffff0000, v69
  v_fma_f32 v10, v10, v246, v247
  v_mfma_f32_16x16x32_bf16 v[200:203], a[48:51], v[60:63], v[200:203]
  ds_read_b64_tr_b16 a[18:19], v24 offset:2304
  v_fma_f32 v11, v11, v246, v247
  v_cvt_pk_bf16_f32 v69, v10, v11
  v_mfma_f32_16x16x32_bf16 v[196:199], a[52:55], v[56:59], v[196:199]
  ds_read_b64_tr_b16 a[20:21], v25 offset:2048
  ds_read_b64_tr_b16 a[22:23], v25 offset:2304
  v_lshlrev_b32 v8, 16, v70
  v_and_b32 v9, 0xffff0000, v70
  v_mfma_f32_16x16x32_bf16 v[204:207], a[52:55], v[60:63], v[204:207]
  buffer_load_dwordx4 v2, s[36:39], s72 offen offset:2048 lds
  v_mfma_f32_16x16x32_bf16 v[208:211], a[56:59], v[56:59], v[208:211]
  ds_read_b64_tr_b16 a[24:25], v24 offset:3072
  v_fma_f32 v8, v8, v246, v247
  v_fma_f32 v9, v9, v246, v247
  v_cvt_pk_bf16_f32 v70, v8, v9
  v_mfma_f32_16x16x32_bf16 v[216:219], a[56:59], v[60:63], v[216:219]
  ds_read_b64_tr_b16 a[26:27], v24 offset:3328
  v_lshlrev_b32 v10, 16, v71
  v_and_b32 v11, 0xffff0000, v71
  v_fma_f32 v10, v10, v246, v247
  v_mfma_f32_16x16x32_bf16 v[212:215], a[60:63], v[56:59], v[212:215]
  ds_read_b64_tr_b16 a[28:29], v25 offset:3072
  ds_read_b64_tr_b16 a[30:31], v25 offset:3328
  v_fma_f32 v11, v11, v246, v247
  v_cvt_pk_bf16_f32 v71, v10, v11
  v_mfma_f32_16x16x32_bf16 v[220:223], a[60:63], v[60:63], v[220:223]
  buffer_load_dwordx4 v3, s[36:39], s72 offen offset:3072 lds
  s_waitcnt lgkmcnt(8)
  v_mfma_f32_16x16x32_bf16 v[96:99], a[0:3], v[64:67], v[96:99]
  ds_read_b64_tr_b16 a[32:33], v24 offset:4096
  ds_read_b64_tr_b16 a[34:35], v24 offset:4352
  ds_read_b64_tr_b16 a[36:37], v25 offset:4096
  ds_read_b64_tr_b16 a[38:39], v25 offset:4352
  v_mfma_f32_16x16x32_bf16 v[104:107], a[0:3], v[68:71], v[104:107]
  s_mov_b32 s0, 3072
  buffer_load_dword a252, v249, s[40:43], s0 offen
  v_mfma_f32_16x16x32_bf16 v[100:103], a[4:7], v[64:67], v[100:103]
  s_add_u32 m0, s69, 98304
  s_mov_b32 s72, 1835008
  ds_read_b64_tr_b16 a[40:41], v24 offset:5120
  ds_read_b64_tr_b16 a[42:43], v24 offset:5376
  v_mfma_f32_16x16x32_bf16 v[108:111], a[4:7], v[68:71], v[108:111]
  buffer_load_dwordx4 v0, s[36:39], s72 offen offset:0 lds
  v_mfma_f32_16x16x32_bf16 v[112:115], a[8:11], v[64:67], v[112:115]
  ds_read_b64_tr_b16 a[44:45], v25 offset:5120
  ds_read_b64_tr_b16 a[46:47], v25 offset:5376
  v_lshlrev_b32 v8, 16, v72
  v_mfma_f32_16x16x32_bf16 v[120:123], a[8:11], v[68:71], v[120:123]
  ds_read_b64_tr_b16 a[48:49], v24 offset:6144
  ds_read_b64_tr_b16 a[50:51], v24 offset:6400
  v_and_b32 v9, 0xffff0000, v72
  v_mfma_f32_16x16x32_bf16 v[116:119], a[12:15], v[64:67], v[116:119]
  ds_read_b64_tr_b16 a[52:53], v25 offset:6144
  ds_read_b64_tr_b16 a[54:55], v25 offset:6400
  v_fma_f32 v8, v8, v238, v239
  v_mfma_f32_16x16x32_bf16 v[124:127], a[12:15], v[68:71], v[124:127]
  buffer_load_dwordx4 v1, s[36:39], s72 offen offset:1024 lds
  s_waitcnt lgkmcnt(12)
  v_mfma_f32_16x16x32_bf16 v[128:131], a[16:19], v[64:67], v[128:131]
  ds_read_b64_tr_b16 a[56:57], v24 offset:7168
  ds_read_b64_tr_b16 a[58:59], v24 offset:7424
  v_fma_f32 v9, v9, v238, v239
  v_mfma_f32_16x16x32_bf16 v[136:139], a[16:19], v[68:71], v[136:139]
  ds_read_b64_tr_b16 a[60:61], v25 offset:7168
  ds_read_b64_tr_b16 a[62:63], v25 offset:7424
  v_cvt_pk_bf16_f32 v72, v8, v9
  v_mfma_f32_16x16x32_bf16 v[132:135], a[20:23], v[64:67], v[132:135]
  v_lshlrev_b32 v10, 16, v73
  v_and_b32 v11, 0xffff0000, v73
  v_fma_f32 v10, v10, v238, v239
  v_mfma_f32_16x16x32_bf16 v[140:143], a[20:23], v[68:71], v[140:143]
  buffer_load_dwordx4 v2, s[36:39], s72 offen offset:2048 lds
  v_mfma_f32_16x16x32_bf16 v[144:147], a[24:27], v[64:67], v[144:147]
  v_fma_f32 v11, v11, v238, v239
  v_cvt_pk_bf16_f32 v73, v10, v11
  v_lshlrev_b32 v8, 16, v74
  v_mfma_f32_16x16x32_bf16 v[152:155], a[24:27], v[68:71], v[152:155]
  v_and_b32 v9, 0xffff0000, v74
  v_fma_f32 v8, v8, v238, v239
  v_fma_f32 v9, v9, v238, v239
  v_mfma_f32_16x16x32_bf16 v[148:151], a[28:31], v[64:67], v[148:151]
  v_cvt_pk_bf16_f32 v74, v8, v9
  v_lshlrev_b32 v10, 16, v75
  v_and_b32 v11, 0xffff0000, v75
  v_mfma_f32_16x16x32_bf16 v[156:159], a[28:31], v[68:71], v[156:159]
  buffer_load_dwordx4 v3, s[36:39], s72 offen offset:3072 lds
  s_waitcnt lgkmcnt(8)
  v_mfma_f32_16x16x32_bf16 v[160:163], a[32:35], v[64:67], v[160:163]
  s_waitcnt vmcnt(13)
  s_waitcnt lgkmcnt(0)
  s_barrier
  ds_read_b64_tr_b16 a[0:1], v24 offset:32768
  v_mfma_f32_16x16x32_bf16 v[168:171], a[32:35], v[68:71], v[168:171]
  ds_read_b64_tr_b16 a[2:3], v24 offset:33024
  v_fma_f32 v10, v10, v238, v239
  v_fma_f32 v11, v11, v238, v239
  v_mfma_f32_16x16x32_bf16 v[164:167], a[36:39], v[64:67], v[164:167]
  s_add_u32 m0, s69, 114688
  s_mov_b32 s72, 1835520
  ds_read_b64_tr_b16 a[4:5], v25 offset:32768
  ds_read_b64_tr_b16 a[6:7], v25 offset:33024
  v_mfma_f32_16x16x32_bf16 v[172:175], a[36:39], v[68:71], v[172:175]
  buffer_load_dwordx4 v0, s[36:39], s72 offen offset:0 lds
  v_mfma_f32_16x16x32_bf16 v[176:179], a[40:43], v[64:67], v[176:179]
  ds_read_b64_tr_b16 a[8:9], v24 offset:33792
  v_cvt_pk_bf16_f32 v75, v10, v11
  v_lshlrev_b32 v8, 16, v76
  v_mfma_f32_16x16x32_bf16 v[184:187], a[40:43], v[68:71], v[184:187]
  ds_read_b64_tr_b16 a[10:11], v24 offset:34048
  v_and_b32 v9, 0xffff0000, v76
  v_fma_f32 v8, v8, v246, v247
  v_mfma_f32_16x16x32_bf16 v[180:183], a[44:47], v[64:67], v[180:183]
  ds_read_b64_tr_b16 a[12:13], v25 offset:33792
  ds_read_b64_tr_b16 a[14:15], v25 offset:34048
  v_fma_f32 v9, v9, v246, v247
  v_mfma_f32_16x16x32_bf16 v[188:191], a[44:47], v[68:71], v[188:191]
  buffer_load_dwordx4 v1, s[36:39], s72 offen offset:1024 lds
  v_mfma_f32_16x16x32_bf16 v[192:195], a[48:51], v[64:67], v[192:195]
  ds_read_b64_tr_b16 a[16:17], v24 offset:34816
  v_cvt_pk_bf16_f32 v76, v8, v9
  v_lshlrev_b32 v10, 16, v77
  v_and_b32 v11, 0xffff0000, v77
  v_mfma_f32_16x16x32_bf16 v[200:203], a[48:51], v[68:71], v[200:203]
  ds_read_b64_tr_b16 a[18:19], v24 offset:35072
  v_fma_f32 v10, v10, v246, v247
  v_fma_f32 v11, v11, v246, v247
  v_cvt_pk_bf16_f32 v77, v10, v11
  v_mfma_f32_16x16x32_bf16 v[196:199], a[52:55], v[64:67], v[196:199]
  ds_read_b64_tr_b16 a[20:21], v25 offset:34816
  ds_read_b64_tr_b16 a[22:23], v25 offset:35072
  v_lshlrev_b32 v8, 16, v78
  v_and_b32 v9, 0xffff0000, v78
  v_mfma_f32_16x16x32_bf16 v[204:207], a[52:55], v[68:71], v[204:207]
  buffer_load_dwordx4 v2, s[36:39], s72 offen offset:2048 lds
  v_mfma_f32_16x16x32_bf16 v[208:211], a[56:59], v[64:67], v[208:211]
  ds_read_b64_tr_b16 a[24:25], v24 offset:35840
  v_fma_f32 v8, v8, v246, v247
  v_fma_f32 v9, v9, v246, v247
  v_cvt_pk_bf16_f32 v78, v8, v9
  v_mfma_f32_16x16x32_bf16 v[216:219], a[56:59], v[68:71], v[216:219]
  ds_read_b64_tr_b16 a[26:27], v24 offset:36096
  v_lshlrev_b32 v10, 16, v79
  v_and_b32 v11, 0xffff0000, v79
  v_fma_f32 v10, v10, v246, v247
  v_mfma_f32_16x16x32_bf16 v[212:215], a[60:63], v[64:67], v[212:215]
  ds_read_b64_tr_b16 a[28:29], v25 offset:35840
  ds_read_b64_tr_b16 a[30:31], v25 offset:36096
  v_fma_f32 v11, v11, v246, v247
  v_cvt_pk_bf16_f32 v79, v10, v11
  v_mfma_f32_16x16x32_bf16 v[220:223], a[60:63], v[68:71], v[220:223]
  buffer_load_dwordx4 v3, s[36:39], s72 offen offset:3072 lds
  s_waitcnt lgkmcnt(8)
  v_mfma_f32_16x16x32_bf16 v[96:99], a[0:3], v[72:75], v[96:99]
  ds_read_b64_tr_b16 a[32:33], v24 offset:36864
  ds_read_b64_tr_b16 a[34:35], v24 offset:37120
  v_lshlrev_b32 v8, 16, v80
  v_mfma_f32_16x16x32_bf16 v[104:107], a[0:3], v[76:79], v[104:107]
  ds_read_b64_tr_b16 a[36:37], v25 offset:36864
  ds_read_b64_tr_b16 a[38:39], v25 offset:37120
  v_and_b32 v9, 0xffff0000, v80
  v_mfma_f32_16x16x32_bf16 v[100:103], a[4:7], v[72:75], v[100:103]
  s_add_u32 m0, s69, 0
  s_mov_b32 s72, 2097152
  ds_read_b64_tr_b16 a[40:41], v24 offset:37888
  ds_read_b64_tr_b16 a[42:43], v24 offset:38144
  v_mfma_f32_16x16x32_bf16 v[108:111], a[4:7], v[76:79], v[108:111]
  buffer_load_dwordx4 v0, s[36:39], s72 offen offset:0 lds
  v_mfma_f32_16x16x32_bf16 v[112:115], a[8:11], v[72:75], v[112:115]
  ds_read_b64_tr_b16 a[44:45], v25 offset:37888
  ds_read_b64_tr_b16 a[46:47], v25 offset:38144
  v_fma_f32 v8, v8, v238, v239
  v_mfma_f32_16x16x32_bf16 v[120:123], a[8:11], v[76:79], v[120:123]
  ds_read_b64_tr_b16 a[48:49], v24 offset:38912
  ds_read_b64_tr_b16 a[50:51], v24 offset:39168
  v_fma_f32 v9, v9, v238, v239
  v_mfma_f32_16x16x32_bf16 v[116:119], a[12:15], v[72:75], v[116:119]
  ds_read_b64_tr_b16 a[52:53], v25 offset:38912
  ds_read_b64_tr_b16 a[54:55], v25 offset:39168
  v_cvt_pk_bf16_f32 v80, v8, v9
  v_mfma_f32_16x16x32_bf16 v[124:127], a[12:15], v[76:79], v[124:127]
  buffer_load_dwordx4 v1, s[36:39], s72 offen offset:1024 lds
  s_waitcnt lgkmcnt(12)
  v_mfma_f32_16x16x32_bf16 v[128:131], a[16:19], v[72:75], v[128:131]
  ds_read_b64_tr_b16 a[56:57], v24 offset:39936
  ds_read_b64_tr_b16 a[58:59], v24 offset:40192
  v_lshlrev_b32 v10, 16, v81
  v_mfma_f32_16x16x32_bf16 v[136:139], a[16:19], v[76:79], v[136:139]
  ds_read_b64_tr_b16 a[60:61], v25 offset:39936
  ds_read_b64_tr_b16 a[62:63], v25 offset:40192
  v_and_b32 v11, 0xffff0000, v81
  v_mfma_f32_16x16x32_bf16 v[132:135], a[20:23], v[72:75], v[132:135]
  v_fma_f32 v10, v10, v238, v239
  v_fma_f32 v11, v11, v238, v239
  v_cvt_pk_bf16_f32 v81, v10, v11
  v_mfma_f32_16x16x32_bf16 v[140:143], a[20:23], v[76:79], v[140:143]
  buffer_load_dwordx4 v2, s[36:39], s72 offen offset:2048 lds
  v_mfma_f32_16x16x32_bf16 v[144:147], a[24:27], v[72:75], v[144:147]
  v_lshlrev_b32 v8, 16, v82
  v_and_b32 v9, 0xffff0000, v82
  v_fma_f32 v8, v8, v238, v239
  v_mfma_f32_16x16x32_bf16 v[152:155], a[24:27], v[76:79], v[152:155]
  v_fma_f32 v9, v9, v238, v239
  v_cvt_pk_bf16_f32 v82, v8, v9
  v_lshlrev_b32 v10, 16, v83
  v_mfma_f32_16x16x32_bf16 v[148:151], a[28:31], v[72:75], v[148:151]
  v_and_b32 v11, 0xffff0000, v83
  v_fma_f32 v10, v10, v238, v239
  v_fma_f32 v11, v11, v238, v239
  v_mfma_f32_16x16x32_bf16 v[156:159], a[28:31], v[76:79], v[156:159]
  buffer_load_dwordx4 v3, s[36:39], s72 offen offset:3072 lds
  s_waitcnt lgkmcnt(8)
  v_mfma_f32_16x16x32_bf16 v[160:163], a[32:35], v[72:75], v[160:163]
  s_waitcnt vmcnt(13)
  s_waitcnt lgkmcnt(0)
  s_barrier
  ds_read_b64_tr_b16 a[0:1], v26 offset:0
  v_mfma_f32_16x16x32_bf16 v[168:171], a[32:35], v[76:79], v[168:171]
  ds_read_b64_tr_b16 a[2:3], v26 offset:256
  v_cvt_pk_bf16_f32 v83, v10, v11
  v_lshlrev_b32 v8, 16, v84
  v_mfma_f32_16x16x32_bf16 v[164:167], a[36:39], v[72:75], v[164:167]
  s_add_u32 m0, s69, 16384
  s_mov_b32 s72, 2097664
  ds_read_b64_tr_b16 a[4:5], v27 offset:0
  ds_read_b64_tr_b16 a[6:7], v27 offset:256
  v_mfma_f32_16x16x32_bf16 v[172:175], a[36:39], v[76:79], v[172:175]
  buffer_load_dwordx4 v0, s[36:39], s72 offen offset:0 lds
  v_mfma_f32_16x16x32_bf16 v[176:179], a[40:43], v[72:75], v[176:179]
  ds_read_b64_tr_b16 a[8:9], v26 offset:1024
  v_and_b32 v9, 0xffff0000, v84
  v_fma_f32 v8, v8, v246, v247
  v_mfma_f32_16x16x32_bf16 v[184:187], a[40:43], v[76:79], v[184:187]
  ds_read_b64_tr_b16 a[10:11], v26 offset:1280
  v_fma_f32 v9, v9, v246, v247
  v_cvt_pk_bf16_f32 v84, v8, v9
  v_mfma_f32_16x16x32_bf16 v[180:183], a[44:47], v[72:75], v[180:183]
  ds_read_b64_tr_b16 a[12:13], v27 offset:1024
  ds_read_b64_tr_b16 a[14:15], v27 offset:1280
  v_lshlrev_b32 v10, 16, v85
  v_mfma_f32_16x16x32_bf16 v[188:191], a[44:47], v[76:79], v[188:191]
  buffer_load_dwordx4 v1, s[36:39], s72 offen offset:1024 lds
  v_mfma_f32_16x16x32_bf16 v[192:195], a[48:51], v[72:75], v[192:195]
  ds_read_b64_tr_b16 a[16:17], v26 offset:2048
  v_and_b32 v11, 0xffff0000, v85
  v_fma_f32 v10, v10, v246, v247
  v_mfma_f32_16x16x32_bf16 v[200:203], a[48:51], v[76:79], v[200:203]
  ds_read_b64_tr_b16 a[18:19], v26 offset:2304
  v_fma_f32 v11, v11, v246, v247
  v_cvt_pk_bf16_f32 v85, v10, v11
  v_mfma_f32_16x16x32_bf16 v[196:199], a[52:55], v[72:75], v[196:199]
  ds_read_b64_tr_b16 a[20:21], v27 offset:2048
  ds_read_b64_tr_b16 a[22:23], v27 offset:2304
  v_lshlrev_b32 v8, 16, v86
  v_and_b32 v9, 0xffff0000, v86
  v_mfma_f32_16x16x32_bf16 v[204:207], a[52:55], v[76:79], v[204:207]
  buffer_load_dwordx4 v2, s[36:39], s72 offen offset:2048 lds
  v_mfma_f32_16x16x32_bf16 v[208:211], a[56:59], v[72:75], v[208:211]
  ds_read_b64_tr_b16 a[24:25], v26 offset:3072
  v_fma_f32 v8, v8, v246, v247
  v_fma_f32 v9, v9, v246, v247
  v_cvt_pk_bf16_f32 v86, v8, v9
  v_mfma_f32_16x16x32_bf16 v[216:219], a[56:59], v[76:79], v[216:219]
  ds_read_b64_tr_b16 a[26:27], v26 offset:3328
  v_lshlrev_b32 v10, 16, v87
  v_and_b32 v11, 0xffff0000, v87
  v_fma_f32 v10, v10, v246, v247
  v_mfma_f32_16x16x32_bf16 v[212:215], a[60:63], v[72:75], v[212:215]
  ds_read_b64_tr_b16 a[28:29], v27 offset:3072
  ds_read_b64_tr_b16 a[30:31], v27 offset:3328
  v_fma_f32 v11, v11, v246, v247
  v_cvt_pk_bf16_f32 v87, v10, v11
  v_mfma_f32_16x16x32_bf16 v[220:223], a[60:63], v[76:79], v[220:223]
  buffer_load_dwordx4 v3, s[36:39], s72 offen offset:3072 lds
  s_waitcnt lgkmcnt(8)
  v_mfma_f32_16x16x32_bf16 v[96:99], a[0:3], v[80:83], v[96:99]
  ds_read_b64_tr_b16 a[32:33], v26 offset:4096
  ds_read_b64_tr_b16 a[34:35], v26 offset:4352
  ds_read_b64_tr_b16 a[36:37], v27 offset:4096
  ds_read_b64_tr_b16 a[38:39], v27 offset:4352
  v_mfma_f32_16x16x32_bf16 v[104:107], a[0:3], v[84:87], v[104:107]
  s_mov_b32 s0, 3072
  buffer_load_dword a252, v249, s[44:47], s0 offen
  v_mfma_f32_16x16x32_bf16 v[100:103], a[4:7], v[80:83], v[100:103]
  s_add_u32 m0, s69, 32768
  s_mov_b32 s72, 2359296
  ds_read_b64_tr_b16 a[40:41], v26 offset:5120
  ds_read_b64_tr_b16 a[42:43], v26 offset:5376
  v_mfma_f32_16x16x32_bf16 v[108:111], a[4:7], v[84:87], v[108:111]
  buffer_load_dwordx4 v0, s[36:39], s72 offen offset:0 lds
  v_mfma_f32_16x16x32_bf16 v[112:115], a[8:11], v[80:83], v[112:115]
  ds_read_b64_tr_b16 a[44:45], v27 offset:5120
  ds_read_b64_tr_b16 a[46:47], v27 offset:5376
  v_lshlrev_b32 v8, 16, v88
  v_mfma_f32_16x16x32_bf16 v[120:123], a[8:11], v[84:87], v[120:123]
  ds_read_b64_tr_b16 a[48:49], v26 offset:6144
  ds_read_b64_tr_b16 a[50:51], v26 offset:6400
  v_and_b32 v9, 0xffff0000, v88
  v_mfma_f32_16x16x32_bf16 v[116:119], a[12:15], v[80:83], v[116:119]
  ds_read_b64_tr_b16 a[52:53], v27 offset:6144
  ds_read_b64_tr_b16 a[54:55], v27 offset:6400
  v_fma_f32 v8, v8, v238, v239
  v_mfma_f32_16x16x32_bf16 v[124:127], a[12:15], v[84:87], v[124:127]
  buffer_load_dwordx4 v1, s[36:39], s72 offen offset:1024 lds
  s_waitcnt lgkmcnt(12)
  v_mfma_f32_16x16x32_bf16 v[128:131], a[16:19], v[80:83], v[128:131]
  ds_read_b64_tr_b16 a[56:57], v26 offset:7168
  ds_read_b64_tr_b16 a[58:59], v26 offset:7424
  v_fma_f32 v9, v9, v238, v239
  v_mfma_f32_16x16x32_bf16 v[136:139], a[16:19], v[84:87], v[136:139]
  ds_read_b64_tr_b16 a[60:61], v27 offset:7168
  ds_read_b64_tr_b16 a[62:63], v27 offset:7424
  v_cvt_pk_bf16_f32 v88, v8, v9
  v_mfma_f32_16x16x32_bf16 v[132:135], a[20:23], v[80:83], v[132:135]
  v_lshlrev_b32 v10, 16, v89
  v_and_b32 v11, 0xffff0000, v89
  v_fma_f32 v10, v10, v238, v239
  v_mfma_f32_16x16x32_bf16 v[140:143], a[20:23], v[84:87], v[140:143]
  buffer_load_dwordx4 v2, s[36:39], s72 offen offset:2048 lds
  v_mfma_f32_16x16x32_bf16 v[144:147], a[24:27], v[80:83], v[144:147]
  ds_read_b128 v[32:35], v248 offset:32768
  v_fma_f32 v11, v11, v238, v239
  v_cvt_pk_bf16_f32 v89, v10, v11
  v_mfma_f32_16x16x32_bf16 v[152:155], a[24:27], v[84:87], v[152:155]
  v_lshlrev_b32 v8, 16, v90
  v_and_b32 v9, 0xffff0000, v90
  v_fma_f32 v8, v8, v238, v239
  v_mfma_f32_16x16x32_bf16 v[148:151], a[28:31], v[80:83], v[148:151]
  ds_read_b128 v[36:39], v248 offset:40960
  v_fma_f32 v9, v9, v238, v239
  v_cvt_pk_bf16_f32 v90, v8, v9
  v_mfma_f32_16x16x32_bf16 v[156:159], a[28:31], v[84:87], v[156:159]
  buffer_load_dwordx4 v3, s[36:39], s72 offen offset:3072 lds
  s_waitcnt lgkmcnt(10)
  v_mfma_f32_16x16x32_bf16 v[160:163], a[32:35], v[80:83], v[160:163]
  s_waitcnt vmcnt(13)
  s_waitcnt lgkmcnt(0)
  s_barrier
  ds_read_b64_tr_b16 a[0:1], v26 offset:32768
  v_mfma_f32_16x16x32_bf16 v[168:171], a[32:35], v[84:87], v[168:171]
  ds_read_b64_tr_b16 a[2:3], v26 offset:33024
  v_lshlrev_b32 v10, 16, v91
  v_and_b32 v11, 0xffff0000, v91
  v_mfma_f32_16x16x32_bf16 v[164:167], a[36:39], v[80:83], v[164:167]
  s_add_u32 m0, s69, 49152
  s_mov_b32 s72, 2359808
  ds_read_b64_tr_b16 a[4:5], v27 offset:32768
  ds_read_b64_tr_b16 a[6:7], v27 offset:33024
  v_mfma_f32_16x16x32_bf16 v[172:175], a[36:39], v[84:87], v[172:175]
  buffer_load_dwordx4 v0, s[36:39], s72 offen offset:0 lds
  v_mfma_f32_16x16x32_bf16 v[176:179], a[40:43], v[80:83], v[176:179]
  ds_read_b64_tr_b16 a[8:9], v26 offset:33792
  v_fma_f32 v10, v10, v238, v239
  v_fma_f32 v11, v11, v238, v239
  v_mfma_f32_16x16x32_bf16 v[184:187], a[40:43], v[84:87], v[184:187]
  ds_read_b64_tr_b16 a[10:11], v26 offset:34048
  v_cvt_pk_bf16_f32 v91, v10, v11
  v_lshlrev_b32 v8, 16, v92
  v_and_b32 v9, 0xffff0000, v92
  v_mfma_f32_16x16x32_bf16 v[180:183], a[44:47], v[80:83], v[180:183]
  ds_read_b64_tr_b16 a[12:13], v27 offset:33792
  ds_read_b64_tr_b16 a[14:15], v27 offset:34048
  v_fma_f32 v8, v8, v246, v247
  v_fma_f32 v9, v9, v246, v247
  v_mfma_f32_16x16x32_bf16 v[188:191], a[44:47], v[84:87], v[188:191]
  buffer_load_dwordx4 v1, s[36:39], s72 offen offset:1024 lds
  v_mfma_f32_16x16x32_bf16 v[192:195], a[48:51], v[80:83], v[192:195]
  ds_read_b64_tr_b16 a[16:17], v26 offset:34816
  v_cvt_pk_bf16_f32 v92, v8, v9
  v_lshlrev_b32 v10, 16, v93
  v_and_b32 v11, 0xffff0000, v93
  v_mfma_f32_16x16x32_bf16 v[200:203], a[48:51], v[84:87], v[200:203]
  ds_read_b64_tr_b16 a[18:19], v26 offset:35072
  v_fma_f32 v10, v10, v246, v247
  v_fma_f32 v11, v11, v246, v247
  v_cvt_pk_bf16_f32 v93, v10, v11
  v_mfma_f32_16x16x32_bf16 v[196:199], a[52:55], v[80:83], v[196:199]
  ds_read_b64_tr_b16 a[20:21], v27 offset:34816
  ds_read_b64_tr_b16 a[22:23], v27 offset:35072
  v_lshlrev_b32 v8, 16, v94
  v_and_b32 v9, 0xffff0000, v94
  v_mfma_f32_16x16x32_bf16 v[204:207], a[52:55], v[84:87], v[204:207]
  buffer_load_dwordx4 v2, s[36:39], s72 offen offset:2048 lds
  v_mfma_f32_16x16x32_bf16 v[208:211], a[56:59], v[80:83], v[208:211]
  ds_read_b64_tr_b16 a[24:25], v26 offset:35840
  v_fma_f32 v8, v8, v246, v247
  v_fma_f32 v9, v9, v246, v247
  v_cvt_pk_bf16_f32 v94, v8, v9
  v_mfma_f32_16x16x32_bf16 v[216:219], a[56:59], v[84:87], v[216:219]
  ds_read_b64_tr_b16 a[26:27], v26 offset:36096
  v_lshlrev_b32 v10, 16, v95
  v_and_b32 v11, 0xffff0000, v95
  v_fma_f32 v10, v10, v246, v247
  v_mfma_f32_16x16x32_bf16 v[212:215], a[60:63], v[80:83], v[212:215]
  ds_read_b64_tr_b16 a[28:29], v27 offset:35840
  ds_read_b64_tr_b16 a[30:31], v27 offset:36096
  v_fma_f32 v11, v11, v246, v247
  v_cvt_pk_bf16_f32 v95, v10, v11
  v_mfma_f32_16x16x32_bf16 v[220:223], a[60:63], v[84:87], v[220:223]
  buffer_load_dwordx4 v3, s[36:39], s72 offen offset:3072 lds
  s_waitcnt lgkmcnt(8)
  v_mfma_f32_16x16x32_bf16 v[96:99], a[0:3], v[88:91], v[96:99]
  ds_read_b64_tr_b16 a[32:33], v26 offset:36864
  ds_read_b64_tr_b16 a[34:35], v26 offset:37120
  v_lshlrev_b32 v8, 16, v32
  v_mfma_f32_16x16x32_bf16 v[104:107], a[0:3], v[92:95], v[104:107]
  ds_read_b64_tr_b16 a[36:37], v27 offset:36864
  ds_read_b64_tr_b16 a[38:39], v27 offset:37120
  v_and_b32 v9, 0xffff0000, v32
  v_mfma_f32_16x16x32_bf16 v[100:103], a[4:7], v[88:91], v[100:103]
  s_add_u32 m0, s69, 65536
  s_mov_b32 s72, 2621440
  ds_read_b64_tr_b16 a[40:41], v26 offset:37888
  ds_read_b64_tr_b16 a[42:43], v26 offset:38144
  v_mfma_f32_16x16x32_bf16 v[108:111], a[4:7], v[92:95], v[108:111]
  buffer_load_dwordx4 v0, s[36:39], s72 offen offset:0 lds
  v_mfma_f32_16x16x32_bf16 v[112:115], a[8:11], v[88:91], v[112:115]
  ds_read_b64_tr_b16 a[44:45], v27 offset:37888
  ds_read_b64_tr_b16 a[46:47], v27 offset:38144
  v_fma_f32 v8, v8, v238, v239
  v_mfma_f32_16x16x32_bf16 v[120:123], a[8:11], v[92:95], v[120:123]
  ds_read_b64_tr_b16 a[48:49], v26 offset:38912
  ds_read_b64_tr_b16 a[50:51], v26 offset:39168
  v_fma_f32 v9, v9, v238, v239
  v_mfma_f32_16x16x32_bf16 v[116:119], a[12:15], v[88:91], v[116:119]
  ds_read_b64_tr_b16 a[52:53], v27 offset:38912
  ds_read_b64_tr_b16 a[54:55], v27 offset:39168
  v_cvt_pk_bf16_f32 v32, v8, v9
  v_mfma_f32_16x16x32_bf16 v[124:127], a[12:15], v[92:95], v[124:127]
  buffer_load_dwordx4 v1, s[36:39], s72 offen offset:1024 lds
  s_waitcnt lgkmcnt(12)
  v_mfma_f32_16x16x32_bf16 v[128:131], a[16:19], v[88:91], v[128:131]
  ds_read_b64_tr_b16 a[56:57], v26 offset:39936
  ds_read_b64_tr_b16 a[58:59], v26 offset:40192
  v_lshlrev_b32 v10, 16, v33
  v_mfma_f32_16x16x32_bf16 v[136:139], a[16:19], v[92:95], v[136:139]
  ds_read_b64_tr_b16 a[60:61], v27 offset:39936
  ds_read_b64_tr_b16 a[62:63], v27 offset:40192
  v_and_b32 v11, 0xffff0000, v33
  v_mfma_f32_16x16x32_bf16 v[132:135], a[20:23], v[88:91], v[132:135]
  v_fma_f32 v10, v10, v238, v239
  v_fma_f32 v11, v11, v238, v239
  v_cvt_pk_bf16_f32 v33, v10, v11
  v_mfma_f32_16x16x32_bf16 v[140:143], a[20:23], v[92:95], v[140:143]
  buffer_load_dwordx4 v2, s[36:39], s72 offen offset:2048 lds
  v_mfma_f32_16x16x32_bf16 v[144:147], a[24:27], v[88:91], v[144:147]
  ds_read_b128 v[40:43], v248 offset:33792
  v_lshlrev_b32 v8, 16, v34
  v_and_b32 v9, 0xffff0000, v34
  v_mfma_f32_16x16x32_bf16 v[152:155], a[24:27], v[92:95], v[152:155]
  v_fma_f32 v8, v8, v238, v239
  v_fma_f32 v9, v9, v238, v239
  v_cvt_pk_bf16_f32 v34, v8, v9
  v_mfma_f32_16x16x32_bf16 v[148:151], a[28:31], v[88:91], v[148:151]
  ds_read_b128 v[44:47], v248 offset:41984
  v_lshlrev_b32 v10, 16, v35
  v_and_b32 v11, 0xffff0000, v35
  v_mfma_f32_16x16x32_bf16 v[156:159], a[28:31], v[92:95], v[156:159]
  buffer_load_dwordx4 v3, s[36:39], s72 offen offset:3072 lds
  s_waitcnt lgkmcnt(10)
  v_mfma_f32_16x16x32_bf16 v[160:163], a[32:35], v[88:91], v[160:163]
  s_waitcnt vmcnt(13)
  s_waitcnt lgkmcnt(0)
  s_barrier
  ds_read_b64_tr_b16 a[0:1], v24 offset:0
  v_mfma_f32_16x16x32_bf16 v[168:171], a[32:35], v[92:95], v[168:171]
  ds_read_b64_tr_b16 a[2:3], v24 offset:256
  v_fma_f32 v10, v10, v238, v239
  v_fma_f32 v11, v11, v238, v239
  v_mfma_f32_16x16x32_bf16 v[164:167], a[36:39], v[88:91], v[164:167]
  s_add_u32 m0, s69, 81920
  s_mov_b32 s72, 2621952
  ds_read_b64_tr_b16 a[4:5], v25 offset:0
  ds_read_b64_tr_b16 a[6:7], v25 offset:256
  v_mfma_f32_16x16x32_bf16 v[172:175], a[36:39], v[92:95], v[172:175]
  buffer_load_dwordx4 v0, s[36:39], s72 offen offset:0 lds
  v_mfma_f32_16x16x32_bf16 v[176:179], a[40:43], v[88:91], v[176:179]
  ds_read_b64_tr_b16 a[8:9], v24 offset:1024
  v_cvt_pk_bf16_f32 v35, v10, v11
  v_lshlrev_b32 v8, 16, v36
  v_mfma_f32_16x16x32_bf16 v[184:187], a[40:43], v[92:95], v[184:187]
  ds_read_b64_tr_b16 a[10:11], v24 offset:1280
  v_and_b32 v9, 0xffff0000, v36
  v_fma_f32 v8, v8, v246, v247
  v_mfma_f32_16x16x32_bf16 v[180:183], a[44:47], v[88:91], v[180:183]
  ds_read_b64_tr_b16 a[12:13], v25 offset:1024
  ds_read_b64_tr_b16 a[14:15], v25 offset:1280
  v_fma_f32 v9, v9, v246, v247
  v_mfma_f32_16x16x32_bf16 v[188:191], a[44:47], v[92:95], v[188:191]
  buffer_load_dwordx4 v1, s[36:39], s72 offen offset:1024 lds
  v_mfma_f32_16x16x32_bf16 v[192:195], a[48:51], v[88:91], v[192:195]
  ds_read_b64_tr_b16 a[16:17], v24 offset:2048
  v_cvt_pk_bf16_f32 v36, v8, v9
  v_lshlrev_b32 v10, 16, v37
  v_and_b32 v11, 0xffff0000, v37
  v_mfma_f32_16x16x32_bf16 v[200:203], a[48:51], v[92:95], v[200:203]
  ds_read_b64_tr_b16 a[18:19], v24 offset:2304
  v_fma_f32 v10, v10, v246, v247
  v_fma_f32 v11, v11, v246, v247
  v_cvt_pk_bf16_f32 v37, v10, v11
  v_mfma_f32_16x16x32_bf16 v[196:199], a[52:55], v[88:91], v[196:199]
  ds_read_b64_tr_b16 a[20:21], v25 offset:2048
  ds_read_b64_tr_b16 a[22:23], v25 offset:2304
  v_lshlrev_b32 v8, 16, v38
  v_and_b32 v9, 0xffff0000, v38
  v_mfma_f32_16x16x32_bf16 v[204:207], a[52:55], v[92:95], v[204:207]
  buffer_load_dwordx4 v2, s[36:39], s72 offen offset:2048 lds
  v_mfma_f32_16x16x32_bf16 v[208:211], a[56:59], v[88:91], v[208:211]
  ds_read_b64_tr_b16 a[24:25], v24 offset:3072
  v_fma_f32 v8, v8, v246, v247
  v_fma_f32 v9, v9, v246, v247
  v_cvt_pk_bf16_f32 v38, v8, v9
  v_mfma_f32_16x16x32_bf16 v[216:219], a[56:59], v[92:95], v[216:219]
  ds_read_b64_tr_b16 a[26:27], v24 offset:3328
  v_lshlrev_b32 v10, 16, v39
  v_and_b32 v11, 0xffff0000, v39
  v_fma_f32 v10, v10, v246, v247
  v_mfma_f32_16x16x32_bf16 v[212:215], a[60:63], v[88:91], v[212:215]
  ds_read_b64_tr_b16 a[28:29], v25 offset:3072
  ds_read_b64_tr_b16 a[30:31], v25 offset:3328
  v_fma_f32 v11, v11, v246, v247
  v_cvt_pk_bf16_f32 v39, v10, v11
  v_mfma_f32_16x16x32_bf16 v[220:223], a[60:63], v[92:95], v[220:223]
  buffer_load_dwordx4 v3, s[36:39], s72 offen offset:3072 lds
  s_waitcnt lgkmcnt(8)
  v_mfma_f32_16x16x32_bf16 v[96:99], a[0:3], v[32:35], v[96:99]
  ds_read_b64_tr_b16 a[32:33], v24 offset:4096
  ds_read_b64_tr_b16 a[34:35], v24 offset:4352
  v_lshlrev_b32 v8, 16, v40
  v_mfma_f32_16x16x32_bf16 v[104:107], a[0:3], v[36:39], v[104:107]
  ds_read_b64_tr_b16 a[36:37], v25 offset:4096
  ds_read_b64_tr_b16 a[38:39], v25 offset:4352
  v_and_b32 v9, 0xffff0000, v40
  v_mfma_f32_16x16x32_bf16 v[100:103], a[4:7], v[32:35], v[100:103]
  s_add_u32 m0, s69, 98304
  s_mov_b32 s72, 2883584
  ds_read_b64_tr_b16 a[40:41], v24 offset:5120
  ds_read_b64_tr_b16 a[42:43], v24 offset:5376
  v_mfma_f32_16x16x32_bf16 v[108:111], a[4:7], v[36:39], v[108:111]
  buffer_load_dwordx4 v0, s[36:39], s72 offen offset:0 lds
  v_mfma_f32_16x16x32_bf16 v[112:115], a[8:11], v[32:35], v[112:115]
  ds_read_b64_tr_b16 a[44:45], v25 offset:5120
  ds_read_b64_tr_b16 a[46:47], v25 offset:5376
  v_fma_f32 v8, v8, v238, v239
  v_mfma_f32_16x16x32_bf16 v[120:123], a[8:11], v[36:39], v[120:123]
  ds_read_b64_tr_b16 a[48:49], v24 offset:6144
  ds_read_b64_tr_b16 a[50:51], v24 offset:6400
  v_fma_f32 v9, v9, v238, v239
  v_mfma_f32_16x16x32_bf16 v[116:119], a[12:15], v[32:35], v[116:119]
  ds_read_b64_tr_b16 a[52:53], v25 offset:6144
  ds_read_b64_tr_b16 a[54:55], v25 offset:6400
  v_cvt_pk_bf16_f32 v40, v8, v9
  v_mfma_f32_16x16x32_bf16 v[124:127], a[12:15], v[36:39], v[124:127]
  buffer_load_dwordx4 v1, s[36:39], s72 offen offset:1024 lds
  s_waitcnt lgkmcnt(12)
  v_mfma_f32_16x16x32_bf16 v[128:131], a[16:19], v[32:35], v[128:131]
  ds_read_b64_tr_b16 a[56:57], v24 offset:7168
  ds_read_b64_tr_b16 a[58:59], v24 offset:7424
  v_lshlrev_b32 v10, 16, v41
  v_mfma_f32_16x16x32_bf16 v[136:139], a[16:19], v[36:39], v[136:139]
  ds_read_b64_tr_b16 a[60:61], v25 offset:7168
  ds_read_b64_tr_b16 a[62:63], v25 offset:7424
  v_and_b32 v11, 0xffff0000, v41
  v_mfma_f32_16x16x32_bf16 v[132:135], a[20:23], v[32:35], v[132:135]
  v_fma_f32 v10, v10, v238, v239
  v_fma_f32 v11, v11, v238, v239
  v_cvt_pk_bf16_f32 v41, v10, v11
  v_mfma_f32_16x16x32_bf16 v[140:143], a[20:23], v[36:39], v[140:143]
  buffer_load_dwordx4 v2, s[36:39], s72 offen offset:2048 lds
  v_mfma_f32_16x16x32_bf16 v[144:147], a[24:27], v[32:35], v[144:147]
  ds_read_b128 v[48:51], v248 offset:34816
  v_lshlrev_b32 v8, 16, v42
  v_and_b32 v9, 0xffff0000, v42
  v_mfma_f32_16x16x32_bf16 v[152:155], a[24:27], v[36:39], v[152:155]
  v_fma_f32 v8, v8, v238, v239
  v_fma_f32 v9, v9, v238, v239
  v_cvt_pk_bf16_f32 v42, v8, v9
  v_mfma_f32_16x16x32_bf16 v[148:151], a[28:31], v[32:35], v[148:151]
  ds_read_b128 v[52:55], v248 offset:43008
  v_lshlrev_b32 v10, 16, v43
  v_and_b32 v11, 0xffff0000, v43
  v_mfma_f32_16x16x32_bf16 v[156:159], a[28:31], v[36:39], v[156:159]
  buffer_load_dwordx4 v3, s[36:39], s72 offen offset:3072 lds
  s_waitcnt lgkmcnt(10)
  v_mfma_f32_16x16x32_bf16 v[160:163], a[32:35], v[32:35], v[160:163]
  s_waitcnt vmcnt(12)
  s_waitcnt lgkmcnt(0)
  s_barrier
  ds_read_b64_tr_b16 a[0:1], v24 offset:32768
  v_mfma_f32_16x16x32_bf16 v[168:171], a[32:35], v[36:39], v[168:171]
  ds_read_b64_tr_b16 a[2:3], v24 offset:33024
  v_fma_f32 v10, v10, v238, v239
  v_fma_f32 v11, v11, v238, v239
  v_mfma_f32_16x16x32_bf16 v[164:167], a[36:39], v[32:35], v[164:167]
  s_add_u32 m0, s69, 114688
  s_mov_b32 s72, 2884096
  ds_read_b64_tr_b16 a[4:5], v25 offset:32768
  ds_read_b64_tr_b16 a[6:7], v25 offset:33024
  v_mfma_f32_16x16x32_bf16 v[172:175], a[36:39], v[36:39], v[172:175]
  buffer_load_dwordx4 v0, s[36:39], s72 offen offset:0 lds
  v_mfma_f32_16x16x32_bf16 v[176:179], a[40:43], v[32:35], v[176:179]
  ds_read_b64_tr_b16 a[8:9], v24 offset:33792
  v_cvt_pk_bf16_f32 v43, v10, v11
  v_lshlrev_b32 v8, 16, v44
  v_mfma_f32_16x16x32_bf16 v[184:187], a[40:43], v[36:39], v[184:187]
  ds_read_b64_tr_b16 a[10:11], v24 offset:34048
  v_and_b32 v9, 0xffff0000, v44
  v_fma_f32 v8, v8, v246, v247
  v_mfma_f32_16x16x32_bf16 v[180:183], a[44:47], v[32:35], v[180:183]
  ds_read_b64_tr_b16 a[12:13], v25 offset:33792
  ds_read_b64_tr_b16 a[14:15], v25 offset:34048
  v_fma_f32 v9, v9, v246, v247
  v_mfma_f32_16x16x32_bf16 v[188:191], a[44:47], v[36:39], v[188:191]
  buffer_load_dwordx4 v1, s[36:39], s72 offen offset:1024 lds
  v_mfma_f32_16x16x32_bf16 v[192:195], a[48:51], v[32:35], v[192:195]
  ds_read_b64_tr_b16 a[16:17], v24 offset:34816
  v_cvt_pk_bf16_f32 v44, v8, v9
  v_lshlrev_b32 v10, 16, v45
  v_and_b32 v11, 0xffff0000, v45
  v_mfma_f32_16x16x32_bf16 v[200:203], a[48:51], v[36:39], v[200:203]
  ds_read_b64_tr_b16 a[18:19], v24 offset:35072
  v_fma_f32 v10, v10, v246, v247
  v_fma_f32 v11, v11, v246, v247
  v_cvt_pk_bf16_f32 v45, v10, v11
  v_mfma_f32_16x16x32_bf16 v[196:199], a[52:55], v[32:35], v[196:199]
  ds_read_b64_tr_b16 a[20:21], v25 offset:34816
  ds_read_b64_tr_b16 a[22:23], v25 offset:35072
  v_lshlrev_b32 v8, 16, v46
  v_and_b32 v9, 0xffff0000, v46
  v_mfma_f32_16x16x32_bf16 v[204:207], a[52:55], v[36:39], v[204:207]
  buffer_load_dwordx4 v2, s[36:39], s72 offen offset:2048 lds
  v_mfma_f32_16x16x32_bf16 v[208:211], a[56:59], v[32:35], v[208:211]
  ds_read_b64_tr_b16 a[24:25], v24 offset:35840
  v_fma_f32 v8, v8, v246, v247
  v_fma_f32 v9, v9, v246, v247
  v_cvt_pk_bf16_f32 v46, v8, v9
  v_mfma_f32_16x16x32_bf16 v[216:219], a[56:59], v[36:39], v[216:219]
  ds_read_b64_tr_b16 a[26:27], v24 offset:36096
  v_lshlrev_b32 v10, 16, v47
  v_and_b32 v11, 0xffff0000, v47
  v_fma_f32 v10, v10, v246, v247
  v_mfma_f32_16x16x32_bf16 v[212:215], a[60:63], v[32:35], v[212:215]
  ds_read_b64_tr_b16 a[28:29], v25 offset:35840
  ds_read_b64_tr_b16 a[30:31], v25 offset:36096
  v_fma_f32 v11, v11, v246, v247
  v_cvt_pk_bf16_f32 v47, v10, v11
  v_mfma_f32_16x16x32_bf16 v[220:223], a[60:63], v[36:39], v[220:223]
  buffer_load_dwordx4 v3, s[36:39], s72 offen offset:3072 lds
  s_waitcnt lgkmcnt(8)
  v_mfma_f32_16x16x32_bf16 v[96:99], a[0:3], v[40:43], v[96:99]
  ds_read_b64_tr_b16 a[32:33], v24 offset:36864
  ds_read_b64_tr_b16 a[34:35], v24 offset:37120
  v_lshlrev_b32 v8, 16, v48
  v_mfma_f32_16x16x32_bf16 v[104:107], a[0:3], v[44:47], v[104:107]
  ds_read_b64_tr_b16 a[36:37], v25 offset:36864
  ds_read_b64_tr_b16 a[38:39], v25 offset:37120
  v_and_b32 v9, 0xffff0000, v48
  v_mfma_f32_16x16x32_bf16 v[100:103], a[4:7], v[40:43], v[100:103]
  s_add_u32 m0, s69, 0
  s_mov_b32 s72, 3145728
  ds_read_b64_tr_b16 a[40:41], v24 offset:37888
  ds_read_b64_tr_b16 a[42:43], v24 offset:38144
  v_mfma_f32_16x16x32_bf16 v[108:111], a[4:7], v[44:47], v[108:111]
  buffer_load_dwordx4 v0, s[36:39], s72 offen offset:0 lds
  v_mfma_f32_16x16x32_bf16 v[112:115], a[8:11], v[40:43], v[112:115]
  ds_read_b64_tr_b16 a[44:45], v25 offset:37888
  ds_read_b64_tr_b16 a[46:47], v25 offset:38144
  v_fma_f32 v8, v8, v238, v239
  v_mfma_f32_16x16x32_bf16 v[120:123], a[8:11], v[44:47], v[120:123]
  ds_read_b64_tr_b16 a[48:49], v24 offset:38912
  ds_read_b64_tr_b16 a[50:51], v24 offset:39168
  v_fma_f32 v9, v9, v238, v239
  v_mfma_f32_16x16x32_bf16 v[116:119], a[12:15], v[40:43], v[116:119]
  ds_read_b64_tr_b16 a[52:53], v25 offset:38912
  ds_read_b64_tr_b16 a[54:55], v25 offset:39168
  v_cvt_pk_bf16_f32 v48, v8, v9
  v_mfma_f32_16x16x32_bf16 v[124:127], a[12:15], v[44:47], v[124:127]
  buffer_load_dwordx4 v1, s[36:39], s72 offen offset:1024 lds
  s_waitcnt lgkmcnt(12)
  v_mfma_f32_16x16x32_bf16 v[128:131], a[16:19], v[40:43], v[128:131]
  ds_read_b64_tr_b16 a[56:57], v24 offset:39936
  ds_read_b64_tr_b16 a[58:59], v24 offset:40192
  v_lshlrev_b32 v10, 16, v49
  v_mfma_f32_16x16x32_bf16 v[136:139], a[16:19], v[44:47], v[136:139]
  ds_read_b64_tr_b16 a[60:61], v25 offset:39936
  ds_read_b64_tr_b16 a[62:63], v25 offset:40192
  v_and_b32 v11, 0xffff0000, v49
  v_mfma_f32_16x16x32_bf16 v[132:135], a[20:23], v[40:43], v[132:135]
  v_fma_f32 v10, v10, v238, v239
  v_fma_f32 v11, v11, v238, v239
  v_cvt_pk_bf16_f32 v49, v10, v11
  v_mfma_f32_16x16x32_bf16 v[140:143], a[20:23], v[44:47], v[140:143]
  buffer_load_dwordx4 v2, s[36:39], s72 offen offset:2048 lds
  v_mfma_f32_16x16x32_bf16 v[144:147], a[24:27], v[40:43], v[144:147]
  ds_read_b128 v[56:59], v248 offset:35840
  v_lshlrev_b32 v8, 16, v50
  v_and_b32 v9, 0xffff0000, v50
  v_mfma_f32_16x16x32_bf16 v[152:155], a[24:27], v[44:47], v[152:155]
  v_fma_f32 v8, v8, v238, v239
  v_fma_f32 v9, v9, v238, v239
  v_cvt_pk_bf16_f32 v50, v8, v9
  v_mfma_f32_16x16x32_bf16 v[148:151], a[28:31], v[40:43], v[148:151]
  ds_read_b128 v[60:63], v248 offset:44032
  v_lshlrev_b32 v10, 16, v51
  v_and_b32 v11, 0xffff0000, v51
  v_mfma_f32_16x16x32_bf16 v[156:159], a[28:31], v[44:47], v[156:159]
  buffer_load_dwordx4 v3, s[36:39], s72 offen offset:3072 lds
  s_waitcnt lgkmcnt(10)
  v_mfma_f32_16x16x32_bf16 v[160:163], a[32:35], v[40:43], v[160:163]
  s_waitcnt vmcnt(12)
  s_waitcnt lgkmcnt(0)
  s_barrier
  ds_read_b64_tr_b16 a[0:1], v26 offset:0
  v_mfma_f32_16x16x32_bf16 v[168:171], a[32:35], v[44:47], v[168:171]
  ds_read_b64_tr_b16 a[2:3], v26 offset:256
  v_fma_f32 v10, v10, v238, v239
  v_fma_f32 v11, v11, v238, v239
  v_mfma_f32_16x16x32_bf16 v[164:167], a[36:39], v[40:43], v[164:167]
  s_add_u32 m0, s69, 16384
  s_mov_b32 s72, 3146240
  ds_read_b64_tr_b16 a[4:5], v27 offset:0
  ds_read_b64_tr_b16 a[6:7], v27 offset:256
  v_mfma_f32_16x16x32_bf16 v[172:175], a[36:39], v[44:47], v[172:175]
  buffer_load_dwordx4 v0, s[36:39], s72 offen offset:0 lds
  v_mfma_f32_16x16x32_bf16 v[176:179], a[40:43], v[40:43], v[176:179]
  ds_read_b64_tr_b16 a[8:9], v26 offset:1024
  v_cvt_pk_bf16_f32 v51, v10, v11
  v_lshlrev_b32 v8, 16, v52
  v_mfma_f32_16x16x32_bf16 v[184:187], a[40:43], v[44:47], v[184:187]
  ds_read_b64_tr_b16 a[10:11], v26 offset:1280
  v_and_b32 v9, 0xffff0000, v52
  v_fma_f32 v8, v8, v246, v247
  v_mfma_f32_16x16x32_bf16 v[180:183], a[44:47], v[40:43], v[180:183]
  ds_read_b64_tr_b16 a[12:13], v27 offset:1024
  ds_read_b64_tr_b16 a[14:15], v27 offset:1280
  v_fma_f32 v9, v9, v246, v247
  v_mfma_f32_16x16x32_bf16 v[188:191], a[44:47], v[44:47], v[188:191]
  buffer_load_dwordx4 v1, s[36:39], s72 offen offset:1024 lds
  v_mfma_f32_16x16x32_bf16 v[192:195], a[48:51], v[40:43], v[192:195]
  ds_read_b64_tr_b16 a[16:17], v26 offset:2048
  v_cvt_pk_bf16_f32 v52, v8, v9
  v_lshlrev_b32 v10, 16, v53
  v_and_b32 v11, 0xffff0000, v53
  v_mfma_f32_16x16x32_bf16 v[200:203], a[48:51], v[44:47], v[200:203]
  ds_read_b64_tr_b16 a[18:19], v26 offset:2304
  v_fma_f32 v10, v10, v246, v247
  v_fma_f32 v11, v11, v246, v247
  v_cvt_pk_bf16_f32 v53, v10, v11
  v_mfma_f32_16x16x32_bf16 v[196:199], a[52:55], v[40:43], v[196:199]
  ds_read_b64_tr_b16 a[20:21], v27 offset:2048
  ds_read_b64_tr_b16 a[22:23], v27 offset:2304
  v_lshlrev_b32 v8, 16, v54
  v_and_b32 v9, 0xffff0000, v54
  v_mfma_f32_16x16x32_bf16 v[204:207], a[52:55], v[44:47], v[204:207]
  buffer_load_dwordx4 v2, s[36:39], s72 offen offset:2048 lds
  v_mfma_f32_16x16x32_bf16 v[208:211], a[56:59], v[40:43], v[208:211]
  ds_read_b64_tr_b16 a[24:25], v26 offset:3072
  v_fma_f32 v8, v8, v246, v247
  v_fma_f32 v9, v9, v246, v247
  v_cvt_pk_bf16_f32 v54, v8, v9
  v_mfma_f32_16x16x32_bf16 v[216:219], a[56:59], v[44:47], v[216:219]
  ds_read_b64_tr_b16 a[26:27], v26 offset:3328
  v_lshlrev_b32 v10, 16, v55
  v_and_b32 v11, 0xffff0000, v55
  v_fma_f32 v10, v10, v246, v247
  v_mfma_f32_16x16x32_bf16 v[212:215], a[60:63], v[40:43], v[212:215]
  ds_read_b64_tr_b16 a[28:29], v27 offset:3072
  ds_read_b64_tr_b16 a[30:31], v27 offset:3328
  v_fma_f32 v11, v11, v246, v247
  v_cvt_pk_bf16_f32 v55, v10, v11
  v_mfma_f32_16x16x32_bf16 v[220:223], a[60:63], v[44:47], v[220:223]
  buffer_load_dwordx4 v3, s[36:39], s72 offen offset:3072 lds
  s_waitcnt lgkmcnt(8)
  v_mfma_f32_16x16x32_bf16 v[96:99], a[0:3], v[48:51], v[96:99]
  ds_read_b64_tr_b16 a[32:33], v26 offset:4096
  ds_read_b64_tr_b16 a[34:35], v26 offset:4352
  v_lshlrev_b32 v8, 16, v56
  v_mfma_f32_16x16x32_bf16 v[104:107], a[0:3], v[52:55], v[104:107]
  ds_read_b64_tr_b16 a[36:37], v27 offset:4096
  ds_read_b64_tr_b16 a[38:39], v27 offset:4352
  v_and_b32 v9, 0xffff0000, v56
  v_mfma_f32_16x16x32_bf16 v[100:103], a[4:7], v[48:51], v[100:103]
  s_add_u32 m0, s69, 32768
  s_mov_b32 s72, 3407872
  ds_read_b64_tr_b16 a[40:41], v26 offset:5120
  ds_read_b64_tr_b16 a[42:43], v26 offset:5376
  v_mfma_f32_16x16x32_bf16 v[108:111], a[4:7], v[52:55], v[108:111]
  buffer_load_dwordx4 v0, s[36:39], s72 offen offset:0 lds
  v_mfma_f32_16x16x32_bf16 v[112:115], a[8:11], v[48:51], v[112:115]
  ds_read_b64_tr_b16 a[44:45], v27 offset:5120
  ds_read_b64_tr_b16 a[46:47], v27 offset:5376
  v_fma_f32 v8, v8, v238, v239
  v_mfma_f32_16x16x32_bf16 v[120:123], a[8:11], v[52:55], v[120:123]
  ds_read_b64_tr_b16 a[48:49], v26 offset:6144
  ds_read_b64_tr_b16 a[50:51], v26 offset:6400
  v_fma_f32 v9, v9, v238, v239
  v_mfma_f32_16x16x32_bf16 v[116:119], a[12:15], v[48:51], v[116:119]
  ds_read_b64_tr_b16 a[52:53], v27 offset:6144
  ds_read_b64_tr_b16 a[54:55], v27 offset:6400
  v_cvt_pk_bf16_f32 v56, v8, v9
  v_mfma_f32_16x16x32_bf16 v[124:127], a[12:15], v[52:55], v[124:127]
  buffer_load_dwordx4 v1, s[36:39], s72 offen offset:1024 lds
  s_waitcnt lgkmcnt(12)
  v_mfma_f32_16x16x32_bf16 v[128:131], a[16:19], v[48:51], v[128:131]
  ds_read_b64_tr_b16 a[56:57], v26 offset:7168
  ds_read_b64_tr_b16 a[58:59], v26 offset:7424
  v_lshlrev_b32 v10, 16, v57
  v_mfma_f32_16x16x32_bf16 v[136:139], a[16:19], v[52:55], v[136:139]
  ds_read_b64_tr_b16 a[60:61], v27 offset:7168
  ds_read_b64_tr_b16 a[62:63], v27 offset:7424
  v_and_b32 v11, 0xffff0000, v57
  v_mfma_f32_16x16x32_bf16 v[132:135], a[20:23], v[48:51], v[132:135]
  v_fma_f32 v10, v10, v238, v239
  v_fma_f32 v11, v11, v238, v239
  v_cvt_pk_bf16_f32 v57, v10, v11
  v_mfma_f32_16x16x32_bf16 v[140:143], a[20:23], v[52:55], v[140:143]
  buffer_load_dwordx4 v2, s[36:39], s72 offen offset:2048 lds
  v_mfma_f32_16x16x32_bf16 v[144:147], a[24:27], v[48:51], v[144:147]
  ds_read_b128 v[64:67], v248 offset:36864
  v_lshlrev_b32 v8, 16, v58
  v_and_b32 v9, 0xffff0000, v58
  v_mfma_f32_16x16x32_bf16 v[152:155], a[24:27], v[52:55], v[152:155]
  v_fma_f32 v8, v8, v238, v239
  v_fma_f32 v9, v9, v238, v239
  v_cvt_pk_bf16_f32 v58, v8, v9
  v_mfma_f32_16x16x32_bf16 v[148:151], a[28:31], v[48:51], v[148:151]
  ds_read_b128 v[68:71], v248 offset:45056
  v_lshlrev_b32 v10, 16, v59
  v_and_b32 v11, 0xffff0000, v59
  v_mfma_f32_16x16x32_bf16 v[156:159], a[28:31], v[52:55], v[156:159]
  buffer_load_dwordx4 v3, s[36:39], s72 offen offset:3072 lds
  s_waitcnt lgkmcnt(10)
  v_mfma_f32_16x16x32_bf16 v[160:163], a[32:35], v[48:51], v[160:163]
  s_waitcnt vmcnt(12)
  s_waitcnt lgkmcnt(0)
  s_barrier
  ds_read_b64_tr_b16 a[0:1], v26 offset:32768
  v_mfma_f32_16x16x32_bf16 v[168:171], a[32:35], v[52:55], v[168:171]
  ds_read_b64_tr_b16 a[2:3], v26 offset:33024
  v_fma_f32 v10, v10, v238, v239
  v_fma_f32 v11, v11, v238, v239
  v_mfma_f32_16x16x32_bf16 v[164:167], a[36:39], v[48:51], v[164:167]
  s_add_u32 m0, s69, 49152
  s_mov_b32 s72, 3408384
  ds_read_b64_tr_b16 a[4:5], v27 offset:32768
  ds_read_b64_tr_b16 a[6:7], v27 offset:33024
  v_mfma_f32_16x16x32_bf16 v[172:175], a[36:39], v[52:55], v[172:175]
  buffer_load_dwordx4 v0, s[36:39], s72 offen offset:0 lds
  v_mfma_f32_16x16x32_bf16 v[176:179], a[40:43], v[48:51], v[176:179]
  ds_read_b64_tr_b16 a[8:9], v26 offset:33792
  v_cvt_pk_bf16_f32 v59, v10, v11
  v_lshlrev_b32 v8, 16, v60
  v_mfma_f32_16x16x32_bf16 v[184:187], a[40:43], v[52:55], v[184:187]
  ds_read_b64_tr_b16 a[10:11], v26 offset:34048
  v_and_b32 v9, 0xffff0000, v60
  v_fma_f32 v8, v8, v246, v247
  v_mfma_f32_16x16x32_bf16 v[180:183], a[44:47], v[48:51], v[180:183]
  ds_read_b64_tr_b16 a[12:13], v27 offset:33792
  ds_read_b64_tr_b16 a[14:15], v27 offset:34048
  v_fma_f32 v9, v9, v246, v247
  v_mfma_f32_16x16x32_bf16 v[188:191], a[44:47], v[52:55], v[188:191]
  buffer_load_dwordx4 v1, s[36:39], s72 offen offset:1024 lds
  v_mfma_f32_16x16x32_bf16 v[192:195], a[48:51], v[48:51], v[192:195]
  ds_read_b64_tr_b16 a[16:17], v26 offset:34816
  v_cvt_pk_bf16_f32 v60, v8, v9
  v_lshlrev_b32 v10, 16, v61
  v_and_b32 v11, 0xffff0000, v61
  v_mfma_f32_16x16x32_bf16 v[200:203], a[48:51], v[52:55], v[200:203]
  ds_read_b64_tr_b16 a[18:19], v26 offset:35072
  v_fma_f32 v10, v10, v246, v247
  v_fma_f32 v11, v11, v246, v247
  v_cvt_pk_bf16_f32 v61, v10, v11
  v_mfma_f32_16x16x32_bf16 v[196:199], a[52:55], v[48:51], v[196:199]
  ds_read_b64_tr_b16 a[20:21], v27 offset:34816
  ds_read_b64_tr_b16 a[22:23], v27 offset:35072
  v_lshlrev_b32 v8, 16, v62
  v_and_b32 v9, 0xffff0000, v62
  v_mfma_f32_16x16x32_bf16 v[204:207], a[52:55], v[52:55], v[204:207]
  buffer_load_dwordx4 v2, s[36:39], s72 offen offset:2048 lds
  v_mfma_f32_16x16x32_bf16 v[208:211], a[56:59], v[48:51], v[208:211]
  ds_read_b64_tr_b16 a[24:25], v26 offset:35840
  v_fma_f32 v8, v8, v246, v247
  v_fma_f32 v9, v9, v246, v247
  v_cvt_pk_bf16_f32 v62, v8, v9
  v_mfma_f32_16x16x32_bf16 v[216:219], a[56:59], v[52:55], v[216:219]
  ds_read_b64_tr_b16 a[26:27], v26 offset:36096
  v_lshlrev_b32 v10, 16, v63
  v_and_b32 v11, 0xffff0000, v63
  v_fma_f32 v10, v10, v246, v247
  v_mfma_f32_16x16x32_bf16 v[212:215], a[60:63], v[48:51], v[212:215]
  ds_read_b64_tr_b16 a[28:29], v27 offset:35840
  ds_read_b64_tr_b16 a[30:31], v27 offset:36096
  v_fma_f32 v11, v11, v246, v247
  v_cvt_pk_bf16_f32 v63, v10, v11
  v_mfma_f32_16x16x32_bf16 v[220:223], a[60:63], v[52:55], v[220:223]
  buffer_load_dwordx4 v3, s[36:39], s72 offen offset:3072 lds
  s_waitcnt lgkmcnt(8)
  v_mfma_f32_16x16x32_bf16 v[96:99], a[0:3], v[56:59], v[96:99]
  ds_read_b64_tr_b16 a[32:33], v26 offset:36864
  ds_read_b64_tr_b16 a[34:35], v26 offset:37120
  v_lshlrev_b32 v8, 16, v64
  v_mfma_f32_16x16x32_bf16 v[104:107], a[0:3], v[60:63], v[104:107]
  ds_read_b64_tr_b16 a[36:37], v27 offset:36864
  ds_read_b64_tr_b16 a[38:39], v27 offset:37120
  v_and_b32 v9, 0xffff0000, v64
  v_mfma_f32_16x16x32_bf16 v[100:103], a[4:7], v[56:59], v[100:103]
  s_add_u32 m0, s69, 65536
  s_mov_b32 s72, 0
  ds_read_b64_tr_b16 a[40:41], v26 offset:37888
  ds_read_b64_tr_b16 a[42:43], v26 offset:38144
  v_mfma_f32_16x16x32_bf16 v[108:111], a[4:7], v[60:63], v[108:111]
  buffer_load_dwordx4 v224, s[40:43], s72 offen offset:0 lds
  v_mfma_f32_16x16x32_bf16 v[112:115], a[8:11], v[56:59], v[112:115]
  ds_read_b64_tr_b16 a[44:45], v27 offset:37888
  ds_read_b64_tr_b16 a[46:47], v27 offset:38144
  v_fma_f32 v8, v8, v238, v239
  v_mfma_f32_16x16x32_bf16 v[120:123], a[8:11], v[60:63], v[120:123]
  ds_read_b64_tr_b16 a[48:49], v26 offset:38912
  ds_read_b64_tr_b16 a[50:51], v26 offset:39168
  v_fma_f32 v9, v9, v238, v239
  v_mfma_f32_16x16x32_bf16 v[116:119], a[12:15], v[56:59], v[116:119]
  ds_read_b64_tr_b16 a[52:53], v27 offset:38912
  ds_read_b64_tr_b16 a[54:55], v27 offset:39168
  v_cvt_pk_bf16_f32 v64, v8, v9
  v_mfma_f32_16x16x32_bf16 v[124:127], a[12:15], v[60:63], v[124:127]
  buffer_load_dwordx4 v225, s[40:43], s72 offen offset:1024 lds
  s_waitcnt lgkmcnt(12)
  v_mfma_f32_16x16x32_bf16 v[128:131], a[16:19], v[56:59], v[128:131]
  ds_read_b64_tr_b16 a[56:57], v26 offset:39936
  ds_read_b64_tr_b16 a[58:59], v26 offset:40192
  v_lshlrev_b32 v10, 16, v65
  v_mfma_f32_16x16x32_bf16 v[136:139], a[16:19], v[60:63], v[136:139]
  ds_read_b64_tr_b16 a[60:61], v27 offset:39936
  ds_read_b64_tr_b16 a[62:63], v27 offset:40192
  v_and_b32 v11, 0xffff0000, v65
  v_mfma_f32_16x16x32_bf16 v[132:135], a[20:23], v[56:59], v[132:135]
  v_fma_f32 v10, v10, v238, v239
  v_fma_f32 v11, v11, v238, v239
  v_cvt_pk_bf16_f32 v65, v10, v11
  v_mfma_f32_16x16x32_bf16 v[140:143], a[20:23], v[60:63], v[140:143]
  buffer_load_dwordx4 v226, s[40:43], s72 offen offset:2048 lds
  v_mfma_f32_16x16x32_bf16 v[144:147], a[24:27], v[56:59], v[144:147]
  ds_read_b128 v[72:75], v248 offset:37888
  v_lshlrev_b32 v8, 16, v66
  v_and_b32 v9, 0xffff0000, v66
  v_mfma_f32_16x16x32_bf16 v[152:155], a[24:27], v[60:63], v[152:155]
  v_fma_f32 v8, v8, v238, v239
  v_fma_f32 v9, v9, v238, v239
  v_cvt_pk_bf16_f32 v66, v8, v9
  v_mfma_f32_16x16x32_bf16 v[148:151], a[28:31], v[56:59], v[148:151]
  ds_read_b128 v[76:79], v248 offset:46080
  v_lshlrev_b32 v10, 16, v67
  v_and_b32 v11, 0xffff0000, v67
  v_mfma_f32_16x16x32_bf16 v[156:159], a[28:31], v[60:63], v[156:159]
  buffer_load_dwordx4 v227, s[40:43], s72 offen offset:3072 lds
  s_waitcnt lgkmcnt(10)
  v_mfma_f32_16x16x32_bf16 v[160:163], a[32:35], v[56:59], v[160:163]
  s_waitcnt vmcnt(12)
  s_waitcnt lgkmcnt(0)
  s_barrier
  ds_read_b64_tr_b16 a[0:1], v24 offset:0
  v_mfma_f32_16x16x32_bf16 v[168:171], a[32:35], v[60:63], v[168:171]
  ds_read_b64_tr_b16 a[2:3], v24 offset:256
  v_fma_f32 v10, v10, v238, v239
  v_fma_f32 v11, v11, v238, v239
  v_mfma_f32_16x16x32_bf16 v[164:167], a[36:39], v[56:59], v[164:167]
  s_add_u32 m0, s69, 81920
  s_mov_b32 s72, 16384
  ds_read_b64_tr_b16 a[4:5], v25 offset:0
  ds_read_b64_tr_b16 a[6:7], v25 offset:256
  v_mfma_f32_16x16x32_bf16 v[172:175], a[36:39], v[60:63], v[172:175]
  buffer_load_dwordx4 v224, s[40:43], s72 offen offset:0 lds
  v_mfma_f32_16x16x32_bf16 v[176:179], a[40:43], v[56:59], v[176:179]
  ds_read_b64_tr_b16 a[8:9], v24 offset:1024
  v_cvt_pk_bf16_f32 v67, v10, v11
  v_lshlrev_b32 v8, 16, v68
  v_mfma_f32_16x16x32_bf16 v[184:187], a[40:43], v[60:63], v[184:187]
  ds_read_b64_tr_b16 a[10:11], v24 offset:1280
  v_and_b32 v9, 0xffff0000, v68
  v_fma_f32 v8, v8, v246, v247
  v_mfma_f32_16x16x32_bf16 v[180:183], a[44:47], v[56:59], v[180:183]
  ds_read_b64_tr_b16 a[12:13], v25 offset:1024
  ds_read_b64_tr_b16 a[14:15], v25 offset:1280
  v_fma_f32 v9, v9, v246, v247
  v_mfma_f32_16x16x32_bf16 v[188:191], a[44:47], v[60:63], v[188:191]
  buffer_load_dwordx4 v225, s[40:43], s72 offen offset:1024 lds
  v_mfma_f32_16x16x32_bf16 v[192:195], a[48:51], v[56:59], v[192:195]
  ds_read_b64_tr_b16 a[16:17], v24 offset:2048
  v_cvt_pk_bf16_f32 v68, v8, v9
  v_lshlrev_b32 v10, 16, v69
  v_and_b32 v11, 0xffff0000, v69
  v_mfma_f32_16x16x32_bf16 v[200:203], a[48:51], v[60:63], v[200:203]
  ds_read_b64_tr_b16 a[18:19], v24 offset:2304
  v_fma_f32 v10, v10, v246, v247
  v_fma_f32 v11, v11, v246, v247
  v_cvt_pk_bf16_f32 v69, v10, v11
  v_mfma_f32_16x16x32_bf16 v[196:199], a[52:55], v[56:59], v[196:199]
  ds_read_b64_tr_b16 a[20:21], v25 offset:2048
  ds_read_b64_tr_b16 a[22:23], v25 offset:2304
  v_lshlrev_b32 v8, 16, v70
  v_and_b32 v9, 0xffff0000, v70
  v_mfma_f32_16x16x32_bf16 v[204:207], a[52:55], v[60:63], v[204:207]
  buffer_load_dwordx4 v226, s[40:43], s72 offen offset:2048 lds
  v_mfma_f32_16x16x32_bf16 v[208:211], a[56:59], v[56:59], v[208:211]
  ds_read_b64_tr_b16 a[24:25], v24 offset:3072
  v_fma_f32 v8, v8, v246, v247
  v_fma_f32 v9, v9, v246, v247
  v_cvt_pk_bf16_f32 v70, v8, v9
  v_mfma_f32_16x16x32_bf16 v[216:219], a[56:59], v[60:63], v[216:219]
  ds_read_b64_tr_b16 a[26:27], v24 offset:3328
  v_lshlrev_b32 v10, 16, v71
  v_and_b32 v11, 0xffff0000, v71
  v_fma_f32 v10, v10, v246, v247
  v_mfma_f32_16x16x32_bf16 v[212:215], a[60:63], v[56:59], v[212:215]
  ds_read_b64_tr_b16 a[28:29], v25 offset:3072
  ds_read_b64_tr_b16 a[30:31], v25 offset:3328
  v_fma_f32 v11, v11, v246, v247
  v_cvt_pk_bf16_f32 v71, v10, v11
  v_mfma_f32_16x16x32_bf16 v[220:223], a[60:63], v[60:63], v[220:223]
  buffer_load_dwordx4 v227, s[40:43], s72 offen offset:3072 lds
  s_waitcnt lgkmcnt(8)
  v_mfma_f32_16x16x32_bf16 v[96:99], a[0:3], v[64:67], v[96:99]
  ds_read_b64_tr_b16 a[32:33], v24 offset:4096
  ds_read_b64_tr_b16 a[34:35], v24 offset:4352
  v_lshlrev_b32 v8, 16, v72
  v_mfma_f32_16x16x32_bf16 v[104:107], a[0:3], v[68:71], v[104:107]
  ds_read_b64_tr_b16 a[36:37], v25 offset:4096
  ds_read_b64_tr_b16 a[38:39], v25 offset:4352
  v_and_b32 v9, 0xffff0000, v72
  v_mfma_f32_16x16x32_bf16 v[100:103], a[4:7], v[64:67], v[100:103]
  s_add_u32 m0, s69, 98304
  s_mov_b32 s72, 0
  ds_read_b64_tr_b16 a[40:41], v24 offset:5120
  ds_read_b64_tr_b16 a[42:43], v24 offset:5376
  v_mfma_f32_16x16x32_bf16 v[108:111], a[4:7], v[68:71], v[108:111]
  buffer_load_dwordx4 v228, s[44:47], s72 offen offset:0 lds
  v_mfma_f32_16x16x32_bf16 v[112:115], a[8:11], v[64:67], v[112:115]
  ds_read_b64_tr_b16 a[44:45], v25 offset:5120
  ds_read_b64_tr_b16 a[46:47], v25 offset:5376
  v_fma_f32 v8, v8, v238, v239
  v_mfma_f32_16x16x32_bf16 v[120:123], a[8:11], v[68:71], v[120:123]
  ds_read_b64_tr_b16 a[48:49], v24 offset:6144
  ds_read_b64_tr_b16 a[50:51], v24 offset:6400
  v_fma_f32 v9, v9, v238, v239
  v_mfma_f32_16x16x32_bf16 v[116:119], a[12:15], v[64:67], v[116:119]
  ds_read_b64_tr_b16 a[52:53], v25 offset:6144
  ds_read_b64_tr_b16 a[54:55], v25 offset:6400
  v_cvt_pk_bf16_f32 v72, v8, v9
  v_mfma_f32_16x16x32_bf16 v[124:127], a[12:15], v[68:71], v[124:127]
  buffer_load_dwordx4 v229, s[44:47], s72 offen offset:1024 lds
  s_waitcnt lgkmcnt(12)
  v_mfma_f32_16x16x32_bf16 v[128:131], a[16:19], v[64:67], v[128:131]
  ds_read_b64_tr_b16 a[56:57], v24 offset:7168
  ds_read_b64_tr_b16 a[58:59], v24 offset:7424
  v_lshlrev_b32 v10, 16, v73
  v_mfma_f32_16x16x32_bf16 v[136:139], a[16:19], v[68:71], v[136:139]
  ds_read_b64_tr_b16 a[60:61], v25 offset:7168
  ds_read_b64_tr_b16 a[62:63], v25 offset:7424
  v_and_b32 v11, 0xffff0000, v73
  v_mfma_f32_16x16x32_bf16 v[132:135], a[20:23], v[64:67], v[132:135]
  v_fma_f32 v10, v10, v238, v239
  v_fma_f32 v11, v11, v238, v239
  v_cvt_pk_bf16_f32 v73, v10, v11
  v_mfma_f32_16x16x32_bf16 v[140:143], a[20:23], v[68:71], v[140:143]
  buffer_load_dwordx4 v230, s[44:47], s72 offen offset:2048 lds
  v_mfma_f32_16x16x32_bf16 v[144:147], a[24:27], v[64:67], v[144:147]
  v_lshlrev_b32 v8, 16, v74
  v_and_b32 v9, 0xffff0000, v74
  v_fma_f32 v8, v8, v238, v239
  v_mfma_f32_16x16x32_bf16 v[152:155], a[24:27], v[68:71], v[152:155]
  v_fma_f32 v9, v9, v238, v239
  v_cvt_pk_bf16_f32 v74, v8, v9
  v_lshlrev_b32 v10, 16, v75
  v_mfma_f32_16x16x32_bf16 v[148:151], a[28:31], v[64:67], v[148:151]
  v_and_b32 v11, 0xffff0000, v75
  v_fma_f32 v10, v10, v238, v239
  v_fma_f32 v11, v11, v238, v239
  v_mfma_f32_16x16x32_bf16 v[156:159], a[28:31], v[68:71], v[156:159]
  buffer_load_dwordx4 v231, s[44:47], s72 offen offset:3072 lds
  s_waitcnt lgkmcnt(8)
  v_mfma_f32_16x16x32_bf16 v[160:163], a[32:35], v[64:67], v[160:163]
  s_waitcnt vmcnt(12)
  s_waitcnt lgkmcnt(0)
  s_barrier
  ds_read_b64_tr_b16 a[0:1], v24 offset:32768
  v_mfma_f32_16x16x32_bf16 v[168:171], a[32:35], v[68:71], v[168:171]
  ds_read_b64_tr_b16 a[2:3], v24 offset:33024
  v_cvt_pk_bf16_f32 v75, v10, v11
  v_lshlrev_b32 v8, 16, v76
  v_mfma_f32_16x16x32_bf16 v[164:167], a[36:39], v[64:67], v[164:167]
  s_add_u32 m0, s69, 114688
  s_mov_b32 s72, 32768
  ds_read_b64_tr_b16 a[4:5], v25 offset:32768
  ds_read_b64_tr_b16 a[6:7], v25 offset:33024
  v_mfma_f32_16x16x32_bf16 v[172:175], a[36:39], v[68:71], v[172:175]
  buffer_load_dwordx4 v224, s[40:43], s72 offen offset:0 lds
  v_mfma_f32_16x16x32_bf16 v[176:179], a[40:43], v[64:67], v[176:179]
  ds_read_b64_tr_b16 a[8:9], v24 offset:33792
  v_and_b32 v9, 0xffff0000, v76
  v_fma_f32 v8, v8, v246, v247
  v_mfma_f32_16x16x32_bf16 v[184:187], a[40:43], v[68:71], v[184:187]
  ds_read_b64_tr_b16 a[10:11], v24 offset:34048
  v_fma_f32 v9, v9, v246, v247
  v_cvt_pk_bf16_f32 v76, v8, v9
  v_mfma_f32_16x16x32_bf16 v[180:183], a[44:47], v[64:67], v[180:183]
  ds_read_b64_tr_b16 a[12:13], v25 offset:33792
  ds_read_b64_tr_b16 a[14:15], v25 offset:34048
  v_lshlrev_b32 v10, 16, v77
  v_mfma_f32_16x16x32_bf16 v[188:191], a[44:47], v[68:71], v[188:191]
  buffer_load_dwordx4 v225, s[40:43], s72 offen offset:1024 lds
  v_mfma_f32_16x16x32_bf16 v[192:195], a[48:51], v[64:67], v[192:195]
  ds_read_b64_tr_b16 a[16:17], v24 offset:34816
  v_and_b32 v11, 0xffff0000, v77
  v_fma_f32 v10, v10, v246, v247
  v_mfma_f32_16x16x32_bf16 v[200:203], a[48:51], v[68:71], v[200:203]
  ds_read_b64_tr_b16 a[18:19], v24 offset:35072
  v_fma_f32 v11, v11, v246, v247
  v_cvt_pk_bf16_f32 v77, v10, v11
  v_mfma_f32_16x16x32_bf16 v[196:199], a[52:55], v[64:67], v[196:199]
  ds_read_b64_tr_b16 a[20:21], v25 offset:34816
  ds_read_b64_tr_b16 a[22:23], v25 offset:35072
  v_lshlrev_b32 v8, 16, v78
  v_and_b32 v9, 0xffff0000, v78
  v_mfma_f32_16x16x32_bf16 v[204:207], a[52:55], v[68:71], v[204:207]
  buffer_load_dwordx4 v226, s[40:43], s72 offen offset:2048 lds
  v_mfma_f32_16x16x32_bf16 v[208:211], a[56:59], v[64:67], v[208:211]
  ds_read_b64_tr_b16 a[24:25], v24 offset:35840
  v_fma_f32 v8, v8, v246, v247
  v_fma_f32 v9, v9, v246, v247
  v_cvt_pk_bf16_f32 v78, v8, v9
  v_mfma_f32_16x16x32_bf16 v[216:219], a[56:59], v[68:71], v[216:219]
  ds_read_b64_tr_b16 a[26:27], v24 offset:36096
  v_lshlrev_b32 v10, 16, v79
  v_and_b32 v11, 0xffff0000, v79
  v_fma_f32 v10, v10, v246, v247
  v_mfma_f32_16x16x32_bf16 v[212:215], a[60:63], v[64:67], v[212:215]
  ds_read_b64_tr_b16 a[28:29], v25 offset:35840
  ds_read_b64_tr_b16 a[30:31], v25 offset:36096
  v_fma_f32 v11, v11, v246, v247
  v_cvt_pk_bf16_f32 v79, v10, v11
  v_mfma_f32_16x16x32_bf16 v[220:223], a[60:63], v[68:71], v[220:223]
  buffer_load_dwordx4 v227, s[40:43], s72 offen offset:3072 lds
  s_waitcnt lgkmcnt(8)
  v_mfma_f32_16x16x32_bf16 v[96:99], a[0:3], v[72:75], v[96:99]
  ds_read_b64_tr_b16 a[32:33], v24 offset:36864
  ds_read_b64_tr_b16 a[34:35], v24 offset:37120
  v_accvgpr_write_b32 a254, v246
  v_mfma_f32_16x16x32_bf16 v[104:107], a[0:3], v[76:79], v[104:107]
  ds_read_b64_tr_b16 a[36:37], v25 offset:36864
  ds_read_b64_tr_b16 a[38:39], v25 offset:37120
  v_accvgpr_write_b32 a255, v247
  v_mfma_f32_16x16x32_bf16 v[100:103], a[4:7], v[72:75], v[100:103]
  s_add_u32 m0, s69, 0
  s_mov_b32 s72, 16384
  ds_read_b64_tr_b16 a[40:41], v24 offset:37888
  ds_read_b64_tr_b16 a[42:43], v24 offset:38144
  v_mfma_f32_16x16x32_bf16 v[108:111], a[4:7], v[76:79], v[108:111]
  buffer_load_dwordx4 v228, s[44:47], s72 offen offset:0 lds
  v_mfma_f32_16x16x32_bf16 v[112:115], a[8:11], v[72:75], v[112:115]
  ds_read_b64_tr_b16 a[44:45], v25 offset:37888
  ds_read_b64_tr_b16 a[46:47], v25 offset:38144
  v_mfma_f32_16x16x32_bf16 v[120:123], a[8:11], v[76:79], v[120:123]
  ds_read_b64_tr_b16 a[48:49], v24 offset:38912
  ds_read_b64_tr_b16 a[50:51], v24 offset:39168
  v_mfma_f32_16x16x32_bf16 v[116:119], a[12:15], v[72:75], v[116:119]
  ds_read_b64_tr_b16 a[52:53], v25 offset:38912
  ds_read_b64_tr_b16 a[54:55], v25 offset:39168
  v_cvt_pk_bf16_f32 v0, v96, v97
  v_mfma_f32_16x16x32_bf16 v[124:127], a[12:15], v[76:79], v[124:127]
  buffer_load_dwordx4 v229, s[44:47], s72 offen offset:1024 lds
  s_waitcnt lgkmcnt(12)
  v_mfma_f32_16x16x32_bf16 v[128:131], a[16:19], v[72:75], v[128:131]
  ds_read_b64_tr_b16 a[56:57], v24 offset:39936
  ds_read_b64_tr_b16 a[58:59], v24 offset:40192
  v_cvt_pk_bf16_f32 v2, v100, v101
  v_mfma_f32_16x16x32_bf16 v[136:139], a[16:19], v[76:79], v[136:139]
  ds_read_b64_tr_b16 a[60:61], v25 offset:39936
  ds_read_b64_tr_b16 a[62:63], v25 offset:40192
  v_cvt_pk_bf16_f32 v1, v98, v99
  v_mfma_f32_16x16x32_bf16 v[132:135], a[20:23], v[72:75], v[132:135]
  v_cvt_pk_bf16_f32 v3, v102, v103
  v_cvt_pk_bf16_f32 v4, v104, v105
  v_permlane16_swap_b32 v0, v2
  v_cvt_pk_bf16_f32 v8, v112, v113
  v_mfma_f32_16x16x32_bf16 v[140:143], a[20:23], v[76:79], v[140:143]
  buffer_load_dwordx4 v230, s[44:47], s72 offen offset:2048 lds
  v_cvt_pk_bf16_f32 v10, v116, v117
  v_mfma_f32_16x16x32_bf16 v[144:147], a[24:27], v[72:75], v[144:147]
  v_cvt_pk_bf16_f32 v6, v108, v109
  v_permlane16_swap_b32 v1, v3
  v_cvt_pk_bf16_f32 v5, v106, v107
  v_cvt_pk_bf16_f32 v9, v114, v115
  v_mfma_f32_16x16x32_bf16 v[152:155], a[24:27], v[76:79], v[152:155]
  v_cvt_pk_bf16_f32 v7, v110, v111
  v_permlane16_swap_b32 v4, v6
  s_nop 0
  v_permlane16_swap_b32 v5, v7
  v_cvt_pk_bf16_f32 v11, v118, v119
  v_mfma_f32_16x16x32_bf16 v[148:151], a[28:31], v[72:75], v[148:151]
  v_cvt_pk_bf16_f32 v12, v120, v121
  v_permlane16_swap_b32 v8, v10
  v_cvt_pk_bf16_f32 v14, v124, v125
  v_permlane16_swap_b32 v9, v11
  v_mfma_f32_16x16x32_bf16 v[156:159], a[28:31], v[76:79], v[156:159]
  buffer_load_dwordx4 v231, s[44:47], s72 offen offset:3072 lds
  s_waitcnt lgkmcnt(8)
  v_mfma_f32_16x16x32_bf16 v[160:163], a[32:35], v[72:75], v[160:163]
  s_waitcnt vmcnt(12)
  s_waitcnt lgkmcnt(0)
  s_barrier
  ds_read_b128 a[0:3], v241 offset:0
  v_mfma_f32_16x16x32_bf16 v[168:171], a[32:35], v[76:79], v[168:171]
  v_cvt_pk_bf16_f32 v13, v122, v123
  v_cvt_pk_bf16_f32 v15, v126, v127
  v_permlane16_swap_b32 v12, v14
  s_nop 0
  v_permlane16_swap_b32 v13, v15
  v_mfma_f32_16x16x32_bf16 v[164:167], a[36:39], v[72:75], v[164:167]
  s_add_u32 m0, s69, 16384
  s_mov_b32 s72, 49152
  ds_read_b128 a[4:7], v241 offset:8192
  v_cvt_pk_bf16_f32 v16, v128, v129
  v_mfma_f32_16x16x32_bf16 v[172:175], a[36:39], v[76:79], v[172:175]
  buffer_load_dwordx4 v224, s[40:43], s72 offen offset:0 lds
  v_cvt_pk_bf16_f32 v18, v132, v133
  v_cvt_pk_bf16_f32 v17, v130, v131
  v_mfma_f32_16x16x32_bf16 v[176:179], a[40:43], v[72:75], v[176:179]
  ds_read_b128 a[8:11], v241 offset:1024
  v_cvt_pk_bf16_f32 v19, v134, v135
  v_cvt_pk_bf16_f32 v20, v136, v137
  v_permlane16_swap_b32 v16, v18
  v_cvt_pk_bf16_f32 v22, v140, v141
  v_mfma_f32_16x16x32_bf16 v[184:187], a[40:43], v[76:79], v[184:187]
  v_permlane16_swap_b32 v17, v19
  v_cvt_pk_bf16_f32 v21, v138, v139
  v_cvt_pk_bf16_f32 v23, v142, v143
  v_permlane16_swap_b32 v20, v22
  s_nop 0
  v_permlane16_swap_b32 v21, v23
  v_mfma_f32_16x16x32_bf16 v[180:183], a[44:47], v[72:75], v[180:183]
  ds_read_b128 a[12:15], v241 offset:9216
  v_cvt_pk_bf16_f32 v24, v144, v145
  v_cvt_pk_bf16_f32 v26, v148, v149
  v_cvt_pk_bf16_f32 v25, v146, v147
  v_mfma_f32_16x16x32_bf16 v[188:191], a[44:47], v[76:79], v[188:191]
  buffer_load_dwordx4 v225, s[40:43], s72 offen offset:1024 lds
  v_mfma_f32_16x16x32_bf16 v[192:195], a[48:51], v[72:75], v[192:195]
  ds_read_b128 a[16:19], v241 offset:2048
  v_cvt_pk_bf16_f32 v27, v150, v151
  v_cvt_pk_bf16_f32 v28, v152, v153
  v_permlane16_swap_b32 v24, v26
  v_cvt_pk_bf16_f32 v30, v156, v157
  v_mfma_f32_16x16x32_bf16 v[200:203], a[48:51], v[76:79], v[200:203]
  v_permlane16_swap_b32 v25, v27
  v_cvt_pk_bf16_f32 v29, v154, v155
  v_cvt_pk_bf16_f32 v31, v158, v159
  v_permlane16_swap_b32 v28, v30
  s_nop 0
  v_permlane16_swap_b32 v29, v31
  v_mfma_f32_16x16x32_bf16 v[196:199], a[52:55], v[72:75], v[196:199]
  ds_read_b128 a[20:23], v241 offset:10240
  v_cvt_pk_bf16_f32 v160, v160, v161
  v_cvt_pk_bf16_f32 v164, v164, v165
  v_cvt_pk_bf16_f32 v162, v162, v163
  v_mfma_f32_16x16x32_bf16 v[204:207], a[52:55], v[76:79], v[204:207]
  buffer_load_dwordx4 v226, s[40:43], s72 offen offset:2048 lds
  v_cvt_pk_bf16_f32 v166, v166, v167
  v_mfma_f32_16x16x32_bf16 v[208:211], a[56:59], v[72:75], v[208:211]
  ds_read_b128 a[24:27], v241 offset:3072
  v_cvt_pk_bf16_f32 v168, v168, v169
  v_permlane16_swap_b32 v160, v164
  v_cvt_pk_bf16_f32 v172, v172, v173
  v_mfma_f32_16x16x32_bf16 v[216:219], a[56:59], v[76:79], v[216:219]
  v_permlane16_swap_b32 v162, v166
  v_cvt_pk_bf16_f32 v170, v170, v171
  v_accvgpr_write_b32 a64, v160
  v_cvt_pk_bf16_f32 v174, v174, v175
  v_mfma_f32_16x16x32_bf16 v[212:215], a[60:63], v[72:75], v[212:215]
  ds_read_b128 a[28:31], v241 offset:11264
  v_accvgpr_write_b32 a66, v164
  v_permlane16_swap_b32 v168, v172
  v_accvgpr_write_b32 a65, v162
  v_mfma_f32_16x16x32_bf16 v[220:223], a[60:63], v[76:79], v[220:223]
  buffer_load_dwordx4 v227, s[40:43], s72 offen offset:3072 lds
L_s0:
  s_waitcnt lgkmcnt(4)
  v_mfma_f32_16x16x32_bf16 v[32:35], a[0:3], v[0:3], 0
  ds_read_b128 a[32:35], v241 offset:4096
  v_accvgpr_write_b32 a67, v166
  v_permlane16_swap_b32 v170, v174
  v_accvgpr_write_b32 a68, v168
  v_mfma_f32_16x16x32_bf16 v[40:43], a[0:3], v[4:7], 0
  v_accvgpr_write_b32 a70, v172
  v_accvgpr_write_b32 a69, v170
  v_accvgpr_write_b32 a71, v174
  v_cvt_pk_bf16_f32 v176, v176, v177
  v_mfma_f32_16x16x32_bf16 v[36:39], a[4:7], v[0:3], 0
  s_add_u32 m0, s69, 32768
  s_mov_b32 s72, 32768
  ds_read_b128 a[36:39], v241 offset:12288
  v_cvt_pk_bf16_f32 v180, v180, v181
  v_mfma_f32_16x16x32_bf16 v[44:47], a[4:7], v[4:7], 0
  buffer_load_dwordx4 v228, s[44:47], s72 offen offset:0 lds
  v_cvt_pk_bf16_f32 v178, v178, v179
  v_mfma_f32_16x16x32_bf16 v[32:35], a[8:11], v[8:11], v[32:35]
  ds_read_b128 a[40:43], v241 offset:5120
  v_cvt_pk_bf16_f32 v182, v182, v183
  v_cvt_pk_bf16_f32 v184, v184, v185
  v_permlane16_swap_b32 v176, v180
  v_mfma_f32_16x16x32_bf16 v[40:43], a[8:11], v[12:15], v[40:43]
  v_cvt_pk_bf16_f32 v188, v188, v189
  v_permlane16_swap_b32 v178, v182
  v_cvt_pk_bf16_f32 v186, v186, v187
  v_accvgpr_write_b32 a72, v176
  v_mfma_f32_16x16x32_bf16 v[36:39], a[12:15], v[8:11], v[36:39]
  ds_read_b128 a[44:47], v241 offset:13312
  v_cvt_pk_bf16_f32 v190, v190, v191
  v_accvgpr_write_b32 a74, v180
  v_permlane16_swap_b32 v184, v188
  v_mfma_f32_16x16x32_bf16 v[44:47], a[12:15], v[12:15], v[44:47]
  buffer_load_dwordx4 v229, s[44:47], s72 offen offset:1024 lds
  s_waitcnt lgkmcnt(4)
  v_mfma_f32_16x16x32_bf16 v[32:35], a[16:19], v[16:19], v[32:35]
  ds_read_b128 a[48:51], v241 offset:6144
  v_accvgpr_write_b32 a73, v178
  v_accvgpr_write_b32 a75, v182
  v_permlane16_swap_b32 v186, v190
  v_mfma_f32_16x16x32_bf16 v[40:43], a[16:19], v[20:23], v[40:43]
  v_accvgpr_write_b32 a76, v184
  v_accvgpr_write_b32 a78, v188
  v_accvgpr_write_b32 a77, v186
  v_accvgpr_write_b32 a79, v190
  v_mfma_f32_16x16x32_bf16 v[36:39], a[20:23], v[16:19], v[36:39]
  ds_read_b128 a[52:55], v241 offset:14336
  v_cvt_pk_bf16_f32 v192, v192, v193
  v_cvt_pk_bf16_f32 v196, v196, v197
  v_cvt_pk_bf16_f32 v194, v194, v195
  v_mfma_f32_16x16x32_bf16 v[44:47], a[20:23], v[20:23], v[44:47]
  buffer_load_dwordx4 v230, s[44:47], s72 offen offset:2048 lds
  v_cvt_pk_bf16_f32 v198, v198, v199
  v_mfma_f32_16x16x32_bf16 v[32:35], a[24:27], v[24:27], v[32:35]
  ds_read_b128 a[56:59], v241 offset:7168
  v_cvt_pk_bf16_f32 v200, v200, v201
  v_permlane16_swap_b32 v192, v196
  v_cvt_pk_bf16_f32 v204, v204, v205
  v_mfma_f32_16x16x32_bf16 v[40:43], a[24:27], v[28:31], v[40:43]
  v_permlane16_swap_b32 v194, v198
  v_cvt_pk_bf16_f32 v202, v202, v203
  v_accvgpr_write_b32 a80, v192
  v_cvt_pk_bf16_f32 v206, v206, v207
  v_mfma_f32_16x16x32_bf16 v[36:39], a[28:31], v[24:27], v[36:39]
  ds_read_b128 a[60:63], v241 offset:15360
  v_accvgpr_write_b32 a82, v196
  v_permlane16_swap_b32 v200, v204
  v_accvgpr_write_b32 a81, v194
  v_mfma_f32_16x16x32_bf16 v[44:47], a[28:31], v[28:31], v[44:47]
  buffer_load_dwordx4 v231, s[44:47], s72 offen offset:3072 lds
  s_waitcnt lgkmcnt(4)
  v_mfma_f32_16x16x32_bf16 v[32:35], a[32:35], a[64:67], v[32:35]
  ds_read_b128 a[0:3], v241 offset:16384
  v_accvgpr_write_b32 a83, v198
  v_permlane16_swap_b32 v202, v206
  v_accvgpr_write_b32 a84, v200
  v_mfma_f32_16x16x32_bf16 v[40:43], a[32:35], a[68:71], v[40:43]
  v_accvgpr_write_b32 a86, v204
  v_accvgpr_write_b32 a85, v202
  v_accvgpr_write_b32 a87, v206
  v_cvt_pk_bf16_f32 v208, v208, v209
  v_mfma_f32_16x16x32_bf16 v[36:39], a[36:39], a[64:67], v[36:39]
  s_add_u32 m0, s69, 49152
  s_mov_b32 s72, 65536
  ds_read_b128 a[4:7], v241 offset:24576
  v_cvt_pk_bf16_f32 v212, v212, v213
  v_mfma_f32_16x16x32_bf16 v[44:47], a[36:39], a[68:71], v[44:47]
  buffer_load_dwordx4 v224, s[40:43], s72 offen offset:0 lds
  v_cvt_pk_bf16_f32 v210, v210, v211
  v_mfma_f32_16x16x32_bf16 v[32:35], a[40:43], a[72:75], v[32:35]
  ds_read_b128 a[8:11], v241 offset:17408
  v_cvt_pk_bf16_f32 v214, v214, v215
  v_cvt_pk_bf16_f32 v216, v216, v217
  v_permlane16_swap_b32 v208, v212
  v_mfma_f32_16x16x32_bf16 v[40:43], a[40:43], a[76:79], v[40:43]
  v_cvt_pk_bf16_f32 v220, v220, v221
  v_permlane16_swap_b32 v210, v214
  v_cvt_pk_bf16_f32 v218, v218, v219
  v_accvgpr_write_b32 a88, v208
  v_mfma_f32_16x16x32_bf16 v[36:39], a[44:47], a[72:75], v[36:39]
  ds_read_b128 a[12:15], v241 offset:25600
  v_cvt_pk_bf16_f32 v222, v222, v223
  v_accvgpr_write_b32 a90, v212
  v_permlane16_swap_b32 v216, v220
  v_mfma_f32_16x16x32_bf16 v[44:47], a[44:47], a[76:79], v[44:47]
  buffer_load_dwordx4 v225, s[40:43], s72 offen offset:1024 lds
  s_waitcnt lgkmcnt(4)
  v_mfma_f32_16x16x32_bf16 v[32:35], a[48:51], a[80:83], v[32:35]
  ds_read_b128 a[16:19], v241 offset:18432
  v_accvgpr_write_b32 a89, v210
  v_accvgpr_write_b32 a91, v214
  v_permlane16_swap_b32 v218, v222
  v_mfma_f32_16x16x32_bf16 v[40:43], a[48:51], a[84:87], v[40:43]
  v_accvgpr_write_b32 a92, v216
  v_accvgpr_write_b32 a94, v220
  v_accvgpr_write_b32 a93, v218
  v_accvgpr_write_b32 a95, v222
  v_mfma_f32_16x16x32_bf16 v[36:39], a[52:55], a[80:83], v[36:39]
  ds_read_b128 a[20:23], v241 offset:26624
  v_mfma_f32_16x16x32_bf16 v[44:47], a[52:55], a[84:87], v[44:47]
  buffer_load_dwordx4 v226, s[40:43], s72 offen offset:2048 lds
  v_mfma_f32_16x16x32_bf16 v[32:35], a[56:59], a[88:91], v[32:35]
  ds_read_b128 a[24:27], v241 offset:19456
  v_mfma_f32_16x16x32_bf16 v[40:43], a[56:59], a[92:95], v[40:43]
  v_mov_b64 v[64:65], 0
  v_mfma_f32_16x16x32_bf16 v[36:39], a[60:63], a[88:91], v[36:39]
  ds_read_b128 a[28:31], v241 offset:27648
  v_mfma_f32_16x16x32_bf16 v[44:47], a[60:63], a[92:95], v[44:47]
  buffer_load_dwordx4 v227, s[40:43], s72 offen offset:3072 lds
  s_waitcnt lgkmcnt(4)
  v_mfma_f32_16x16x32_bf16 v[48:51], a[0:3], v[0:3], 0
  ds_read_b128 a[32:35], v241 offset:20480
  v_mfma_f32_16x16x32_bf16 v[56:59], a[0:3], v[4:7], 0
  v_mov_b64 v[66:67], 0
  v_mov_b64 v[68:69], 0
  v_mfma_f32_16x16x32_bf16 v[52:55], a[4:7], v[0:3], 0
  ds_read_b128 a[36:39], v241 offset:28672
  v_exp_f32 v242, v32
  v_mfma_f32_16x16x32_bf16 v[60:63], a[4:7], v[4:7], 0
  v_mov_b64 v[70:71], 0
  v_mov_b64 v[246:247], 0
  v_exp_f32 v243, v33
  v_mfma_f32_16x16x32_bf16 v[48:51], a[8:11], v[8:11], v[48:51]
  ds_read_b128 a[40:43], v241 offset:21504
  v_exp_f32 v244, v34
  v_mfma_f32_16x16x32_bf16 v[56:59], a[8:11], v[12:15], v[56:59]
  v_add_f32 v72, v242, v243
  v_max3_f32 v248, v32, v33, v34
  v_exp_f32 v245, v35
  v_mfma_f32_16x16x32_bf16 v[52:55], a[12:15], v[8:11], v[52:55]
  ds_read_b128 a[44:47], v241 offset:29696
  v_cvt_pk_bf16_f32 v80, v242, v243
  v_exp_f32 v242, v36
  v_mfma_f32_16x16x32_bf16 v[60:63], a[12:15], v[12:15], v[60:63]
  v_add_f32 v72, v72, v244
  v_max3_f32 v248, v248, v35, v36
  s_waitcnt lgkmcnt(4)
  v_mfma_f32_16x16x32_bf16 v[48:51], a[16:19], v[16:19], v[48:51]
  s_waitcnt vmcnt(16)
  s_barrier
  ds_read_b128 a[48:51], v241 offset:22528
  v_mfma_f32_16x16x32_bf16 v[56:59], a[16:19], v[20:23], v[56:59]
  v_add_f32 v72, v72, v245
  v_exp_f32 v243, v37
  v_cvt_pk_bf16_f32 v81, v244, v245
  v_mfma_f32_16x16x32_bf16 v[52:55], a[20:23], v[16:19], v[52:55]
  s_add_u32 m0, s69, 65536
  s_mov_b32 s72, 49152
  ds_read_b128 a[52:55], v241 offset:30720
  v_mfma_f32_16x16x32_bf16 v[60:63], a[20:23], v[20:23], v[60:63]
  buffer_load_dwordx4 v228, s[44:47], s72 offen offset:0 lds
  v_mfma_f32_16x16x32_bf16 v[48:51], a[24:27], v[24:27], v[48:51]
  ds_read_b128 a[56:59], v241 offset:23552
  v_exp_f32 v244, v38
  v_max3_f32 v248, v248, v37, v38
  v_mfma_f32_16x16x32_bf16 v[56:59], a[24:27], v[28:31], v[56:59]
  v_add_f32 v72, v72, v242
  v_add_f32 v72, v72, v243
  v_exp_f32 v245, v39
  v_mfma_f32_16x16x32_bf16 v[52:55], a[28:31], v[24:27], v[52:55]
  ds_read_b128 a[60:63], v241 offset:31744
  v_cvt_pk_bf16_f32 v82, v242, v243
  v_max_f32 v248, v248, v39
  v_mfma_f32_16x16x32_bf16 v[60:63], a[28:31], v[28:31], v[60:63]
  buffer_load_dwordx4 v229, s[44:47], s72 offen offset:1024 lds
  s_waitcnt lgkmcnt(4)
  v_mfma_f32_16x16x32_bf16 v[48:51], a[32:35], a[64:67], v[48:51]
  ds_read_b64_tr_b16 a[0:1], v234 offset:32768
  v_exp_f32 v242, v40
  v_add_f32 v72, v72, v244
  v_mfma_f32_16x16x32_bf16 v[56:59], a[32:35], a[68:71], v[56:59]
  ds_read_b64_tr_b16 a[2:3], v234 offset:40960
  v_add_f32 v72, v72, v245
  v_exp_f32 v243, v41
  v_mfma_f32_16x16x32_bf16 v[52:55], a[36:39], a[64:67], v[52:55]
  ds_read_b64_tr_b16 a[4:5], v235 offset:32768
  ds_read_b64_tr_b16 a[6:7], v235 offset:40960
  v_max3_f32 v74, v40, v41, v42
  v_mfma_f32_16x16x32_bf16 v[60:63], a[36:39], a[68:71], v[60:63]
  buffer_load_dwordx4 v230, s[44:47], s72 offen offset:2048 lds
  v_mfma_f32_16x16x32_bf16 v[48:51], a[40:43], a[72:75], v[48:51]
  ds_read_b64_tr_b16 a[8:9], v234 offset:33792
  v_cvt_pk_bf16_f32 v83, v244, v245
  v_exp_f32 v244, v42
  v_mfma_f32_16x16x32_bf16 v[56:59], a[40:43], a[76:79], v[56:59]
  ds_read_b64_tr_b16 a[10:11], v234 offset:41984
  v_add_f32 v73, v242, v243
  v_exp_f32 v245, v43
  v_mfma_f32_16x16x32_bf16 v[52:55], a[44:47], a[72:75], v[52:55]
  ds_read_b64_tr_b16 a[12:13], v235 offset:33792
  ds_read_b64_tr_b16 a[14:15], v235 offset:41984
  v_max3_f32 v74, v74, v43, v44
  v_mfma_f32_16x16x32_bf16 v[60:63], a[44:47], a[76:79], v[60:63]
  buffer_load_dwordx4 v231, s[44:47], s72 offen offset:3072 lds
  s_waitcnt lgkmcnt(8)
  v_mfma_f32_16x16x32_bf16 v[48:51], a[48:51], a[80:83], v[48:51]
  ds_read_b64_tr_b16 a[16:17], v234 offset:34816
  v_cvt_pk_bf16_f32 v84, v242, v243
  v_exp_f32 v242, v44
  v_mfma_f32_16x16x32_bf16 v[56:59], a[48:51], a[84:87], v[56:59]
  ds_read_b64_tr_b16 a[18:19], v234 offset:43008
  v_add_f32 v73, v73, v244
  v_add_f32 v73, v73, v245
  v_mfma_f32_16x16x32_bf16 v[52:55], a[52:55], a[80:83], v[52:55]
  ds_read_b64_tr_b16 a[20:21], v235 offset:34816
  v_max3_f32 v74, v74, v45, v46
  v_exp_f32 v243, v45
  v_mfma_f32_16x16x32_bf16 v[60:63], a[52:55], a[84:87], v[60:63]
  ds_read_b64_tr_b16 a[22:23], v235 offset:43008
  v_cvt_pk_bf16_f32 v85, v244, v245
  v_exp_f32 v244, v46
  v_mfma_f32_16x16x32_bf16 v[48:51], a[56:59], a[88:91], v[48:51]
  ds_read_b64_tr_b16 a[24:25], v234 offset:35840
  v_add_f32 v73, v73, v242
  v_max_f32 v74, v74, v47
  v_add_f32 v73, v73, v243
  v_mfma_f32_16x16x32_bf16 v[56:59], a[56:59], a[92:95], v[56:59]
  ds_read_b64_tr_b16 a[26:27], v234 offset:44032
  v_exp_f32 v245, v47
  v_cvt_pk_bf16_f32 v86, v242, v243
  v_mfma_f32_16x16x32_bf16 v[52:55], a[60:63], a[88:91], v[52:55]
  ds_read_b64_tr_b16 a[28:29], v235 offset:35840
  v_add_f32 v73, v73, v244
  v_add_f32 v73, v73, v245
  v_cvt_pk_bf16_f32 v87, v244, v245
  v_mfma_f32_16x16x32_bf16 v[60:63], a[60:63], a[92:95], v[60:63]
  ds_read_b64_tr_b16 a[30:31], v235 offset:44032
  s_mov_b32 s87, 0x41800000
  v_max_f32_e64 v248, |v248|, |v74|
  v_cmp_lt_f32 vcc, s87, v248
  s_nop 0
  s_cbranch_vccnz L_st15
L_rt15:
L_fl:
  s_waitcnt lgkmcnt(8)
  v_mfma_f32_16x16x32_bf16 v[96:99], a[0:3], v[80:83], 0
  ds_read_b64_tr_b16 a[32:33], v234 offset:36864
  ds_read_b64_tr_b16 a[34:35], v234 offset:45056
  v_add_f32 v246, v246, v72
  v_add_f32 v247, v247, v73
  v_mfma_f32_16x16x32_bf16 v[104:107], a[0:3], v[84:87], 0
  s_mov_b32 s0, 0
  buffer_load_dword a252, v236, s[60:63], s0 offen
  v_mfma_f32_16x16x32_bf16 v[100:103], a[4:7], v[80:83], 0
  ds_read_b64_tr_b16 a[36:37], v235 offset:36864
  v_exp_f32 v242, v48
  v_mfma_f32_16x16x32_bf16 v[108:111], a[4:7], v[84:87], 0
  ds_read_b64_tr_b16 a[38:39], v235 offset:45056
  v_exp_f32 v243, v49
  v_mfma_f32_16x16x32_bf16 v[112:115], a[8:11], v[80:83], 0
  ds_read_b64_tr_b16 a[40:41], v234 offset:37888
  ds_read_b64_tr_b16 a[42:43], v234 offset:46080
  v_lshlrev_b32 v209, 2, v251
  v_mfma_f32_16x16x32_bf16 v[120:123], a[8:11], v[84:87], 0
  s_mov_b32 s0, 0
  buffer_load_dword a252, v236, s[64:67], s0 offen
  v_mfma_f32_16x16x32_bf16 v[116:119], a[12:15], v[80:83], 0
  ds_read_b64_tr_b16 a[44:45], v235 offset:37888
  v_exp_f32 v244, v50
  v_mfma_f32_16x16x32_bf16 v[124:127], a[12:15], v[84:87], 0
  ds_read_b64_tr_b16 a[46:47], v235 offset:46080
  s_mul_i32 s87, s70, 458752
  s_waitcnt lgkmcnt(8)
  v_mfma_f32_16x16x32_bf16 v[128:131], a[16:19], v[80:83], 0
  ds_read_b64_tr_b16 a[48:49], v234 offset:38912
  v_add_f32 v72, v242, v243
  v_mfma_f32_16x16x32_bf16 v[136:139], a[16:19], v[84:87], 0
  ds_read_b64_tr_b16 a[50:51], v234 offset:47104
  v_exp_f32 v245, v51
  v_mfma_f32_16x16x32_bf16 v[132:135], a[20:23], v[80:83], 0
  ds_read_b64_tr_b16 a[52:53], v235 offset:38912
  v_cvt_pk_bf16_f32 v88, v242, v243
  v_mfma_f32_16x16x32_bf16 v[140:143], a[20:23], v[84:87], 0
  ds_read_b64_tr_b16 a[54:55], v235 offset:47104
  v_exp_f32 v242, v52
  v_mfma_f32_16x16x32_bf16 v[144:147], a[24:27], v[80:83], 0
  ds_read_b64_tr_b16 a[56:57], v234 offset:39936
  ds_read_b64_tr_b16 a[58:59], v234 offset:48128
  v_mfma_f32_16x16x32_bf16 v[152:155], a[24:27], v[84:87], 0
  buffer_load_dword v208, v209, s[56:59], 0 offen sc1
  v_mfma_f32_16x16x32_bf16 v[148:151], a[28:31], v[80:83], 0
  ds_read_b64_tr_b16 a[60:61], v235 offset:39936
  v_add_f32 v72, v72, v244
  v_mfma_f32_16x16x32_bf16 v[156:159], a[28:31], v[84:87], 0
  ds_read_b64_tr_b16 a[62:63], v235 offset:48128
  s_waitcnt lgkmcnt(8)
  v_mfma_f32_16x16x32_bf16 v[160:163], a[32:35], v[80:83], 0
  ds_read_b128 a[0:3], v241 offset:49152
  v_add_f32 v72, v72, v245
  v_mfma_f32_16x16x32_bf16 v[168:171], a[32:35], v[84:87], 0
  v_exp_f32 v243, v53
  v_mfma_f32_16x16x32_bf16 v[164:167], a[36:39], v[80:83], 0
  ds_read_b128 a[4:7], v241 offset:57344
  v_cvt_pk_bf16_f32 v89, v244, v245
  v_mfma_f32_16x16x32_bf16 v[172:175], a[36:39], v[84:87], 0
  v_exp_f32 v244, v54
  v_mfma_f32_16x16x32_bf16 v[176:179], a[40:43], v[80:83], 0
  ds_read_b128 a[8:11], v241 offset:50176
  s_add_u32 s36, s12, s87
  s_addc_u32 s37, s13, 0
  v_mfma_f32_16x16x32_bf16 v[184:187], a[40:43], v[84:87], 0
  v_add_f32 v72, v72, v242
  v_add_f32 v72, v72, v243
  v_mfma_f32_16x16x32_bf16 v[180:183], a[44:47], v[80:83], 0
  ds_read_b128 a[12:15], v241 offset:58368
  s_sub_u32 s36, s36, 3072
  s_subb_u32 s37, s37, 0
  v_mfma_f32_16x16x32_bf16 v[188:191], a[44:47], v[84:87], 0
  s_and_b32 s37, s37, 0xffff
  s_waitcnt lgkmcnt(4)
  v_mfma_f32_16x16x32_bf16 v[192:195], a[48:51], v[80:83], 0
  ds_read_b128 a[16:19], v241 offset:51200
  s_mov_b32 s38, 461824
  s_mov_b32 s39, 0x20000
  v_mfma_f32_16x16x32_bf16 v[200:203], a[48:51], v[84:87], 0
  v_exp_f32 v245, v55
  v_mfma_f32_16x16x32_bf16 v[196:199], a[52:55], v[80:83], 0
  ds_read_b128 a[20:23], v241 offset:59392
  v_cvt_pk_bf16_f32 v90, v242, v243
  v_mfma_f32_16x16x32_bf16 v[204:207], a[52:55], v[84:87], 0
  v_exp_f32 v242, v56
  v_mfma_f32_16x16x32_bf16 a[96:99], a[56:59], v[80:83], 0
  ds_read_b128 a[24:27], v241 offset:52224
  v_add_f32 v72, v72, v244
  v_mfma_f32_16x16x32_bf16 a[104:107], a[56:59], v[84:87], 0
  v_add_f32 v72, v72, v245
  v_exp_f32 v243, v57
  v_mfma_f32_16x16x32_bf16 a[100:103], a[60:63], v[80:83], 0
  ds_read_b128 a[28:31], v241 offset:60416
  v_cvt_pk_bf16_f32 v91, v244, v245
  v_mfma_f32_16x16x32_bf16 a[108:111], a[60:63], v[84:87], 0
  v_mul_u32_u24 v222, 3584, v251
  s_lshl_b32 s87, s14, 4
  s_waitcnt lgkmcnt(4)
  v_mfma_f32_16x16x32_bf16 v[32:35], a[0:3], v[0:3], v[64:67]
  ds_read_b128 a[32:35], v241 offset:53248
  v_add_u32 v222, s87, v222
  s_mul_i32 s96, s68, 229376
  v_mfma_f32_16x16x32_bf16 v[40:43], a[0:3], v[4:7], v[68:71]
  v_exp_f32 v244, v58
  v_mfma_f32_16x16x32_bf16 v[36:39], a[4:7], v[0:3], v[64:67]
  ds_read_b128 a[36:39], v241 offset:61440
  v_add_f32 v73, v242, v243
  v_mfma_f32_16x16x32_bf16 v[44:47], a[4:7], v[4:7], v[68:71]
  v_exp_f32 v245, v59
  v_mfma_f32_16x16x32_bf16 v[32:35], a[8:11], v[8:11], v[32:35]
  ds_read_b128 a[40:43], v241 offset:54272
  v_cvt_pk_bf16_f32 v92, v242, v243
  v_mfma_f32_16x16x32_bf16 v[40:43], a[8:11], v[12:15], v[40:43]
  v_exp_f32 v242, v60
  v_mfma_f32_16x16x32_bf16 v[36:39], a[12:15], v[8:11], v[36:39]
  ds_read_b128 a[44:47], v241 offset:62464
  v_add_f32 v73, v73, v244
  v_mfma_f32_16x16x32_bf16 v[44:47], a[12:15], v[12:15], v[44:47]
  v_add_f32 v73, v73, v245
  s_waitcnt lgkmcnt(4)
  v_mfma_f32_16x16x32_bf16 v[32:35], a[16:19], v[16:19], v[32:35]
  s_waitcnt vmcnt(15)
  s_barrier
  ds_read_b128 a[48:51], v241 offset:55296
  v_mfma_f32_16x16x32_bf16 v[40:43], a[16:19], v[20:23], v[40:43]
  v_exp_f32 v243, v61
  v_mfma_f32_16x16x32_bf16 v[36:39], a[20:23], v[16:19], v[36:39]
  s_add_u32 m0, s69, 81920
  s_mov_b32 s72, 81920
  ds_read_b128 a[52:55], v241 offset:63488
  v_mfma_f32_16x16x32_bf16 v[44:47], a[20:23], v[20:23], v[44:47]
  buffer_load_dwordx4 v224, s[40:43], s72 offen offset:0 lds
  v_mfma_f32_16x16x32_bf16 v[32:35], a[24:27], v[24:27], v[32:35]
  ds_read_b128 a[56:59], v241 offset:56320
  v_cvt_pk_bf16_f32 v93, v244, v245
  v_mfma_f32_16x16x32_bf16 v[40:43], a[24:27], v[28:31], v[40:43]
  v_exp_f32 v244, v62
  v_mfma_f32_16x16x32_bf16 v[36:39], a[28:31], v[24:27], v[36:39]
  ds_read_b128 a[60:63], v241 offset:64512
  v_add_f32 v73, v73, v242
  v_mfma_f32_16x16x32_bf16 v[44:47], a[28:31], v[28:31], v[44:47]
  buffer_load_dwordx4 v225, s[40:43], s72 offen offset:1024 lds
  s_waitcnt lgkmcnt(4)
  v_mfma_f32_16x16x32_bf16 v[32:35], a[32:35], a[64:67], v[32:35]
  ds_read_b64_tr_b16 a[0:1], v232 offset:0
  v_add_f32 v73, v73, v243
  v_mfma_f32_16x16x32_bf16 v[40:43], a[32:35], a[68:71], v[40:43]
  ds_read_b64_tr_b16 a[2:3], v232 offset:8192
  v_exp_f32 v245, v63
  v_mfma_f32_16x16x32_bf16 v[36:39], a[36:39], a[64:67], v[36:39]
  ds_read_b64_tr_b16 a[4:5], v233 offset:0
  ds_read_b64_tr_b16 a[6:7], v233 offset:8192
  v_mfma_f32_16x16x32_bf16 v[44:47], a[36:39], a[68:71], v[44:47]
  buffer_load_dwordx4 v226, s[40:43], s72 offen offset:2048 lds
  v_mfma_f32_16x16x32_bf16 v[32:35], a[40:43], a[72:75], v[32:35]
  ds_read_b64_tr_b16 a[8:9], v232 offset:1024
  v_cvt_pk_bf16_f32 v94, v242, v243
  v_mfma_f32_16x16x32_bf16 v[40:43], a[40:43], a[76:79], v[40:43]
  ds_read_b64_tr_b16 a[10:11], v232 offset:9216
  v_add_f32 v73, v73, v244
  v_mfma_f32_16x16x32_bf16 v[36:39], a[44:47], a[72:75], v[36:39]
  ds_read_b64_tr_b16 a[12:13], v233 offset:1024
  ds_read_b64_tr_b16 a[14:15], v233 offset:9216
  v_mfma_f32_16x16x32_bf16 v[44:47], a[44:47], a[76:79], v[44:47]
  buffer_load_dwordx4 v227, s[40:43], s72 offen offset:3072 lds
  s_waitcnt lgkmcnt(8)
  v_mfma_f32_16x16x32_bf16 v[32:35], a[48:51], a[80:83], v[32:35]
  ds_read_b64_tr_b16 a[16:17], v232 offset:2048
  v_add_f32 v73, v73, v245
  v_mfma_f32_16x16x32_bf16 v[40:43], a[48:51], a[84:87], v[40:43]
  ds_read_b64_tr_b16 a[18:19], v232 offset:10240
  v_cvt_pk_bf16_f32 v95, v244, v245
  v_mfma_f32_16x16x32_bf16 v[36:39], a[52:55], a[80:83], v[36:39]
  s_add_u32 m0, s69, 98304
  s_mov_b32 s72, 65536
  ds_read_b64_tr_b16 a[20:21], v233 offset:2048
  ds_read_b64_tr_b16 a[22:23], v233 offset:10240
  v_mfma_f32_16x16x32_bf16 v[44:47], a[52:55], a[84:87], v[44:47]
  buffer_load_dwordx4 v228, s[44:47], s72 offen offset:0 lds
  v_mfma_f32_16x16x32_bf16 v[32:35], a[56:59], a[88:91], v[32:35]
  ds_read_b64_tr_b16 a[24:25], v232 offset:3072
  v_max_f32 v248, v72, v73
  v_mfma_f32_16x16x32_bf16 v[40:43], a[56:59], a[92:95], v[40:43]
  ds_read_b64_tr_b16 a[26:27], v232 offset:11264
  v_cmp_lt_f32 vcc, s73, v248
  v_mfma_f32_16x16x32_bf16 v[36:39], a[60:63], a[88:91], v[36:39]
  ds_read_b64_tr_b16 a[28:29], v233 offset:3072
  ds_read_b64_tr_b16 a[30:31], v233 offset:11264
  v_mfma_f32_16x16x32_bf16 v[44:47], a[60:63], a[92:95], v[44:47]
  buffer_load_dwordx4 v229, s[44:47], s72 offen offset:1024 lds
  s_cbranch_vccnz L_st17
L_rt17:
  s_waitcnt lgkmcnt(8)
  v_mfma_f32_16x16x32_bf16 v[96:99], a[0:3], v[88:91], v[96:99]
  ds_read_b64_tr_b16 a[32:33], v232 offset:4096
  v_add_f32 v246, v246, v72
  v_mfma_f32_16x16x32_bf16 v[104:107], a[0:3], v[92:95], v[104:107]
  ds_read_b64_tr_b16 a[34:35], v232 offset:12288
  v_add_f32 v247, v247, v73
  v_mfma_f32_16x16x32_bf16 v[100:103], a[4:7], v[88:91], v[100:103]
  ds_read_b64_tr_b16 a[36:37], v233 offset:4096
  ds_read_b64_tr_b16 a[38:39], v233 offset:12288
  v_mfma_f32_16x16x32_bf16 v[108:111], a[4:7], v[92:95], v[108:111]
  buffer_load_dwordx4 v230, s[44:47], s72 offen offset:2048 lds
  v_mfma_f32_16x16x32_bf16 v[112:115], a[8:11], v[88:91], v[112:115]
  ds_read_b64_tr_b16 a[40:41], v232 offset:5120
  v_exp_f32 v242, v32
  v_mfma_f32_16x16x32_bf16 v[120:123], a[8:11], v[92:95], v[120:123]
  ds_read_b64_tr_b16 a[42:43], v232 offset:13312
  v_exp_f32 v243, v33
  v_mfma_f32_16x16x32_bf16 v[116:119], a[12:15], v[88:91], v[116:119]
  ds_read_b64_tr_b16 a[44:45], v233 offset:5120
  ds_read_b64_tr_b16 a[46:47], v233 offset:13312
  v_mfma_f32_16x16x32_bf16 v[124:127], a[12:15], v[92:95], v[124:127]
  buffer_load_dwordx4 v231, s[44:47], s72 offen offset:3072 lds
  s_waitcnt lgkmcnt(8)
  v_mfma_f32_16x16x32_bf16 v[128:131], a[16:19], v[88:91], v[128:131]
  ds_read_b64_tr_b16 a[48:49], v232 offset:6144
  v_exp_f32 v244, v34
  v_mfma_f32_16x16x32_bf16 v[136:139], a[16:19], v[92:95], v[136:139]
  ds_read_b64_tr_b16 a[50:51], v232 offset:14336
  v_add_f32 v72, v242, v243
  v_mfma_f32_16x16x32_bf16 v[132:135], a[20:23], v[88:91], v[132:135]
  ds_read_b64_tr_b16 a[52:53], v233 offset:6144
  ds_read_b64_tr_b16 a[54:55], v233 offset:14336
  v_mfma_f32_16x16x32_bf16 v[140:143], a[20:23], v[92:95], v[140:143]
  s_mov_b32 s0, 134144
  buffer_load_dword a252, v249, s[40:43], s0 offen
  v_mfma_f32_16x16x32_bf16 v[144:147], a[24:27], v[88:91], v[144:147]
  ds_read_b64_tr_b16 a[56:57], v232 offset:7168
  v_exp_f32 v245, v35
  v_mfma_f32_16x16x32_bf16 v[152:155], a[24:27], v[92:95], v[152:155]
  ds_read_b64_tr_b16 a[58:59], v232 offset:15360
  v_cvt_pk_bf16_f32 v80, v242, v243
  v_mfma_f32_16x16x32_bf16 v[148:151], a[28:31], v[88:91], v[148:151]
  ds_read_b64_tr_b16 a[60:61], v233 offset:7168
  s_add_u32 s97, s68, 4
  s_min_u32 s97, s97, 6
  v_mfma_f32_16x16x32_bf16 v[156:159], a[28:31], v[92:95], v[156:159]
  ds_read_b64_tr_b16 a[62:63], v233 offset:15360
  s_waitcnt lgkmcnt(8)
  v_mfma_f32_16x16x32_bf16 v[160:163], a[32:35], v[88:91], v[160:163]
  ds_read_b128 a[0:3], v240 offset:16384
  s_mul_i32 s97, s97, 229376
  s_lshl_b32 s95, s68, 10
  v_mfma_f32_16x16x32_bf16 v[168:171], a[32:35], v[92:95], v[168:171]
  v_exp_f32 v242, v36
  v_mfma_f32_16x16x32_bf16 v[164:167], a[36:39], v[88:91], v[164:167]
  ds_read_b128 a[4:7], v240 offset:24576
  v_add_f32 v72, v72, v244
  v_mfma_f32_16x16x32_bf16 v[172:175], a[36:39], v[92:95], v[172:175]
  v_add_f32 v72, v72, v245
  v_exp_f32 v243, v37
  v_mfma_f32_16x16x32_bf16 v[176:179], a[40:43], v[88:91], v[176:179]
  ds_read_b128 a[8:11], v240 offset:17408
  v_cvt_pk_bf16_f32 v81, v244, v245
  v_mfma_f32_16x16x32_bf16 v[184:187], a[40:43], v[92:95], v[184:187]
  v_exp_f32 v244, v38
  v_mfma_f32_16x16x32_bf16 v[180:183], a[44:47], v[88:91], v[180:183]
  ds_read_b128 a[12:15], v240 offset:25600
  v_add_f32 v72, v72, v242
  v_mfma_f32_16x16x32_bf16 v[188:191], a[44:47], v[92:95], v[188:191]
  v_add_f32 v72, v72, v243
  s_waitcnt lgkmcnt(4)
  v_mfma_f32_16x16x32_bf16 v[192:195], a[48:51], v[88:91], v[192:195]
  ds_read_b128 a[16:19], v240 offset:18432
  v_min_u32 v223, 55, v251
  v_lshlrev_b32 v223, 2, v223
  v_mfma_f32_16x16x32_bf16 v[200:203], a[48:51], v[92:95], v[200:203]
  v_exp_f32 v245, v39
  v_mfma_f32_16x16x32_bf16 v[196:199], a[52:55], v[88:91], v[196:199]
  ds_read_b128 a[20:23], v240 offset:26624
  v_cvt_pk_bf16_f32 v82, v242, v243
  v_mfma_f32_16x16x32_bf16 v[204:207], a[52:55], v[92:95], v[204:207]
  v_exp_f32 v242, v40
  v_mfma_f32_16x16x32_bf16 a[96:99], a[56:59], v[88:91], a[96:99]
  ds_read_b128 a[24:27], v240 offset:19456
  v_add_f32 v72, v72, v244
  v_mfma_f32_16x16x32_bf16 a[104:107], a[56:59], v[92:95], a[104:107]
  v_add_f32 v72, v72, v245
  v_exp_f32 v243, v41
  v_mfma_f32_16x16x32_bf16 a[100:103], a[60:63], v[88:91], a[100:103]
  ds_read_b128 a[28:31], v240 offset:27648
  v_cvt_pk_bf16_f32 v83, v244, v245
  v_mfma_f32_16x16x32_bf16 a[108:111], a[60:63], v[92:95], a[108:111]
  s_mul_i32 s92, s14, 7168
  s_mul_i32 s93, s68, 224
  s_waitcnt lgkmcnt(4)
  v_mfma_f32_16x16x32_bf16 v[48:51], a[0:3], v[0:3], v[64:67]
  ds_read_b128 a[32:35], v240 offset:20480
  s_add_u32 s92, s92, s93
  s_add_u32 s93, s92, 3584
  v_mfma_f32_16x16x32_bf16 v[56:59], a[0:3], v[4:7], v[68:71]
  v_exp_f32 v244, v42
  v_mfma_f32_16x16x32_bf16 v[52:55], a[4:7], v[0:3], v[64:67]
  ds_read_b128 a[36:39], v240 offset:28672
  v_add_f32 v73, v242, v243
  v_mfma_f32_16x16x32_bf16 v[60:63], a[4:7], v[4:7], v[68:71]
  v_exp_f32 v245, v43
  v_mfma_f32_16x16x32_bf16 v[48:51], a[8:11], v[8:11], v[48:51]
  ds_read_b128 a[40:43], v240 offset:21504
  v_cvt_pk_bf16_f32 v84, v242, v243
  v_mfma_f32_16x16x32_bf16 v[56:59], a[8:11], v[12:15], v[56:59]
  v_exp_f32 v242, v44
  v_mfma_f32_16x16x32_bf16 v[52:55], a[12:15], v[8:11], v[52:55]
  ds_read_b128 a[44:47], v240 offset:29696
  v_add_f32 v73, v73, v244
  v_mfma_f32_16x16x32_bf16 v[60:63], a[12:15], v[12:15], v[60:63]
  v_add_f32 v73, v73, v245
  s_waitcnt lgkmcnt(4)
  v_mfma_f32_16x16x32_bf16 v[48:51], a[16:19], v[16:19], v[48:51]
  s_waitcnt vmcnt(16)
  s_barrier
  ds_read_b128 a[48:51], v240 offset:22528
  v_mfma_f32_16x16x32_bf16 v[56:59], a[16:19], v[20:23], v[56:59]
  v_exp_f32 v243, v45
  v_mfma_f32_16x16x32_bf16 v[52:55], a[20:23], v[16:19], v[52:55]
  s_add_u32 m0, s69, 114688
  s_mov_b32 s72, 98304
  ds_read_b128 a[52:55], v240 offset:30720
  v_mfma_f32_16x16x32_bf16 v[60:63], a[20:23], v[20:23], v[60:63]
  buffer_load_dwordx4 v224, s[40:43], s72 offen offset:0 lds
  v_mfma_f32_16x16x32_bf16 v[48:51], a[24:27], v[24:27], v[48:51]
  ds_read_b128 a[56:59], v240 offset:23552
  v_cvt_pk_bf16_f32 v85, v244, v245
  v_mfma_f32_16x16x32_bf16 v[56:59], a[24:27], v[28:31], v[56:59]
  v_exp_f32 v244, v46
  v_mfma_f32_16x16x32_bf16 v[52:55], a[28:31], v[24:27], v[52:55]
  ds_read_b128 a[60:63], v240 offset:31744
  v_add_f32 v73, v73, v242
  v_mfma_f32_16x16x32_bf16 v[60:63], a[28:31], v[28:31], v[60:63]
  buffer_load_dwordx4 v225, s[40:43], s72 offen offset:1024 lds
  s_waitcnt lgkmcnt(4)
  v_mfma_f32_16x16x32_bf16 v[48:51], a[32:35], a[64:67], v[48:51]
  ds_read_b64_tr_b16 a[0:1], v232 offset:32768
  v_add_f32 v73, v73, v243
  v_mfma_f32_16x16x32_bf16 v[56:59], a[32:35], a[68:71], v[56:59]
  ds_read_b64_tr_b16 a[2:3], v232 offset:40960
  v_exp_f32 v245, v47
  v_mfma_f32_16x16x32_bf16 v[52:55], a[36:39], a[64:67], v[52:55]
  ds_read_b64_tr_b16 a[4:5], v233 offset:32768
  ds_read_b64_tr_b16 a[6:7], v233 offset:40960
  v_mfma_f32_16x16x32_bf16 v[60:63], a[36:39], a[68:71], v[60:63]
  buffer_load_dwordx4 v226, s[40:43], s72 offen offset:2048 lds
  v_mfma_f32_16x16x32_bf16 v[48:51], a[40:43], a[72:75], v[48:51]
  ds_read_b64_tr_b16 a[8:9], v232 offset:33792
  v_cvt_pk_bf16_f32 v86, v242, v243
  v_mfma_f32_16x16x32_bf16 v[56:59], a[40:43], a[76:79], v[56:59]
  ds_read_b64_tr_b16 a[10:11], v232 offset:41984
  v_add_f32 v73, v73, v244
  v_mfma_f32_16x16x32_bf16 v[52:55], a[44:47], a[72:75], v[52:55]
  ds_read_b64_tr_b16 a[12:13], v233 offset:33792
  ds_read_b64_tr_b16 a[14:15], v233 offset:41984
  v_mfma_f32_16x16x32_bf16 v[60:63], a[44:47], a[76:79], v[60:63]
  buffer_load_dwordx4 v227, s[40:43], s72 offen offset:3072 lds
  s_waitcnt lgkmcnt(8)
  v_mfma_f32_16x16x32_bf16 v[48:51], a[48:51], a[80:83], v[48:51]
  ds_read_b64_tr_b16 a[16:17], v232 offset:34816
  v_add_f32 v73, v73, v245
  v_mfma_f32_16x16x32_bf16 v[56:59], a[48:51], a[84:87], v[56:59]
  ds_read_b64_tr_b16 a[18:19], v232 offset:43008
  v_cvt_pk_bf16_f32 v87, v244, v245
  v_mfma_f32_16x16x32_bf16 v[52:55], a[52:55], a[80:83], v[52:55]
  s_add_u32 m0, s69, 0
  s_mov_b32 s72, 81920
  ds_read_b64_tr_b16 a[20:21], v233 offset:34816
  ds_read_b64_tr_b16 a[22:23], v233 offset:43008
  v_mfma_f32_16x16x32_bf16 v[60:63], a[52:55], a[84:87], v[60:63]
  buffer_load_dwordx4 v228, s[44:47], s72 offen offset:0 lds
  v_mfma_f32_16x16x32_bf16 v[48:51], a[56:59], a[88:91], v[48:51]
  ds_read_b64_tr_b16 a[24:25], v232 offset:35840
  v_max_f32 v248, v72, v73
  v_mfma_f32_16x16x32_bf16 v[56:59], a[56:59], a[92:95], v[56:59]
  ds_read_b64_tr_b16 a[26:27], v232 offset:44032
  v_cmp_lt_f32 vcc, s73, v248
  v_mfma_f32_16x16x32_bf16 v[52:55], a[60:63], a[88:91], v[52:55]
  ds_read_b64_tr_b16 a[28:29], v233 offset:35840
  ds_read_b64_tr_b16 a[30:31], v233 offset:44032
  v_mfma_f32_16x16x32_bf16 v[60:63], a[60:63], a[92:95], v[60:63]
  buffer_load_dwordx4 v229, s[44:47], s72 offen offset:1024 lds
  s_cbranch_vccnz L_st19
L_rt19:
  s_waitcnt lgkmcnt(8)
  v_mfma_f32_16x16x32_bf16 v[96:99], a[0:3], v[80:83], v[96:99]
  ds_read_b64_tr_b16 a[32:33], v232 offset:36864
  v_add_f32 v246, v246, v72
  v_mfma_f32_16x16x32_bf16 v[104:107], a[0:3], v[84:87], v[104:107]
  ds_read_b64_tr_b16 a[34:35], v232 offset:45056
  v_add_f32 v247, v247, v73
  v_mfma_f32_16x16x32_bf16 v[100:103], a[4:7], v[80:83], v[100:103]
  ds_read_b64_tr_b16 a[36:37], v233 offset:36864
  ds_read_b64_tr_b16 a[38:39], v233 offset:45056
  v_mfma_f32_16x16x32_bf16 v[108:111], a[4:7], v[84:87], v[108:111]
  buffer_load_dwordx4 v230, s[44:47], s72 offen offset:2048 lds
  v_mfma_f32_16x16x32_bf16 v[112:115], a[8:11], v[80:83], v[112:115]
  ds_read_b64_tr_b16 a[40:41], v232 offset:37888
  v_exp_f32 v242, v48
  v_mfma_f32_16x16x32_bf16 v[120:123], a[8:11], v[84:87], v[120:123]
  ds_read_b64_tr_b16 a[42:43], v232 offset:46080
  v_exp_f32 v243, v49
  v_mfma_f32_16x16x32_bf16 v[116:119], a[12:15], v[80:83], v[116:119]
  ds_read_b64_tr_b16 a[44:45], v233 offset:37888
  ds_read_b64_tr_b16 a[46:47], v233 offset:46080
  v_mfma_f32_16x16x32_bf16 v[124:127], a[12:15], v[84:87], v[124:127]
  buffer_load_dwordx4 v231, s[44:47], s72 offen offset:3072 lds
  s_waitcnt lgkmcnt(8)
  v_mfma_f32_16x16x32_bf16 v[128:131], a[16:19], v[80:83], v[128:131]
  ds_read_b64_tr_b16 a[48:49], v232 offset:38912
  v_exp_f32 v244, v50
  v_mfma_f32_16x16x32_bf16 v[136:139], a[16:19], v[84:87], v[136:139]
  ds_read_b64_tr_b16 a[50:51], v232 offset:47104
  v_add_f32 v72, v242, v243
  v_mfma_f32_16x16x32_bf16 v[132:135], a[20:23], v[80:83], v[132:135]
  ds_read_b64_tr_b16 a[52:53], v233 offset:38912
  ds_read_b64_tr_b16 a[54:55], v233 offset:47104
  v_mfma_f32_16x16x32_bf16 v[140:143], a[20:23], v[84:87], v[140:143]
  s_mov_b32 s0, 134144
  buffer_load_dword a252, v249, s[44:47], s0 offen
  v_mfma_f32_16x16x32_bf16 v[144:147], a[24:27], v[80:83], v[144:147]
  ds_read_b64_tr_b16 a[56:57], v232 offset:39936
  v_exp_f32 v245, v51
  v_mfma_f32_16x16x32_bf16 v[152:155], a[24:27], v[84:87], v[152:155]
  ds_read_b64_tr_b16 a[58:59], v232 offset:48128
  v_cvt_pk_bf16_f32 v88, v242, v243
  v_mfma_f32_16x16x32_bf16 v[148:151], a[28:31], v[80:83], v[148:151]
  ds_read_b64_tr_b16 a[60:61], v233 offset:39936
  ds_read_b64_tr_b16 a[62:63], v233 offset:48128
  v_mfma_f32_16x16x32_bf16 v[156:159], a[28:31], v[84:87], v[156:159]
  s_add_u32 m0, s95, 131072
  s_add_u32 s94, s96, 0
  s_mov_b64 exec, 0xffff
  buffer_load_dwordx4 v222, s[60:63], s94 offen lds
  s_mov_b64 exec, -1
  s_waitcnt lgkmcnt(8)
  v_mfma_f32_16x16x32_bf16 v[160:163], a[32:35], v[80:83], v[160:163]
  ds_read_b128 a[0:3], v240 offset:49152
  v_exp_f32 v242, v52
  v_mfma_f32_16x16x32_bf16 v[168:171], a[32:35], v[84:87], v[168:171]
  v_add_f32 v72, v72, v244
  v_add_f32 v72, v72, v245
  v_mfma_f32_16x16x32_bf16 v[164:167], a[36:39], v[80:83], v[164:167]
  ds_read_b128 a[4:7], v240 offset:57344
  v_exp_f32 v243, v53
  v_mfma_f32_16x16x32_bf16 v[172:175], a[36:39], v[84:87], v[172:175]
  s_add_u32 m0, s95, 131328
  s_add_u32 s94, s96, 57344
  s_mov_b64 exec, 0xffff
  buffer_load_dwordx4 v222, s[60:63], s94 offen lds
  s_mov_b64 exec, -1
  v_mfma_f32_16x16x32_bf16 v[176:179], a[40:43], v[80:83], v[176:179]
  ds_read_b128 a[8:11], v240 offset:50176
  v_cvt_pk_bf16_f32 v89, v244, v245
  v_mfma_f32_16x16x32_bf16 v[184:187], a[40:43], v[84:87], v[184:187]
  v_exp_f32 v244, v54
  v_mfma_f32_16x16x32_bf16 v[180:183], a[44:47], v[80:83], v[180:183]
  ds_read_b128 a[12:15], v240 offset:58368
  v_add_f32 v72, v72, v242
  v_mfma_f32_16x16x32_bf16 v[188:191], a[44:47], v[84:87], v[188:191]
  s_add_u32 m0, s95, 131584
  s_add_u32 s94, s96, 114688
  s_mov_b64 exec, 0xffff
  buffer_load_dwordx4 v222, s[60:63], s94 offen lds
  s_mov_b64 exec, -1
  s_waitcnt lgkmcnt(4)
  v_mfma_f32_16x16x32_bf16 v[192:195], a[48:51], v[80:83], v[192:195]
  ds_read_b128 a[16:19], v240 offset:51200
  v_add_f32 v72, v72, v243
  v_mfma_f32_16x16x32_bf16 v[200:203], a[48:51], v[84:87], v[200:203]
  v_exp_f32 v245, v55
  v_mfma_f32_16x16x32_bf16 v[196:199], a[52:55], v[80:83], v[196:199]
  ds_read_b128 a[20:23], v240 offset:59392
  v_cvt_pk_bf16_f32 v90, v242, v243
  v_mfma_f32_16x16x32_bf16 v[204:207], a[52:55], v[84:87], v[204:207]
  s_waitcnt vmcnt(21)
  v_cmp_eq_u32_e64 s[90:91], 0, v208
  s_add_u32 m0, s95, 131840
  s_add_u32 s94, s96, 172032
  s_mov_b64 exec, 0xffff
  buffer_load_dwordx4 v222, s[60:63], s94 offen lds
  s_mov_b64 exec, -1
  v_mfma_f32_16x16x32_bf16 a[96:99], a[56:59], v[80:83], a[96:99]
  ds_read_b128 a[24:27], v240 offset:52224
  v_mfma_f32_16x16x32_bf16 a[104:107], a[56:59], v[84:87], a[104:107]
  v_exp_f32 v242, v56
  s_cmp_lg_u64 s[90:91], 0
  s_cbranch_scc1 L_spin1
L_spin1r:
  v_mfma_f32_16x16x32_bf16 a[100:103], a[60:63], v[80:83], a[100:103]
  ds_read_b128 a[28:31], v240 offset:60416
  v_add_f32 v72, v72, v244
  v_mov_b32 v209, v208
  v_mfma_f32_16x16x32_bf16 a[108:111], a[60:63], v[84:87], a[108:111]
  v_add_f32 v72, v72, v245
  v_max_u32_dpp v209, v209, v209 quad_perm:[1,0,3,2] row_mask:0xf bank_mask:0xf
  s_waitcnt lgkmcnt(4)
  v_mfma_f32_16x16x32_bf16 v[32:35], a[0:3], v[0:3], v[64:67]
  ds_read_b128 a[32:35], v240 offset:53248
  v_exp_f32 v243, v57
  v_max_u32_dpp v209, v209, v209 quad_perm:[2,3,0,1] row_mask:0xf bank_mask:0xf
  v_mfma_f32_16x16x32_bf16 v[40:43], a[0:3], v[4:7], v[68:71]
  v_cvt_pk_bf16_f32 v91, v244, v245
  v_exp_f32 v244, v58
  v_max_u32_dpp v209, v209, v209 row_half_mirror row_mask:0xf bank_mask:0xf
  v_mfma_f32_16x16x32_bf16 v[36:39], a[4:7], v[0:3], v[64:67]
  ds_read_b128 a[36:39], v240 offset:61440
  v_add_f32 v73, v242, v243
  v_max_u32_dpp v209, v209, v209 row_mirror row_mask:0xf bank_mask:0xf
  v_mfma_f32_16x16x32_bf16 v[44:47], a[4:7], v[4:7], v[68:71]
  v_exp_f32 v245, v59
  v_mov_b32 v210, v209
  v_mfma_f32_16x16x32_bf16 v[32:35], a[8:11], v[8:11], v[32:35]
  ds_read_b128 a[40:43], v240 offset:54272
  v_cvt_pk_bf16_f32 v92, v242, v243
  v_permlane16_swap_b32 v209, v210
  v_mfma_f32_16x16x32_bf16 v[40:43], a[8:11], v[12:15], v[40:43]
  v_exp_f32 v242, v60
  v_max_u32 v209, v209, v210
  v_mfma_f32_16x16x32_bf16 v[36:39], a[12:15], v[8:11], v[36:39]
  ds_read_b128 a[44:47], v240 offset:62464
  v_add_f32 v73, v73, v244
  v_mov_b32 v210, v209
  v_mfma_f32_16x16x32_bf16 v[44:47], a[12:15], v[12:15], v[44:47]
  v_add_f32 v73, v73, v245
  v_permlane32_swap_b32 v209, v210
  s_waitcnt lgkmcnt(4)
  v_mfma_f32_16x16x32_bf16 v[32:35], a[16:19], v[16:19], v[32:35]
  s_waitcnt vmcnt(18)
  s_barrier
  ds_read_b128 a[48:51], v240 offset:55296
  v_mfma_f32_16x16x32_bf16 v[40:43], a[16:19], v[20:23], v[40:43]
  v_exp_f32 v243, v61
  v_max_u32 v209, v209, v210
  v_mfma_f32_16x16x32_bf16 v[36:39], a[20:23], v[16:19], v[36:39]
  s_add_u32 m0, s69, 16384
  s_mov_b32 s72, 114688
  ds_read_b128 a[52:55], v240 offset:63488
  v_cmp_eq_u32_e64 s[90:91], v209, v208
  v_mfma_f32_16x16x32_bf16 v[44:47], a[20:23], v[20:23], v[44:47]
  buffer_load_dwordx4 v224, s[40:43], s72 offen offset:0 lds
  v_cndmask_b32_e64 v208, v208, 0, s[90:91]
  v_mfma_f32_16x16x32_bf16 v[32:35], a[24:27], v[24:27], v[32:35]
  ds_read_b128 a[56:59], v240 offset:56320
  v_cvt_pk_bf16_f32 v93, v244, v245
  v_max_u32_dpp v208, v208, v208 quad_perm:[1,0,3,2] row_mask:0xf bank_mask:0xf
  v_mfma_f32_16x16x32_bf16 v[40:43], a[24:27], v[28:31], v[40:43]
  v_exp_f32 v244, v62
  v_max_u32_dpp v208, v208, v208 quad_perm:[2,3,0,1] row_mask:0xf bank_mask:0xf
  v_mfma_f32_16x16x32_bf16 v[36:39], a[28:31], v[24:27], v[36:39]
  ds_read_b128 a[60:63], v240 offset:64512
  v_add_f32 v73, v73, v242
  v_max_u32_dpp v208, v208, v208 row_half_mirror row_mask:0xf bank_mask:0xf
  v_mfma_f32_16x16x32_bf16 v[44:47], a[28:31], v[28:31], v[44:47]
  buffer_load_dwordx4 v225, s[40:43], s72 offen offset:1024 lds
  s_waitcnt lgkmcnt(4)
  v_mfma_f32_16x16x32_bf16 v[32:35], a[32:35], a[64:67], v[32:35]
  ds_read_b64_tr_b16 a[0:1], v234 offset:0
  v_add_f32 v73, v73, v243
  v_max_u32_dpp v208, v208, v208 row_mirror row_mask:0xf bank_mask:0xf
  v_mfma_f32_16x16x32_bf16 v[40:43], a[32:35], a[68:71], v[40:43]
  ds_read_b64_tr_b16 a[2:3], v234 offset:8192
  v_exp_f32 v245, v63
  v_mov_b32 v210, v208
  v_mfma_f32_16x16x32_bf16 v[36:39], a[36:39], a[64:67], v[36:39]
  ds_read_b64_tr_b16 a[4:5], v235 offset:0
  ds_read_b64_tr_b16 a[6:7], v235 offset:8192
  v_permlane16_swap_b32 v208, v210
  v_mfma_f32_16x16x32_bf16 v[44:47], a[36:39], a[68:71], v[44:47]
  buffer_load_dwordx4 v226, s[40:43], s72 offen offset:2048 lds
  v_max_u32 v208, v208, v210
  v_mfma_f32_16x16x32_bf16 v[32:35], a[40:43], a[72:75], v[32:35]
  ds_read_b64_tr_b16 a[8:9], v234 offset:1024
  v_cvt_pk_bf16_f32 v94, v242, v243
  v_mov_b32 v210, v208
  v_mfma_f32_16x16x32_bf16 v[40:43], a[40:43], a[76:79], v[40:43]
  ds_read_b64_tr_b16 a[10:11], v234 offset:9216
  v_add_f32 v73, v73, v244
  v_permlane32_swap_b32 v208, v210
  v_mfma_f32_16x16x32_bf16 v[36:39], a[44:47], a[72:75], v[36:39]
  ds_read_b64_tr_b16 a[12:13], v235 offset:1024
  ds_read_b64_tr_b16 a[14:15], v235 offset:9216
  v_max_u32 v208, v208, v210
  v_mfma_f32_16x16x32_bf16 v[44:47], a[44:47], a[76:79], v[44:47]
  buffer_load_dwordx4 v227, s[40:43], s72 offen offset:3072 lds
  s_waitcnt lgkmcnt(8)
  v_mfma_f32_16x16x32_bf16 v[32:35], a[48:51], a[80:83], v[32:35]
  ds_read_b64_tr_b16 a[16:17], v234 offset:2048
  v_add_f32 v73, v73, v245
  v_readfirstlane_b32 s85, v209
  v_mfma_f32_16x16x32_bf16 v[40:43], a[48:51], a[84:87], v[40:43]
  ds_read_b64_tr_b16 a[18:19], v234 offset:10240
  v_cvt_pk_bf16_f32 v95, v244, v245
  v_readfirstlane_b32 s86, v208
  v_mfma_f32_16x16x32_bf16 v[36:39], a[52:55], a[80:83], v[36:39]
  s_add_u32 m0, s69, 32768
  s_mov_b32 s72, 98304
  ds_read_b64_tr_b16 a[20:21], v235 offset:2048
  ds_read_b64_tr_b16 a[22:23], v235 offset:10240
  v_mfma_f32_16x16x32_bf16 v[44:47], a[52:55], a[84:87], v[44:47]
  buffer_load_dwordx4 v228, s[44:47], s72 offen offset:0 lds
  s_mov_b32 s90, 0xaaaaaaaa
  v_mfma_f32_16x16x32_bf16 v[32:35], a[56:59], a[88:91], v[32:35]
  ds_read_b64_tr_b16 a[24:25], v234 offset:3072
  v_max_f32 v248, v72, v73
  s_mov_b32 s91, 0xaaaaaaaa
  v_mfma_f32_16x16x32_bf16 v[40:43], a[56:59], a[92:95], v[40:43]
  ds_read_b64_tr_b16 a[26:27], v234 offset:11264
  v_cmp_lt_f32 vcc, s73, v248
  v_cndmask_b32_e64 v208, v209, v208, s[90:91]
  v_mfma_f32_16x16x32_bf16 v[36:39], a[60:63], a[88:91], v[36:39]
  ds_read_b64_tr_b16 a[28:29], v235 offset:3072
  ds_read_b64_tr_b16 a[30:31], v235 offset:11264
  v_not_b32 v208, v208
  v_mfma_f32_16x16x32_bf16 v[44:47], a[60:63], a[92:95], v[44:47]
  buffer_load_dwordx4 v229, s[44:47], s72 offen offset:1024 lds
  s_cbranch_vccnz L_st21
L_rt21:
  s_waitcnt lgkmcnt(8)
  v_mfma_f32_16x16x32_bf16 v[96:99], a[0:3], v[88:91], v[96:99]
  ds_read_b64_tr_b16 a[32:33], v234 offset:4096
  v_add_f32 v246, v246, v72
  v_and_b32 v208, 2047, v208
  v_mfma_f32_16x16x32_bf16 v[104:107], a[0:3], v[92:95], v[104:107]
  ds_read_b64_tr_b16 a[34:35], v234 offset:12288
  v_add_f32 v247, v247, v73
  v_lshlrev_b32 v209, 3, v208
  v_mfma_f32_16x16x32_bf16 v[100:103], a[4:7], v[88:91], v[100:103]
  ds_read_b64_tr_b16 a[36:37], v235 offset:4096
  ds_read_b64_tr_b16 a[38:39], v235 offset:12288
  s_mov_b32 s89, 16842752
  v_mfma_f32_16x16x32_bf16 v[108:111], a[4:7], v[92:95], v[108:111]
  buffer_load_dwordx4 v230, s[44:47], s72 offen offset:2048 lds
  v_mul_u32_u24 v208, 896, v208
  v_mfma_f32_16x16x32_bf16 v[112:115], a[8:11], v[88:91], v[112:115]
  ds_read_b64_tr_b16 a[40:41], v234 offset:5120
  v_exp_f32 v242, v32
  v_mfma_f32_16x16x32_bf16 v[120:123], a[8:11], v[92:95], v[120:123]
  ds_read_b64_tr_b16 a[42:43], v234 offset:13312
  v_exp_f32 v243, v33
  v_mfma_f32_16x16x32_bf16 v[116:119], a[12:15], v[88:91], v[116:119]
  ds_read_b64_tr_b16 a[44:45], v235 offset:5120
  ds_read_b64_tr_b16 a[46:47], v235 offset:13312
  v_lshrrev_b32 v210, 4, v251
  v_mfma_f32_16x16x32_bf16 v[124:127], a[12:15], v[92:95], v[124:127]
  buffer_load_dwordx4 v231, s[44:47], s72 offen offset:3072 lds
  s_waitcnt lgkmcnt(8)
  v_mfma_f32_16x16x32_bf16 v[128:131], a[16:19], v[88:91], v[128:131]
  ds_read_b64_tr_b16 a[48:49], v234 offset:6144
  v_exp_f32 v244, v34
  v_mfma_f32_16x16x32_bf16 v[136:139], a[16:19], v[92:95], v[136:139]
  ds_read_b64_tr_b16 a[50:51], v234 offset:14336
  v_add_f32 v72, v242, v243
  v_lshl_add_u32 v208, v210, 4, v208
  v_mfma_f32_16x16x32_bf16 v[132:135], a[20:23], v[88:91], v[132:135]
  ds_read_b64_tr_b16 a[52:53], v235 offset:6144
  ds_read_b64_tr_b16 a[54:55], v235 offset:14336
  s_lshl_b32 s87, s68, 7
  v_mfma_f32_16x16x32_bf16 v[140:143], a[20:23], v[92:95], v[140:143]
  s_add_u32 s0, s1, 0
  buffer_load_dword a252, v249, s[52:55], s0 offen
  v_mfma_f32_16x16x32_bf16 v[144:147], a[24:27], v[88:91], v[144:147]
  ds_read_b64_tr_b16 a[56:57], v234 offset:7168
  v_exp_f32 v245, v35
  v_mfma_f32_16x16x32_bf16 v[152:155], a[24:27], v[92:95], v[152:155]
  ds_read_b64_tr_b16 a[58:59], v234 offset:15360
  v_cvt_pk_bf16_f32 v80, v242, v243
  s_add_u32 s88, s68, 4
  v_mfma_f32_16x16x32_bf16 v[148:151], a[28:31], v[88:91], v[148:151]
  ds_read_b64_tr_b16 a[60:61], v235 offset:7168
  ds_read_b64_tr_b16 a[62:63], v235 offset:15360
  s_min_u32 s88, s88, 6
  v_mfma_f32_16x16x32_bf16 v[156:159], a[28:31], v[92:95], v[156:159]
  s_add_u32 m0, s95, 135168
  s_add_u32 s94, s97, 0
  s_mov_b64 exec, 0xffff
  buffer_load_dwordx4 v222, s[60:63], s94 offen lds
  s_mov_b64 exec, -1
  s_waitcnt lgkmcnt(8)
  v_mfma_f32_16x16x32_bf16 v[160:163], a[32:35], v[88:91], v[160:163]
  ds_read_b128 a[0:3], v241 offset:16384
  v_exp_f32 v242, v36
  v_mfma_f32_16x16x32_bf16 v[168:171], a[32:35], v[92:95], v[168:171]
  v_add_f32 v72, v72, v244
  v_add_f32 v72, v72, v245
  s_lshl_b32 s88, s88, 7
  v_mfma_f32_16x16x32_bf16 v[164:167], a[36:39], v[88:91], v[164:167]
  ds_read_b128 a[4:7], v241 offset:24576
  v_exp_f32 v243, v37
  v_mfma_f32_16x16x32_bf16 v[172:175], a[36:39], v[92:95], v[172:175]
  buffer_load_dwordx2 v[210:211], v209, s[48:51], s89 offen sc1
  v_mfma_f32_16x16x32_bf16 v[176:179], a[40:43], v[88:91], v[176:179]
  ds_read_b128 a[8:11], v241 offset:17408
  v_cvt_pk_bf16_f32 v81, v244, v245
  v_mfma_f32_16x16x32_bf16 v[184:187], a[40:43], v[92:95], v[184:187]
  v_exp_f32 v244, v38
  v_mfma_f32_16x16x32_bf16 v[180:183], a[44:47], v[88:91], v[180:183]
  ds_read_b128 a[12:15], v241 offset:25600
  v_add_f32 v72, v72, v242
  v_mfma_f32_16x16x32_bf16 v[188:191], a[44:47], v[92:95], v[188:191]
  buffer_load_dwordx4 a[112:115], v208, s[32:35], s87 offen offset:3072
  s_waitcnt lgkmcnt(4)
  v_mfma_f32_16x16x32_bf16 v[192:195], a[48:51], v[88:91], v[192:195]
  ds_read_b128 a[16:19], v241 offset:18432
  v_add_f32 v72, v72, v243
  v_mfma_f32_16x16x32_bf16 v[200:203], a[48:51], v[92:95], v[200:203]
  v_exp_f32 v245, v39
  v_mfma_f32_16x16x32_bf16 v[196:199], a[52:55], v[88:91], v[196:199]
  ds_read_b128 a[20:23], v241 offset:26624
  v_cvt_pk_bf16_f32 v82, v242, v243
  v_mfma_f32_16x16x32_bf16 v[204:207], a[52:55], v[92:95], v[204:207]
  buffer_load_dwordx4 a[116:119], v208, s[32:35], s87 offen offset:3136
  v_mfma_f32_16x16x32_bf16 a[96:99], a[56:59], v[88:91], a[96:99]
  ds_read_b128 a[24:27], v241 offset:19456
  v_exp_f32 v242, v40
  v_mfma_f32_16x16x32_bf16 a[104:107], a[56:59], v[92:95], a[104:107]
  v_add_f32 v72, v72, v244
  v_add_f32 v72, v72, v245
  v_mfma_f32_16x16x32_bf16 a[100:103], a[60:63], v[88:91], a[100:103]
  ds_read_b128 a[28:31], v241 offset:27648
  v_exp_f32 v243, v41
  v_mfma_f32_16x16x32_bf16 a[108:111], a[60:63], v[92:95], a[108:111]
  buffer_load_dwordx4 a[120:123], v208, s[32:35], s88 offen offset:3072
  s_waitcnt lgkmcnt(4)
  v_mfma_f32_16x16x32_bf16 v[48:51], a[0:3], v[0:3], v[64:67]
  ds_read_b128 a[32:35], v241 offset:20480
  v_cvt_pk_bf16_f32 v83, v244, v245
  v_mfma_f32_16x16x32_bf16 v[56:59], a[0:3], v[4:7], v[68:71]
  v_exp_f32 v244, v42
  v_mfma_f32_16x16x32_bf16 v[52:55], a[4:7], v[0:3], v[64:67]
  ds_read_b128 a[36:39], v241 offset:28672
  v_add_f32 v73, v242, v243
  v_mfma_f32_16x16x32_bf16 v[60:63], a[4:7], v[4:7], v[68:71]
  buffer_load_dwordx4 a[124:127], v208, s[32:35], s88 offen offset:3136
  v_mfma_f32_16x16x32_bf16 v[48:51], a[8:11], v[8:11], v[48:51]
  ds_read_b128 a[40:43], v241 offset:21504
  v_exp_f32 v245, v43
  v_mfma_f32_16x16x32_bf16 v[56:59], a[8:11], v[12:15], v[56:59]
  v_cvt_pk_bf16_f32 v84, v242, v243
  v_exp_f32 v242, v44
  v_mfma_f32_16x16x32_bf16 v[52:55], a[12:15], v[8:11], v[52:55]
  ds_read_b128 a[44:47], v241 offset:29696
  v_add_f32 v73, v73, v244
  v_bfe_u32 v208, v251, 1, 1
  v_mfma_f32_16x16x32_bf16 v[60:63], a[12:15], v[12:15], v[60:63]
  s_add_u32 m0, s95, 135424
  s_add_u32 s94, s97, 57344
  s_mov_b64 exec, 0xffff
  buffer_load_dwordx4 v222, s[60:63], s94 offen lds
  s_mov_b64 exec, -1
  s_waitcnt lgkmcnt(4)
  v_mfma_f32_16x16x32_bf16 v[48:51], a[16:19], v[16:19], v[48:51]
  s_waitcnt vmcnt(25)
  s_barrier
  ds_read_b128 a[48:51], v241 offset:22528
  v_mfma_f32_16x16x32_bf16 v[56:59], a[16:19], v[20:23], v[56:59]
  v_add_f32 v73, v73, v245
  v_exp_f32 v243, v45
  v_mfma_f32_16x16x32_bf16 v[52:55], a[20:23], v[16:19], v[52:55]
  s_add_u32 m0, s69, 49152
  s_mov_b32 s72, 131072
  ds_read_b128 a[52:55], v241 offset:30720
  v_mfma_f32_16x16x32_bf16 v[60:63], a[20:23], v[20:23], v[60:63]
  buffer_load_dwordx4 v224, s[40:43], s72 offen offset:0 lds
  v_mfma_f32_16x16x32_bf16 v[48:51], a[24:27], v[24:27], v[48:51]
  ds_read_b128 a[56:59], v241 offset:23552
  v_cvt_pk_bf16_f32 v85, v244, v245
  v_lshlrev_b32 v208, 13, v208
  v_mfma_f32_16x16x32_bf16 v[56:59], a[24:27], v[28:31], v[56:59]
  v_exp_f32 v244, v46
  v_lshrrev_b32 v209, 4, v251
  v_mfma_f32_16x16x32_bf16 v[52:55], a[28:31], v[24:27], v[52:55]
  ds_read_b128 a[60:63], v241 offset:31744
  v_add_f32 v73, v73, v242
  v_lshl_add_u32 v208, v209, 7, v208
  v_mfma_f32_16x16x32_bf16 v[60:63], a[28:31], v[28:31], v[60:63]
  buffer_load_dwordx4 v225, s[40:43], s72 offen offset:1024 lds
  s_waitcnt lgkmcnt(4)
  v_mfma_f32_16x16x32_bf16 v[48:51], a[32:35], a[64:67], v[48:51]
  ds_read_b64_tr_b16 a[0:1], v234 offset:32768
  v_add_f32 v73, v73, v243
  v_bfe_u32 v209, v251, 2, 2
  v_mfma_f32_16x16x32_bf16 v[56:59], a[32:35], a[68:71], v[56:59]
  ds_read_b64_tr_b16 a[2:3], v234 offset:40960
  v_exp_f32 v245, v47
  v_mfma_f32_16x16x32_bf16 v[52:55], a[36:39], a[64:67], v[52:55]
  ds_read_b64_tr_b16 a[4:5], v235 offset:32768
  ds_read_b64_tr_b16 a[6:7], v235 offset:40960
  v_lshl_add_u32 v208, v209, 4, v208
  v_mfma_f32_16x16x32_bf16 v[60:63], a[36:39], a[68:71], v[60:63]
  buffer_load_dwordx4 v226, s[40:43], s72 offen offset:2048 lds
  v_mfma_f32_16x16x32_bf16 v[48:51], a[40:43], a[72:75], v[48:51]
  ds_read_b64_tr_b16 a[8:9], v234 offset:33792
  v_cvt_pk_bf16_f32 v86, v242, v243
  v_and_b32 v209, 1, v251
  v_mfma_f32_16x16x32_bf16 v[56:59], a[40:43], a[76:79], v[56:59]
  ds_read_b64_tr_b16 a[10:11], v234 offset:41984
  v_add_f32 v73, v73, v244
  v_lshl_add_u32 v208, v209, 3, v208
  v_mfma_f32_16x16x32_bf16 v[52:55], a[44:47], a[72:75], v[52:55]
  ds_read_b64_tr_b16 a[12:13], v235 offset:33792
  ds_read_b64_tr_b16 a[14:15], v235 offset:41984
  s_lshl_b32 s87, s68, 10
  v_mfma_f32_16x16x32_bf16 v[60:63], a[44:47], a[76:79], v[60:63]
  buffer_load_dwordx4 v227, s[40:43], s72 offen offset:3072 lds
  s_waitcnt lgkmcnt(8)
  v_mfma_f32_16x16x32_bf16 v[48:51], a[48:51], a[80:83], v[48:51]
  ds_read_b64_tr_b16 a[16:17], v234 offset:34816
  v_add_f32 v73, v73, v245
  s_add_u32 s87, s87, 131072
  v_mfma_f32_16x16x32_bf16 v[56:59], a[48:51], a[84:87], v[56:59]
  ds_read_b64_tr_b16 a[18:19], v234 offset:43008
  v_cvt_pk_bf16_f32 v87, v244, v245
  v_add_u32 v208, s87, v208
  v_mfma_f32_16x16x32_bf16 v[52:55], a[52:55], a[80:83], v[52:55]
  s_add_u32 m0, s69, 65536
  s_mov_b32 s72, 114688
  ds_read_b64_tr_b16 a[20:21], v235 offset:34816
  ds_read_b64_tr_b16 a[22:23], v235 offset:43008
  v_mfma_f32_16x16x32_bf16 v[60:63], a[52:55], a[84:87], v[60:63]
  buffer_load_dwordx4 v228, s[44:47], s72 offen offset:0 lds
  v_mfma_f32_16x16x32_bf16 v[48:51], a[56:59], a[88:91], v[48:51]
  ds_read_b64_tr_b16 a[24:25], v234 offset:35840
  v_max_f32 v248, v72, v73
  v_mov_b32 v209, 0x3f803f80
  v_mfma_f32_16x16x32_bf16 v[56:59], a[56:59], a[92:95], v[56:59]
  ds_read_b64_tr_b16 a[26:27], v234 offset:44032
  v_cmp_lt_f32 vcc, s73, v248
  v_accvgpr_write_b32 a152, v209
  v_mfma_f32_16x16x32_bf16 v[52:55], a[60:63], a[88:91], v[52:55]
  ds_read_b64_tr_b16 a[28:29], v235 offset:35840
  ds_read_b64_tr_b16 a[30:31], v235 offset:44032
  v_accvgpr_write_b32 a153, v209
  v_mfma_f32_16x16x32_bf16 v[60:63], a[60:63], a[92:95], v[60:63]
  buffer_load_dwordx4 v229, s[44:47], s72 offen offset:1024 lds
  s_cbranch_vccnz L_st23
L_rt23:
  s_waitcnt lgkmcnt(8)
  v_mfma_f32_16x16x32_bf16 v[96:99], a[0:3], v[80:83], v[96:99]
  ds_read_b64_tr_b16 a[32:33], v234 offset:36864
  v_add_f32 v246, v246, v72
  v_accvgpr_write_b32 a154, v209
  v_mfma_f32_16x16x32_bf16 v[104:107], a[0:3], v[84:87], v[104:107]
  ds_read_b64_tr_b16 a[34:35], v234 offset:45056
  v_add_f32 v247, v247, v73
  v_accvgpr_write_b32 a155, v209
  v_mfma_f32_16x16x32_bf16 v[100:103], a[4:7], v[80:83], v[100:103]
  ds_read_b64_tr_b16 a[36:37], v235 offset:36864
  ds_read_b64_tr_b16 a[38:39], v235 offset:45056
  v_mfma_f32_16x16x32_bf16 v[108:111], a[4:7], v[84:87], v[108:111]
  buffer_load_dwordx4 v230, s[44:47], s72 offen offset:2048 lds
  v_mfma_f32_16x16x32_bf16 v[112:115], a[8:11], v[80:83], v[112:115]
  ds_read_b64_tr_b16 a[40:41], v234 offset:37888
  v_exp_f32 v242, v48
  v_mfma_f32_16x16x32_bf16 v[120:123], a[8:11], v[84:87], v[120:123]
  ds_read_b64_tr_b16 a[42:43], v234 offset:46080
  v_exp_f32 v243, v49
  v_mfma_f32_16x16x32_bf16 v[116:119], a[12:15], v[80:83], v[116:119]
  ds_read_b64_tr_b16 a[44:45], v235 offset:37888
  ds_read_b64_tr_b16 a[46:47], v235 offset:46080
  v_mfma_f32_16x16x32_bf16 v[124:127], a[12:15], v[84:87], v[124:127]
  buffer_load_dwordx4 v231, s[44:47], s72 offen offset:3072 lds
  s_waitcnt lgkmcnt(8)
  v_mfma_f32_16x16x32_bf16 v[128:131], a[16:19], v[80:83], v[128:131]
  ds_read_b64_tr_b16 a[48:49], v234 offset:38912
  v_exp_f32 v244, v50
  v_mfma_f32_16x16x32_bf16 v[136:139], a[16:19], v[84:87], v[136:139]
  ds_read_b64_tr_b16 a[50:51], v234 offset:47104
  v_add_f32 v72, v242, v243
  v_mfma_f32_16x16x32_bf16 v[132:135], a[20:23], v[80:83], v[132:135]
  ds_read_b64_tr_b16 a[52:53], v235 offset:38912
  ds_read_b64_tr_b16 a[54:55], v235 offset:47104
  v_mfma_f32_16x16x32_bf16 v[140:143], a[20:23], v[84:87], v[140:143]
  buffer_store_dwordx4 a[248:251], v250, s[48:51], s4 offen offset:0 sc1
  v_mfma_f32_16x16x32_bf16 v[144:147], a[24:27], v[80:83], v[144:147]
  ds_read_b64_tr_b16 a[56:57], v234 offset:39936
  v_exp_f32 v245, v51
  v_mfma_f32_16x16x32_bf16 v[152:155], a[24:27], v[84:87], v[152:155]
  ds_read_b64_tr_b16 a[58:59], v234 offset:48128
  v_cvt_pk_bf16_f32 v88, v242, v243
  v_mfma_f32_16x16x32_bf16 v[148:151], a[28:31], v[80:83], v[148:151]
  ds_read_b64_tr_b16 a[60:61], v235 offset:39936
  ds_read_b64_tr_b16 a[62:63], v235 offset:48128
  v_mfma_f32_16x16x32_bf16 v[156:159], a[28:31], v[84:87], v[156:159]
  buffer_store_dwordx4 a[248:251], v250, s[48:51], s4 offen offset:1024 sc1
  s_waitcnt lgkmcnt(8)
  v_mfma_f32_16x16x32_bf16 v[160:163], a[32:35], v[80:83], v[160:163]
  ds_read_b128 a[0:3], v241 offset:49152
  v_exp_f32 v242, v52
  v_mfma_f32_16x16x32_bf16 v[168:171], a[32:35], v[84:87], v[168:171]
  v_add_f32 v72, v72, v244
  v_add_f32 v72, v72, v245
  v_mfma_f32_16x16x32_bf16 v[164:167], a[36:39], v[80:83], v[164:167]
  ds_read_b128 a[4:7], v241 offset:57344
  v_exp_f32 v243, v53
  v_mfma_f32_16x16x32_bf16 v[172:175], a[36:39], v[84:87], v[172:175]
  s_add_u32 m0, s95, 135680
  s_add_u32 s94, s97, 114688
  s_mov_b64 exec, 0xffff
  buffer_load_dwordx4 v222, s[60:63], s94 offen lds
  s_mov_b64 exec, -1
  v_mfma_f32_16x16x32_bf16 v[176:179], a[40:43], v[80:83], v[176:179]
  ds_read_b128 a[8:11], v241 offset:50176
  v_cvt_pk_bf16_f32 v89, v244, v245
  v_mfma_f32_16x16x32_bf16 v[184:187], a[40:43], v[84:87], v[184:187]
  v_exp_f32 v244, v54
  v_mfma_f32_16x16x32_bf16 v[180:183], a[44:47], v[80:83], v[180:183]
  ds_read_b128 a[12:15], v241 offset:58368
  v_add_f32 v72, v72, v242
  v_mfma_f32_16x16x32_bf16 v[188:191], a[44:47], v[84:87], v[188:191]
  s_add_u32 m0, s95, 135936
  s_add_u32 s94, s97, 172032
  s_mov_b64 exec, 0xffff
  buffer_load_dwordx4 v222, s[60:63], s94 offen lds
  s_mov_b64 exec, -1
  s_waitcnt lgkmcnt(4)
  v_mfma_f32_16x16x32_bf16 v[192:195], a[48:51], v[80:83], v[192:195]
  ds_read_b128 a[16:19], v241 offset:51200
  v_add_f32 v72, v72, v243
  v_mfma_f32_16x16x32_bf16 v[200:203], a[48:51], v[84:87], v[200:203]
  v_exp_f32 v245, v55
  v_mfma_f32_16x16x32_bf16 v[196:199], a[52:55], v[80:83], v[196:199]
  ds_read_b128 a[20:23], v241 offset:59392
  v_cvt_pk_bf16_f32 v90, v242, v243
  v_mfma_f32_16x16x32_bf16 v[204:207], a[52:55], v[84:87], v[204:207]
  s_add_u32 m0, s95, 139264
  s_add_u32 s94, s96, 0
  s_mov_b64 exec, 0xffff
  buffer_load_dwordx4 v222, s[64:67], s94 offen lds
  s_mov_b64 exec, -1
  v_mfma_f32_16x16x32_bf16 a[96:99], a[56:59], v[80:83], a[96:99]
  ds_read_b128 a[24:27], v241 offset:52224
  v_exp_f32 v242, v56
  v_mfma_f32_16x16x32_bf16 a[104:107], a[56:59], v[84:87], a[104:107]
  v_add_f32 v72, v72, v244
  v_add_f32 v72, v72, v245
  v_mfma_f32_16x16x32_bf16 a[100:103], a[60:63], v[80:83], a[100:103]
  ds_read_b128 a[28:31], v241 offset:60416
  v_exp_f32 v243, v57
  v_mfma_f32_16x16x32_bf16 a[108:111], a[60:63], v[84:87], a[108:111]
  s_add_u32 m0, s95, 139520
  s_add_u32 s94, s96, 57344
  s_mov_b64 exec, 0xffff
  buffer_load_dwordx4 v222, s[64:67], s94 offen lds
  s_mov_b64 exec, -1
  s_waitcnt lgkmcnt(4)
  v_mfma_f32_16x16x32_bf16 v[32:35], a[0:3], v[0:3], v[64:67]
  ds_read_b128 a[32:35], v241 offset:53248
  v_cvt_pk_bf16_f32 v91, v244, v245
  v_mfma_f32_16x16x32_bf16 v[40:43], a[0:3], v[4:7], v[68:71]
  v_exp_f32 v244, v58
  v_mfma_f32_16x16x32_bf16 v[36:39], a[4:7], v[0:3], v[64:67]
  ds_read_b128 a[36:39], v241 offset:61440
  v_add_f32 v73, v242, v243
  v_mfma_f32_16x16x32_bf16 v[44:47], a[4:7], v[4:7], v[68:71]
  s_add_u32 m0, s95, 139776
  s_add_u32 s94, s96, 114688
  s_mov_b64 exec, 0xffff
  buffer_load_dwordx4 v222, s[64:67], s94 offen lds
  s_mov_b64 exec, -1
  v_mfma_f32_16x16x32_bf16 v[32:35], a[8:11], v[8:11], v[32:35]
  ds_read_b128 a[40:43], v241 offset:54272
  v_exp_f32 v245, v59
  v_mfma_f32_16x16x32_bf16 v[40:43], a[8:11], v[12:15], v[40:43]
  v_cvt_pk_bf16_f32 v92, v242, v243
  v_exp_f32 v242, v60
  v_mfma_f32_16x16x32_bf16 v[36:39], a[12:15], v[8:11], v[36:39]
  ds_read_b128 a[44:47], v241 offset:62464
  v_add_f32 v73, v73, v244
  v_mfma_f32_16x16x32_bf16 v[44:47], a[12:15], v[12:15], v[44:47]
  s_add_u32 m0, s95, 140032
  s_add_u32 s94, s96, 172032
  s_mov_b64 exec, 0xffff
  buffer_load_dwordx4 v222, s[64:67], s94 offen lds
  s_mov_b64 exec, -1
  s_waitcnt lgkmcnt(4)
  v_mfma_f32_16x16x32_bf16 v[32:35], a[16:19], v[16:19], v[32:35]
  s_waitcnt vmcnt(28)
  s_barrier
  ds_read_b128 a[48:51], v241 offset:55296
  v_mfma_f32_16x16x32_bf16 v[40:43], a[16:19], v[20:23], v[40:43]
  v_add_f32 v73, v73, v245
  v_exp_f32 v243, v61
  v_mfma_f32_16x16x32_bf16 v[36:39], a[20:23], v[16:19], v[36:39]
  s_add_u32 m0, s69, 81920
  s_mov_b32 s72, 147456
  ds_read_b128 a[52:55], v241 offset:63488
  v_mfma_f32_16x16x32_bf16 v[44:47], a[20:23], v[20:23], v[44:47]
  buffer_load_dwordx4 v224, s[40:43], s72 offen offset:0 lds
  v_mfma_f32_16x16x32_bf16 v[32:35], a[24:27], v[24:27], v[32:35]
  ds_read_b128 a[56:59], v241 offset:56320
  v_cvt_pk_bf16_f32 v93, v244, v245
  v_mfma_f32_16x16x32_bf16 v[40:43], a[24:27], v[28:31], v[40:43]
  v_exp_f32 v244, v62
  v_mfma_f32_16x16x32_bf16 v[36:39], a[28:31], v[24:27], v[36:39]
  ds_read_b128 a[60:63], v241 offset:64512
  v_add_f32 v73, v73, v242
  v_mfma_f32_16x16x32_bf16 v[44:47], a[28:31], v[28:31], v[44:47]
  buffer_load_dwordx4 v225, s[40:43], s72 offen offset:1024 lds
  s_waitcnt lgkmcnt(4)
  v_mfma_f32_16x16x32_bf16 v[32:35], a[32:35], a[64:67], v[32:35]
  ds_read_b64_tr_b16 a[0:1], v232 offset:0
  v_add_f32 v73, v73, v243
  v_mfma_f32_16x16x32_bf16 v[40:43], a[32:35], a[68:71], v[40:43]
  ds_read_b64_tr_b16 a[2:3], v232 offset:8192
  v_exp_f32 v245, v63
  v_mfma_f32_16x16x32_bf16 v[36:39], a[36:39], a[64:67], v[36:39]
  ds_read_b64_tr_b16 a[4:5], v233 offset:0
  ds_read_b64_tr_b16 a[6:7], v233 offset:8192
  v_mfma_f32_16x16x32_bf16 v[44:47], a[36:39], a[68:71], v[44:47]
  buffer_load_dwordx4 v226, s[40:43], s72 offen offset:2048 lds
  v_mfma_f32_16x16x32_bf16 v[32:35], a[40:43], a[72:75], v[32:35]
  ds_read_b64_tr_b16 a[8:9], v232 offset:1024
  v_cvt_pk_bf16_f32 v94, v242, v243
  v_mfma_f32_16x16x32_bf16 v[40:43], a[40:43], a[76:79], v[40:43]
  ds_read_b64_tr_b16 a[10:11], v232 offset:9216
  v_add_f32 v73, v73, v244
  v_mfma_f32_16x16x32_bf16 v[36:39], a[44:47], a[72:75], v[36:39]
  ds_read_b64_tr_b16 a[12:13], v233 offset:1024
  ds_read_b64_tr_b16 a[14:15], v233 offset:9216
  v_mfma_f32_16x16x32_bf16 v[44:47], a[44:47], a[76:79], v[44:47]
  buffer_load_dwordx4 v227, s[40:43], s72 offen offset:3072 lds
  s_waitcnt lgkmcnt(8)
  v_mfma_f32_16x16x32_bf16 v[32:35], a[48:51], a[80:83], v[32:35]
  ds_read_b64_tr_b16 a[16:17], v232 offset:2048
  v_add_f32 v73, v73, v245
  v_mfma_f32_16x16x32_bf16 v[40:43], a[48:51], a[84:87], v[40:43]
  ds_read_b64_tr_b16 a[18:19], v232 offset:10240
  v_cvt_pk_bf16_f32 v95, v244, v245
  v_mfma_f32_16x16x32_bf16 v[36:39], a[52:55], a[80:83], v[36:39]
  s_add_u32 m0, s69, 98304
  s_mov_b32 s72, 131072
  ds_read_b64_tr_b16 a[20:21], v233 offset:2048
  ds_read_b64_tr_b16 a[22:23], v233 offset:10240
  v_mfma_f32_16x16x32_bf16 v[44:47], a[52:55], a[84:87], v[44:47]
  buffer_load_dwordx4 v228, s[44:47], s72 offen offset:0 lds
  v_mfma_f32_16x16x32_bf16 v[32:35], a[56:59], a[88:91], v[32:35]
  ds_read_b64_tr_b16 a[24:25], v232 offset:3072
  v_max_f32 v248, v72, v73
  v_mfma_f32_16x16x32_bf16 v[40:43], a[56:59], a[92:95], v[40:43]
  ds_read_b64_tr_b16 a[26:27], v232 offset:11264
  v_cmp_lt_f32 vcc, s73, v248
  v_mfma_f32_16x16x32_bf16 v[36:39], a[60:63], a[88:91], v[36:39]
  ds_read_b64_tr_b16 a[28:29], v233 offset:3072
  ds_read_b64_tr_b16 a[30:31], v233 offset:11264
  v_mfma_f32_16x16x32_bf16 v[44:47], a[60:63], a[92:95], v[44:47]
  buffer_load_dwordx4 v229, s[44:47], s72 offen offset:1024 lds
  s_cbranch_vccnz L_st25
L_rt25:
  s_waitcnt lgkmcnt(8)
  v_mfma_f32_16x16x32_bf16 v[96:99], a[0:3], v[88:91], v[96:99]
  ds_read_b64_tr_b16 a[32:33], v232 offset:4096
  v_add_f32 v246, v246, v72
  v_mfma_f32_16x16x32_bf16 v[104:107], a[0:3], v[92:95], v[104:107]
  ds_read_b64_tr_b16 a[34:35], v232 offset:12288
  v_add_f32 v247, v247, v73
  v_mfma_f32_16x16x32_bf16 v[100:103], a[4:7], v[88:91], v[100:103]
  ds_read_b64_tr_b16 a[36:37], v233 offset:4096
  ds_read_b64_tr_b16 a[38:39], v233 offset:12288
  v_mfma_f32_16x16x32_bf16 v[108:111], a[4:7], v[92:95], v[108:111]
  buffer_load_dwordx4 v230, s[44:47], s72 offen offset:2048 lds
  v_mfma_f32_16x16x32_bf16 v[112:115], a[8:11], v[88:91], v[112:115]
  ds_read_b64_tr_b16 a[40:41], v232 offset:5120
  v_exp_f32 v242, v32
  v_mfma_f32_16x16x32_bf16 v[120:123], a[8:11], v[92:95], v[120:123]
  ds_read_b64_tr_b16 a[42:43], v232 offset:13312
  v_exp_f32 v243, v33
  v_mfma_f32_16x16x32_bf16 v[116:119], a[12:15], v[88:91], v[116:119]
  ds_read_b64_tr_b16 a[44:45], v233 offset:5120
  ds_read_b64_tr_b16 a[46:47], v233 offset:13312
  v_mfma_f32_16x16x32_bf16 v[124:127], a[12:15], v[92:95], v[124:127]
  buffer_load_dwordx4 v231, s[44:47], s72 offen offset:3072 lds
  s_waitcnt lgkmcnt(8)
  v_mfma_f32_16x16x32_bf16 v[128:131], a[16:19], v[88:91], v[128:131]
  ds_read_b64_tr_b16 a[48:49], v232 offset:6144
  v_exp_f32 v244, v34
  v_mfma_f32_16x16x32_bf16 v[136:139], a[16:19], v[92:95], v[136:139]
  ds_read_b64_tr_b16 a[50:51], v232 offset:14336
  v_add_f32 v72, v242, v243
  v_mfma_f32_16x16x32_bf16 v[132:135], a[20:23], v[88:91], v[132:135]
  ds_read_b64_tr_b16 a[52:53], v233 offset:6144
  ds_read_b64_tr_b16 a[54:55], v233 offset:14336
  v_mfma_f32_16x16x32_bf16 v[140:143], a[20:23], v[92:95], v[140:143]
  s_mov_b32 s0, 3072
  buffer_load_dword a252, v249, s[36:39], s0 offen
  v_mfma_f32_16x16x32_bf16 v[144:147], a[24:27], v[88:91], v[144:147]
  ds_read_b64_tr_b16 a[56:57], v232 offset:7168
  v_exp_f32 v245, v35
  v_mfma_f32_16x16x32_bf16 v[152:155], a[24:27], v[92:95], v[152:155]
  ds_read_b64_tr_b16 a[58:59], v232 offset:15360
  v_cvt_pk_bf16_f32 v80, v242, v243
  v_mfma_f32_16x16x32_bf16 v[148:151], a[28:31], v[88:91], v[148:151]
  ds_read_b64_tr_b16 a[60:61], v233 offset:7168
  ds_read_b64_tr_b16 a[62:63], v233 offset:15360
  v_mfma_f32_16x16x32_bf16 v[156:159], a[28:31], v[92:95], v[156:159]
  s_add_u32 m0, s95, 143360
  s_add_u32 s94, s97, 0
  s_mov_b64 exec, 0xffff
  buffer_load_dwordx4 v222, s[64:67], s94 offen lds
  s_mov_b64 exec, -1
  s_waitcnt lgkmcnt(8)
  v_mfma_f32_16x16x32_bf16 v[160:163], a[32:35], v[88:91], v[160:163]
  ds_read_b128 a[0:3], v240 offset:16384
  v_exp_f32 v242, v36
  v_mfma_f32_16x16x32_bf16 v[168:171], a[32:35], v[92:95], v[168:171]
  v_add_f32 v72, v72, v244
  v_add_f32 v72, v72, v245
  v_mfma_f32_16x16x32_bf16 v[164:167], a[36:39], v[88:91], v[164:167]
  ds_read_b128 a[4:7], v240 offset:24576
  v_exp_f32 v243, v37
  v_mfma_f32_16x16x32_bf16 v[172:175], a[36:39], v[92:95], v[172:175]
  s_add_u32 m0, s95, 143616
  s_add_u32 s94, s97, 57344
  s_mov_b64 exec, 0xffff
  buffer_load_dwordx4 v222, s[64:67], s94 offen lds
  s_mov_b64 exec, -1
  v_mfma_f32_16x16x32_bf16 v[176:179], a[40:43], v[88:91], v[176:179]
  ds_read_b128 a[8:11], v240 offset:17408
  v_cvt_pk_bf16_f32 v81, v244, v245
  v_mfma_f32_16x16x32_bf16 v[184:187], a[40:43], v[92:95], v[184:187]
  v_exp_f32 v244, v38
  v_mfma_f32_16x16x32_bf16 v[180:183], a[44:47], v[88:91], v[180:183]
  ds_read_b128 a[12:15], v240 offset:25600
  v_add_f32 v72, v72, v242
  v_mfma_f32_16x16x32_bf16 v[188:191], a[44:47], v[92:95], v[188:191]
  s_add_u32 m0, s95, 143872
  s_add_u32 s94, s97, 114688
  s_mov_b64 exec, 0xffff
  buffer_load_dwordx4 v222, s[64:67], s94 offen lds
  s_mov_b64 exec, -1
  s_waitcnt lgkmcnt(4)
  v_mfma_f32_16x16x32_bf16 v[192:195], a[48:51], v[88:91], v[192:195]
  ds_read_b128 a[16:19], v240 offset:18432
  v_add_f32 v72, v72, v243
  v_mfma_f32_16x16x32_bf16 v[200:203], a[48:51], v[92:95], v[200:203]
  v_exp_f32 v245, v39
  v_mfma_f32_16x16x32_bf16 v[196:199], a[52:55], v[88:91], v[196:199]
  ds_read_b128 a[20:23], v240 offset:26624
  v_cvt_pk_bf16_f32 v82, v242, v243
  v_mfma_f32_16x16x32_bf16 v[204:207], a[52:55], v[92:95], v[204:207]
  s_add_u32 m0, s95, 144128
  s_add_u32 s94, s97, 172032
  s_mov_b64 exec, 0xffff
  buffer_load_dwordx4 v222, s[64:67], s94 offen lds
  s_mov_b64 exec, -1
  v_mfma_f32_16x16x32_bf16 a[96:99], a[56:59], v[88:91], a[96:99]
  ds_read_b128 a[24:27], v240 offset:19456
  v_mfma_f32_16x16x32_bf16 a[104:107], a[56:59], v[92:95], a[104:107]
  v_exp_f32 v242, v40
  v_mfma_f32_16x16x32_bf16 a[100:103], a[60:63], v[88:91], a[100:103]
  ds_read_b128 a[28:31], v240 offset:27648
  v_add_f32 v72, v72, v244
  v_mfma_f32_16x16x32_bf16 a[108:111], a[60:63], v[92:95], a[108:111]
  v_add_f32 v72, v72, v245
  s_waitcnt lgkmcnt(4)
  v_mfma_f32_16x16x32_bf16 v[48:51], a[0:3], v[0:3], v[64:67]
  ds_read_b128 a[32:35], v240 offset:20480
  v_exp_f32 v243, v41
  v_mfma_f32_16x16x32_bf16 v[56:59], a[0:3], v[4:7], v[68:71]
  v_cvt_pk_bf16_f32 v83, v244, v245
  v_exp_f32 v244, v42
  v_mfma_f32_16x16x32_bf16 v[52:55], a[4:7], v[0:3], v[64:67]
  ds_read_b128 a[36:39], v240 offset:28672
  v_add_f32 v73, v242, v243
  v_mfma_f32_16x16x32_bf16 v[60:63], a[4:7], v[4:7], v[68:71]
  v_exp_f32 v245, v43
  v_mfma_f32_16x16x32_bf16 v[48:51], a[8:11], v[8:11], v[48:51]
  ds_read_b128 a[40:43], v240 offset:21504
  v_cvt_pk_bf16_f32 v84, v242, v243
  v_mfma_f32_16x16x32_bf16 v[56:59], a[8:11], v[12:15], v[56:59]
  v_exp_f32 v242, v44
  v_mfma_f32_16x16x32_bf16 v[52:55], a[12:15], v[8:11], v[52:55]
  ds_read_b128 a[44:47], v240 offset:29696
  v_add_f32 v73, v73, v244
  v_mfma_f32_16x16x32_bf16 v[60:63], a[12:15], v[12:15], v[60:63]
  v_add_f32 v73, v73, v245
  s_waitcnt lgkmcnt(4)
  v_mfma_f32_16x16x32_bf16 v[48:51], a[16:19], v[16:19], v[48:51]
  s_waitcnt vmcnt(25)
  s_barrier
  ds_read_b128 a[48:51], v240 offset:22528
  v_mfma_f32_16x16x32_bf16 v[56:59], a[16:19], v[20:23], v[56:59]
  v_exp_f32 v243, v45
  v_mfma_f32_16x16x32_bf16 v[52:55], a[20:23], v[16:19], v[52:55]
  s_add_u32 m0, s69, 114688
  s_mov_b32 s72, 163840
  ds_read_b128 a[52:55], v240 offset:30720
  v_mfma_f32_16x16x32_bf16 v[60:63], a[20:23], v[20:23], v[60:63]
  buffer_load_dwordx4 v224, s[40:43], s72 offen offset:0 lds
  v_mfma_f32_16x16x32_bf16 v[48:51], a[24:27], v[24:27], v[48:51]
  ds_read_b128 a[56:59], v240 offset:23552
  v_cvt_pk_bf16_f32 v85, v244, v245
  v_mfma_f32_16x16x32_bf16 v[56:59], a[24:27], v[28:31], v[56:59]
  v_exp_f32 v244, v46
  v_mfma_f32_16x16x32_bf16 v[52:55], a[28:31], v[24:27], v[52:55]
  ds_read_b128 a[60:63], v240 offset:31744
  v_add_f32 v73, v73, v242
  v_mfma_f32_16x16x32_bf16 v[60:63], a[28:31], v[28:31], v[60:63]
  buffer_load_dwordx4 v225, s[40:43], s72 offen offset:1024 lds
  s_waitcnt lgkmcnt(4)
  v_mfma_f32_16x16x32_bf16 v[48:51], a[32:35], a[64:67], v[48:51]
  ds_read_b64_tr_b16 a[0:1], v232 offset:32768
  v_add_f32 v73, v73, v243
  v_mfma_f32_16x16x32_bf16 v[56:59], a[32:35], a[68:71], v[56:59]
  ds_read_b64_tr_b16 a[2:3], v232 offset:40960
  v_exp_f32 v245, v47
  v_mfma_f32_16x16x32_bf16 v[52:55], a[36:39], a[64:67], v[52:55]
  ds_read_b64_tr_b16 a[4:5], v233 offset:32768
  ds_read_b64_tr_b16 a[6:7], v233 offset:40960
  v_mfma_f32_16x16x32_bf16 v[60:63], a[36:39], a[68:71], v[60:63]
  buffer_load_dwordx4 v226, s[40:43], s72 offen offset:2048 lds
  v_mfma_f32_16x16x32_bf16 v[48:51], a[40:43], a[72:75], v[48:51]
  ds_read_b64_tr_b16 a[8:9], v232 offset:33792
  v_cvt_pk_bf16_f32 v86, v242, v243
  v_mfma_f32_16x16x32_bf16 v[56:59], a[40:43], a[76:79], v[56:59]
  ds_read_b64_tr_b16 a[10:11], v232 offset:41984
  v_add_f32 v73, v73, v244
  v_mfma_f32_16x16x32_bf16 v[52:55], a[44:47], a[72:75], v[52:55]
  ds_read_b64_tr_b16 a[12:13], v233 offset:33792
  ds_read_b64_tr_b16 a[14:15], v233 offset:41984
  v_mfma_f32_16x16x32_bf16 v[60:63], a[44:47], a[76:79], v[60:63]
  buffer_load_dwordx4 v227, s[40:43], s72 offen offset:3072 lds
  s_waitcnt lgkmcnt(8)
  v_mfma_f32_16x16x32_bf16 v[48:51], a[48:51], a[80:83], v[48:51]
  ds_read_b64_tr_b16 a[16:17], v232 offset:34816
  v_add_f32 v73, v73, v245
  v_mfma_f32_16x16x32_bf16 v[56:59], a[48:51], a[84:87], v[56:59]
  ds_read_b64_tr_b16 a[18:19], v232 offset:43008
  v_cvt_pk_bf16_f32 v87, v244, v245
  v_mfma_f32_16x16x32_bf16 v[52:55], a[52:55], a[80:83], v[52:55]
  s_add_u32 m0, s69, 0
  s_mov_b32 s72, 147456
  ds_read_b64_tr_b16 a[20:21], v233 offset:34816
  ds_read_b64_tr_b16 a[22:23], v233 offset:43008
  v_mfma_f32_16x16x32_bf16 v[60:63], a[52:55], a[84:87], v[60:63]
  buffer_load_dwordx4 v228, s[44:47], s72 offen offset:0 lds
  v_mfma_f32_16x16x32_bf16 v[48:51], a[56:59], a[88:91], v[48:51]
  ds_read_b64_tr_b16 a[24:25], v232 offset:35840
  v_max_f32 v248, v72, v73
  v_mfma_f32_16x16x32_bf16 v[56:59], a[56:59], a[92:95], v[56:59]
  ds_read_b64_tr_b16 a[26:27], v232 offset:44032
  v_cmp_lt_f32 vcc, s73, v248
  v_mfma_f32_16x16x32_bf16 v[52:55], a[60:63], a[88:91], v[52:55]
  ds_read_b64_tr_b16 a[28:29], v233 offset:35840
  ds_read_b64_tr_b16 a[30:31], v233 offset:44032
  v_mfma_f32_16x16x32_bf16 v[60:63], a[60:63], a[92:95], v[60:63]
  buffer_load_dwordx4 v229, s[44:47], s72 offen offset:1024 lds
  s_cbranch_vccnz L_st27
L_rt27:
  s_waitcnt lgkmcnt(8)
  v_mfma_f32_16x16x32_bf16 v[96:99], a[0:3], v[80:83], v[96:99]
  ds_read_b64_tr_b16 a[32:33], v232 offset:36864
  v_add_f32 v246, v246, v72
  v_mfma_f32_16x16x32_bf16 v[104:107], a[0:3], v[84:87], v[104:107]
  ds_read_b64_tr_b16 a[34:35], v232 offset:45056
  v_add_f32 v247, v247, v73
  v_mfma_f32_16x16x32_bf16 v[100:103], a[4:7], v[80:83], v[100:103]
  ds_read_b64_tr_b16 a[36:37], v233 offset:36864
  ds_read_b64_tr_b16 a[38:39], v233 offset:45056
  v_mfma_f32_16x16x32_bf16 v[108:111], a[4:7], v[84:87], v[108:111]
  buffer_load_dwordx4 v230, s[44:47], s72 offen offset:2048 lds
  v_mfma_f32_16x16x32_bf16 v[112:115], a[8:11], v[80:83], v[112:115]
  ds_read_b64_tr_b16 a[40:41], v232 offset:37888
  v_exp_f32 v242, v48
  v_mfma_f32_16x16x32_bf16 v[120:123], a[8:11], v[84:87], v[120:123]
  ds_read_b64_tr_b16 a[42:43], v232 offset:46080
  v_exp_f32 v243, v49
  v_mfma_f32_16x16x32_bf16 v[116:119], a[12:15], v[80:83], v[116:119]
  ds_read_b64_tr_b16 a[44:45], v233 offset:37888
  ds_read_b64_tr_b16 a[46:47], v233 offset:46080
  v_mfma_f32_16x16x32_bf16 v[124:127], a[12:15], v[84:87], v[124:127]
  buffer_load_dwordx4 v231, s[44:47], s72 offen offset:3072 lds
  s_waitcnt lgkmcnt(8)
  v_mfma_f32_16x16x32_bf16 v[128:131], a[16:19], v[80:83], v[128:131]
  ds_read_b64_tr_b16 a[48:49], v232 offset:38912
  v_exp_f32 v244, v50
  v_mfma_f32_16x16x32_bf16 v[136:139], a[16:19], v[84:87], v[136:139]
  ds_read_b64_tr_b16 a[50:51], v232 offset:47104
  v_add_f32 v72, v242, v243
  v_mfma_f32_16x16x32_bf16 v[132:135], a[20:23], v[80:83], v[132:135]
  ds_read_b64_tr_b16 a[52:53], v233 offset:38912
  ds_read_b64_tr_b16 a[54:55], v233 offset:47104
  v_mfma_f32_16x16x32_bf16 v[140:143], a[20:23], v[84:87], v[140:143]
  buffer_store_dwordx4 a[248:251], v250, s[48:51], s5 offen offset:0 sc1
  v_mfma_f32_16x16x32_bf16 v[144:147], a[24:27], v[80:83], v[144:147]
  ds_read_b64_tr_b16 a[56:57], v232 offset:39936
  v_exp_f32 v245, v51
  v_mfma_f32_16x16x32_bf16 v[152:155], a[24:27], v[84:87], v[152:155]
  ds_read_b64_tr_b16 a[58:59], v232 offset:48128
  v_cvt_pk_bf16_f32 v88, v242, v243
  v_mfma_f32_16x16x32_bf16 v[148:151], a[28:31], v[80:83], v[148:151]
  ds_read_b64_tr_b16 a[60:61], v233 offset:39936
  ds_read_b64_tr_b16 a[62:63], v233 offset:48128
  v_mfma_f32_16x16x32_bf16 v[156:159], a[28:31], v[84:87], v[156:159]
  buffer_store_dwordx4 a[248:251], v250, s[48:51], s5 offen offset:1024 sc1
  s_waitcnt lgkmcnt(8)
  v_mfma_f32_16x16x32_bf16 v[160:163], a[32:35], v[80:83], v[160:163]
  ds_read_b128 a[0:3], v240 offset:49152
  v_exp_f32 v242, v52
  v_mfma_f32_16x16x32_bf16 v[168:171], a[32:35], v[84:87], v[168:171]
  v_add_f32 v72, v72, v244
  v_add_f32 v72, v72, v245
  v_mfma_f32_16x16x32_bf16 v[164:167], a[36:39], v[80:83], v[164:167]
  ds_read_b128 a[4:7], v240 offset:57344
  v_exp_f32 v243, v53
  v_mfma_f32_16x16x32_bf16 v[172:175], a[36:39], v[84:87], v[172:175]
  buffer_load_dword a144, v223, s[52:55], s92 offen offset:0
  v_mfma_f32_16x16x32_bf16 v[176:179], a[40:43], v[80:83], v[176:179]
  ds_read_b128 a[8:11], v240 offset:50176
  v_cvt_pk_bf16_f32 v89, v244, v245
  v_mfma_f32_16x16x32_bf16 v[184:187], a[40:43], v[84:87], v[184:187]
  v_exp_f32 v244, v54
  v_mfma_f32_16x16x32_bf16 v[180:183], a[44:47], v[80:83], v[180:183]
  ds_read_b128 a[12:15], v240 offset:58368
  v_add_f32 v72, v72, v242
  v_mfma_f32_16x16x32_bf16 v[188:191], a[44:47], v[84:87], v[188:191]
  buffer_load_dword a145, v223, s[52:55], s92 offen offset:896
  s_waitcnt lgkmcnt(4)
  v_mfma_f32_16x16x32_bf16 v[192:195], a[48:51], v[80:83], v[192:195]
  ds_read_b128 a[16:19], v240 offset:51200
  v_add_f32 v72, v72, v243
  v_mfma_f32_16x16x32_bf16 v[200:203], a[48:51], v[84:87], v[200:203]
  v_exp_f32 v245, v55
  v_mfma_f32_16x16x32_bf16 v[196:199], a[52:55], v[80:83], v[196:199]
  ds_read_b128 a[20:23], v240 offset:59392
  v_cvt_pk_bf16_f32 v90, v242, v243
  v_mfma_f32_16x16x32_bf16 v[204:207], a[52:55], v[84:87], v[204:207]
  buffer_load_dword a146, v223, s[52:55], s92 offen offset:1792
  v_mfma_f32_16x16x32_bf16 a[96:99], a[56:59], v[80:83], a[96:99]
  ds_read_b128 a[24:27], v240 offset:52224
  v_exp_f32 v242, v56
  v_mfma_f32_16x16x32_bf16 a[104:107], a[56:59], v[84:87], a[104:107]
  v_add_f32 v72, v72, v244
  v_add_f32 v72, v72, v245
  v_mfma_f32_16x16x32_bf16 a[100:103], a[60:63], v[80:83], a[100:103]
  ds_read_b128 a[28:31], v240 offset:60416
  v_exp_f32 v243, v57
  v_mfma_f32_16x16x32_bf16 a[108:111], a[60:63], v[84:87], a[108:111]
  buffer_load_dword a147, v223, s[52:55], s92 offen offset:2688
  s_waitcnt lgkmcnt(4)
  v_mfma_f32_16x16x32_bf16 v[32:35], a[0:3], v[0:3], v[64:67]
  ds_read_b128 a[32:35], v240 offset:53248
  v_cvt_pk_bf16_f32 v91, v244, v245
  v_mfma_f32_16x16x32_bf16 v[40:43], a[0:3], v[4:7], v[68:71]
  v_exp_f32 v244, v58
  v_mfma_f32_16x16x32_bf16 v[36:39], a[4:7], v[0:3], v[64:67]
  ds_read_b128 a[36:39], v240 offset:61440
  v_add_f32 v73, v242, v243
  v_mfma_f32_16x16x32_bf16 v[44:47], a[4:7], v[4:7], v[68:71]
  v_exp_f32 v245, v59
  v_mfma_f32_16x16x32_bf16 v[32:35], a[8:11], v[8:11], v[32:35]
  ds_read_b128 a[40:43], v240 offset:54272
  v_cvt_pk_bf16_f32 v92, v242, v243
  v_mfma_f32_16x16x32_bf16 v[40:43], a[8:11], v[12:15], v[40:43]
  v_exp_f32 v242, v60
  v_mfma_f32_16x16x32_bf16 v[36:39], a[12:15], v[8:11], v[36:39]
  ds_read_b128 a[44:47], v240 offset:62464
  v_add_f32 v73, v73, v244
  v_mfma_f32_16x16x32_bf16 v[44:47], a[12:15], v[12:15], v[44:47]
  v_add_f32 v73, v73, v245
  s_waitcnt lgkmcnt(4)
  v_mfma_f32_16x16x32_bf16 v[32:35], a[16:19], v[16:19], v[32:35]
  s_waitcnt vmcnt(23)
  s_barrier
  ds_read_b128 a[48:51], v240 offset:55296
  v_mfma_f32_16x16x32_bf16 v[40:43], a[16:19], v[20:23], v[40:43]
  v_exp_f32 v243, v61
  v_mfma_f32_16x16x32_bf16 v[36:39], a[20:23], v[16:19], v[36:39]
  s_add_u32 m0, s69, 16384
  s_mov_b32 s72, 180224
  ds_read_b128 a[52:55], v240 offset:63488
  v_mfma_f32_16x16x32_bf16 v[44:47], a[20:23], v[20:23], v[44:47]
  buffer_load_dwordx4 v224, s[40:43], s72 offen offset:0 lds
  v_mfma_f32_16x16x32_bf16 v[32:35], a[24:27], v[24:27], v[32:35]
  ds_read_b128 a[56:59], v240 offset:56320
  v_cvt_pk_bf16_f32 v93, v244, v245
  v_mfma_f32_16x16x32_bf16 v[40:43], a[24:27], v[28:31], v[40:43]
  v_exp_f32 v244, v62
  v_mfma_f32_16x16x32_bf16 v[36:39], a[28:31], v[24:27], v[36:39]
  ds_read_b128 a[60:63], v240 offset:64512
  v_add_f32 v73, v73, v242
  v_mfma_f32_16x16x32_bf16 v[44:47], a[28:31], v[28:31], v[44:47]
  buffer_load_dwordx4 v225, s[40:43], s72 offen offset:1024 lds
  s_waitcnt lgkmcnt(4)
  v_mfma_f32_16x16x32_bf16 v[32:35], a[32:35], a[64:67], v[32:35]
  ds_read_b64_tr_b16 a[0:1], v234 offset:0
  v_add_f32 v73, v73, v243
  v_mfma_f32_16x16x32_bf16 v[40:43], a[32:35], a[68:71], v[40:43]
  ds_read_b64_tr_b16 a[2:3], v234 offset:8192
  v_exp_f32 v245, v63
  v_mfma_f32_16x16x32_bf16 v[36:39], a[36:39], a[64:67], v[36:39]
  ds_read_b64_tr_b16 a[4:5], v235 offset:0
  ds_read_b64_tr_b16 a[6:7], v235 offset:8192
  v_mfma_f32_16x16x32_bf16 v[44:47], a[36:39], a[68:71], v[44:47]
  buffer_load_dwordx4 v226, s[40:43], s72 offen offset:2048 lds
  v_mfma_f32_16x16x32_bf16 v[32:35], a[40:43], a[72:75], v[32:35]
  ds_read_b64_tr_b16 a[8:9], v234 offset:1024
  v_cvt_pk_bf16_f32 v94, v242, v243
  v_mfma_f32_16x16x32_bf16 v[40:43], a[40:43], a[76:79], v[40:43]
  ds_read_b64_tr_b16 a[10:11], v234 offset:9216
  v_add_f32 v73, v73, v244
  v_mfma_f32_16x16x32_bf16 v[36:39], a[44:47], a[72:75], v[36:39]
  ds_read_b64_tr_b16 a[12:13], v235 offset:1024
  ds_read_b64_tr_b16 a[14:15], v235 offset:9216
  v_mfma_f32_16x16x32_bf16 v[44:47], a[44:47], a[76:79], v[44:47]
  buffer_load_dwordx4 v227, s[40:43], s72 offen offset:3072 lds
  s_waitcnt lgkmcnt(8)
  v_mfma_f32_16x16x32_bf16 v[32:35], a[48:51], a[80:83], v[32:35]
  ds_read_b64_tr_b16 a[16:17], v234 offset:2048
  v_add_f32 v73, v73, v245
  v_mfma_f32_16x16x32_bf16 v[40:43], a[48:51], a[84:87], v[40:43]
  ds_read_b64_tr_b16 a[18:19], v234 offset:10240
  v_cvt_pk_bf16_f32 v95, v244, v245
  v_mfma_f32_16x16x32_bf16 v[36:39], a[52:55], a[80:83], v[36:39]
  s_add_u32 m0, s69, 32768
  s_mov_b32 s72, 163840
  ds_read_b64_tr_b16 a[20:21], v235 offset:2048
  ds_read_b64_tr_b16 a[22:23], v235 offset:10240
  v_mfma_f32_16x16x32_bf16 v[44:47], a[52:55], a[84:87], v[44:47]
  buffer_load_dwordx4 v228, s[44:47], s72 offen offset:0 lds
  v_mfma_f32_16x16x32_bf16 v[32:35], a[56:59], a[88:91], v[32:35]
  ds_read_b64_tr_b16 a[24:25], v234 offset:3072
  v_max_f32 v248, v72, v73
  v_mfma_f32_16x16x32_bf16 v[40:43], a[56:59], a[92:95], v[40:43]
  ds_read_b64_tr_b16 a[26:27], v234 offset:11264
  v_cmp_lt_f32 vcc, s73, v248
  v_mfma_f32_16x16x32_bf16 v[36:39], a[60:63], a[88:91], v[36:39]
  ds_read_b64_tr_b16 a[28:29], v235 offset:3072
  ds_read_b64_tr_b16 a[30:31], v235 offset:11264
  v_mfma_f32_16x16x32_bf16 v[44:47], a[60:63], a[92:95], v[44:47]
  buffer_load_dwordx4 v229, s[44:47], s72 offen offset:1024 lds
  s_cbranch_vccnz L_st29
L_rt29:
  s_waitcnt lgkmcnt(8)
  v_mfma_f32_16x16x32_bf16 v[96:99], a[0:3], v[88:91], v[96:99]
  ds_read_b64_tr_b16 a[32:33], v234 offset:4096
  v_add_f32 v246, v246, v72
  v_mfma_f32_16x16x32_bf16 v[104:107], a[0:3], v[92:95], v[104:107]
  ds_read_b64_tr_b16 a[34:35], v234 offset:12288
  v_add_f32 v247, v247, v73
  v_mfma_f32_16x16x32_bf16 v[100:103], a[4:7], v[88:91], v[100:103]
  ds_read_b64_tr_b16 a[36:37], v235 offset:4096
  ds_read_b64_tr_b16 a[38:39], v235 offset:12288
  v_mfma_f32_16x16x32_bf16 v[108:111], a[4:7], v[92:95], v[108:111]
  buffer_load_dwordx4 v230, s[44:47], s72 offen offset:2048 lds
  v_mfma_f32_16x16x32_bf16 v[112:115], a[8:11], v[88:91], v[112:115]
  ds_read_b64_tr_b16 a[40:41], v234 offset:5120
  v_exp_f32 v242, v32
  v_mfma_f32_16x16x32_bf16 v[120:123], a[8:11], v[92:95], v[120:123]
  ds_read_b64_tr_b16 a[42:43], v234 offset:13312
  v_exp_f32 v243, v33
  v_mfma_f32_16x16x32_bf16 v[116:119], a[12:15], v[88:91], v[116:119]
  ds_read_b64_tr_b16 a[44:45], v235 offset:5120
  ds_read_b64_tr_b16 a[46:47], v235 offset:13312
  v_mfma_f32_16x16x32_bf16 v[124:127], a[12:15], v[92:95], v[124:127]
  buffer_load_dwordx4 v231, s[44:47], s72 offen offset:3072 lds
  s_waitcnt lgkmcnt(8)
  v_mfma_f32_16x16x32_bf16 v[128:131], a[16:19], v[88:91], v[128:131]
  ds_read_b64_tr_b16 a[48:49], v234 offset:6144
  v_exp_f32 v244, v34
  v_mfma_f32_16x16x32_bf16 v[136:139], a[16:19], v[92:95], v[136:139]
  ds_read_b64_tr_b16 a[50:51], v234 offset:14336
  v_add_f32 v72, v242, v243
  v_mfma_f32_16x16x32_bf16 v[132:135], a[20:23], v[88:91], v[132:135]
  ds_read_b64_tr_b16 a[52:53], v235 offset:6144
  ds_read_b64_tr_b16 a[54:55], v235 offset:14336
  v_mfma_f32_16x16x32_bf16 v[140:143], a[20:23], v[92:95], v[140:143]
  s_mov_b32 s0, 134144
  buffer_load_dword a252, v249, s[36:39], s0 offen
  v_mfma_f32_16x16x32_bf16 v[144:147], a[24:27], v[88:91], v[144:147]
  ds_read_b64_tr_b16 a[56:57], v234 offset:7168
  v_exp_f32 v245, v35
  v_mfma_f32_16x16x32_bf16 v[152:155], a[24:27], v[92:95], v[152:155]
  ds_read_b64_tr_b16 a[58:59], v234 offset:15360
  v_cvt_pk_bf16_f32 v80, v242, v243
  v_mfma_f32_16x16x32_bf16 v[148:151], a[28:31], v[88:91], v[148:151]
  ds_read_b64_tr_b16 a[60:61], v235 offset:7168
  ds_read_b64_tr_b16 a[62:63], v235 offset:15360
  v_mfma_f32_16x16x32_bf16 v[156:159], a[28:31], v[92:95], v[156:159]
  buffer_load_dword a148, v223, s[52:55], s93 offen offset:0
  s_waitcnt lgkmcnt(8)
  v_mfma_f32_16x16x32_bf16 v[160:163], a[32:35], v[88:91], v[160:163]
  ds_read_b128 a[0:3], v241 offset:16384
  v_exp_f32 v242, v36
  v_mfma_f32_16x16x32_bf16 v[168:171], a[32:35], v[92:95], v[168:171]
  v_add_f32 v72, v72, v244
  v_add_f32 v72, v72, v245
  s_waitcnt vmcnt(24)
  v_mfma_f32_16x16x32_bf16 v[164:167], a[36:39], v[88:91], v[164:167]
  ds_read_b128 a[4:7], v241 offset:24576
  v_exp_f32 v243, v37
  v_mfma_f32_16x16x32_bf16 v[172:175], a[36:39], v[92:95], v[172:175]
  buffer_load_dword a149, v223, s[52:55], s93 offen offset:896
  v_mfma_f32_16x16x32_bf16 v[176:179], a[40:43], v[88:91], v[176:179]
  ds_read_b128 a[8:11], v241 offset:17408
  v_cvt_pk_bf16_f32 v81, v244, v245
  ds_read_b64_tr_b16 a[128:129], v208 offset:0
  v_mfma_f32_16x16x32_bf16 v[184:187], a[40:43], v[92:95], v[184:187]
  v_exp_f32 v244, v38
  ds_read_b64_tr_b16 a[130:131], v208 offset:64
  v_mfma_f32_16x16x32_bf16 v[180:183], a[44:47], v[88:91], v[180:183]
  ds_read_b128 a[12:15], v241 offset:25600
  v_add_f32 v72, v72, v242
  ds_read_b64_tr_b16 a[132:133], v208 offset:512
  v_mfma_f32_16x16x32_bf16 v[188:191], a[44:47], v[92:95], v[188:191]
  buffer_load_dword a150, v223, s[52:55], s93 offen offset:1792
  s_waitcnt lgkmcnt(7)
  v_mfma_f32_16x16x32_bf16 v[192:195], a[48:51], v[88:91], v[192:195]
  ds_read_b128 a[16:19], v241 offset:18432
  v_add_f32 v72, v72, v243
  ds_read_b64_tr_b16 a[134:135], v208 offset:576
  v_mfma_f32_16x16x32_bf16 v[200:203], a[48:51], v[92:95], v[200:203]
  v_exp_f32 v245, v39
  ds_read_b64_tr_b16 a[136:137], v208 offset:4096
  v_mfma_f32_16x16x32_bf16 v[196:199], a[52:55], v[88:91], v[196:199]
  ds_read_b128 a[20:23], v241 offset:26624
  v_cvt_pk_bf16_f32 v82, v242, v243
  ds_read_b64_tr_b16 a[138:139], v208 offset:4160
  v_mfma_f32_16x16x32_bf16 v[204:207], a[52:55], v[92:95], v[204:207]
  buffer_load_dword a151, v223, s[52:55], s93 offen offset:2688
  v_mfma_f32_16x16x32_bf16 a[96:99], a[56:59], v[88:91], a[96:99]
  ds_read_b128 a[24:27], v241 offset:19456
  ds_read_b64_tr_b16 a[140:141], v208 offset:4608
  ds_read_b64_tr_b16 a[142:143], v208 offset:4672
  v_mfma_f32_16x16x32_bf16 a[104:107], a[56:59], v[92:95], a[104:107]
  v_exp_f32 v242, v40
  v_mfma_f32_16x16x32_bf16 a[100:103], a[60:63], v[88:91], a[100:103]
  ds_read_b128 a[28:31], v241 offset:27648
  v_add_f32 v72, v72, v244
  v_mfma_f32_16x16x32_bf16 a[108:111], a[60:63], v[92:95], a[108:111]
  v_add_f32 v72, v72, v245
  s_waitcnt lgkmcnt(10)
  v_mfma_f32_16x16x32_bf16 v[48:51], a[0:3], v[0:3], v[64:67]
  ds_read_b128 a[32:35], v241 offset:20480
  v_exp_f32 v243, v41
  v_mfma_f32_16x16x32_bf16 v[56:59], a[0:3], v[4:7], v[68:71]
  v_cvt_pk_bf16_f32 v83, v244, v245
  v_exp_f32 v244, v42
  v_mfma_f32_16x16x32_bf16 v[52:55], a[4:7], v[0:3], v[64:67]
  ds_read_b128 a[36:39], v241 offset:28672
  v_add_f32 v73, v242, v243
  v_mfma_f32_16x16x32_bf16 v[60:63], a[4:7], v[4:7], v[68:71]
  v_exp_f32 v245, v43
  v_mfma_f32_16x16x32_bf16 v[48:51], a[8:11], v[8:11], v[48:51]
  ds_read_b128 a[40:43], v241 offset:21504
  v_cvt_pk_bf16_f32 v84, v242, v243
  v_mfma_f32_16x16x32_bf16 v[56:59], a[8:11], v[12:15], v[56:59]
  v_exp_f32 v242, v44
  v_mfma_f32_16x16x32_bf16 v[216:219], a[128:131], a[152:155], 0
  v_mfma_f32_16x16x32_bf16 v[52:55], a[12:15], v[8:11], v[52:55]
  ds_read_b128 a[44:47], v241 offset:29696
  v_add_f32 v73, v73, v244
  v_mfma_f32_16x16x32_bf16 v[60:63], a[12:15], v[12:15], v[60:63]
  v_add_f32 v73, v73, v245
  s_waitcnt lgkmcnt(4)
  v_mfma_f32_16x16x32_bf16 v[48:51], a[16:19], v[16:19], v[48:51]
  s_waitcnt vmcnt(23)
  s_barrier
  ds_read_b128 a[48:51], v241 offset:22528
  v_mfma_f32_16x16x32_bf16 v[56:59], a[16:19], v[20:23], v[56:59]
  v_exp_f32 v243, v45
  v_mfma_f32_16x16x32_bf16 v[216:219], a[132:135], a[152:155], v[216:219]
  v_mfma_f32_16x16x32_bf16 v[52:55], a[20:23], v[16:19], v[52:55]
  s_add_u32 m0, s69, 49152
  s_mov_b32 s72, 196608
  ds_read_b128 a[52:55], v241 offset:30720
  v_mfma_f32_16x16x32_bf16 v[60:63], a[20:23], v[20:23], v[60:63]
  buffer_load_dwordx4 v224, s[40:43], s72 offen offset:0 lds
  v_mfma_f32_16x16x32_bf16 v[48:51], a[24:27], v[24:27], v[48:51]
  ds_read_b128 a[56:59], v241 offset:23552
  v_cvt_pk_bf16_f32 v85, v244, v245
  v_mfma_f32_16x16x32_bf16 v[56:59], a[24:27], v[28:31], v[56:59]
  v_exp_f32 v244, v46
  v_mfma_f32_16x16x32_bf16 v[212:215], a[128:131], a[112:115], 0
  v_mfma_f32_16x16x32_bf16 v[52:55], a[28:31], v[24:27], v[52:55]
  ds_read_b128 a[60:63], v241 offset:31744
  v_add_f32 v73, v73, v242
  v_mfma_f32_16x16x32_bf16 v[60:63], a[28:31], v[28:31], v[60:63]
  buffer_load_dwordx4 v225, s[40:43], s72 offen offset:1024 lds
  s_waitcnt lgkmcnt(4)
  v_mfma_f32_16x16x32_bf16 v[48:51], a[32:35], a[64:67], v[48:51]
  ds_read_b64_tr_b16 a[0:1], v234 offset:32768
  ds_read_b64_tr_b16 a[2:3], v234 offset:40960
  v_add_f32 v73, v73, v243
  v_mfma_f32_16x16x32_bf16 v[56:59], a[32:35], a[68:71], v[56:59]
  v_exp_f32 v245, v47
  v_mfma_f32_16x16x32_bf16 v[212:215], a[132:135], a[116:119], v[212:215]
  v_mfma_f32_16x16x32_bf16 v[52:55], a[36:39], a[64:67], v[52:55]
  ds_read_b64_tr_b16 a[4:5], v235 offset:32768
  ds_read_b64_tr_b16 a[6:7], v235 offset:40960
  v_mfma_f32_16x16x32_bf16 v[60:63], a[36:39], a[68:71], v[60:63]
  buffer_load_dwordx4 v226, s[40:43], s72 offen offset:2048 lds
  v_mfma_f32_16x16x32_bf16 v[48:51], a[40:43], a[72:75], v[48:51]
  ds_read_b64_tr_b16 a[8:9], v234 offset:33792
  ds_read_b64_tr_b16 a[10:11], v234 offset:41984
  v_cvt_pk_bf16_f32 v86, v242, v243
  v_mfma_f32_16x16x32_bf16 v[56:59], a[40:43], a[76:79], v[56:59]
  v_add_f32 v73, v73, v244
  s_cmp_eq_u32 s68, 3
  s_cbranch_scc1 L_w3a
  v_mfma_f32_16x16x32_bf16 v[216:219], a[136:139], a[152:155], v[216:219]
  v_mfma_f32_16x16x32_bf16 v[212:215], a[136:139], a[120:123], v[212:215]
L_w3a:
  v_mfma_f32_16x16x32_bf16 v[52:55], a[44:47], a[72:75], v[52:55]
  ds_read_b64_tr_b16 a[12:13], v235 offset:33792
  ds_read_b64_tr_b16 a[14:15], v235 offset:41984
  v_mfma_f32_16x16x32_bf16 v[60:63], a[44:47], a[76:79], v[60:63]
  buffer_load_dwordx4 v227, s[40:43], s72 offen offset:3072 lds
  s_waitcnt lgkmcnt(8)
  v_mfma_f32_16x16x32_bf16 v[48:51], a[48:51], a[80:83], v[48:51]
  ds_read_b64_tr_b16 a[16:17], v234 offset:34816
  ds_read_b64_tr_b16 a[18:19], v234 offset:43008
  v_add_f32 v73, v73, v245
  v_mfma_f32_16x16x32_bf16 v[56:59], a[48:51], a[84:87], v[56:59]
  v_cvt_pk_bf16_f32 v87, v244, v245
  s_cmp_eq_u32 s68, 3
  s_cbranch_scc1 L_w3b
  v_mfma_f32_16x16x32_bf16 v[216:219], a[140:143], a[152:155], v[216:219]
  v_mfma_f32_16x16x32_bf16 v[212:215], a[140:143], a[124:127], v[212:215]
L_w3b:
  v_mfma_f32_16x16x32_bf16 v[52:55], a[52:55], a[80:83], v[52:55]
  s_add_u32 m0, s69, 65536
  s_mov_b32 s72, 180224
  ds_read_b64_tr_b16 a[20:21], v235 offset:34816
  ds_read_b64_tr_b16 a[22:23], v235 offset:43008
  v_mfma_f32_16x16x32_bf16 v[60:63], a[52:55], a[84:87], v[60:63]
  buffer_load_dwordx4 v228, s[44:47], s72 offen offset:0 lds
  v_mfma_f32_16x16x32_bf16 v[48:51], a[56:59], a[88:91], v[48:51]
  ds_read_b64_tr_b16 a[24:25], v234 offset:35840
  v_max_f32 v248, v72, v73
  v_mul_f32 v212, v212, v210
  v_mfma_f32_16x16x32_bf16 v[56:59], a[56:59], a[92:95], v[56:59]
  ds_read_b64_tr_b16 a[26:27], v234 offset:44032
  v_cmp_lt_f32 vcc, s73, v248
  v_mul_f32 v213, v213, v210
  v_mfma_f32_16x16x32_bf16 v[52:55], a[60:63], a[88:91], v[52:55]
  ds_read_b64_tr_b16 a[28:29], v235 offset:35840
  ds_read_b64_tr_b16 a[30:31], v235 offset:44032
  v_mul_f32 v214, v214, v210
  v_mfma_f32_16x16x32_bf16 v[60:63], a[60:63], a[92:95], v[60:63]
  buffer_load_dwordx4 v229, s[44:47], s72 offen offset:1024 lds
  s_cbranch_vccnz L_st31
L_rt31:
  s_waitcnt lgkmcnt(8)
  v_mfma_f32_16x16x32_bf16 v[96:99], a[0:3], v[80:83], v[96:99]
  ds_read_b64_tr_b16 a[32:33], v234 offset:36864
  v_add_f32 v246, v246, v72
  v_mul_f32 v215, v215, v210
  v_mfma_f32_16x16x32_bf16 v[104:107], a[0:3], v[84:87], v[104:107]
  ds_read_b64_tr_b16 a[34:35], v234 offset:45056
  v_add_f32 v247, v247, v73
  v_fmac_f32 v212, v216, v211
  v_mfma_f32_16x16x32_bf16 v[100:103], a[4:7], v[80:83], v[100:103]
  ds_read_b64_tr_b16 a[36:37], v235 offset:36864
  ds_read_b64_tr_b16 a[38:39], v235 offset:45056
  v_fmac_f32 v213, v217, v211
  v_mfma_f32_16x16x32_bf16 v[108:111], a[4:7], v[84:87], v[108:111]
  buffer_load_dwordx4 v230, s[44:47], s72 offen offset:2048 lds
  v_mfma_f32_16x16x32_bf16 v[112:115], a[8:11], v[80:83], v[112:115]
  ds_read_b64_tr_b16 a[40:41], v234 offset:37888
  v_exp_f32 v242, v48
  v_mfma_f32_16x16x32_bf16 v[120:123], a[8:11], v[84:87], v[120:123]
  ds_read_b64_tr_b16 a[42:43], v234 offset:46080
  v_exp_f32 v243, v49
  v_mfma_f32_16x16x32_bf16 v[116:119], a[12:15], v[80:83], v[116:119]
  ds_read_b64_tr_b16 a[44:45], v235 offset:37888
  ds_read_b64_tr_b16 a[46:47], v235 offset:46080
  v_fmac_f32 v214, v218, v211
  v_mfma_f32_16x16x32_bf16 v[124:127], a[12:15], v[84:87], v[124:127]
  buffer_load_dwordx4 v231, s[44:47], s72 offen offset:3072 lds
  s_waitcnt lgkmcnt(8)
  v_mfma_f32_16x16x32_bf16 v[128:131], a[16:19], v[80:83], v[128:131]
  ds_read_b64_tr_b16 a[48:49], v234 offset:38912
  v_exp_f32 v244, v50
  v_mfma_f32_16x16x32_bf16 v[136:139], a[16:19], v[84:87], v[136:139]
  ds_read_b64_tr_b16 a[50:51], v234 offset:47104
  v_add_f32 v72, v242, v243
  v_mfma_f32_16x16x32_bf16 v[132:135], a[20:23], v[80:83], v[132:135]
  ds_read_b64_tr_b16 a[52:53], v235 offset:38912
  ds_read_b64_tr_b16 a[54:55], v235 offset:47104
  v_mfma_f32_16x16x32_bf16 v[140:143], a[20:23], v[84:87], v[140:143]
  buffer_store_dwordx4 a[248:251], v250, s[48:51], s6 offen offset:0 sc1
  v_mfma_f32_16x16x32_bf16 v[144:147], a[24:27], v[80:83], v[144:147]
  ds_read_b64_tr_b16 a[56:57], v234 offset:39936
  v_exp_f32 v245, v51
  v_mfma_f32_16x16x32_bf16 v[152:155], a[24:27], v[84:87], v[152:155]
  ds_read_b64_tr_b16 a[58:59], v234 offset:48128
  v_cvt_pk_bf16_f32 v88, v242, v243
  v_mfma_f32_16x16x32_bf16 v[148:151], a[28:31], v[80:83], v[148:151]
  ds_read_b64_tr_b16 a[60:61], v235 offset:39936
  ds_read_b64_tr_b16 a[62:63], v235 offset:48128
  v_mfma_f32_16x16x32_bf16 v[156:159], a[28:31], v[84:87], v[156:159]
  buffer_store_dwordx4 a[248:251], v250, s[48:51], s6 offen offset:1024 sc1
  s_waitcnt lgkmcnt(8)
  v_mfma_f32_16x16x32_bf16 v[160:163], a[32:35], v[80:83], v[160:163]
  ds_read_b128 a[0:3], v241 offset:49152
  v_fmac_f32 v215, v219, v211
  s_lshl_b32 s87, s68, 10
  v_mfma_f32_16x16x32_bf16 v[168:171], a[32:35], v[84:87], v[168:171]
  v_exp_f32 v242, v52
  v_mfma_f32_16x16x32_bf16 v[164:167], a[36:39], v[80:83], v[164:167]
  ds_read_b128 a[4:7], v241 offset:57344
  v_add_f32 v72, v72, v244
  v_mfma_f32_16x16x32_bf16 v[172:175], a[36:39], v[84:87], v[172:175]
  buffer_store_dwordx4 a[248:251], v250, s[48:51], s7 offen offset:0 sc1
  v_mfma_f32_16x16x32_bf16 v[176:179], a[40:43], v[80:83], v[176:179]
  ds_read_b128 a[8:11], v241 offset:50176
  v_add_f32 v72, v72, v245
  v_mfma_f32_16x16x32_bf16 v[184:187], a[40:43], v[84:87], v[184:187]
  v_exp_f32 v243, v53
  v_mfma_f32_16x16x32_bf16 v[180:183], a[44:47], v[80:83], v[180:183]
  ds_read_b128 a[12:15], v241 offset:58368
  v_cvt_pk_bf16_f32 v89, v244, v245
  v_mfma_f32_16x16x32_bf16 v[188:191], a[44:47], v[84:87], v[188:191]
  s_add_u32 s87, s87, 149504
  v_add_u32 v208, s87, v250
  s_waitcnt lgkmcnt(4)
  v_mfma_f32_16x16x32_bf16 v[192:195], a[48:51], v[80:83], v[192:195]
  ds_read_b128 a[16:19], v241 offset:51200
  ds_write_b128 v208, v[212:215]
  v_mfma_f32_16x16x32_bf16 v[200:203], a[48:51], v[84:87], v[200:203]
  v_exp_f32 v244, v54
  v_mfma_f32_16x16x32_bf16 v[196:199], a[52:55], v[80:83], v[196:199]
  ds_read_b128 a[20:23], v241 offset:59392
  v_add_f32 v72, v72, v242
  v_mfma_f32_16x16x32_bf16 v[204:207], a[52:55], v[84:87], v[204:207]
  v_add_f32 v72, v72, v243
  v_exp_f32 v245, v55
  v_mfma_f32_16x16x32_bf16 a[96:99], a[56:59], v[80:83], a[96:99]
  ds_read_b128 a[24:27], v241 offset:52224
  v_cvt_pk_bf16_f32 v90, v242, v243
  v_mfma_f32_16x16x32_bf16 a[104:107], a[56:59], v[84:87], a[104:107]
  v_exp_f32 v242, v56
  v_mfma_f32_16x16x32_bf16 a[100:103], a[60:63], v[80:83], a[100:103]
  ds_read_b128 a[28:31], v241 offset:60416
  v_add_f32 v72, v72, v244
  v_mfma_f32_16x16x32_bf16 a[108:111], a[60:63], v[84:87], a[108:111]
  v_add_f32 v72, v72, v245
  s_waitcnt lgkmcnt(5)
  v_mfma_f32_16x16x32_bf16 v[32:35], a[0:3], v[0:3], v[64:67]
  ds_read_b128 a[32:35], v241 offset:53248
  v_exp_f32 v243, v57
  v_mfma_f32_16x16x32_bf16 v[40:43], a[0:3], v[4:7], v[68:71]
  v_cvt_pk_bf16_f32 v91, v244, v245
  v_exp_f32 v244, v58
  v_mfma_f32_16x16x32_bf16 v[36:39], a[4:7], v[0:3], v[64:67]
  ds_read_b128 a[36:39], v241 offset:61440
  v_add_f32 v73, v242, v243
  v_mfma_f32_16x16x32_bf16 v[44:47], a[4:7], v[4:7], v[68:71]
  v_exp_f32 v245, v59
  v_mfma_f32_16x16x32_bf16 v[32:35], a[8:11], v[8:11], v[32:35]
  ds_read_b128 a[40:43], v241 offset:54272
  v_cvt_pk_bf16_f32 v92, v242, v243
  v_mfma_f32_16x16x32_bf16 v[40:43], a[8:11], v[12:15], v[40:43]
  v_exp_f32 v242, v60
  v_mfma_f32_16x16x32_bf16 v[36:39], a[12:15], v[8:11], v[36:39]
  ds_read_b128 a[44:47], v241 offset:62464
  v_add_f32 v73, v73, v244
  v_mfma_f32_16x16x32_bf16 v[44:47], a[12:15], v[12:15], v[44:47]
  v_add_f32 v73, v73, v245
  s_waitcnt lgkmcnt(4)
  v_mfma_f32_16x16x32_bf16 v[32:35], a[16:19], v[16:19], v[32:35]
  s_waitcnt vmcnt(20)
  s_waitcnt lgkmcnt(0)
  s_barrier
  ds_read_b128 a[48:51], v241 offset:55296
  v_mfma_f32_16x16x32_bf16 v[40:43], a[16:19], v[20:23], v[40:43]
  v_exp_f32 v243, v61
  v_mfma_f32_16x16x32_bf16 v[36:39], a[20:23], v[16:19], v[36:39]
  s_add_u32 m0, s69, 81920
  s_mov_b32 s72, 212992
  ds_read_b128 a[52:55], v241 offset:63488
  v_mfma_f32_16x16x32_bf16 v[44:47], a[20:23], v[20:23], v[44:47]
  buffer_load_dwordx4 v224, s[40:43], s72 offen offset:0 lds
  v_mfma_f32_16x16x32_bf16 v[32:35], a[24:27], v[24:27], v[32:35]
  ds_read_b128 a[56:59], v241 offset:56320
  v_cvt_pk_bf16_f32 v93, v244, v245
  v_bfe_u32 v208, v251, 2, 1
  v_mfma_f32_16x16x32_bf16 v[40:43], a[24:27], v[28:31], v[40:43]
  v_exp_f32 v244, v62
  v_lshlrev_b32 v208, 8, v208
  v_mfma_f32_16x16x32_bf16 v[36:39], a[28:31], v[24:27], v[36:39]
  ds_read_b128 a[60:63], v241 offset:64512
  v_add_f32 v73, v73, v242
  v_bfe_u32 v209, v251, 3, 1
  v_mfma_f32_16x16x32_bf16 v[44:47], a[28:31], v[28:31], v[44:47]
  buffer_load_dwordx4 v225, s[40:43], s72 offen offset:1024 lds
  v_mfma_f32_16x16x32_bf16 v[32:35], a[32:35], a[64:67], v[32:35]
  ds_read_b64_tr_b16 a[0:1], v232 offset:0
  v_add_f32 v73, v73, v243
  v_lshl_add_u32 v208, v209, 4, v208
  v_mfma_f32_16x16x32_bf16 v[40:43], a[32:35], a[68:71], v[40:43]
  ds_read_b64_tr_b16 a[2:3], v232 offset:8192
  v_exp_f32 v245, v63
  v_mfma_f32_16x16x32_bf16 v[36:39], a[36:39], a[64:67], v[36:39]
  ds_read_b64_tr_b16 a[4:5], v233 offset:0
  ds_read_b64_tr_b16 a[6:7], v233 offset:8192
  v_and_b32 v209, 3, v251
  v_mfma_f32_16x16x32_bf16 v[44:47], a[36:39], a[68:71], v[44:47]
  buffer_load_dwordx4 v226, s[40:43], s72 offen offset:2048 lds
  v_mfma_f32_16x16x32_bf16 v[32:35], a[40:43], a[72:75], v[32:35]
  ds_read_b64_tr_b16 a[8:9], v232 offset:1024
  v_cvt_pk_bf16_f32 v94, v242, v243
  v_lshl_add_u32 v208, v209, 2, v208
  v_mfma_f32_16x16x32_bf16 v[40:43], a[40:43], a[76:79], v[40:43]
  ds_read_b64_tr_b16 a[10:11], v232 offset:9216
  v_add_f32 v73, v73, v244
  v_add_u32 v208, 149504, v208
  v_mfma_f32_16x16x32_bf16 v[36:39], a[44:47], a[72:75], v[36:39]
  ds_read_b64_tr_b16 a[12:13], v233 offset:1024
  ds_read_b64_tr_b16 a[14:15], v233 offset:9216
  ds_read2st64_b32 v[212:213], v208 offset0:0 offset1:2
  v_mfma_f32_16x16x32_bf16 v[44:47], a[44:47], a[76:79], v[44:47]
  buffer_load_dwordx4 v227, s[40:43], s72 offen offset:3072 lds
  s_waitcnt lgkmcnt(9)
  v_mfma_f32_16x16x32_bf16 v[32:35], a[48:51], a[80:83], v[32:35]
  ds_read_b64_tr_b16 a[16:17], v232 offset:2048
  v_add_f32 v73, v73, v245
  ds_read2st64_b32 v[214:215], v208 offset0:4 offset1:6
  v_mfma_f32_16x16x32_bf16 v[40:43], a[48:51], a[84:87], v[40:43]
  ds_read_b64_tr_b16 a[18:19], v232 offset:10240
  v_cvt_pk_bf16_f32 v95, v244, v245
  ds_read2st64_b32 v[216:217], v208 offset0:8 offset1:10
  v_mfma_f32_16x16x32_bf16 v[36:39], a[52:55], a[80:83], v[36:39]
  s_add_u32 m0, s69, 98304
  s_mov_b32 s72, 196608
  ds_read_b64_tr_b16 a[20:21], v233 offset:2048
  ds_read_b64_tr_b16 a[22:23], v233 offset:10240
  v_mfma_f32_16x16x32_bf16 v[44:47], a[52:55], a[84:87], v[44:47]
  buffer_load_dwordx4 v228, s[44:47], s72 offen offset:0 lds
  v_mfma_f32_16x16x32_bf16 v[32:35], a[56:59], a[88:91], v[32:35]
  ds_read_b64_tr_b16 a[24:25], v232 offset:3072
  v_max_f32 v248, v72, v73
  ds_read2st64_b32 v[218:219], v208 offset0:12 offset1:14
  v_mfma_f32_16x16x32_bf16 v[40:43], a[56:59], a[92:95], v[40:43]
  ds_read_b64_tr_b16 a[26:27], v232 offset:11264
  v_cmp_lt_f32 vcc, s73, v248
  s_lshl_b32 s87, s68, 6
  v_mfma_f32_16x16x32_bf16 v[36:39], a[60:63], a[88:91], v[36:39]
  ds_read_b64_tr_b16 a[28:29], v233 offset:3072
  ds_read_b64_tr_b16 a[30:31], v233 offset:11264
  s_add_u32 s87, s87, 153600
  v_mfma_f32_16x16x32_bf16 v[44:47], a[60:63], a[92:95], v[44:47]
  buffer_load_dwordx4 v229, s[44:47], s72 offen offset:1024 lds
  s_cbranch_vccnz L_st33
L_rt33:
  s_waitcnt lgkmcnt(12)
  v_mfma_f32_16x16x32_bf16 v[96:99], a[0:3], v[88:91], v[96:99]
  ds_read_b64_tr_b16 a[32:33], v232 offset:4096
  v_add_f32 v246, v246, v72
  v_and_b32 v209, 15, v251
  v_mfma_f32_16x16x32_bf16 v[104:107], a[0:3], v[92:95], v[104:107]
  ds_read_b64_tr_b16 a[34:35], v232 offset:12288
  v_add_f32 v247, v247, v73
  v_lshlrev_b32 v209, 2, v209
  v_mfma_f32_16x16x32_bf16 v[100:103], a[4:7], v[88:91], v[100:103]
  ds_read_b64_tr_b16 a[36:37], v233 offset:4096
  ds_read_b64_tr_b16 a[38:39], v233 offset:12288
  v_add_u32 v209, s87, v209
  v_mfma_f32_16x16x32_bf16 v[108:111], a[4:7], v[92:95], v[108:111]
  buffer_load_dwordx4 v230, s[44:47], s72 offen offset:2048 lds
  v_mfma_f32_16x16x32_bf16 v[112:115], a[8:11], v[88:91], v[112:115]
  ds_read_b64_tr_b16 a[40:41], v232 offset:5120
  v_exp_f32 v242, v32
  v_mfma_f32_16x16x32_bf16 v[120:123], a[8:11], v[92:95], v[120:123]
  ds_read_b64_tr_b16 a[42:43], v232 offset:13312
  v_exp_f32 v243, v33
  v_mfma_f32_16x16x32_bf16 v[116:119], a[12:15], v[88:91], v[116:119]
  ds_read_b64_tr_b16 a[44:45], v233 offset:5120
  ds_read_b64_tr_b16 a[46:47], v233 offset:13312
  v_mov_b32 v210, s87
  v_mfma_f32_16x16x32_bf16 v[124:127], a[12:15], v[92:95], v[124:127]
  buffer_load_dwordx4 v231, s[44:47], s72 offen offset:3072 lds
  s_waitcnt lgkmcnt(8)
  v_mfma_f32_16x16x32_bf16 v[128:131], a[16:19], v[88:91], v[128:131]
  ds_read_b64_tr_b16 a[48:49], v232 offset:6144
  v_exp_f32 v244, v34
  v_mfma_f32_16x16x32_bf16 v[136:139], a[16:19], v[92:95], v[136:139]
  ds_read_b64_tr_b16 a[50:51], v232 offset:14336
  v_add_f32 v72, v242, v243
  v_add_f32 v212, v212, v214
  v_mfma_f32_16x16x32_bf16 v[132:135], a[20:23], v[88:91], v[132:135]
  ds_read_b64_tr_b16 a[52:53], v233 offset:6144
  ds_read_b64_tr_b16 a[54:55], v233 offset:14336
  v_add_f32 v216, v216, v218
  v_mfma_f32_16x16x32_bf16 v[140:143], a[20:23], v[92:95], v[140:143]
  s_mov_b32 s0, 265216
  buffer_load_dword a252, v249, s[36:39], s0 offen
  v_mfma_f32_16x16x32_bf16 v[144:147], a[24:27], v[88:91], v[144:147]
  ds_read_b64_tr_b16 a[56:57], v232 offset:7168
  v_exp_f32 v245, v35
  v_mfma_f32_16x16x32_bf16 v[152:155], a[24:27], v[92:95], v[152:155]
  ds_read_b64_tr_b16 a[58:59], v232 offset:15360
  v_cvt_pk_bf16_f32 v80, v242, v243
  v_add_f32 v212, v212, v216
  v_mfma_f32_16x16x32_bf16 v[148:151], a[28:31], v[88:91], v[148:151]
  ds_read_b64_tr_b16 a[60:61], v233 offset:7168
  v_mul_f32 v212, 0x41317218, v212
  v_add_f32 v213, v213, v215
  v_mfma_f32_16x16x32_bf16 v[156:159], a[28:31], v[92:95], v[156:159]
  ds_read_b64_tr_b16 a[62:63], v233 offset:15360
  v_add_f32 v217, v217, v219
  s_waitcnt lgkmcnt(8)
  v_mfma_f32_16x16x32_bf16 v[160:163], a[32:35], v[88:91], v[160:163]
  ds_read_b128 a[0:3], v240 offset:16384
  v_add_f32 v213, v213, v217
  v_mul_f32 v213, 0x41317218, v213
  v_mfma_f32_16x16x32_bf16 v[168:171], a[32:35], v[92:95], v[168:171]
  v_exp_f32 v242, v36
  v_cvt_pk_bf16_f32 v213, v212, v213
  v_mfma_f32_16x16x32_bf16 v[164:167], a[36:39], v[88:91], v[164:167]
  ds_read_b128 a[4:7], v240 offset:24576
  v_add_f32 v72, v72, v244
  v_lshlrev_b32 v212, 16, v213
  v_mfma_f32_16x16x32_bf16 v[172:175], a[36:39], v[92:95], v[172:175]
  v_add_f32 v72, v72, v245
  v_exp_f32 v243, v37
  v_mfma_f32_16x16x32_bf16 v[176:179], a[40:43], v[88:91], v[176:179]
  ds_read_b128 a[8:11], v240 offset:17408
  v_cvt_pk_bf16_f32 v81, v244, v245
  v_and_b32 v213, 0xffff0000, v213
  v_mfma_f32_16x16x32_bf16 v[184:187], a[40:43], v[92:95], v[184:187]
  v_exp_f32 v244, v38
  v_mul_f32 v214, 0xbfb8aa3b, v212
  v_mfma_f32_16x16x32_bf16 v[180:183], a[44:47], v[88:91], v[180:183]
  ds_read_b128 a[12:15], v240 offset:25600
  v_add_f32 v72, v72, v242
  v_exp_f32 v214, v214
  v_mfma_f32_16x16x32_bf16 v[188:191], a[44:47], v[92:95], v[188:191]
  v_add_f32 v72, v72, v243
  v_add_f32 v214, 1.0, v214
  s_waitcnt lgkmcnt(4)
  v_mfma_f32_16x16x32_bf16 v[192:195], a[48:51], v[88:91], v[192:195]
  ds_read_b128 a[16:19], v240 offset:18432
  v_rcp_f32 v214, v214
  v_mfma_f32_16x16x32_bf16 v[200:203], a[48:51], v[92:95], v[200:203]
  v_exp_f32 v245, v39
  v_mul_f32 v212, v212, v214
  v_mfma_f32_16x16x32_bf16 v[196:199], a[52:55], v[88:91], v[196:199]
  ds_read_b128 a[20:23], v240 offset:26624
  v_cvt_pk_bf16_f32 v82, v242, v243
  v_cvt_pk_bf16_f32 v212, 0, v212
  v_mfma_f32_16x16x32_bf16 v[204:207], a[52:55], v[92:95], v[204:207]
  v_exp_f32 v242, v40
  v_mul_f32 v212, v212, v213
  v_mfma_f32_16x16x32_bf16 a[96:99], a[56:59], v[88:91], a[96:99]
  ds_read_b128 a[24:27], v240 offset:19456
  v_add_f32 v72, v72, v244
  v_cvt_pk_bf16_f32 v212, 0, v212
  v_mfma_f32_16x16x32_bf16 a[104:107], a[56:59], v[92:95], a[104:107]
  v_add_f32 v72, v72, v245
  v_exp_f32 v243, v41
  v_mfma_f32_16x16x32_bf16 a[100:103], a[60:63], v[88:91], a[100:103]
  ds_read_b128 a[28:31], v240 offset:27648
  v_cvt_pk_bf16_f32 v83, v244, v245
  v_mfma_f32_16x16x32_bf16 a[108:111], a[60:63], v[92:95], a[108:111]
  ds_write_b32 v209, v212
  s_waitcnt lgkmcnt(5)
  v_mfma_f32_16x16x32_bf16 v[48:51], a[0:3], v[0:3], v[64:67]
  ds_read_b128 a[32:35], v240 offset:20480
  ds_read_b128 v[212:215], v210 offset:0
  ds_read_b128 v[216:219], v210 offset:32
  v_mfma_f32_16x16x32_bf16 v[56:59], a[0:3], v[4:7], v[68:71]
  v_exp_f32 v244, v42
  v_accvgpr_read_b32 v209, a144
  v_mfma_f32_16x16x32_bf16 v[52:55], a[4:7], v[0:3], v[64:67]
  ds_read_b128 a[36:39], v240 offset:28672
  v_add_f32 v73, v242, v243
  v_lshlrev_b32 v208, 16, v209
  v_mfma_f32_16x16x32_bf16 v[60:63], a[4:7], v[4:7], v[68:71]
  v_exp_f32 v245, v43
  v_and_b32 v209, 0xffff0000, v209
  v_mfma_f32_16x16x32_bf16 v[48:51], a[8:11], v[8:11], v[48:51]
  ds_read_b128 a[40:43], v240 offset:21504
  v_cvt_pk_bf16_f32 v84, v242, v243
  s_waitcnt lgkmcnt(3)
  v_mul_f32 v220, v208, v212
  v_mfma_f32_16x16x32_bf16 v[56:59], a[8:11], v[12:15], v[56:59]
  v_exp_f32 v242, v44
  v_mul_f32 v221, v209, v212
  v_mfma_f32_16x16x32_bf16 v[52:55], a[12:15], v[8:11], v[52:55]
  ds_read_b128 a[44:47], v240 offset:29696
  v_add_f32 v73, v73, v244
  s_waitcnt lgkmcnt(3)
  v_mul_f32 v222, v208, v216
  v_mfma_f32_16x16x32_bf16 v[60:63], a[12:15], v[12:15], v[60:63]
  v_add_f32 v73, v73, v245
  v_mul_f32 v223, v209, v216
  v_mfma_f32_16x16x32_bf16 v[48:51], a[16:19], v[16:19], v[48:51]
  s_waitcnt vmcnt(16)
  s_barrier
  ds_read_b128 a[48:51], v240 offset:22528
  v_mfma_f32_16x16x32_bf16 v[56:59], a[16:19], v[20:23], v[56:59]
  v_exp_f32 v243, v45
  v_accvgpr_read_b32 v209, a145
  v_mfma_f32_16x16x32_bf16 v[52:55], a[20:23], v[16:19], v[52:55]
  s_add_u32 m0, s69, 114688
  s_mov_b32 s72, 229376
  ds_read_b128 a[52:55], v240 offset:30720
  v_mfma_f32_16x16x32_bf16 v[60:63], a[20:23], v[20:23], v[60:63]
  buffer_load_dwordx4 v224, s[40:43], s72 offen offset:0 lds
  v_mfma_f32_16x16x32_bf16 v[48:51], a[24:27], v[24:27], v[48:51]
  ds_read_b128 a[56:59], v240 offset:23552
  v_cvt_pk_bf16_f32 v85, v244, v245
  v_lshlrev_b32 v208, 16, v209
  v_mfma_f32_16x16x32_bf16 v[56:59], a[24:27], v[28:31], v[56:59]
  v_exp_f32 v244, v46
  v_and_b32 v209, 0xffff0000, v209
  v_mfma_f32_16x16x32_bf16 v[52:55], a[28:31], v[24:27], v[52:55]
  ds_read_b128 a[60:63], v240 offset:31744
  v_add_f32 v73, v73, v242
  v_fmac_f32 v220, v208, v213
  v_mfma_f32_16x16x32_bf16 v[60:63], a[28:31], v[28:31], v[60:63]
  buffer_load_dwordx4 v225, s[40:43], s72 offen offset:1024 lds
  s_waitcnt lgkmcnt(4)
  v_mfma_f32_16x16x32_bf16 v[48:51], a[32:35], a[64:67], v[48:51]
  ds_read_b64_tr_b16 a[0:1], v232 offset:32768
  v_add_f32 v73, v73, v243
  v_fmac_f32 v221, v209, v213
  v_mfma_f32_16x16x32_bf16 v[56:59], a[32:35], a[68:71], v[56:59]
  ds_read_b64_tr_b16 a[2:3], v232 offset:40960
  v_exp_f32 v245, v47
  v_mfma_f32_16x16x32_bf16 v[52:55], a[36:39], a[64:67], v[52:55]
  ds_read_b64_tr_b16 a[4:5], v233 offset:32768
  ds_read_b64_tr_b16 a[6:7], v233 offset:40960
  v_fmac_f32 v222, v208, v217
  v_mfma_f32_16x16x32_bf16 v[60:63], a[36:39], a[68:71], v[60:63]
  buffer_load_dwordx4 v226, s[40:43], s72 offen offset:2048 lds
  v_mfma_f32_16x16x32_bf16 v[48:51], a[40:43], a[72:75], v[48:51]
  ds_read_b64_tr_b16 a[8:9], v232 offset:33792
  v_cvt_pk_bf16_f32 v86, v242, v243
  v_fmac_f32 v223, v209, v217
  v_mfma_f32_16x16x32_bf16 v[56:59], a[40:43], a[76:79], v[56:59]
  ds_read_b64_tr_b16 a[10:11], v232 offset:41984
  v_add_f32 v73, v73, v244
  v_accvgpr_read_b32 v209, a146
  v_mfma_f32_16x16x32_bf16 v[52:55], a[44:47], a[72:75], v[52:55]
  ds_read_b64_tr_b16 a[12:13], v233 offset:33792
  ds_read_b64_tr_b16 a[14:15], v233 offset:41984
  v_lshlrev_b32 v208, 16, v209
  v_mfma_f32_16x16x32_bf16 v[60:63], a[44:47], a[76:79], v[60:63]
  buffer_load_dwordx4 v227, s[40:43], s72 offen offset:3072 lds
  s_waitcnt lgkmcnt(8)
  v_mfma_f32_16x16x32_bf16 v[48:51], a[48:51], a[80:83], v[48:51]
  ds_read_b64_tr_b16 a[16:17], v232 offset:34816
  v_add_f32 v73, v73, v245
  v_and_b32 v209, 0xffff0000, v209
  v_mfma_f32_16x16x32_bf16 v[56:59], a[48:51], a[84:87], v[56:59]
  ds_read_b64_tr_b16 a[18:19], v232 offset:43008
  v_cvt_pk_bf16_f32 v87, v244, v245
  v_fmac_f32 v220, v208, v214
  v_mfma_f32_16x16x32_bf16 v[52:55], a[52:55], a[80:83], v[52:55]
  s_add_u32 m0, s69, 0
  s_mov_b32 s72, 212992
  ds_read_b64_tr_b16 a[20:21], v233 offset:34816
  ds_read_b64_tr_b16 a[22:23], v233 offset:43008
  v_mfma_f32_16x16x32_bf16 v[60:63], a[52:55], a[84:87], v[60:63]
  buffer_load_dwordx4 v228, s[44:47], s72 offen offset:0 lds
  v_mfma_f32_16x16x32_bf16 v[48:51], a[56:59], a[88:91], v[48:51]
  ds_read_b64_tr_b16 a[24:25], v232 offset:35840
  v_max_f32 v248, v72, v73
  v_fmac_f32 v221, v209, v214
  v_mfma_f32_16x16x32_bf16 v[56:59], a[56:59], a[92:95], v[56:59]
  ds_read_b64_tr_b16 a[26:27], v232 offset:44032
  v_cmp_lt_f32 vcc, s73, v248
  v_fmac_f32 v222, v208, v218
  v_mfma_f32_16x16x32_bf16 v[52:55], a[60:63], a[88:91], v[52:55]
  ds_read_b64_tr_b16 a[28:29], v233 offset:35840
  ds_read_b64_tr_b16 a[30:31], v233 offset:44032
  v_fmac_f32 v223, v209, v218
  v_mfma_f32_16x16x32_bf16 v[60:63], a[60:63], a[92:95], v[60:63]
  buffer_load_dwordx4 v229, s[44:47], s72 offen offset:1024 lds
  s_cbranch_vccnz L_st35
L_rt35:
  s_waitcnt lgkmcnt(8)
  v_mfma_f32_16x16x32_bf16 v[96:99], a[0:3], v[80:83], v[96:99]
  ds_read_b64_tr_b16 a[32:33], v232 offset:36864
  v_add_f32 v246, v246, v72
  v_accvgpr_read_b32 v209, a147
  v_mfma_f32_16x16x32_bf16 v[104:107], a[0:3], v[84:87], v[104:107]
  ds_read_b64_tr_b16 a[34:35], v232 offset:45056
  v_add_f32 v247, v247, v73
  v_lshlrev_b32 v208, 16, v209
  v_mfma_f32_16x16x32_bf16 v[100:103], a[4:7], v[80:83], v[100:103]
  ds_read_b64_tr_b16 a[36:37], v233 offset:36864
  ds_read_b64_tr_b16 a[38:39], v233 offset:45056
  v_and_b32 v209, 0xffff0000, v209
  v_mfma_f32_16x16x32_bf16 v[108:111], a[4:7], v[84:87], v[108:111]
  buffer_load_dwordx4 v230, s[44:47], s72 offen offset:2048 lds
  v_mfma_f32_16x16x32_bf16 v[112:115], a[8:11], v[80:83], v[112:115]
  ds_read_b64_tr_b16 a[40:41], v232 offset:37888
  v_exp_f32 v242, v48
  v_mfma_f32_16x16x32_bf16 v[120:123], a[8:11], v[84:87], v[120:123]
  ds_read_b64_tr_b16 a[42:43], v232 offset:46080
  v_exp_f32 v243, v49
  v_mfma_f32_16x16x32_bf16 v[116:119], a[12:15], v[80:83], v[116:119]
  ds_read_b64_tr_b16 a[44:45], v233 offset:37888
  ds_read_b64_tr_b16 a[46:47], v233 offset:46080
  v_fmac_f32 v220, v208, v215
  v_mfma_f32_16x16x32_bf16 v[124:127], a[12:15], v[84:87], v[124:127]
  buffer_load_dwordx4 v231, s[44:47], s72 offen offset:3072 lds
  s_waitcnt lgkmcnt(8)
  v_mfma_f32_16x16x32_bf16 v[128:131], a[16:19], v[80:83], v[128:131]
  ds_read_b64_tr_b16 a[48:49], v232 offset:38912
  v_exp_f32 v244, v50
  v_mfma_f32_16x16x32_bf16 v[136:139], a[16:19], v[84:87], v[136:139]
  ds_read_b64_tr_b16 a[50:51], v232 offset:47104
  v_add_f32 v72, v242, v243
  v_fmac_f32 v221, v209, v215
  v_mfma_f32_16x16x32_bf16 v[132:135], a[20:23], v[80:83], v[132:135]
  ds_read_b64_tr_b16 a[52:53], v233 offset:38912
  ds_read_b64_tr_b16 a[54:55], v233 offset:47104
  v_fmac_f32 v222, v208, v219
  v_mfma_f32_16x16x32_bf16 v[140:143], a[20:23], v[84:87], v[140:143]
  buffer_store_dwordx4 a[248:251], v250, s[48:51], s7 offen offset:1024 sc1
  v_mfma_f32_16x16x32_bf16 v[144:147], a[24:27], v[80:83], v[144:147]
  ds_read_b64_tr_b16 a[56:57], v232 offset:39936
  v_exp_f32 v245, v51
  v_mfma_f32_16x16x32_bf16 v[152:155], a[24:27], v[84:87], v[152:155]
  ds_read_b64_tr_b16 a[58:59], v232 offset:48128
  v_cvt_pk_bf16_f32 v88, v242, v243
  v_fmac_f32 v223, v209, v219
  v_mfma_f32_16x16x32_bf16 v[148:151], a[28:31], v[80:83], v[148:151]
  ds_read_b64_tr_b16 a[60:61], v233 offset:39936
  ds_read_b64_tr_b16 a[62:63], v233 offset:48128
  ds_read_b128 v[212:215], v210 offset:16
  v_mfma_f32_16x16x32_bf16 v[156:159], a[28:31], v[84:87], v[156:159]
  buffer_store_dwordx4 a[248:251], v250, s[48:51], s8 offen offset:0 sc1
  s_waitcnt lgkmcnt(9)
  v_mfma_f32_16x16x32_bf16 v[160:163], a[32:35], v[80:83], v[160:163]
  ds_read_b128 a[0:3], v240 offset:49152
  ds_read_b128 v[216:219], v210 offset:48
  v_accvgpr_read_b32 v209, a148
  v_mfma_f32_16x16x32_bf16 v[168:171], a[32:35], v[84:87], v[168:171]
  v_exp_f32 v242, v52
  v_lshlrev_b32 v208, 16, v209
  v_mfma_f32_16x16x32_bf16 v[164:167], a[36:39], v[80:83], v[164:167]
  ds_read_b128 a[4:7], v240 offset:57344
  v_add_f32 v72, v72, v244
  v_and_b32 v209, 0xffff0000, v209
  v_mfma_f32_16x16x32_bf16 v[172:175], a[36:39], v[84:87], v[172:175]
  buffer_store_dwordx4 a[248:251], v250, s[48:51], s8 offen offset:1024 sc1
  v_mfma_f32_16x16x32_bf16 v[176:179], a[40:43], v[80:83], v[176:179]
  ds_read_b128 a[8:11], v240 offset:50176
  v_add_f32 v72, v72, v245
  s_waitcnt lgkmcnt(4)
  v_fmac_f32 v220, v208, v212
  v_mfma_f32_16x16x32_bf16 v[184:187], a[40:43], v[84:87], v[184:187]
  v_exp_f32 v243, v53
  v_fmac_f32 v221, v209, v212
  v_mfma_f32_16x16x32_bf16 v[180:183], a[44:47], v[80:83], v[180:183]
  ds_read_b128 a[12:15], v240 offset:58368
  v_cvt_pk_bf16_f32 v89, v244, v245
  s_waitcnt lgkmcnt(3)
  v_fmac_f32 v222, v208, v216
  v_mfma_f32_16x16x32_bf16 v[188:191], a[44:47], v[84:87], v[188:191]
  v_fmac_f32 v223, v209, v216
  v_accvgpr_read_b32 v209, a149
  v_mfma_f32_16x16x32_bf16 v[192:195], a[48:51], v[80:83], v[192:195]
  ds_read_b128 a[16:19], v240 offset:51200
  v_lshlrev_b32 v208, 16, v209
  v_and_b32 v209, 0xffff0000, v209
  v_mfma_f32_16x16x32_bf16 v[200:203], a[48:51], v[84:87], v[200:203]
  v_exp_f32 v244, v54
  v_fmac_f32 v220, v208, v213
  v_mfma_f32_16x16x32_bf16 v[196:199], a[52:55], v[80:83], v[196:199]
  ds_read_b128 a[20:23], v240 offset:59392
  v_add_f32 v72, v72, v242
  v_fmac_f32 v221, v209, v213
  v_mfma_f32_16x16x32_bf16 v[204:207], a[52:55], v[84:87], v[204:207]
  v_add_f32 v72, v72, v243
  v_exp_f32 v245, v55
  v_mfma_f32_16x16x32_bf16 a[96:99], a[56:59], v[80:83], a[96:99]
  ds_read_b128 a[24:27], v240 offset:52224
  v_cvt_pk_bf16_f32 v90, v242, v243
  v_fmac_f32 v222, v208, v217
  v_mfma_f32_16x16x32_bf16 a[104:107], a[56:59], v[84:87], a[104:107]
  v_exp_f32 v242, v56
  v_fmac_f32 v223, v209, v217
  v_mfma_f32_16x16x32_bf16 a[100:103], a[60:63], v[80:83], a[100:103]
  ds_read_b128 a[28:31], v240 offset:60416
  v_add_f32 v72, v72, v244
  v_accvgpr_read_b32 v209, a150
  v_mfma_f32_16x16x32_bf16 a[108:111], a[60:63], v[84:87], a[108:111]
  v_add_f32 v72, v72, v245
  v_lshlrev_b32 v208, 16, v209
  s_waitcnt lgkmcnt(4)
  v_mfma_f32_16x16x32_bf16 v[32:35], a[0:3], v[0:3], v[64:67]
  ds_read_b128 a[32:35], v240 offset:53248
  v_exp_f32 v243, v57
  v_mfma_f32_16x16x32_bf16 v[40:43], a[0:3], v[4:7], v[68:71]
  v_cvt_pk_bf16_f32 v91, v244, v245
  v_exp_f32 v244, v58
  v_mfma_f32_16x16x32_bf16 v[36:39], a[4:7], v[0:3], v[64:67]
  ds_read_b128 a[36:39], v240 offset:61440
  v_add_f32 v73, v242, v243
  v_and_b32 v209, 0xffff0000, v209
  v_mfma_f32_16x16x32_bf16 v[44:47], a[4:7], v[4:7], v[68:71]
  v_exp_f32 v245, v59
  v_fmac_f32 v220, v208, v214
  v_mfma_f32_16x16x32_bf16 v[32:35], a[8:11], v[8:11], v[32:35]
  ds_read_b128 a[40:43], v240 offset:54272
  v_cvt_pk_bf16_f32 v92, v242, v243
  v_fmac_f32 v221, v209, v214
  v_mfma_f32_16x16x32_bf16 v[40:43], a[8:11], v[12:15], v[40:43]
  v_exp_f32 v242, v60
  v_fmac_f32 v222, v208, v218
  v_mfma_f32_16x16x32_bf16 v[36:39], a[12:15], v[8:11], v[36:39]
  ds_read_b128 a[44:47], v240 offset:62464
  v_add_f32 v73, v73, v244
  v_fmac_f32 v223, v209, v218
  v_mfma_f32_16x16x32_bf16 v[44:47], a[12:15], v[12:15], v[44:47]
  v_add_f32 v73, v73, v245
  v_accvgpr_read_b32 v209, a151
  s_waitcnt lgkmcnt(4)
  v_mfma_f32_16x16x32_bf16 v[32:35], a[16:19], v[16:19], v[32:35]
  s_waitcnt vmcnt(16)
  s_barrier
  ds_read_b128 a[48:51], v240 offset:55296
  v_mfma_f32_16x16x32_bf16 v[40:43], a[16:19], v[20:23], v[40:43]
  v_exp_f32 v243, v61
  v_lshlrev_b32 v208, 16, v209
  v_mfma_f32_16x16x32_bf16 v[36:39], a[20:23], v[16:19], v[36:39]
  s_add_u32 m0, s69, 16384
  s_mov_b32 s72, 245760
  ds_read_b128 a[52:55], v240 offset:63488
  v_mfma_f32_16x16x32_bf16 v[44:47], a[20:23], v[20:23], v[44:47]
  buffer_load_dwordx4 v224, s[40:43], s72 offen offset:0 lds
  v_mfma_f32_16x16x32_bf16 v[32:35], a[24:27], v[24:27], v[32:35]
  ds_read_b128 a[56:59], v240 offset:56320
  v_cvt_pk_bf16_f32 v93, v244, v245
  v_and_b32 v209, 0xffff0000, v209
  v_mfma_f32_16x16x32_bf16 v[40:43], a[24:27], v[28:31], v[40:43]
  v_exp_f32 v244, v62
  v_fmac_f32 v220, v208, v215
  v_mfma_f32_16x16x32_bf16 v[36:39], a[28:31], v[24:27], v[36:39]
  ds_read_b128 a[60:63], v240 offset:64512
  v_add_f32 v73, v73, v242
  v_fmac_f32 v221, v209, v215
  v_mfma_f32_16x16x32_bf16 v[44:47], a[28:31], v[28:31], v[44:47]
  buffer_load_dwordx4 v225, s[40:43], s72 offen offset:1024 lds
  s_waitcnt lgkmcnt(4)
  v_mfma_f32_16x16x32_bf16 v[32:35], a[32:35], a[64:67], v[32:35]
  ds_read_b64_tr_b16 a[0:1], v234 offset:0
  v_add_f32 v73, v73, v243
  v_fmac_f32 v222, v208, v219
  v_mfma_f32_16x16x32_bf16 v[40:43], a[32:35], a[68:71], v[40:43]
  ds_read_b64_tr_b16 a[2:3], v234 offset:8192
  v_exp_f32 v245, v63
  v_mfma_f32_16x16x32_bf16 v[36:39], a[36:39], a[64:67], v[36:39]
  ds_read_b64_tr_b16 a[4:5], v235 offset:0
  ds_read_b64_tr_b16 a[6:7], v235 offset:8192
  v_fmac_f32 v223, v209, v219
  v_mfma_f32_16x16x32_bf16 v[44:47], a[36:39], a[68:71], v[44:47]
  buffer_load_dwordx4 v226, s[40:43], s72 offen offset:2048 lds
  v_mfma_f32_16x16x32_bf16 v[32:35], a[40:43], a[72:75], v[32:35]
  ds_read_b64_tr_b16 a[8:9], v234 offset:1024
  v_cvt_pk_bf16_f32 v94, v242, v243
  v_lshlrev_b32 v208, 2, v251
  v_mfma_f32_16x16x32_bf16 v[40:43], a[40:43], a[76:79], v[40:43]
  ds_read_b64_tr_b16 a[10:11], v234 offset:9216
  v_add_f32 v73, v73, v244
  v_mfma_f32_16x16x32_bf16 v[36:39], a[44:47], a[72:75], v[36:39]
  ds_read_b64_tr_b16 a[12:13], v235 offset:1024
  ds_read_b64_tr_b16 a[14:15], v235 offset:9216
  v_mfma_f32_16x16x32_bf16 v[44:47], a[44:47], a[76:79], v[44:47]
  buffer_load_dwordx4 v227, s[40:43], s72 offen offset:3072 lds
  s_waitcnt lgkmcnt(8)
  v_mfma_f32_16x16x32_bf16 v[32:35], a[48:51], a[80:83], v[32:35]
  ds_read_b64_tr_b16 a[16:17], v234 offset:2048
  v_add_f32 v73, v73, v245
  v_mfma_f32_16x16x32_bf16 v[40:43], a[48:51], a[84:87], v[40:43]
  ds_read_b64_tr_b16 a[18:19], v234 offset:10240
  v_cvt_pk_bf16_f32 v95, v244, v245
  v_mfma_f32_16x16x32_bf16 v[36:39], a[52:55], a[80:83], v[36:39]
  s_add_u32 m0, s69, 32768
  s_mov_b32 s72, 229376
  ds_read_b64_tr_b16 a[20:21], v235 offset:2048
  ds_read_b64_tr_b16 a[22:23], v235 offset:10240
  v_mfma_f32_16x16x32_bf16 v[44:47], a[52:55], a[84:87], v[44:47]
  buffer_load_dwordx4 v228, s[44:47], s72 offen offset:0 lds
  v_mfma_f32_16x16x32_bf16 v[32:35], a[56:59], a[88:91], v[32:35]
  ds_read_b64_tr_b16 a[24:25], v234 offset:3072
  v_max_f32 v248, v72, v73
  v_mfma_f32_16x16x32_bf16 v[40:43], a[56:59], a[92:95], v[40:43]
  ds_read_b64_tr_b16 a[26:27], v234 offset:11264
  v_cmp_lt_f32 vcc, s73, v248
  v_mfma_f32_16x16x32_bf16 v[36:39], a[60:63], a[88:91], v[36:39]
  ds_read_b64_tr_b16 a[28:29], v235 offset:3072
  ds_read_b64_tr_b16 a[30:31], v235 offset:11264
  v_mfma_f32_16x16x32_bf16 v[44:47], a[60:63], a[92:95], v[44:47]
  buffer_load_dwordx4 v229, s[44:47], s72 offen offset:1024 lds
  s_cbranch_vccnz L_st37
L_rt37:
  s_waitcnt lgkmcnt(8)
  v_mfma_f32_16x16x32_bf16 v[96:99], a[0:3], v[88:91], v[96:99]
  ds_read_b64_tr_b16 a[32:33], v234 offset:4096
  v_add_f32 v246, v246, v72
  v_mfma_f32_16x16x32_bf16 v[104:107], a[0:3], v[92:95], v[104:107]
  ds_read_b64_tr_b16 a[34:35], v234 offset:12288
  v_add_f32 v247, v247, v73
  v_mfma_f32_16x16x32_bf16 v[100:103], a[4:7], v[88:91], v[100:103]
  ds_read_b64_tr_b16 a[36:37], v235 offset:4096
  ds_read_b64_tr_b16 a[38:39], v235 offset:12288
  v_mfma_f32_16x16x32_bf16 v[108:111], a[4:7], v[92:95], v[108:111]
  buffer_load_dwordx4 v230, s[44:47], s72 offen offset:2048 lds
  v_mfma_f32_16x16x32_bf16 v[112:115], a[8:11], v[88:91], v[112:115]
  ds_read_b64_tr_b16 a[40:41], v234 offset:5120
  v_exp_f32 v242, v32
  v_mfma_f32_16x16x32_bf16 v[120:123], a[8:11], v[92:95], v[120:123]
  ds_read_b64_tr_b16 a[42:43], v234 offset:13312
  v_exp_f32 v243, v33
  v_mfma_f32_16x16x32_bf16 v[116:119], a[12:15], v[88:91], v[116:119]
  ds_read_b64_tr_b16 a[44:45], v235 offset:5120
  ds_read_b64_tr_b16 a[46:47], v235 offset:13312
  v_mfma_f32_16x16x32_bf16 v[124:127], a[12:15], v[92:95], v[124:127]
  buffer_load_dwordx4 v231, s[44:47], s72 offen offset:3072 lds
  s_waitcnt lgkmcnt(8)
  v_mfma_f32_16x16x32_bf16 v[128:131], a[16:19], v[88:91], v[128:131]
  ds_read_b64_tr_b16 a[48:49], v234 offset:6144
  v_exp_f32 v244, v34
  v_mfma_f32_16x16x32_bf16 v[136:139], a[16:19], v[92:95], v[136:139]
  ds_read_b64_tr_b16 a[50:51], v234 offset:14336
  v_add_f32 v72, v242, v243
  v_mfma_f32_16x16x32_bf16 v[132:135], a[20:23], v[88:91], v[132:135]
  ds_read_b64_tr_b16 a[52:53], v235 offset:6144
  ds_read_b64_tr_b16 a[54:55], v235 offset:14336
  v_mfma_f32_16x16x32_bf16 v[140:143], a[20:23], v[92:95], v[140:143]
  s_mov_b32 s0, 396288
  buffer_load_dword a252, v249, s[36:39], s0 offen
  v_mfma_f32_16x16x32_bf16 v[144:147], a[24:27], v[88:91], v[144:147]
  ds_read_b64_tr_b16 a[56:57], v234 offset:7168
  v_exp_f32 v245, v35
  v_mfma_f32_16x16x32_bf16 v[152:155], a[24:27], v[92:95], v[152:155]
  ds_read_b64_tr_b16 a[58:59], v234 offset:15360
  v_cvt_pk_bf16_f32 v80, v242, v243
  v_mfma_f32_16x16x32_bf16 v[148:151], a[28:31], v[88:91], v[148:151]
  ds_read_b64_tr_b16 a[60:61], v235 offset:7168
  v_cmp_lt_u32_e64 s[90:91], 55, v251
  v_mov_b32 v209, 2146435072
  v_mfma_f32_16x16x32_bf16 v[156:159], a[28:31], v[92:95], v[156:159]
  ds_read_b64_tr_b16 a[62:63], v235 offset:15360
  s_waitcnt lgkmcnt(8)
  v_mfma_f32_16x16x32_bf16 v[160:163], a[32:35], v[88:91], v[160:163]
  ds_read_b128 a[0:3], v241 offset:16384
  v_cndmask_b32_e64 v208, v208, v209, s[90:91]
  s_mul_i32 s87, s68, 224
  v_mfma_f32_16x16x32_bf16 v[168:171], a[32:35], v[92:95], v[168:171]
  v_exp_f32 v242, v36
  v_mfma_f32_16x16x32_bf16 v[164:167], a[36:39], v[88:91], v[164:167]
  ds_read_b128 a[4:7], v241 offset:24576
  v_add_f32 v72, v72, v244
  v_mfma_f32_16x16x32_bf16 v[172:175], a[36:39], v[92:95], v[172:175]
  v_add_f32 v72, v72, v245
  v_exp_f32 v243, v37
  v_mfma_f32_16x16x32_bf16 v[176:179], a[40:43], v[88:91], v[176:179]
  ds_read_b128 a[8:11], v241 offset:17408
  v_cvt_pk_bf16_f32 v81, v244, v245
  v_mfma_f32_16x16x32_bf16 v[184:187], a[40:43], v[92:95], v[184:187]
  v_exp_f32 v244, v38
  v_mfma_f32_16x16x32_bf16 v[180:183], a[44:47], v[88:91], v[180:183]
  ds_read_b128 a[12:15], v241 offset:25600
  v_add_f32 v72, v72, v242
  v_mfma_f32_16x16x32_bf16 v[188:191], a[44:47], v[92:95], v[188:191]
  v_add_f32 v72, v72, v243
  s_waitcnt lgkmcnt(4)
  v_mfma_f32_16x16x32_bf16 v[192:195], a[48:51], v[88:91], v[192:195]
  ds_read_b128 a[16:19], v241 offset:18432
  s_and_b32 s88, s71, 3
  s_lshl_b32 s88, s88, 12
  v_mfma_f32_16x16x32_bf16 v[200:203], a[48:51], v[92:95], v[200:203]
  v_exp_f32 v245, v39
  v_mfma_f32_16x16x32_bf16 v[196:199], a[52:55], v[88:91], v[196:199]
  ds_read_b128 a[20:23], v241 offset:26624
  v_cvt_pk_bf16_f32 v82, v242, v243
  v_mfma_f32_16x16x32_bf16 v[204:207], a[52:55], v[92:95], v[204:207]
  v_exp_f32 v242, v40
  v_mfma_f32_16x16x32_bf16 a[96:99], a[56:59], v[88:91], a[96:99]
  ds_read_b128 a[24:27], v241 offset:19456
  v_add_f32 v72, v72, v244
  v_mfma_f32_16x16x32_bf16 a[104:107], a[56:59], v[92:95], a[104:107]
  v_add_f32 v72, v72, v245
  v_exp_f32 v243, v41
  v_mfma_f32_16x16x32_bf16 a[100:103], a[60:63], v[88:91], a[100:103]
  ds_read_b128 a[28:31], v241 offset:27648
  v_cvt_pk_bf16_f32 v83, v244, v245
  v_mfma_f32_16x16x32_bf16 a[108:111], a[60:63], v[92:95], a[108:111]
  s_add_u32 s87, s87, s88
  s_add_u32 s87, s87, 16777216
  s_waitcnt lgkmcnt(4)
  v_mfma_f32_16x16x32_bf16 v[48:51], a[0:3], v[0:3], v[64:67]
  ds_read_b128 a[32:35], v241 offset:20480
  s_cmp_ge_u32 s70, 7
  s_cselect_b32 s87, s73, s87
  v_mfma_f32_16x16x32_bf16 v[56:59], a[0:3], v[4:7], v[68:71]
  v_exp_f32 v244, v42
  v_mfma_f32_16x16x32_bf16 v[52:55], a[4:7], v[0:3], v[64:67]
  ds_read_b128 a[36:39], v241 offset:28672
  v_add_f32 v73, v242, v243
  v_mfma_f32_16x16x32_bf16 v[60:63], a[4:7], v[4:7], v[68:71]
  v_exp_f32 v245, v43
  v_mfma_f32_16x16x32_bf16 v[48:51], a[8:11], v[8:11], v[48:51]
  ds_read_b128 a[40:43], v241 offset:21504
  v_cvt_pk_bf16_f32 v84, v242, v243
  v_mfma_f32_16x16x32_bf16 v[56:59], a[8:11], v[12:15], v[56:59]
  v_exp_f32 v242, v44
  v_mfma_f32_16x16x32_bf16 v[52:55], a[12:15], v[8:11], v[52:55]
  ds_read_b128 a[44:47], v241 offset:29696
  v_add_f32 v73, v73, v244
  v_mfma_f32_16x16x32_bf16 v[60:63], a[12:15], v[12:15], v[60:63]
  v_add_f32 v73, v73, v245
  s_waitcnt lgkmcnt(4)
  v_mfma_f32_16x16x32_bf16 v[48:51], a[16:19], v[16:19], v[48:51]
  s_waitcnt vmcnt(16)
  s_barrier
  ds_read_b128 a[48:51], v241 offset:22528
  v_mfma_f32_16x16x32_bf16 v[56:59], a[16:19], v[20:23], v[56:59]
  v_exp_f32 v243, v45
  v_lshrrev_b32 v252, 2, v251
  v_mfma_f32_16x16x32_bf16 v[52:55], a[20:23], v[16:19], v[52:55]
  s_add_u32 m0, s69, 49152
  s_mov_b32 s72, 245760
  ds_read_b128 a[52:55], v241 offset:30720
  v_mfma_f32_16x16x32_bf16 v[60:63], a[20:23], v[20:23], v[60:63]
  buffer_load_dwordx4 v228, s[44:47], s72 offen offset:0 lds
  v_mfma_f32_16x16x32_bf16 v[48:51], a[24:27], v[24:27], v[48:51]
  ds_read_b128 a[56:59], v241 offset:23552
  v_cvt_pk_bf16_f32 v85, v244, v245
  v_mul_u32_u24 v252, 896, v252
  v_mfma_f32_16x16x32_bf16 v[56:59], a[24:27], v[28:31], v[56:59]
  v_exp_f32 v244, v46
  v_bfe_u32 v253, v228, 4, 2
  v_mfma_f32_16x16x32_bf16 v[52:55], a[28:31], v[24:27], v[52:55]
  ds_read_b128 a[60:63], v241 offset:31744
  v_add_f32 v73, v73, v242
  v_lshl_add_u32 v252, v253, 4, v252
  v_mfma_f32_16x16x32_bf16 v[60:63], a[28:31], v[28:31], v[60:63]
  buffer_load_dwordx4 v229, s[44:47], s72 offen offset:1024 lds
  s_waitcnt lgkmcnt(4)
  v_mfma_f32_16x16x32_bf16 v[48:51], a[32:35], a[64:67], v[48:51]
  ds_read_b64_tr_b16 a[0:1], v234 offset:32768
  v_add_f32 v73, v73, v243
  s_mul_i32 s89, s68, 57344
  v_mfma_f32_16x16x32_bf16 v[56:59], a[32:35], a[68:71], v[56:59]
  ds_read_b64_tr_b16 a[2:3], v234 offset:40960
  v_exp_f32 v245, v47
  v_mfma_f32_16x16x32_bf16 v[52:55], a[36:39], a[64:67], v[52:55]
  ds_read_b64_tr_b16 a[4:5], v235 offset:32768
  ds_read_b64_tr_b16 a[6:7], v235 offset:40960
  v_add_u32 v252, s89, v252
  v_mfma_f32_16x16x32_bf16 v[60:63], a[36:39], a[68:71], v[60:63]
  buffer_load_dwordx4 v230, s[44:47], s72 offen offset:2048 lds
  v_mfma_f32_16x16x32_bf16 v[48:51], a[40:43], a[72:75], v[48:51]
  ds_read_b64_tr_b16 a[8:9], v234 offset:33792
  v_cvt_pk_bf16_f32 v86, v242, v243
  v_add_u32 v224, 3072, v252
  v_mfma_f32_16x16x32_bf16 v[56:59], a[40:43], a[76:79], v[56:59]
  ds_read_b64_tr_b16 a[10:11], v234 offset:41984
  v_add_f32 v73, v73, v244
  v_add_u32 v225, 16384, v252
  v_mfma_f32_16x16x32_bf16 v[52:55], a[44:47], a[72:75], v[52:55]
  ds_read_b64_tr_b16 a[12:13], v235 offset:33792
  ds_read_b64_tr_b16 a[14:15], v235 offset:41984
  v_add_u32 v226, 29696, v252
  v_mfma_f32_16x16x32_bf16 v[60:63], a[44:47], a[76:79], v[60:63]
  buffer_load_dwordx4 v231, s[44:47], s72 offen offset:3072 lds
  s_waitcnt lgkmcnt(8)
  v_mfma_f32_16x16x32_bf16 v[48:51], a[48:51], a[80:83], v[48:51]
  ds_read_b64_tr_b16 a[16:17], v234 offset:34816
  v_add_f32 v73, v73, v245
  v_add_u32 v227, 43008, v252
  v_mfma_f32_16x16x32_bf16 v[56:59], a[48:51], a[84:87], v[56:59]
  ds_read_b64_tr_b16 a[18:19], v234 offset:43008
  v_cvt_pk_bf16_f32 v87, v244, v245
  v_mfma_f32_16x16x32_bf16 v[52:55], a[52:55], a[80:83], v[52:55]
  s_add_u32 m0, s69, 65536
  s_add_u32 s72, s76, 0
  ds_read_b64_tr_b16 a[20:21], v235 offset:34816
  ds_read_b64_tr_b16 a[22:23], v235 offset:43008
  v_mfma_f32_16x16x32_bf16 v[60:63], a[52:55], a[84:87], v[60:63]
  buffer_load_dwordx4 v224, s[36:39], s72 offen offset:0 lds
  v_mfma_f32_16x16x32_bf16 v[48:51], a[56:59], a[88:91], v[48:51]
  ds_read_b64_tr_b16 a[24:25], v234 offset:35840
  v_max_f32 v248, v72, v73
  v_mfma_f32_16x16x32_bf16 v[56:59], a[56:59], a[92:95], v[56:59]
  ds_read_b64_tr_b16 a[26:27], v234 offset:44032
  v_cmp_lt_f32 vcc, s73, v248
  v_mfma_f32_16x16x32_bf16 v[52:55], a[60:63], a[88:91], v[52:55]
  ds_read_b64_tr_b16 a[28:29], v235 offset:35840
  ds_read_b64_tr_b16 a[30:31], v235 offset:44032
  v_mfma_f32_16x16x32_bf16 v[60:63], a[60:63], a[92:95], v[60:63]
  buffer_load_dwordx4 v225, s[36:39], s72 offen offset:1024 lds
  s_cbranch_vccnz L_st39
L_rt39:
  s_waitcnt lgkmcnt(8)
  v_mfma_f32_16x16x32_bf16 v[96:99], a[0:3], v[80:83], v[96:99]
  ds_read_b64_tr_b16 a[32:33], v234 offset:36864
  v_add_f32 v246, v246, v72
  v_mfma_f32_16x16x32_bf16 v[104:107], a[0:3], v[84:87], v[104:107]
  ds_read_b64_tr_b16 a[34:35], v234 offset:45056
  v_add_f32 v247, v247, v73
  v_mfma_f32_16x16x32_bf16 v[100:103], a[4:7], v[80:83], v[100:103]
  ds_read_b64_tr_b16 a[36:37], v235 offset:36864
  ds_read_b64_tr_b16 a[38:39], v235 offset:45056
  v_mfma_f32_16x16x32_bf16 v[108:111], a[4:7], v[84:87], v[108:111]
  buffer_load_dwordx4 v226, s[36:39], s72 offen offset:2048 lds
  v_mfma_f32_16x16x32_bf16 v[112:115], a[8:11], v[80:83], v[112:115]
  ds_read_b64_tr_b16 a[40:41], v234 offset:37888
  v_exp_f32 v242, v48
  v_mfma_f32_16x16x32_bf16 v[120:123], a[8:11], v[84:87], v[120:123]
  ds_read_b64_tr_b16 a[42:43], v234 offset:46080
  v_exp_f32 v243, v49
  v_mfma_f32_16x16x32_bf16 v[116:119], a[12:15], v[80:83], v[116:119]
  ds_read_b64_tr_b16 a[44:45], v235 offset:37888
  ds_read_b64_tr_b16 a[46:47], v235 offset:46080
  v_mfma_f32_16x16x32_bf16 v[124:127], a[12:15], v[84:87], v[124:127]
  buffer_load_dwordx4 v227, s[36:39], s72 offen offset:3072 lds
  s_waitcnt lgkmcnt(8)
  v_mfma_f32_16x16x32_bf16 v[128:131], a[16:19], v[80:83], v[128:131]
  ds_read_b64_tr_b16 a[48:49], v234 offset:38912
  v_exp_f32 v244, v50
  v_mfma_f32_16x16x32_bf16 v[136:139], a[16:19], v[84:87], v[136:139]
  ds_read_b64_tr_b16 a[50:51], v234 offset:47104
  v_add_f32 v72, v242, v243
  v_mfma_f32_16x16x32_bf16 v[132:135], a[20:23], v[80:83], v[132:135]
  ds_read_b64_tr_b16 a[52:53], v235 offset:38912
  ds_read_b64_tr_b16 a[54:55], v235 offset:47104
  v_mfma_f32_16x16x32_bf16 v[140:143], a[20:23], v[84:87], v[140:143]
  buffer_store_dwordx4 a[248:251], v250, s[48:51], s9 offen offset:0 sc1
  v_mfma_f32_16x16x32_bf16 v[144:147], a[24:27], v[80:83], v[144:147]
  ds_read_b64_tr_b16 a[56:57], v234 offset:39936
  v_exp_f32 v245, v51
  v_mfma_f32_16x16x32_bf16 v[152:155], a[24:27], v[84:87], v[152:155]
  ds_read_b64_tr_b16 a[58:59], v234 offset:48128
  v_cvt_pk_bf16_f32 v88, v242, v243
  v_mfma_f32_16x16x32_bf16 v[148:151], a[28:31], v[80:83], v[148:151]
  ds_read_b64_tr_b16 a[60:61], v235 offset:39936
  ds_read_b64_tr_b16 a[62:63], v235 offset:48128
  v_mfma_f32_16x16x32_bf16 v[156:159], a[28:31], v[84:87], v[156:159]
  buffer_store_dwordx4 a[248:251], v250, s[48:51], s9 offen offset:1024 sc1
  s_waitcnt lgkmcnt(8)
  v_mfma_f32_16x16x32_bf16 v[160:163], a[32:35], v[80:83], v[160:163]
  ds_read_b128 a[0:3], v241 offset:49152
  v_exp_f32 v242, v52
  v_mfma_f32_16x16x32_bf16 v[168:171], a[32:35], v[84:87], v[168:171]
  v_add_f32 v72, v72, v244
  v_add_f32 v72, v72, v245
  v_mfma_f32_16x16x32_bf16 v[164:167], a[36:39], v[80:83], v[164:167]
  ds_read_b128 a[4:7], v241 offset:57344
  v_exp_f32 v243, v53
  v_mfma_f32_16x16x32_bf16 v[172:175], a[36:39], v[84:87], v[172:175]
  buffer_atomic_add_f32 v220, v208, s[48:51], s87 offen offset:0 sc1
  v_mfma_f32_16x16x32_bf16 v[176:179], a[40:43], v[80:83], v[176:179]
  ds_read_b128 a[8:11], v241 offset:50176
  v_cvt_pk_bf16_f32 v89, v244, v245
  v_mfma_f32_16x16x32_bf16 v[184:187], a[40:43], v[84:87], v[184:187]
  v_exp_f32 v244, v54
  v_mfma_f32_16x16x32_bf16 v[180:183], a[44:47], v[80:83], v[180:183]
  ds_read_b128 a[12:15], v241 offset:58368
  v_add_f32 v72, v72, v242
  v_mfma_f32_16x16x32_bf16 v[188:191], a[44:47], v[84:87], v[188:191]
  buffer_atomic_add_f32 v221, v208, s[48:51], s87 offen offset:896 sc1
  s_waitcnt lgkmcnt(4)
  v_mfma_f32_16x16x32_bf16 v[192:195], a[48:51], v[80:83], v[192:195]
  ds_read_b128 a[16:19], v241 offset:51200
  v_add_f32 v72, v72, v243
  v_mfma_f32_16x16x32_bf16 v[200:203], a[48:51], v[84:87], v[200:203]
  v_exp_f32 v245, v55
  v_mfma_f32_16x16x32_bf16 v[196:199], a[52:55], v[80:83], v[196:199]
  ds_read_b128 a[20:23], v241 offset:59392
  v_cvt_pk_bf16_f32 v90, v242, v243
  v_mfma_f32_16x16x32_bf16 v[204:207], a[52:55], v[84:87], v[204:207]
  buffer_atomic_add_f32 v222, v208, s[48:51], s87 offen offset:1792 sc1
  v_mfma_f32_16x16x32_bf16 a[96:99], a[56:59], v[80:83], a[96:99]
  ds_read_b128 a[24:27], v241 offset:52224
  v_exp_f32 v242, v56
  v_mfma_f32_16x16x32_bf16 a[104:107], a[56:59], v[84:87], a[104:107]
  v_add_f32 v72, v72, v244
  v_add_f32 v72, v72, v245
  v_mfma_f32_16x16x32_bf16 a[100:103], a[60:63], v[80:83], a[100:103]
  ds_read_b128 a[28:31], v241 offset:60416
  v_exp_f32 v243, v57
  v_mfma_f32_16x16x32_bf16 a[108:111], a[60:63], v[84:87], a[108:111]
  buffer_atomic_add_f32 v223, v208, s[48:51], s87 offen offset:2688 sc1
  s_waitcnt lgkmcnt(4)
  v_mfma_f32_16x16x32_bf16 v[32:35], a[0:3], v[0:3], v[64:67]
  ds_read_b128 a[32:35], v241 offset:53248
  v_cvt_pk_bf16_f32 v91, v244, v245
  v_mfma_f32_16x16x32_bf16 v[40:43], a[0:3], v[4:7], v[68:71]
  v_exp_f32 v244, v58
  v_mfma_f32_16x16x32_bf16 v[36:39], a[4:7], v[0:3], v[64:67]
  ds_read_b128 a[36:39], v241 offset:61440
  v_add_f32 v73, v242, v243
  v_mfma_f32_16x16x32_bf16 v[44:47], a[4:7], v[4:7], v[68:71]
  v_exp_f32 v245, v59
  v_mfma_f32_16x16x32_bf16 v[32:35], a[8:11], v[8:11], v[32:35]
  ds_read_b128 a[40:43], v241 offset:54272
  v_cvt_pk_bf16_f32 v92, v242, v243
  v_mfma_f32_16x16x32_bf16 v[40:43], a[8:11], v[12:15], v[40:43]
  v_exp_f32 v242, v60
  v_mfma_f32_16x16x32_bf16 v[36:39], a[12:15], v[8:11], v[36:39]
  ds_read_b128 a[44:47], v241 offset:62464
  v_add_f32 v73, v73, v244
  v_mfma_f32_16x16x32_bf16 v[44:47], a[12:15], v[12:15], v[44:47]
  v_add_f32 v73, v73, v245
  s_waitcnt lgkmcnt(4)
  v_mfma_f32_16x16x32_bf16 v[32:35], a[16:19], v[16:19], v[32:35]
  s_waitcnt vmcnt(19)
  s_barrier
  ds_read_b128 a[48:51], v241 offset:55296
  v_mfma_f32_16x16x32_bf16 v[40:43], a[16:19], v[20:23], v[40:43]
  v_exp_f32 v243, v61
  v_mfma_f32_16x16x32_bf16 v[36:39], a[20:23], v[16:19], v[36:39]
  s_add_u32 m0, s69, 81920
  s_add_u32 s72, s76, 229440
  ds_read_b128 a[52:55], v241 offset:63488
  v_mfma_f32_16x16x32_bf16 v[44:47], a[20:23], v[20:23], v[44:47]
  buffer_load_dwordx4 v224, s[36:39], s72 offen offset:0 lds
  v_mfma_f32_16x16x32_bf16 v[32:35], a[24:27], v[24:27], v[32:35]
  ds_read_b128 a[56:59], v241 offset:56320
  v_cvt_pk_bf16_f32 v93, v244, v245
  v_mfma_f32_16x16x32_bf16 v[40:43], a[24:27], v[28:31], v[40:43]
  v_exp_f32 v244, v62
  v_mfma_f32_16x16x32_bf16 v[36:39], a[28:31], v[24:27], v[36:39]
  ds_read_b128 a[60:63], v241 offset:64512
  v_add_f32 v73, v73, v242
  v_mfma_f32_16x16x32_bf16 v[44:47], a[28:31], v[28:31], v[44:47]
  buffer_load_dwordx4 v225, s[36:39], s72 offen offset:1024 lds
  s_waitcnt lgkmcnt(4)
  v_mfma_f32_16x16x32_bf16 v[32:35], a[32:35], a[64:67], v[32:35]
  ds_read_b64_tr_b16 a[0:1], v232 offset:0
  v_add_f32 v73, v73, v243
  v_mfma_f32_16x16x32_bf16 v[40:43], a[32:35], a[68:71], v[40:43]
  ds_read_b64_tr_b16 a[2:3], v232 offset:8192
  v_exp_f32 v245, v63
  v_mfma_f32_16x16x32_bf16 v[36:39], a[36:39], a[64:67], v[36:39]
  ds_read_b64_tr_b16 a[4:5], v233 offset:0
  ds_read_b64_tr_b16 a[6:7], v233 offset:8192
  v_mfma_f32_16x16x32_bf16 v[44:47], a[36:39], a[68:71], v[44:47]
  buffer_load_dwordx4 v226, s[36:39], s72 offen offset:2048 lds
  v_mfma_f32_16x16x32_bf16 v[32:35], a[40:43], a[72:75], v[32:35]
  ds_read_b64_tr_b16 a[8:9], v232 offset:1024
  v_cvt_pk_bf16_f32 v94, v242, v243
  v_mfma_f32_16x16x32_bf16 v[40:43], a[40:43], a[76:79], v[40:43]
  ds_read_b64_tr_b16 a[10:11], v232 offset:9216
  v_add_f32 v73, v73, v244
  v_mfma_f32_16x16x32_bf16 v[36:39], a[44:47], a[72:75], v[36:39]
  ds_read_b64_tr_b16 a[12:13], v233 offset:1024
  ds_read_b64_tr_b16 a[14:15], v233 offset:9216
  v_mfma_f32_16x16x32_bf16 v[44:47], a[44:47], a[76:79], v[44:47]
  buffer_load_dwordx4 v227, s[36:39], s72 offen offset:3072 lds
  s_waitcnt lgkmcnt(8)
  v_mfma_f32_16x16x32_bf16 v[32:35], a[48:51], a[80:83], v[32:35]
  ds_read_b64_tr_b16 a[16:17], v232 offset:2048
  v_add_f32 v73, v73, v245
  v_mfma_f32_16x16x32_bf16 v[40:43], a[48:51], a[84:87], v[40:43]
  ds_read_b64_tr_b16 a[18:19], v232 offset:10240
  v_cvt_pk_bf16_f32 v95, v244, v245
  v_mfma_f32_16x16x32_bf16 v[36:39], a[52:55], a[80:83], v[36:39]
  s_add_u32 m0, s69, 98304
  s_add_u32 s72, s77, 0
  ds_read_b64_tr_b16 a[20:21], v233 offset:2048
  ds_read_b64_tr_b16 a[22:23], v233 offset:10240
  v_mfma_f32_16x16x32_bf16 v[44:47], a[52:55], a[84:87], v[44:47]
  buffer_load_dwordx4 v224, s[36:39], s72 offen offset:0 lds
  v_mfma_f32_16x16x32_bf16 v[32:35], a[56:59], a[88:91], v[32:35]
  ds_read_b64_tr_b16 a[24:25], v232 offset:3072
  v_max_f32 v248, v72, v73
  v_mfma_f32_16x16x32_bf16 v[40:43], a[56:59], a[92:95], v[40:43]
  ds_read_b64_tr_b16 a[26:27], v232 offset:11264
  v_cmp_lt_f32 vcc, s73, v248
  v_mfma_f32_16x16x32_bf16 v[36:39], a[60:63], a[88:91], v[36:39]
  ds_read_b64_tr_b16 a[28:29], v233 offset:3072
  ds_read_b64_tr_b16 a[30:31], v233 offset:11264
  v_mfma_f32_16x16x32_bf16 v[44:47], a[60:63], a[92:95], v[44:47]
  buffer_load_dwordx4 v225, s[36:39], s72 offen offset:1024 lds
  s_cbranch_vccnz L_st41
L_rt41:
  s_waitcnt lgkmcnt(8)
  v_mfma_f32_16x16x32_bf16 v[96:99], a[0:3], v[88:91], v[96:99]
  ds_read_b64_tr_b16 a[32:33], v232 offset:4096
  v_add_f32 v246, v246, v72
  v_mfma_f32_16x16x32_bf16 v[104:107], a[0:3], v[92:95], v[104:107]
  ds_read_b64_tr_b16 a[34:35], v232 offset:12288
  v_add_f32 v247, v247, v73
  v_mfma_f32_16x16x32_bf16 v[100:103], a[4:7], v[88:91], v[100:103]
  ds_read_b64_tr_b16 a[36:37], v233 offset:4096
  ds_read_b64_tr_b16 a[38:39], v233 offset:12288
  v_mfma_f32_16x16x32_bf16 v[108:111], a[4:7], v[92:95], v[108:111]
  buffer_load_dwordx4 v226, s[36:39], s72 offen offset:2048 lds
  v_mfma_f32_16x16x32_bf16 v[112:115], a[8:11], v[88:91], v[112:115]
  ds_read_b64_tr_b16 a[40:41], v232 offset:5120
  v_exp_f32 v242, v32
  v_mfma_f32_16x16x32_bf16 v[120:123], a[8:11], v[92:95], v[120:123]
  ds_read_b64_tr_b16 a[42:43], v232 offset:13312
  v_exp_f32 v243, v33
  v_mfma_f32_16x16x32_bf16 v[116:119], a[12:15], v[88:91], v[116:119]
  ds_read_b64_tr_b16 a[44:45], v233 offset:5120
  ds_read_b64_tr_b16 a[46:47], v233 offset:13312
  v_mfma_f32_16x16x32_bf16 v[124:127], a[12:15], v[92:95], v[124:127]
  buffer_load_dwordx4 v227, s[36:39], s72 offen offset:3072 lds
  s_waitcnt lgkmcnt(8)
  v_mfma_f32_16x16x32_bf16 v[128:131], a[16:19], v[88:91], v[128:131]
  ds_read_b64_tr_b16 a[48:49], v232 offset:6144
  v_exp_f32 v244, v34
  v_mfma_f32_16x16x32_bf16 v[136:139], a[16:19], v[92:95], v[136:139]
  ds_read_b64_tr_b16 a[50:51], v232 offset:14336
  v_add_f32 v72, v242, v243
  v_mfma_f32_16x16x32_bf16 v[132:135], a[20:23], v[88:91], v[132:135]
  ds_read_b64_tr_b16 a[52:53], v233 offset:6144
  ds_read_b64_tr_b16 a[54:55], v233 offset:14336
  v_mfma_f32_16x16x32_bf16 v[140:143], a[20:23], v[92:95], v[140:143]
  buffer_store_dwordx4 a[248:251], v250, s[48:51], s10 offen offset:0 sc1
  v_mfma_f32_16x16x32_bf16 v[144:147], a[24:27], v[88:91], v[144:147]
  ds_read_b64_tr_b16 a[56:57], v232 offset:7168
  v_exp_f32 v245, v35
  v_mfma_f32_16x16x32_bf16 v[152:155], a[24:27], v[92:95], v[152:155]
  ds_read_b64_tr_b16 a[58:59], v232 offset:15360
  v_cvt_pk_bf16_f32 v80, v242, v243
  v_mfma_f32_16x16x32_bf16 v[148:151], a[28:31], v[88:91], v[148:151]
  ds_read_b64_tr_b16 a[60:61], v233 offset:7168
  ds_read_b64_tr_b16 a[62:63], v233 offset:15360
  v_mfma_f32_16x16x32_bf16 v[156:159], a[28:31], v[92:95], v[156:159]
  buffer_store_dwordx4 a[248:251], v250, s[48:51], s10 offen offset:1024 sc1
  s_waitcnt lgkmcnt(8)
  v_mfma_f32_16x16x32_bf16 v[160:163], a[32:35], v[88:91], v[160:163]
  ds_read_b128 a[0:3], v240 offset:16384
  v_add_u32 v228, 64, v224
  v_mfma_f32_16x16x32_bf16 v[168:171], a[32:35], v[92:95], v[168:171]
  v_exp_f32 v242, v36
  v_mfma_f32_16x16x32_bf16 v[164:167], a[36:39], v[88:91], v[164:167]
  ds_read_b128 a[4:7], v240 offset:24576
  v_add_f32 v72, v72, v244
  v_mfma_f32_16x16x32_bf16 v[172:175], a[36:39], v[92:95], v[172:175]
  v_add_f32 v72, v72, v245
  v_exp_f32 v243, v37
  v_mfma_f32_16x16x32_bf16 v[176:179], a[40:43], v[88:91], v[176:179]
  ds_read_b128 a[8:11], v240 offset:17408
  v_cvt_pk_bf16_f32 v81, v244, v245
  v_mfma_f32_16x16x32_bf16 v[184:187], a[40:43], v[92:95], v[184:187]
  v_exp_f32 v244, v38
  v_mfma_f32_16x16x32_bf16 v[180:183], a[44:47], v[88:91], v[180:183]
  ds_read_b128 a[12:15], v240 offset:25600
  v_add_f32 v72, v72, v242
  v_mfma_f32_16x16x32_bf16 v[188:191], a[44:47], v[92:95], v[188:191]
  v_add_f32 v72, v72, v243
  s_waitcnt lgkmcnt(4)
  v_mfma_f32_16x16x32_bf16 v[192:195], a[48:51], v[88:91], v[192:195]
  ds_read_b128 a[16:19], v240 offset:18432
  v_add_u32 v229, 64, v225
  v_mfma_f32_16x16x32_bf16 v[200:203], a[48:51], v[92:95], v[200:203]
  v_exp_f32 v245, v39
  v_mfma_f32_16x16x32_bf16 v[196:199], a[52:55], v[88:91], v[196:199]
  ds_read_b128 a[20:23], v240 offset:26624
  v_cvt_pk_bf16_f32 v82, v242, v243
  v_mfma_f32_16x16x32_bf16 v[204:207], a[52:55], v[92:95], v[204:207]
  v_exp_f32 v242, v40
  v_mfma_f32_16x16x32_bf16 a[96:99], a[56:59], v[88:91], a[96:99]
  ds_read_b128 a[24:27], v240 offset:19456
  v_add_f32 v72, v72, v244
  v_mfma_f32_16x16x32_bf16 a[104:107], a[56:59], v[92:95], a[104:107]
  v_add_f32 v72, v72, v245
  v_exp_f32 v243, v41
  v_mfma_f32_16x16x32_bf16 a[100:103], a[60:63], v[88:91], a[100:103]
  ds_read_b128 a[28:31], v240 offset:27648
  v_cvt_pk_bf16_f32 v83, v244, v245
  v_mfma_f32_16x16x32_bf16 a[108:111], a[60:63], v[92:95], a[108:111]
  v_add_u32 v230, 64, v226
  s_waitcnt lgkmcnt(4)
  v_mfma_f32_16x16x32_bf16 v[48:51], a[0:3], v[0:3], v[64:67]
  ds_read_b128 a[32:35], v240 offset:20480
  v_add_u32 v231, 64, v227
  v_lshlrev_b32 v216, 28, v251
  v_mfma_f32_16x16x32_bf16 v[56:59], a[0:3], v[4:7], v[68:71]
  v_exp_f32 v244, v42
  v_lshl_or_b32 v216, v251, 24, v216
  v_mfma_f32_16x16x32_bf16 v[52:55], a[4:7], v[0:3], v[64:67]
  ds_read_b128 a[36:39], v240 offset:28672
  v_add_f32 v73, v242, v243
  v_and_b32 v216, 0x70000000, v216
  v_mfma_f32_16x16x32_bf16 v[60:63], a[4:7], v[4:7], v[68:71]
  v_exp_f32 v245, v43
  v_bfe_u32 v217, v251, 3, 1
  v_mfma_f32_16x16x32_bf16 v[48:51], a[8:11], v[8:11], v[48:51]
  ds_read_b128 a[40:43], v240 offset:21504
  v_cvt_pk_bf16_f32 v84, v242, v243
  v_lshl_or_b32 v216, v217, 28, v216
  v_mfma_f32_16x16x32_bf16 v[56:59], a[8:11], v[12:15], v[56:59]
  v_exp_f32 v242, v44
  v_mov_b32 v217, 1
  v_mfma_f32_16x16x32_bf16 v[52:55], a[12:15], v[8:11], v[52:55]
  ds_read_b128 a[44:47], v240 offset:29696
  v_add_f32 v73, v73, v244
  s_and_b32 s88, s71, 3
  v_mfma_f32_16x16x32_bf16 v[60:63], a[12:15], v[12:15], v[60:63]
  v_add_f32 v73, v73, v245
  s_lshl_b32 s88, s88, 12
  s_waitcnt lgkmcnt(4)
  v_mfma_f32_16x16x32_bf16 v[48:51], a[16:19], v[16:19], v[48:51]
  s_waitcnt vmcnt(20)
  s_barrier
  ds_read_b128 a[48:51], v240 offset:22528
  v_mfma_f32_16x16x32_bf16 v[56:59], a[16:19], v[20:23], v[56:59]
  v_exp_f32 v243, v45
  s_add_u32 s88, s88, 16780800
  v_mfma_f32_16x16x32_bf16 v[52:55], a[20:23], v[16:19], v[52:55]
  s_add_u32 m0, s69, 114688
  s_add_u32 s72, s77, 229440
  ds_read_b128 a[52:55], v240 offset:30720
  v_mfma_f32_16x16x32_bf16 v[60:63], a[20:23], v[20:23], v[60:63]
  buffer_load_dwordx4 v224, s[36:39], s72 offen offset:0 lds
  v_mfma_f32_16x16x32_bf16 v[48:51], a[24:27], v[24:27], v[48:51]
  ds_read_b128 a[56:59], v240 offset:23552
  v_cvt_pk_bf16_f32 v85, v244, v245
  s_cmp_eq_u32 s68, 0
  s_cselect_b32 s88, s88, 2146435072
  v_mfma_f32_16x16x32_bf16 v[56:59], a[24:27], v[28:31], v[56:59]
  v_exp_f32 v244, v46
  v_mfma_f32_16x16x32_bf16 v[52:55], a[28:31], v[24:27], v[52:55]
  ds_read_b128 a[60:63], v240 offset:31744
  v_add_f32 v73, v73, v242
  v_mfma_f32_16x16x32_bf16 v[60:63], a[28:31], v[28:31], v[60:63]
  buffer_load_dwordx4 v225, s[36:39], s72 offen offset:1024 lds
  s_waitcnt lgkmcnt(4)
  v_mfma_f32_16x16x32_bf16 v[48:51], a[32:35], a[64:67], v[48:51]
  ds_read_b64_tr_b16 a[0:1], v232 offset:32768
  v_add_f32 v73, v73, v243
  v_mfma_f32_16x16x32_bf16 v[56:59], a[32:35], a[68:71], v[56:59]
  ds_read_b64_tr_b16 a[2:3], v232 offset:40960
  v_exp_f32 v245, v47
  v_mfma_f32_16x16x32_bf16 v[52:55], a[36:39], a[64:67], v[52:55]
  ds_read_b64_tr_b16 a[4:5], v233 offset:32768
  ds_read_b64_tr_b16 a[6:7], v233 offset:40960
  s_lshl_b32 s87, s74, 14
  v_mfma_f32_16x16x32_bf16 v[60:63], a[36:39], a[68:71], v[60:63]
  buffer_load_dwordx4 v226, s[36:39], s72 offen offset:2048 lds
  v_mfma_f32_16x16x32_bf16 v[48:51], a[40:43], a[72:75], v[48:51]
  ds_read_b64_tr_b16 a[8:9], v232 offset:33792
  v_cvt_pk_bf16_f32 v86, v242, v243
  v_add_u32 v240, s87, v232
  v_mfma_f32_16x16x32_bf16 v[56:59], a[40:43], a[76:79], v[56:59]
  ds_read_b64_tr_b16 a[10:11], v232 offset:41984
  v_add_f32 v73, v73, v244
  v_add_u32 v241, s87, v233
  v_mfma_f32_16x16x32_bf16 v[52:55], a[44:47], a[72:75], v[52:55]
  ds_read_b64_tr_b16 a[12:13], v233 offset:33792
  ds_read_b64_tr_b16 a[14:15], v233 offset:41984
  v_add_u32 v236, s87, v234
  v_mfma_f32_16x16x32_bf16 v[60:63], a[44:47], a[76:79], v[60:63]
  buffer_load_dwordx4 v227, s[36:39], s72 offen offset:3072 lds
  s_waitcnt lgkmcnt(8)
  v_mfma_f32_16x16x32_bf16 v[48:51], a[48:51], a[80:83], v[48:51]
  ds_read_b64_tr_b16 a[16:17], v232 offset:34816
  v_add_f32 v73, v73, v245
  v_add_u32 v237, s87, v235
  v_mfma_f32_16x16x32_bf16 v[56:59], a[48:51], a[84:87], v[56:59]
  ds_read_b64_tr_b16 a[18:19], v232 offset:43008
  v_cvt_pk_bf16_f32 v87, v244, v245
  v_mfma_f32_16x16x32_bf16 v[52:55], a[52:55], a[80:83], v[52:55]
  s_add_u32 m0, s69, 0
  s_add_u32 s72, s76, 229376
  ds_read_b64_tr_b16 a[20:21], v233 offset:34816
  ds_read_b64_tr_b16 a[22:23], v233 offset:43008
  v_mfma_f32_16x16x32_bf16 v[60:63], a[52:55], a[84:87], v[60:63]
  buffer_load_dwordx4 v224, s[36:39], s72 offen offset:0 lds
  v_mfma_f32_16x16x32_bf16 v[48:51], a[56:59], a[88:91], v[48:51]
  ds_read_b64_tr_b16 a[24:25], v232 offset:35840
  v_max_f32 v248, v72, v73
  v_mfma_f32_16x16x32_bf16 v[56:59], a[56:59], a[92:95], v[56:59]
  ds_read_b64_tr_b16 a[26:27], v232 offset:44032
  v_cmp_lt_f32 vcc, s73, v248
  v_mfma_f32_16x16x32_bf16 v[52:55], a[60:63], a[88:91], v[52:55]
  ds_read_b64_tr_b16 a[28:29], v233 offset:35840
  ds_read_b64_tr_b16 a[30:31], v233 offset:44032
  v_mfma_f32_16x16x32_bf16 v[60:63], a[60:63], a[92:95], v[60:63]
  buffer_load_dwordx4 v225, s[36:39], s72 offen offset:1024 lds
  s_cbranch_vccnz L_st43
L_rt43:
L_pv14:
  s_waitcnt lgkmcnt(8)
  v_mfma_f32_16x16x32_bf16 v[96:99], a[0:3], v[80:83], v[96:99]
  ds_read_b64_tr_b16 a[32:33], v232 offset:36864
  v_add_f32 v246, v246, v72
  v_mfma_f32_16x16x32_bf16 v[104:107], a[0:3], v[84:87], v[104:107]
  ds_read_b64_tr_b16 a[34:35], v232 offset:45056
  v_add_f32 v247, v247, v73
  v_mfma_f32_16x16x32_bf16 v[100:103], a[4:7], v[80:83], v[100:103]
  ds_read_b64_tr_b16 a[36:37], v233 offset:36864
  ds_read_b64_tr_b16 a[38:39], v233 offset:45056
  v_exp_f32 v242, v48
  v_mfma_f32_16x16x32_bf16 v[108:111], a[4:7], v[84:87], v[108:111]
  buffer_load_dwordx4 v226, s[36:39], s72 offen offset:2048 lds
  v_mfma_f32_16x16x32_bf16 v[112:115], a[8:11], v[80:83], v[112:115]
  ds_read_b64_tr_b16 a[40:41], v232 offset:37888
  v_exp_f32 v243, v49
  v_mfma_f32_16x16x32_bf16 v[120:123], a[8:11], v[84:87], v[120:123]
  ds_read_b64_tr_b16 a[42:43], v232 offset:46080
  v_exp_f32 v244, v50
  v_mfma_f32_16x16x32_bf16 v[116:119], a[12:15], v[80:83], v[116:119]
  ds_read_b64_tr_b16 a[44:45], v233 offset:37888
  ds_read_b64_tr_b16 a[46:47], v233 offset:46080
  v_add_f32 v72, v242, v243
  v_mfma_f32_16x16x32_bf16 v[124:127], a[12:15], v[84:87], v[124:127]
  buffer_load_dwordx4 v227, s[36:39], s72 offen offset:3072 lds
  s_waitcnt lgkmcnt(8)
  v_mfma_f32_16x16x32_bf16 v[128:131], a[16:19], v[80:83], v[128:131]
  ds_read_b64_tr_b16 a[48:49], v232 offset:38912
  v_exp_f32 v245, v51
  v_mfma_f32_16x16x32_bf16 v[136:139], a[16:19], v[84:87], v[136:139]
  ds_read_b64_tr_b16 a[50:51], v232 offset:47104
  v_cvt_pk_bf16_f32 v88, v242, v243
  v_exp_f32 v242, v52
  v_mfma_f32_16x16x32_bf16 v[132:135], a[20:23], v[80:83], v[132:135]
  ds_read_b64_tr_b16 a[52:53], v233 offset:38912
  v_add_f32 v72, v72, v244
  v_add_f32 v72, v72, v245
  v_mfma_f32_16x16x32_bf16 v[140:143], a[20:23], v[84:87], v[140:143]
  ds_read_b64_tr_b16 a[54:55], v233 offset:47104
  v_exp_f32 v243, v53
  v_mfma_f32_16x16x32_bf16 v[144:147], a[24:27], v[80:83], v[144:147]
  ds_read_b64_tr_b16 a[56:57], v232 offset:39936
  v_cvt_pk_bf16_f32 v89, v244, v245
  v_exp_f32 v244, v54
  v_mfma_f32_16x16x32_bf16 v[152:155], a[24:27], v[84:87], v[152:155]
  ds_read_b64_tr_b16 a[58:59], v232 offset:48128
  v_add_f32 v72, v72, v242
  v_add_f32 v72, v72, v243
  v_mfma_f32_16x16x32_bf16 v[148:151], a[28:31], v[80:83], v[148:151]
  ds_read_b64_tr_b16 a[60:61], v233 offset:39936
  v_exp_f32 v245, v55
  v_mfma_f32_16x16x32_bf16 v[156:159], a[28:31], v[84:87], v[156:159]
  ds_read_b64_tr_b16 a[62:63], v233 offset:48128
  v_cvt_pk_bf16_f32 v90, v242, v243
  s_waitcnt lgkmcnt(8)
  v_mfma_f32_16x16x32_bf16 v[160:163], a[32:35], v[80:83], v[160:163]
  ds_read_b64_tr_b16 a[0:1], v232 offset:56320
  v_exp_f32 v242, v56
  v_mfma_f32_16x16x32_bf16 v[168:171], a[32:35], v[84:87], v[168:171]
  ds_read_b64_tr_b16 a[2:3], v232 offset:64512
  v_add_f32 v72, v72, v244
  v_add_f32 v72, v72, v245
  v_mfma_f32_16x16x32_bf16 v[164:167], a[36:39], v[80:83], v[164:167]
  ds_read_b64_tr_b16 a[4:5], v233 offset:56320
  v_exp_f32 v243, v57
  v_mfma_f32_16x16x32_bf16 v[172:175], a[36:39], v[84:87], v[172:175]
  ds_read_b64_tr_b16 a[6:7], v233 offset:64512
  v_cvt_pk_bf16_f32 v91, v244, v245
  v_mfma_f32_16x16x32_bf16 v[176:179], a[40:43], v[80:83], v[176:179]
  ds_read_b64_tr_b16 a[8:9], v232 offset:49152
  v_exp_f32 v244, v58
  v_mfma_f32_16x16x32_bf16 v[184:187], a[40:43], v[84:87], v[184:187]
  ds_read_b64_tr_b16 a[10:11], v232 offset:57344
  v_add_f32 v73, v242, v243
  v_exp_f32 v245, v59
  v_mfma_f32_16x16x32_bf16 v[180:183], a[44:47], v[80:83], v[180:183]
  ds_read_b64_tr_b16 a[12:13], v233 offset:49152
  v_cvt_pk_bf16_f32 v92, v242, v243
  v_exp_f32 v242, v60
  v_mfma_f32_16x16x32_bf16 v[188:191], a[44:47], v[84:87], v[188:191]
  ds_read_b64_tr_b16 a[14:15], v233 offset:57344
  v_add_f32 v73, v73, v244
  s_waitcnt lgkmcnt(8)
  v_mfma_f32_16x16x32_bf16 v[192:195], a[48:51], v[80:83], v[192:195]
  ds_read_b64_tr_b16 a[16:17], v232 offset:50176
  v_add_f32 v73, v73, v245
  v_exp_f32 v243, v61
  v_mfma_f32_16x16x32_bf16 v[200:203], a[48:51], v[84:87], v[200:203]
  ds_read_b64_tr_b16 a[18:19], v232 offset:58368
  v_cvt_pk_bf16_f32 v93, v244, v245
  v_exp_f32 v244, v62
  v_mfma_f32_16x16x32_bf16 v[196:199], a[52:55], v[80:83], v[196:199]
  ds_read_b64_tr_b16 a[20:21], v233 offset:50176
  v_add_f32 v73, v73, v242
  v_add_f32 v73, v73, v243
  v_mfma_f32_16x16x32_bf16 v[204:207], a[52:55], v[84:87], v[204:207]
  ds_read_b64_tr_b16 a[22:23], v233 offset:58368
  v_exp_f32 v245, v63
  v_mfma_f32_16x16x32_bf16 a[96:99], a[56:59], v[80:83], a[96:99]
  ds_read_b64_tr_b16 a[24:25], v232 offset:51200
  v_cvt_pk_bf16_f32 v94, v242, v243
  v_add_f32 v73, v73, v244
  v_mfma_f32_16x16x32_bf16 a[104:107], a[56:59], v[84:87], a[104:107]
  ds_read_b64_tr_b16 a[26:27], v232 offset:59392
  v_add_f32 v73, v73, v245
  v_cvt_pk_bf16_f32 v95, v244, v245
  v_mfma_f32_16x16x32_bf16 a[100:103], a[60:63], v[80:83], a[100:103]
  ds_read_b64_tr_b16 a[28:29], v233 offset:51200
  v_max_f32 v248, v72, v73
  v_cmp_lt_f32 vcc, s73, v248
  v_mfma_f32_16x16x32_bf16 a[108:111], a[60:63], v[84:87], a[108:111]
  ds_read_b64_tr_b16 a[30:31], v233 offset:59392
  s_cbranch_vccnz L_st44
L_rt44:
  s_waitcnt lgkmcnt(8)
  v_mfma_f32_16x16x32_bf16 a[96:99], a[0:3], v[88:91], a[96:99]
  ds_read_b64_tr_b16 a[32:33], v232 offset:52224
  v_add_f32 v246, v246, v72
  v_add_f32 v247, v247, v73
  s_lshl_b32 s87, s68, 13
  v_mfma_f32_16x16x32_bf16 a[104:107], a[0:3], v[92:95], a[104:107]
  ds_read_b64_tr_b16 a[34:35], v232 offset:60416
  s_add_u32 s87, s87, 131072
  v_permlane32_swap_b32 v246, v247
  v_mfma_f32_16x16x32_bf16 a[100:103], a[4:7], v[88:91], a[100:103]
  ds_read_b64_tr_b16 a[36:37], v233 offset:52224
  v_add_f32 v246, v246, v247
  v_mov_b32 v247, v246
  v_mfma_f32_16x16x32_bf16 a[108:111], a[4:7], v[92:95], a[108:111]
  ds_read_b64_tr_b16 a[38:39], v233 offset:60416
  v_add_u32 v248, s87, v250
  v_permlane16_swap_b32 v246, v247
  v_mfma_f32_16x16x32_bf16 v[96:99], a[8:11], v[88:91], v[96:99]
  ds_read_b64_tr_b16 a[40:41], v232 offset:53248
  v_add_f32 v246, v246, v247
  v_rcp_f32 v246, v246
  v_mfma_f32_16x16x32_bf16 v[104:107], a[8:11], v[92:95], v[104:107]
  ds_read_b64_tr_b16 a[42:43], v232 offset:61440
  v_xor_b32 v242, 0x4000, v248
  ds_write_b32 v242, v246 offset:7168
  v_mfma_f32_16x16x32_bf16 v[100:103], a[12:15], v[88:91], v[100:103]
  ds_read_b64_tr_b16 a[44:45], v233 offset:53248
  v_accvgpr_read_b32 v8, a96
  v_accvgpr_read_b32 v9, a97
  v_accvgpr_read_b32 v10, a98
  v_mfma_f32_16x16x32_bf16 v[108:111], a[12:15], v[92:95], v[108:111]
  ds_read_b64_tr_b16 a[46:47], v233 offset:61440
  v_accvgpr_read_b32 v11, a99
  v_accvgpr_read_b32 v12, a100
  v_accvgpr_read_b32 v13, a101
  s_waitcnt lgkmcnt(9)
  v_mfma_f32_16x16x32_bf16 v[112:115], a[16:19], v[88:91], v[112:115]
  s_waitcnt vmcnt(14)
  s_waitcnt vmcnt(8)
  s_waitcnt lgkmcnt(0)
  s_barrier
  ds_read_b64_tr_b16 a[48:49], v232 offset:54272
  v_mfma_f32_16x16x32_bf16 v[120:123], a[16:19], v[92:95], v[120:123]
  ds_read_b64_tr_b16 a[50:51], v232 offset:62464
  v_accvgpr_read_b32 v14, a102
  v_accvgpr_read_b32 v15, a103
  v_cvt_pk_bf16_f32 v0, v8, v9
  v_cvt_pk_bf16_f32 v1, v10, v11
  v_mfma_f32_16x16x32_bf16 v[116:119], a[20:23], v[88:91], v[116:119]
  s_add_u32 m0, s69, 16384
  s_add_u32 s72, s76, 64
  ds_read_b64_tr_b16 a[52:53], v233 offset:54272
  ds_read_b64_tr_b16 a[54:55], v233 offset:62464
  ds_read_b32 v244, v248 offset:7168
  v_mfma_f32_16x16x32_bf16 v[124:127], a[20:23], v[92:95], v[124:127]
  buffer_load_dwordx4 v224, s[36:39], s72 offen offset:0 lds
  v_cvt_pk_bf16_f32 v2, v12, v13
  v_cvt_pk_bf16_f32 v3, v14, v15
  v_mfma_f32_16x16x32_bf16 v[128:131], a[24:27], v[88:91], v[128:131]
  ds_read_b64_tr_b16 a[56:57], v232 offset:55296
  ds_read_b64_tr_b16 a[58:59], v232 offset:63488
  ds_write_b128 v248, v[0:3] offset:0
  v_mfma_f32_16x16x32_bf16 v[136:139], a[24:27], v[92:95], v[136:139]
  v_accvgpr_read_b32 v8, a104
  v_accvgpr_read_b32 v9, a105
  buffer_atomic_add v217, v216, s[48:51], s88 offen sc1
  v_mfma_f32_16x16x32_bf16 v[132:135], a[28:31], v[88:91], v[132:135]
  ds_read_b64_tr_b16 a[60:61], v233 offset:55296
  ds_read_b64_tr_b16 a[62:63], v233 offset:63488
  v_accvgpr_read_b32 v10, a106
  v_accvgpr_read_b32 v11, a107
  v_accvgpr_read_b32 v12, a108
  v_mfma_f32_16x16x32_bf16 v[140:143], a[28:31], v[92:95], v[140:143]
  buffer_load_dwordx4 v225, s[36:39], s72 offen offset:1024 lds
  v_accvgpr_read_b32 v13, a109
  v_mfma_f32_16x16x32_bf16 v[144:147], a[32:35], v[88:91], v[144:147]
  ds_read_b64_tr_b16 a[0:1], v236 offset:14336
  v_accvgpr_read_b32 v14, a110
  v_accvgpr_read_b32 v15, a111
  v_cvt_pk_bf16_f32 v4, v8, v9
  v_cvt_pk_bf16_f32 v5, v10, v11
  v_mfma_f32_16x16x32_bf16 v[152:155], a[32:35], v[92:95], v[152:155]
  ds_read_b64_tr_b16 a[2:3], v236 offset:15360
  v_cvt_pk_bf16_f32 v6, v12, v13
  v_cvt_pk_bf16_f32 v7, v14, v15
  ds_write_b128 v248, v[4:7] offset:1024
  v_mfma_f32_16x16x32_bf16 v[148:151], a[36:39], v[88:91], v[148:151]
  ds_read_b64_tr_b16 a[4:5], v237 offset:14336
  ds_read_b64_tr_b16 a[6:7], v237 offset:15360
  v_cvt_pk_bf16_f32 v96, v96, v97
  v_cvt_pk_bf16_f32 v97, v98, v99
  v_mfma_f32_16x16x32_bf16 v[156:159], a[36:39], v[92:95], v[156:159]
  buffer_load_dwordx4 v226, s[36:39], s72 offen offset:2048 lds
  v_cvt_pk_bf16_f32 v98, v100, v101
  v_cvt_pk_bf16_f32 v99, v102, v103
  v_mfma_f32_16x16x32_bf16 v[160:163], a[40:43], v[88:91], v[160:163]
  ds_read_b64_tr_b16 a[8:9], v236 offset:0
  ds_write_b128 v248, v[96:99] offset:2048
  v_cvt_pk_bf16_f32 v100, v104, v105
  v_cvt_pk_bf16_f32 v101, v106, v107
  v_mfma_f32_16x16x32_bf16 v[168:171], a[40:43], v[92:95], v[168:171]
  ds_read_b64_tr_b16 a[10:11], v236 offset:1024
  v_cvt_pk_bf16_f32 v102, v108, v109
  v_cvt_pk_bf16_f32 v103, v110, v111
  ds_write_b128 v248, v[100:103] offset:3072
  v_mfma_f32_16x16x32_bf16 v[164:167], a[44:47], v[88:91], v[164:167]
  ds_read_b64_tr_b16 a[12:13], v237 offset:0
  ds_read_b64_tr_b16 a[14:15], v237 offset:1024
  v_cvt_pk_bf16_f32 v112, v112, v113
  v_cvt_pk_bf16_f32 v113, v114, v115
  v_cvt_pk_bf16_f32 v114, v116, v117
  v_mfma_f32_16x16x32_bf16 v[172:175], a[44:47], v[92:95], v[172:175]
  buffer_load_dwordx4 v227, s[36:39], s72 offen offset:3072 lds
  s_waitcnt lgkmcnt(11)
  v_mfma_f32_16x16x32_bf16 v[176:179], a[48:51], v[88:91], v[176:179]
  ds_read_b64_tr_b16 a[16:17], v236 offset:2048
  v_cvt_pk_bf16_f32 v115, v118, v119
  ds_write_b128 v248, v[112:115] offset:4096
  v_mfma_f32_16x16x32_bf16 v[184:187], a[48:51], v[92:95], v[184:187]
  ds_read_b64_tr_b16 a[18:19], v236 offset:3072
  v_cvt_pk_bf16_f32 v116, v120, v121
  v_cvt_pk_bf16_f32 v117, v122, v123
  v_cvt_pk_bf16_f32 v118, v124, v125
  v_cvt_pk_bf16_f32 v119, v126, v127
  v_mfma_f32_16x16x32_bf16 v[180:183], a[52:55], v[88:91], v[180:183]
  s_add_u32 m0, s69, 32768
  s_add_u32 s72, s77, 229376
  ds_read_b64_tr_b16 a[20:21], v237 offset:2048
  ds_read_b64_tr_b16 a[22:23], v237 offset:3072
  v_cvt_pk_bf16_f32 v128, v128, v129
  v_cvt_pk_bf16_f32 v129, v130, v131
  v_mfma_f32_16x16x32_bf16 v[188:191], a[52:55], v[92:95], v[188:191]
  buffer_load_dwordx4 v224, s[36:39], s72 offen offset:0 lds
  ds_write_b128 v248, v[116:119] offset:5120
  v_mfma_f32_16x16x32_bf16 v[192:195], a[56:59], v[88:91], v[192:195]
  ds_read_b64_tr_b16 a[24:25], v236 offset:4096
  v_cvt_pk_bf16_f32 v130, v132, v133
  v_cvt_pk_bf16_f32 v131, v134, v135
  ds_write_b128 v248, v[128:131] offset:6144
  v_mfma_f32_16x16x32_bf16 v[200:203], a[56:59], v[92:95], v[200:203]
  ds_read_b64_tr_b16 a[26:27], v236 offset:5120
  v_cvt_pk_bf16_f32 v132, v136, v137
  v_cvt_pk_bf16_f32 v133, v138, v139
  v_cvt_pk_bf16_f32 v134, v140, v141
  v_cvt_pk_bf16_f32 v135, v142, v143
  v_mfma_f32_16x16x32_bf16 v[196:199], a[60:63], v[88:91], v[196:199]
  ds_read_b64_tr_b16 a[28:29], v237 offset:4096
  ds_read_b64_tr_b16 a[30:31], v237 offset:5120
  ds_write_b128 v248, v[132:135] offset:7168
  v_mfma_f32_16x16x32_bf16 v[204:207], a[60:63], v[92:95], v[204:207]
  buffer_load_dwordx4 v225, s[36:39], s72 offen offset:1024 lds
L_g4:
  s_waitcnt lgkmcnt(12)
  v_mfma_f32_16x16x32_bf16 v[32:35], a[0:3], v[0:3], 0
  ds_read_b64_tr_b16 a[32:33], v236 offset:6144
  ds_read_b64_tr_b16 a[34:35], v236 offset:7168
  v_cvt_pk_bf16_f32 v144, v144, v145
  v_mfma_f32_16x16x32_bf16 v[40:43], a[0:3], v[4:7], 0
  ds_read_b64_tr_b16 a[36:37], v237 offset:6144
  ds_read_b64_tr_b16 a[38:39], v237 offset:7168
  v_cvt_pk_bf16_f32 v145, v146, v147
  v_mfma_f32_16x16x32_bf16 v[36:39], a[4:7], v[0:3], 0
  s_waitcnt lgkmcnt(0)
  s_barrier
  ds_read_b64_tr_b16 a[40:41], v236 offset:8192
  ds_read_b64_tr_b16 a[42:43], v236 offset:9216
  v_mfma_f32_16x16x32_bf16 v[44:47], a[4:7], v[4:7], 0
  buffer_load_dwordx4 v226, s[36:39], s72 offen offset:2048 lds
  v_mfma_f32_16x16x32_bf16 v[32:35], a[8:11], v[96:99], v[32:35]
  ds_read_b64_tr_b16 a[44:45], v237 offset:8192
  ds_read_b64_tr_b16 a[46:47], v237 offset:9216
  ds_read_b64_tr_b16 a[48:49], v236 offset:10240
  v_cvt_pk_bf16_f32 v146, v148, v149
  v_cvt_pk_bf16_f32 v147, v150, v151
  v_mfma_f32_16x16x32_bf16 v[40:43], a[8:11], v[100:103], v[40:43]
  ds_read_b64_tr_b16 a[50:51], v236 offset:11264
  ds_read_b128 a[112:115], v242 offset:0
  ds_read_b128 a[116:119], v242 offset:1024
  v_cvt_pk_bf16_f32 v148, v152, v153
  v_cvt_pk_bf16_f32 v149, v154, v155
  v_mfma_f32_16x16x32_bf16 v[36:39], a[12:15], v[96:99], v[36:39]
  ds_read_b64_tr_b16 a[52:53], v237 offset:10240
  ds_read_b64_tr_b16 a[54:55], v237 offset:11264
  ds_read_b128 a[120:123], v242 offset:2048
  ds_read_b128 a[124:127], v242 offset:3072
  v_cvt_pk_bf16_f32 v150, v156, v157
  v_cvt_pk_bf16_f32 v151, v158, v159
  v_mfma_f32_16x16x32_bf16 v[44:47], a[12:15], v[100:103], v[44:47]
  buffer_load_dwordx4 v227, s[36:39], s72 offen offset:3072 lds
  v_mfma_f32_16x16x32_bf16 v[32:35], a[16:19], v[112:115], v[32:35]
  ds_read_b64_tr_b16 a[56:57], v236 offset:12288
  ds_read_b64_tr_b16 a[58:59], v236 offset:13312
  ds_read_b64_tr_b16 a[60:61], v237 offset:12288
  v_cvt_pk_bf16_f32 v160, v160, v161
  v_cvt_pk_bf16_f32 v161, v162, v163
  v_mfma_f32_16x16x32_bf16 v[40:43], a[16:19], v[116:119], v[40:43]
  ds_read_b64_tr_b16 a[62:63], v237 offset:13312
  ds_read_b128 a[128:131], v242 offset:4096
  ds_read_b128 a[132:135], v242 offset:5120
  v_cvt_pk_bf16_f32 v162, v164, v165
  v_cvt_pk_bf16_f32 v163, v166, v167
  v_mfma_f32_16x16x32_bf16 v[36:39], a[20:23], v[112:115], v[36:39]
  s_add_u32 m0, s69, 49152
  s_add_u32 s72, s77, 64
  ds_read_b128 a[136:139], v242 offset:6144
  ds_read_b128 a[140:143], v242 offset:7168
  v_cvt_pk_bf16_f32 v164, v168, v169
  v_cvt_pk_bf16_f32 v165, v170, v171
  v_mfma_f32_16x16x32_bf16 v[44:47], a[20:23], v[116:119], v[44:47]
  buffer_load_dwordx4 v224, s[36:39], s72 offen offset:0 lds
  v_cvt_pk_bf16_f32 v166, v172, v173
  v_cvt_pk_bf16_f32 v167, v174, v175
  v_mfma_f32_16x16x32_bf16 v[32:35], a[24:27], v[128:131], v[32:35]
  v_cvt_pk_bf16_f32 v176, v176, v177
  v_cvt_pk_bf16_f32 v177, v178, v179
  v_cvt_pk_bf16_f32 v192, v192, v193
  v_cvt_pk_bf16_f32 v193, v194, v195
  v_mfma_f32_16x16x32_bf16 v[40:43], a[24:27], v[132:135], v[40:43]
  v_cvt_pk_bf16_f32 v178, v180, v181
  v_cvt_pk_bf16_f32 v179, v182, v183
  v_cvt_pk_bf16_f32 v180, v184, v185
  v_cvt_pk_bf16_f32 v194, v196, v197
  v_mfma_f32_16x16x32_bf16 v[36:39], a[28:31], v[128:131], v[36:39]
  v_cvt_pk_bf16_f32 v181, v186, v187
  v_cvt_pk_bf16_f32 v182, v188, v189
  v_cvt_pk_bf16_f32 v183, v190, v191
  v_mfma_f32_16x16x32_bf16 v[44:47], a[28:31], v[132:135], v[44:47]
  buffer_load_dwordx4 v225, s[36:39], s72 offen offset:1024 lds
  s_waitcnt lgkmcnt(15)
  v_mfma_f32_16x16x32_bf16 v[32:35], a[32:35], v[144:147], v[32:35]
  s_waitcnt vmcnt(15)
  s_waitcnt lgkmcnt(0)
  s_barrier
  ds_read_b64_tr_b16 a[0:1], v236 offset:47104
  v_mfma_f32_16x16x32_bf16 v[40:43], a[32:35], v[148:151], v[40:43]
  ds_read_b64_tr_b16 a[2:3], v236 offset:48128
  v_cvt_pk_bf16_f32 v195, v198, v199
  v_cvt_pk_bf16_f32 v196, v200, v201
  v_cvt_pk_bf16_f32 v197, v202, v203
  v_mfma_f32_16x16x32_bf16 v[36:39], a[36:39], v[144:147], v[36:39]
  ds_read_b64_tr_b16 a[4:5], v237 offset:47104
  ds_read_b64_tr_b16 a[6:7], v237 offset:48128
  v_cvt_pk_bf16_f32 v198, v204, v205
  v_cvt_pk_bf16_f32 v199, v206, v207
  v_mfma_f32_16x16x32_bf16 v[44:47], a[36:39], v[148:151], v[44:47]
  buffer_load_dwordx4 v226, s[36:39], s72 offen offset:2048 lds
  v_mfma_f32_16x16x32_bf16 v[32:35], a[40:43], v[160:163], v[32:35]
  ds_read_b64_tr_b16 a[8:9], v236 offset:32768
  ds_read_b64_tr_b16 a[10:11], v236 offset:33792
  v_mov_b32 v247, v246
  v_mfma_f32_16x16x32_bf16 v[40:43], a[40:43], v[164:167], v[40:43]
  ds_write_b128 v248, v[144:147] offset:0
  v_mfma_f32_16x16x32_bf16 v[36:39], a[44:47], v[160:163], v[36:39]
  ds_read_b64_tr_b16 a[12:13], v237 offset:32768
  ds_read_b64_tr_b16 a[14:15], v237 offset:33792
  v_mov_b32 v245, v244
  v_mfma_f32_16x16x32_bf16 v[44:47], a[44:47], v[164:167], v[44:47]
  buffer_load_dwordx4 v227, s[36:39], s72 offen offset:3072 lds
  ds_write_b128 v248, v[148:151] offset:1024
  v_mfma_f32_16x16x32_bf16 v[32:35], a[48:51], v[176:179], v[32:35]
  ds_read_b64_tr_b16 a[16:17], v236 offset:34816
  ds_read_b64_tr_b16 a[18:19], v236 offset:35840
  v_permlane32_swap_b32 v246, v247
  v_mfma_f32_16x16x32_bf16 v[40:43], a[48:51], v[180:183], v[40:43]
  ds_write_b128 v248, v[160:163] offset:2048
  v_mfma_f32_16x16x32_bf16 v[36:39], a[52:55], v[176:179], v[36:39]
  s_add_u32 s72, s78, 0
  s_add_u32 m0, s69, 65536
  ds_read_b64_tr_b16 a[20:21], v237 offset:34816
  ds_read_b64_tr_b16 a[22:23], v237 offset:35840
  v_mfma_f32_16x16x32_bf16 v[44:47], a[52:55], v[180:183], v[44:47]
  buffer_load_dwordx4 v224, s[36:39], s72 offen offset:0 lds
  ds_write_b128 v248, v[164:167] offset:3072
  v_mfma_f32_16x16x32_bf16 v[32:35], a[56:59], v[192:195], v[32:35]
  ds_read_b64_tr_b16 a[24:25], v236 offset:36864
  ds_read_b64_tr_b16 a[26:27], v236 offset:37888
  v_permlane32_swap_b32 v244, v245
  v_mfma_f32_16x16x32_bf16 v[40:43], a[56:59], v[196:199], v[40:43]
  ds_write_b128 v248, v[176:179] offset:4096
  v_mfma_f32_16x16x32_bf16 v[36:39], a[60:63], v[192:195], v[36:39]
  s_add_u32 m0, s69, 81920
  ds_read_b64_tr_b16 a[28:29], v237 offset:36864
  ds_read_b64_tr_b16 a[30:31], v237 offset:37888
  v_mfma_f32_16x16x32_bf16 v[44:47], a[60:63], v[196:199], v[44:47]
  buffer_load_dwordx4 v228, s[36:39], s72 offen offset:0 lds
  ds_write_b128 v248, v[180:183] offset:5120
  s_waitcnt lgkmcnt(13)
  v_mfma_f32_16x16x32_bf16 v[48:51], a[0:3], v[0:3], 0
  ds_read_b64_tr_b16 a[32:33], v236 offset:38912
  ds_read_b64_tr_b16 a[34:35], v236 offset:39936
  ds_read_b64_tr_b16 a[36:37], v237 offset:38912
  ds_read_b64_tr_b16 a[38:39], v237 offset:39936
  v_mfma_f32_16x16x32_bf16 v[56:59], a[0:3], v[4:7], 0
  ds_write_b128 v248, v[192:195] offset:6144
  v_mfma_f32_16x16x32_bf16 v[52:55], a[4:7], v[0:3], 0
  ds_read_b64_tr_b16 a[40:41], v236 offset:40960
  ds_read_b64_tr_b16 a[42:43], v236 offset:41984
  v_mfma_f32_16x16x32_bf16 v[60:63], a[4:7], v[4:7], 0
  buffer_load_dwordx4 v229, s[36:39], s72 offen offset:1024 lds
  ds_write_b128 v248, v[196:199] offset:7168
  v_mfma_f32_16x16x32_bf16 v[48:51], a[8:11], v[96:99], v[48:51]
  ds_read_b64_tr_b16 a[44:45], v237 offset:40960
  ds_read_b64_tr_b16 a[46:47], v237 offset:41984
  v_mfma_f32_16x16x32_bf16 v[56:59], a[8:11], v[100:103], v[56:59]
  ds_read_b64_tr_b16 a[48:49], v236 offset:43008
  ds_read_b64_tr_b16 a[50:51], v236 offset:44032
  v_mfma_f32_16x16x32_bf16 v[52:55], a[12:15], v[96:99], v[52:55]
  s_add_u32 m0, s69, 65536
  ds_read_b64_tr_b16 a[52:53], v237 offset:43008
  ds_read_b64_tr_b16 a[54:55], v237 offset:44032
  v_mfma_f32_16x16x32_bf16 v[60:63], a[12:15], v[100:103], v[60:63]
  buffer_load_dwordx4 v225, s[36:39], s72 offen offset:1024 lds
  s_waitcnt lgkmcnt(15)
  v_mfma_f32_16x16x32_bf16 v[48:51], a[16:19], v[112:115], v[48:51]
  ds_read_b64_tr_b16 a[56:57], v236 offset:45056
  ds_read_b64_tr_b16 a[58:59], v236 offset:46080
  v_mfma_f32_16x16x32_bf16 v[56:59], a[16:19], v[116:119], v[56:59]
  ds_read_b64_tr_b16 a[60:61], v237 offset:45056
  ds_read_b64_tr_b16 a[62:63], v237 offset:46080
  v_mfma_f32_16x16x32_bf16 v[52:55], a[20:23], v[112:115], v[52:55]
  v_mul_f32 v32, v32, v246
  v_mul_f32 v33, v33, v246
  v_mfma_f32_16x16x32_bf16 v[60:63], a[20:23], v[116:119], v[60:63]
  buffer_load_dwordx4 v226, s[36:39], s72 offen offset:2048 lds
  v_mfma_f32_16x16x32_bf16 v[48:51], a[24:27], v[128:131], v[48:51]
  v_mul_f32 v34, v34, v246
  v_mul_f32 v35, v35, v246
  v_mul_f32 v36, v36, v246
  v_mfma_f32_16x16x32_bf16 v[56:59], a[24:27], v[132:135], v[56:59]
  v_mul_f32 v37, v37, v246
  v_mul_f32 v38, v38, v246
  v_mul_f32 v39, v39, v246
  v_mfma_f32_16x16x32_bf16 v[52:55], a[28:31], v[128:131], v[52:55]
  s_add_u32 m0, s69, 81920
  v_mul_f32 v40, v40, v247
  v_mul_f32 v41, v41, v247
  v_mfma_f32_16x16x32_bf16 v[60:63], a[28:31], v[132:135], v[60:63]
  buffer_load_dwordx4 v230, s[36:39], s72 offen offset:2048 lds
  s_waitcnt lgkmcnt(8)
  v_mfma_f32_16x16x32_bf16 v[48:51], a[32:35], v[144:147], v[48:51]
  s_waitcnt vmcnt(14)
  s_waitcnt lgkmcnt(0)
  s_barrier
  ds_read_b64_tr_b16 a[0:1], v240 offset:14336
  ds_read_b64_tr_b16 a[2:3], v240 offset:15360
  v_mfma_f32_16x16x32_bf16 v[56:59], a[32:35], v[148:151], v[56:59]
  ds_read_b128 a[144:147], v242 offset:0
  v_mul_f32 v42, v42, v247
  v_mul_f32 v43, v43, v247
  v_mfma_f32_16x16x32_bf16 v[52:55], a[36:39], v[144:147], v[52:55]
  ds_read_b64_tr_b16 a[4:5], v241 offset:14336
  ds_read_b64_tr_b16 a[6:7], v241 offset:15360
  ds_read_b128 a[148:151], v242 offset:1024
  v_mfma_f32_16x16x32_bf16 v[60:63], a[36:39], v[148:151], v[60:63]
  buffer_load_dwordx4 v231, s[36:39], s72 offen offset:3072 lds
  v_mfma_f32_16x16x32_bf16 v[48:51], a[40:43], v[160:163], v[48:51]
  s_add_u32 m0, s69, 65536
  ds_read_b64_tr_b16 a[8:9], v240 offset:0
  ds_read_b64_tr_b16 a[10:11], v240 offset:1024
  ds_read_b128 a[152:155], v242 offset:2048
  v_mfma_f32_16x16x32_bf16 v[56:59], a[40:43], v[164:167], v[56:59]
  buffer_load_dwordx4 v227, s[36:39], s72 offen offset:3072 lds
  v_mfma_f32_16x16x32_bf16 v[52:55], a[44:47], v[160:163], v[52:55]
  s_add_u32 s72, s78, 229376
  s_add_u32 m0, s69, 98304
  ds_read_b64_tr_b16 a[12:13], v241 offset:0
  ds_read_b64_tr_b16 a[14:15], v241 offset:1024
  ds_read_b128 a[156:159], v242 offset:3072
  v_mfma_f32_16x16x32_bf16 v[60:63], a[44:47], v[164:167], v[60:63]
  buffer_load_dwordx4 v224, s[36:39], s72 offen offset:0 lds
  v_mfma_f32_16x16x32_bf16 v[48:51], a[48:51], v[176:179], v[48:51]
  ds_read_b64_tr_b16 a[16:17], v240 offset:2048
  ds_read_b64_tr_b16 a[18:19], v240 offset:3072
  v_and_b32 v252, 15, v251
  v_mfma_f32_16x16x32_bf16 v[56:59], a[48:51], v[180:183], v[56:59]
  ds_read_b128 a[160:163], v242 offset:4096
  v_mul_f32 v44, v44, v247
  v_mul_f32 v45, v45, v247
  v_mfma_f32_16x16x32_bf16 v[52:55], a[52:55], v[176:179], v[52:55]
  s_add_u32 m0, s69, 114688
  ds_read_b64_tr_b16 a[20:21], v241 offset:2048
  ds_read_b64_tr_b16 a[22:23], v241 offset:3072
  ds_read_b128 a[164:167], v242 offset:5120
  v_mfma_f32_16x16x32_bf16 v[60:63], a[52:55], v[180:183], v[60:63]
  buffer_load_dwordx4 v228, s[36:39], s72 offen offset:0 lds
  v_mfma_f32_16x16x32_bf16 v[48:51], a[56:59], v[192:195], v[48:51]
  ds_read_b64_tr_b16 a[24:25], v240 offset:4096
  ds_read_b64_tr_b16 a[26:27], v240 offset:5120
  s_lshl_b32 s89, s71, 1
  v_mfma_f32_16x16x32_bf16 v[56:59], a[56:59], v[196:199], v[56:59]
  ds_read_b128 a[168:171], v242 offset:6144
  v_mul_f32 v46, v46, v247
  v_mul_f32 v47, v47, v247
  v_mfma_f32_16x16x32_bf16 v[52:55], a[60:63], v[192:195], v[52:55]
  ds_read_b64_tr_b16 a[28:29], v241 offset:4096
  ds_read_b64_tr_b16 a[30:31], v241 offset:5120
  ds_read_b128 a[172:175], v242 offset:7168
  v_mfma_f32_16x16x32_bf16 v[60:63], a[60:63], v[196:199], v[60:63]
  buffer_load_dwordx4 v229, s[36:39], s72 offen offset:1024 lds
  s_waitcnt lgkmcnt(13)
  v_mfma_f32_16x16x32_bf16 v[64:67], a[0:3], a[112:115], 0
  ds_read_b64_tr_b16 a[32:33], v240 offset:6144
  ds_read_b64_tr_b16 a[34:35], v240 offset:7168
  s_add_u32 s89, s89, s75
  v_mfma_f32_16x16x32_bf16 v[72:75], a[0:3], a[116:119], 0
  ds_read_b64_tr_b16 a[36:37], v241 offset:6144
  ds_read_b64_tr_b16 a[38:39], v241 offset:7168
  s_lshl_b32 s88, s89, 5
  v_mfma_f32_16x16x32_bf16 v[68:71], a[4:7], a[112:115], 0
  s_add_u32 m0, s69, 98304
  ds_read_b64_tr_b16 a[40:41], v240 offset:8192
  ds_read_b64_tr_b16 a[42:43], v240 offset:9216
  v_mfma_f32_16x16x32_bf16 v[76:79], a[4:7], a[116:119], 0
  buffer_load_dwordx4 v225, s[36:39], s72 offen offset:1024 lds
  v_mfma_f32_16x16x32_bf16 v[64:67], a[8:11], a[120:123], v[64:67]
  ds_read_b64_tr_b16 a[44:45], v241 offset:8192
  ds_read_b64_tr_b16 a[46:47], v241 offset:9216
  v_add_u32 v252, s88, v252
  v_mfma_f32_16x16x32_bf16 v[72:75], a[8:11], a[124:127], v[72:75]
  ds_read_b64_tr_b16 a[48:49], v240 offset:10240
  ds_read_b64_tr_b16 a[50:51], v240 offset:11264
  v_lshrrev_b32 v253, 4, v251
  v_mfma_f32_16x16x32_bf16 v[68:71], a[12:15], a[120:123], v[68:71]
  ds_read_b64_tr_b16 a[52:53], v241 offset:10240
  ds_read_b64_tr_b16 a[54:55], v241 offset:11264
  v_lshlrev_b32 v253, 3, v253
  v_mfma_f32_16x16x32_bf16 v[76:79], a[12:15], a[124:127], v[76:79]
  buffer_load_dwordx4 v226, s[36:39], s72 offen offset:2048 lds
  s_waitcnt lgkmcnt(13)
  v_mfma_f32_16x16x32_bf16 v[64:67], a[16:19], a[128:131], v[64:67]
  ds_read_b64_tr_b16 a[56:57], v240 offset:12288
  ds_read_b64_tr_b16 a[58:59], v240 offset:13312
  s_add_u32 s11, s15, 14336
  v_mfma_f32_16x16x32_bf16 v[72:75], a[16:19], a[132:135], v[72:75]
  ds_read_b64_tr_b16 a[60:61], v241 offset:12288
  ds_read_b64_tr_b16 a[62:63], v241 offset:13312
  v_mul_u32_u24 v254, 896, v252
  v_mfma_f32_16x16x32_bf16 v[68:71], a[20:23], a[128:131], v[68:71]
  s_add_u32 m0, s69, 114688
  v_mul_f32 v48, v48, v246
  v_mul_u32_u24 v216, 5, v253
  v_mfma_f32_16x16x32_bf16 v[76:79], a[20:23], a[132:135], v[76:79]
  buffer_load_dwordx4 v230, s[36:39], s72 offen offset:2048 lds
  v_mfma_f32_16x16x32_bf16 v[64:67], a[24:27], a[136:139], v[64:67]
  v_mul_f32 v49, v49, v246
  v_mul_f32 v50, v50, v246
  v_and_b32 v216, 48, v216
  v_mfma_f32_16x16x32_bf16 v[72:75], a[24:27], a[140:143], v[72:75]
  v_mul_f32 v51, v51, v246
  v_mul_f32 v52, v52, v246
  v_add_u32 v254, v254, v216
  v_mfma_f32_16x16x32_bf16 v[68:71], a[28:31], a[136:139], v[68:71]
  v_mul_f32 v53, v53, v246
  v_mul_f32 v54, v54, v246
  v_and_b32 v216, 3, v251
  v_mfma_f32_16x16x32_bf16 v[76:79], a[28:31], a[140:143], v[76:79]
  buffer_load_dwordx4 v231, s[36:39], s72 offen offset:3072 lds
  s_waitcnt lgkmcnt(8)
  v_mfma_f32_16x16x32_bf16 v[64:67], a[32:35], a[144:147], v[64:67]
  s_waitcnt vmcnt(15)
  s_waitcnt lgkmcnt(0)
  s_barrier
  s_add_u32 m0, s69, 98304
  ds_read_b64_tr_b16 a[0:1], v240 offset:47104
  ds_read_b64_tr_b16 a[2:3], v240 offset:48128
  v_mfma_f32_16x16x32_bf16 v[72:75], a[32:35], a[148:151], v[72:75]
  buffer_load_dwordx4 v227, s[36:39], s72 offen offset:3072 lds
  v_mfma_f32_16x16x32_bf16 v[68:71], a[36:39], a[144:147], v[68:71]
  s_add_u32 s72, s79, 0
  s_add_u32 m0, s69, 0
  ds_read_b64_tr_b16 a[4:5], v241 offset:47104
  ds_read_b64_tr_b16 a[6:7], v241 offset:48128
  v_mfma_f32_16x16x32_bf16 v[76:79], a[36:39], a[148:151], v[76:79]
  buffer_load_dwordx4 v224, s[36:39], s72 offen offset:0 lds
  v_mfma_f32_16x16x32_bf16 v[64:67], a[40:43], a[152:155], v[64:67]
  ds_read_b64_tr_b16 a[8:9], v240 offset:32768
  v_mul_f32 v55, v55, v246
  v_lshlrev_b32 v216, 12, v216
  v_mfma_f32_16x16x32_bf16 v[72:75], a[40:43], a[156:159], v[72:75]
  ds_read_b64_tr_b16 a[10:11], v240 offset:33792
  v_mul_f32 v56, v56, v247
  s_cmp_eq_u32 s70, 7
  s_cselect_b32 s96, 1, s68
  v_mfma_f32_16x16x32_bf16 v[68:71], a[44:47], a[152:155], v[68:71]
  s_add_u32 m0, s69, 16384
  ds_read_b64_tr_b16 a[12:13], v241 offset:32768
  ds_read_b64_tr_b16 a[14:15], v241 offset:33792
  v_mfma_f32_16x16x32_bf16 v[76:79], a[44:47], a[156:159], v[76:79]
  buffer_load_dwordx4 v228, s[36:39], s72 offen offset:0 lds
  v_mfma_f32_16x16x32_bf16 v[64:67], a[48:51], a[160:163], v[64:67]
  ds_read_b64_tr_b16 a[16:17], v240 offset:34816
  v_mul_f32 v57, v57, v247
  v_mfma_f32_16x16x32_bf16 v[72:75], a[48:51], a[164:167], v[72:75]
  ds_read_b64_tr_b16 a[18:19], v240 offset:35840
  v_mul_f32 v58, v58, v247
  v_mul_f32 v59, v59, v247
  v_mfma_f32_16x16x32_bf16 v[68:71], a[52:55], a[160:163], v[68:71]
  ds_read_b64_tr_b16 a[20:21], v241 offset:34816
  ds_read_b64_tr_b16 a[22:23], v241 offset:35840
  v_mfma_f32_16x16x32_bf16 v[76:79], a[52:55], a[164:167], v[76:79]
  buffer_load_dwordx4 v229, s[36:39], s72 offen offset:1024 lds
  v_mfma_f32_16x16x32_bf16 v[64:67], a[56:59], a[168:171], v[64:67]
  ds_read_b64_tr_b16 a[24:25], v240 offset:36864
  v_mul_f32 v60, v60, v247
  v_mul_f32 v61, v61, v247
  v_mfma_f32_16x16x32_bf16 v[72:75], a[56:59], a[172:175], v[72:75]
  ds_read_b64_tr_b16 a[26:27], v240 offset:37888
  v_mul_f32 v62, v62, v247
  v_mul_f32 v63, v63, v247
  v_mfma_f32_16x16x32_bf16 v[68:71], a[60:63], a[168:171], v[68:71]
  s_add_u32 m0, s69, 0
  ds_read_b64_tr_b16 a[28:29], v241 offset:36864
  ds_read_b64_tr_b16 a[30:31], v241 offset:37888
  v_mfma_f32_16x16x32_bf16 v[76:79], a[60:63], a[172:175], v[76:79]
  buffer_load_dwordx4 v225, s[36:39], s72 offen offset:1024 lds
  s_waitcnt lgkmcnt(8)
  v_mfma_f32_16x16x32_bf16 v[80:83], a[0:3], a[112:115], 0
  ds_read_b64_tr_b16 a[32:33], v240 offset:38912
  ds_read_b64_tr_b16 a[34:35], v240 offset:39936
  v_mfma_f32_16x16x32_bf16 v[88:91], a[0:3], a[116:119], 0
  ds_read_b64_tr_b16 a[36:37], v241 offset:38912
  ds_read_b64_tr_b16 a[38:39], v241 offset:39936
  v_mfma_f32_16x16x32_bf16 v[84:87], a[4:7], a[112:115], 0
  ds_read_b64_tr_b16 a[40:41], v240 offset:40960
  ds_read_b64_tr_b16 a[42:43], v240 offset:41984
  v_mfma_f32_16x16x32_bf16 v[92:95], a[4:7], a[116:119], 0
  buffer_load_dwordx4 v226, s[36:39], s72 offen offset:2048 lds
  v_mfma_f32_16x16x32_bf16 v[80:83], a[8:11], a[120:123], v[80:83]
  ds_read_b64_tr_b16 a[44:45], v241 offset:40960
  ds_read_b64_tr_b16 a[46:47], v241 offset:41984
  v_fmac_f32 v32, v64, v244
  v_mfma_f32_16x16x32_bf16 v[88:91], a[8:11], a[124:127], v[88:91]
  ds_read_b64_tr_b16 a[48:49], v240 offset:43008
  ds_read_b64_tr_b16 a[50:51], v240 offset:44032
  v_fmac_f32 v33, v65, v244
  v_mfma_f32_16x16x32_bf16 v[84:87], a[12:15], a[120:123], v[84:87]
  s_add_u32 m0, s69, 16384
  ds_read_b64_tr_b16 a[52:53], v241 offset:43008
  ds_read_b64_tr_b16 a[54:55], v241 offset:44032
  v_mfma_f32_16x16x32_bf16 v[92:95], a[12:15], a[124:127], v[92:95]
  buffer_load_dwordx4 v230, s[36:39], s72 offen offset:2048 lds
  s_waitcnt lgkmcnt(12)
  v_mfma_f32_16x16x32_bf16 v[80:83], a[16:19], a[128:131], v[80:83]
  ds_read_b64_tr_b16 a[56:57], v240 offset:45056
  ds_read_b64_tr_b16 a[58:59], v240 offset:46080
  v_fmac_f32 v34, v66, v244
  v_mfma_f32_16x16x32_bf16 v[88:91], a[16:19], a[132:135], v[88:91]
  ds_read_b64_tr_b16 a[60:61], v241 offset:45056
  ds_read_b64_tr_b16 a[62:63], v241 offset:46080
  v_fmac_f32 v35, v67, v244
  v_fmac_f32 v36, v68, v244
  v_mfma_f32_16x16x32_bf16 v[84:87], a[20:23], a[128:131], v[84:87]
  v_fmac_f32 v37, v69, v244
  v_fmac_f32 v38, v70, v244
  v_fmac_f32 v39, v71, v244
  v_cvt_pk_bf16_f32 v208, v32, v33
  v_mfma_f32_16x16x32_bf16 v[92:95], a[20:23], a[132:135], v[92:95]
  buffer_load_dwordx4 v231, s[36:39], s72 offen offset:3072 lds
  v_mfma_f32_16x16x32_bf16 v[80:83], a[24:27], a[136:139], v[80:83]
  s_add_u32 m0, s69, 0
  v_cvt_pk_bf16_f32 v209, v34, v35
  v_cvt_pk_bf16_f32 v210, v36, v37
  v_cvt_pk_bf16_f32 v211, v38, v39
  v_mfma_f32_16x16x32_bf16 v[88:91], a[24:27], a[140:143], v[88:91]
  buffer_load_dwordx4 v227, s[36:39], s72 offen offset:3072 lds
  v_mfma_f32_16x16x32_bf16 v[84:87], a[28:31], a[136:139], v[84:87]
  s_cmp_eq_u32 s96, 0
  s_cselect_b32 s97, 16780800, s73
  s_cselect_b32 s96, 64, 0
  v_mfma_f32_16x16x32_bf16 v[92:95], a[28:31], a[140:143], v[92:95]
  buffer_store_dwordx4 v[208:211], v250, s[48:51], s4 offen offset:0 sc1
  s_waitcnt lgkmcnt(8)
  v_mfma_f32_16x16x32_bf16 v[80:83], a[32:35], a[144:147], v[80:83]
  s_waitcnt vmcnt(17)
  s_waitcnt lgkmcnt(0)
  s_barrier
  ds_read_b64_tr_b16 a[0:1], v236 offset:14336
  v_mfma_f32_16x16x32_bf16 v[88:91], a[32:35], a[148:151], v[88:91]
  ds_read_b64_tr_b16 a[2:3], v236 offset:15360
  v_fmac_f32 v40, v72, v245
  v_fmac_f32 v41, v73, v245
  v_mfma_f32_16x16x32_bf16 v[84:87], a[36:39], a[144:147], v[84:87]
  s_add_u32 s72, s79, 229376
  s_add_u32 m0, s69, 32768
  ds_read_b64_tr_b16 a[4:5], v237 offset:14336
  ds_read_b64_tr_b16 a[6:7], v237 offset:15360
  v_mfma_f32_16x16x32_bf16 v[92:95], a[36:39], a[148:151], v[92:95]
  buffer_load_dwordx4 v224, s[36:39], s72 offen offset:0 lds
  v_mfma_f32_16x16x32_bf16 v[80:83], a[40:43], a[152:155], v[80:83]
  ds_read_b64_tr_b16 a[8:9], v236 offset:0
  v_fmac_f32 v42, v74, v245
  v_fmac_f32 v43, v75, v245
  v_mfma_f32_16x16x32_bf16 v[88:91], a[40:43], a[156:159], v[88:91]
  ds_read_b64_tr_b16 a[10:11], v236 offset:1024
  v_fmac_f32 v44, v76, v245
  v_fmac_f32 v45, v77, v245
  v_mfma_f32_16x16x32_bf16 v[84:87], a[44:47], a[152:155], v[84:87]
  s_add_u32 m0, s69, 49152
  ds_read_b64_tr_b16 a[12:13], v237 offset:0
  ds_read_b64_tr_b16 a[14:15], v237 offset:1024
  v_mfma_f32_16x16x32_bf16 v[92:95], a[44:47], a[156:159], v[92:95]
  buffer_load_dwordx4 v228, s[36:39], s72 offen offset:0 lds
  v_mfma_f32_16x16x32_bf16 v[80:83], a[48:51], a[160:163], v[80:83]
  ds_read_b64_tr_b16 a[16:17], v236 offset:2048
  v_fmac_f32 v46, v78, v245
  v_fmac_f32 v47, v79, v245
  v_mfma_f32_16x16x32_bf16 v[88:91], a[48:51], a[164:167], v[88:91]
  ds_read_b64_tr_b16 a[18:19], v236 offset:3072
  v_cvt_pk_bf16_f32 v212, v40, v41
  v_cvt_pk_bf16_f32 v213, v42, v43
  v_mfma_f32_16x16x32_bf16 v[84:87], a[52:55], a[160:163], v[84:87]
  ds_read_b64_tr_b16 a[20:21], v237 offset:2048
  ds_read_b64_tr_b16 a[22:23], v237 offset:3072
  v_cvt_pk_bf16_f32 v214, v44, v45
  v_cvt_pk_bf16_f32 v215, v46, v47
  v_mfma_f32_16x16x32_bf16 v[92:95], a[52:55], a[164:167], v[92:95]
  buffer_load_dwordx4 v229, s[36:39], s72 offen offset:1024 lds
  v_mfma_f32_16x16x32_bf16 v[80:83], a[56:59], a[168:171], v[80:83]
  ds_read_b64_tr_b16 a[24:25], v236 offset:4096
  ds_read_b64_tr_b16 a[26:27], v236 offset:5120
  s_not_b32 s87, s85
  v_mfma_f32_16x16x32_bf16 v[88:91], a[56:59], a[172:175], v[88:91]
  buffer_store_dwordx4 v[212:215], v250, s[48:51], s4 offen offset:1024 sc1
  v_mfma_f32_16x16x32_bf16 v[84:87], a[60:63], a[168:171], v[84:87]
  s_add_u32 m0, s69, 32768
  ds_read_b64_tr_b16 a[28:29], v237 offset:4096
  ds_read_b64_tr_b16 a[30:31], v237 offset:5120
  v_mfma_f32_16x16x32_bf16 v[92:95], a[60:63], a[172:175], v[92:95]
  buffer_load_dwordx4 v225, s[36:39], s72 offen offset:1024 lds
  s_cmp_eq_u32 s74, 1
  s_cbranch_scc1 L_g4b
  s_waitcnt lgkmcnt(8)
  v_mfma_f32_16x16x32_bf16 v[32:35], a[0:3], v[0:3], 0
  ds_read_b64_tr_b16 a[32:33], v236 offset:6144
  ds_read_b64_tr_b16 a[34:35], v236 offset:7168
  s_bfe_u32 s87, s87, 393221
  v_mfma_f32_16x16x32_bf16 v[40:43], a[0:3], v[4:7], 0
  ds_read_b64_tr_b16 a[36:37], v237 offset:6144
  ds_read_b64_tr_b16 a[38:39], v237 offset:7168
  s_not_b32 s88, s86
  v_mfma_f32_16x16x32_bf16 v[36:39], a[4:7], v[0:3], 0
  ds_read_b64_tr_b16 a[40:41], v236 offset:8192
  ds_read_b64_tr_b16 a[42:43], v236 offset:9216
  s_bfe_u32 s88, s88, 393221
  v_mfma_f32_16x16x32_bf16 v[44:47], a[4:7], v[4:7], 0
  buffer_load_dwordx4 v226, s[36:39], s72 offen offset:2048 lds
  v_mfma_f32_16x16x32_bf16 v[32:35], a[8:11], v[96:99], v[32:35]
  ds_read_b64_tr_b16 a[44:45], v237 offset:8192
  ds_read_b64_tr_b16 a[46:47], v237 offset:9216
  v_fmac_f32 v48, v80, v244
  v_mfma_f32_16x16x32_bf16 v[40:43], a[8:11], v[100:103], v[40:43]
  ds_read_b64_tr_b16 a[48:49], v236 offset:10240
  ds_read_b64_tr_b16 a[50:51], v236 offset:11264
  v_fmac_f32 v49, v81, v244
  v_mfma_f32_16x16x32_bf16 v[36:39], a[12:15], v[96:99], v[36:39]
  s_add_u32 m0, s69, 49152
  ds_read_b64_tr_b16 a[52:53], v237 offset:10240
  ds_read_b64_tr_b16 a[54:55], v237 offset:11264
  v_mfma_f32_16x16x32_bf16 v[44:47], a[12:15], v[100:103], v[44:47]
  buffer_load_dwordx4 v230, s[36:39], s72 offen offset:2048 lds
  s_waitcnt lgkmcnt(12)
  v_mfma_f32_16x16x32_bf16 v[32:35], a[16:19], v[112:115], v[32:35]
  ds_read_b64_tr_b16 a[56:57], v236 offset:12288
  ds_read_b64_tr_b16 a[58:59], v236 offset:13312
  v_fmac_f32 v50, v82, v244
  v_mfma_f32_16x16x32_bf16 v[40:43], a[16:19], v[116:119], v[40:43]
  ds_read_b64_tr_b16 a[60:61], v237 offset:12288
  ds_read_b64_tr_b16 a[62:63], v237 offset:13312
  v_fmac_f32 v51, v83, v244
  v_fmac_f32 v52, v84, v244
  v_mfma_f32_16x16x32_bf16 v[36:39], a[20:23], v[112:115], v[36:39]
  v_fmac_f32 v53, v85, v244
  v_fmac_f32 v54, v86, v244
  v_fmac_f32 v55, v87, v244
  v_cvt_pk_bf16_f32 v208, v48, v49
  v_mfma_f32_16x16x32_bf16 v[44:47], a[20:23], v[116:119], v[44:47]
  buffer_load_dwordx4 v231, s[36:39], s72 offen offset:3072 lds
  v_mfma_f32_16x16x32_bf16 v[32:35], a[24:27], v[128:131], v[32:35]
  s_add_u32 m0, s69, 32768
  v_cvt_pk_bf16_f32 v209, v50, v51
  v_cvt_pk_bf16_f32 v210, v52, v53
  v_cvt_pk_bf16_f32 v211, v54, v55
  v_mfma_f32_16x16x32_bf16 v[40:43], a[24:27], v[132:135], v[40:43]
  buffer_load_dwordx4 v227, s[36:39], s72 offen offset:3072 lds
  v_mfma_f32_16x16x32_bf16 v[36:39], a[28:31], v[128:131], v[36:39]
  s_bitcmp0_b32 s85, 4
  s_cselect_b32 s92, 2, 1
  s_bitcmp0_b32 s86, 4
  s_cselect_b32 s93, 2, 1
  v_mfma_f32_16x16x32_bf16 v[44:47], a[28:31], v[132:135], v[44:47]
  buffer_store_dwordx4 v[208:211], v250, s[48:51], s5 offen offset:0 sc1
  s_waitcnt lgkmcnt(8)
  v_mfma_f32_16x16x32_bf16 v[32:35], a[32:35], v[144:147], v[32:35]
  s_waitcnt vmcnt(19)
  s_waitcnt lgkmcnt(0)
  s_barrier
  ds_read_b64_tr_b16 a[0:1], v236 offset:47104
  v_mfma_f32_16x16x32_bf16 v[40:43], a[32:35], v[148:151], v[40:43]
  ds_read_b64_tr_b16 a[2:3], v236 offset:48128
  v_fmac_f32 v56, v88, v245
  s_cmp_eq_u32 s87, s89
  s_cselect_b32 s14, s92, 0
  v_mfma_f32_16x16x32_bf16 v[36:39], a[36:39], v[144:147], v[36:39]
  s_add_u32 s72, s80, 0
  s_add_u32 m0, s69, 65536
  ds_read_b64_tr_b16 a[4:5], v237 offset:47104
  ds_read_b64_tr_b16 a[6:7], v237 offset:48128
  v_mfma_f32_16x16x32_bf16 v[44:47], a[36:39], v[148:151], v[44:47]
  buffer_load_dwordx4 v224, s[36:39], s72 offen offset:0 lds
  v_mfma_f32_16x16x32_bf16 v[32:35], a[40:43], v[160:163], v[32:35]
  ds_read_b64_tr_b16 a[8:9], v236 offset:32768
  v_fmac_f32 v57, v89, v245
  s_cmp_eq_u32 s88, s89
  s_cselect_b32 s93, s93, 0
  v_mfma_f32_16x16x32_bf16 v[40:43], a[40:43], v[164:167], v[40:43]
  ds_read_b64_tr_b16 a[10:11], v236 offset:33792
  v_fmac_f32 v58, v90, v245
  v_fmac_f32 v59, v91, v245
  v_mfma_f32_16x16x32_bf16 v[36:39], a[44:47], v[160:163], v[36:39]
  s_add_u32 m0, s69, 81920
  ds_read_b64_tr_b16 a[12:13], v237 offset:32768
  ds_read_b64_tr_b16 a[14:15], v237 offset:33792
  v_mfma_f32_16x16x32_bf16 v[44:47], a[44:47], v[164:167], v[44:47]
  buffer_load_dwordx4 v228, s[36:39], s72 offen offset:0 lds
  v_mfma_f32_16x16x32_bf16 v[32:35], a[48:51], v[176:179], v[32:35]
  ds_read_b64_tr_b16 a[16:17], v236 offset:34816
  v_fmac_f32 v60, v92, v245
  v_fmac_f32 v61, v93, v245
  v_mfma_f32_16x16x32_bf16 v[40:43], a[48:51], v[180:183], v[40:43]
  ds_read_b64_tr_b16 a[18:19], v236 offset:35840
  v_fmac_f32 v62, v94, v245
  v_fmac_f32 v63, v95, v245
  v_mfma_f32_16x16x32_bf16 v[36:39], a[52:55], v[176:179], v[36:39]
  ds_read_b64_tr_b16 a[20:21], v237 offset:34816
  ds_read_b64_tr_b16 a[22:23], v237 offset:35840
  s_or_b32 s14, s14, s93
  v_mfma_f32_16x16x32_bf16 v[44:47], a[52:55], v[180:183], v[44:47]
  buffer_load_dwordx4 v229, s[36:39], s72 offen offset:1024 lds
  v_mfma_f32_16x16x32_bf16 v[32:35], a[56:59], v[192:195], v[32:35]
  ds_read_b64_tr_b16 a[24:25], v236 offset:36864
  v_cvt_pk_bf16_f32 v212, v56, v57
  v_cvt_pk_bf16_f32 v213, v58, v59
  v_mfma_f32_16x16x32_bf16 v[40:43], a[56:59], v[196:199], v[40:43]
  ds_read_b64_tr_b16 a[26:27], v236 offset:37888
  v_cvt_pk_bf16_f32 v214, v60, v61
  v_cvt_pk_bf16_f32 v215, v62, v63
  v_mfma_f32_16x16x32_bf16 v[36:39], a[60:63], v[192:195], v[36:39]
  s_add_u32 m0, s69, 65536
  ds_read_b64_tr_b16 a[28:29], v237 offset:36864
  ds_read_b64_tr_b16 a[30:31], v237 offset:37888
  v_mfma_f32_16x16x32_bf16 v[44:47], a[60:63], v[196:199], v[44:47]
  buffer_load_dwordx4 v225, s[36:39], s72 offen offset:1024 lds
  s_waitcnt lgkmcnt(8)
  v_mfma_f32_16x16x32_bf16 v[64:67], a[0:3], a[112:115], 0
  ds_read_b64_tr_b16 a[32:33], v236 offset:38912
  ds_read_b64_tr_b16 a[34:35], v236 offset:39936
  s_cmp_eq_u32 s70, 7
  s_cselect_b32 s14, 0, s14
  v_mfma_f32_16x16x32_bf16 v[72:75], a[0:3], a[116:119], 0
  ds_read_b64_tr_b16 a[36:37], v237 offset:38912
  ds_read_b64_tr_b16 a[38:39], v237 offset:39936
  v_mfma_f32_16x16x32_bf16 v[68:71], a[4:7], a[112:115], 0
  ds_read_b64_tr_b16 a[40:41], v236 offset:40960
  ds_read_b64_tr_b16 a[42:43], v236 offset:41984
  v_mfma_f32_16x16x32_bf16 v[76:79], a[4:7], a[116:119], 0
  buffer_load_dwordx4 v226, s[36:39], s72 offen offset:2048 lds
  v_mfma_f32_16x16x32_bf16 v[64:67], a[8:11], a[120:123], v[64:67]
  ds_read_b64_tr_b16 a[44:45], v237 offset:40960
  ds_read_b64_tr_b16 a[46:47], v237 offset:41984
  v_mfma_f32_16x16x32_bf16 v[72:75], a[8:11], a[124:127], v[72:75]
  ds_read_b64_tr_b16 a[48:49], v236 offset:43008
  ds_read_b64_tr_b16 a[50:51], v236 offset:44032
  v_mfma_f32_16x16x32_bf16 v[68:71], a[12:15], a[120:123], v[68:71]
  s_add_u32 m0, s69, 81920
  ds_read_b64_tr_b16 a[52:53], v237 offset:43008
  ds_read_b64_tr_b16 a[54:55], v237 offset:44032
  v_mfma_f32_16x16x32_bf16 v[76:79], a[12:15], a[124:127], v[76:79]
  buffer_load_dwordx4 v230, s[36:39], s72 offen offset:2048 lds
  s_waitcnt lgkmcnt(12)
  v_mfma_f32_16x16x32_bf16 v[64:67], a[16:19], a[128:131], v[64:67]
  ds_read_b64_tr_b16 a[56:57], v236 offset:45056
  ds_read_b64_tr_b16 a[58:59], v236 offset:46080
  v_mfma_f32_16x16x32_bf16 v[72:75], a[16:19], a[132:135], v[72:75]
  ds_read_b64_tr_b16 a[60:61], v237 offset:45056
  ds_read_b64_tr_b16 a[62:63], v237 offset:46080
  v_mfma_f32_16x16x32_bf16 v[68:71], a[20:23], a[128:131], v[68:71]
  v_mul_f32 v32, v32, v246
  v_mul_f32 v33, v33, v246
  v_mfma_f32_16x16x32_bf16 v[76:79], a[20:23], a[132:135], v[76:79]
  buffer_load_dwordx4 v231, s[36:39], s72 offen offset:3072 lds
  v_mfma_f32_16x16x32_bf16 v[64:67], a[24:27], a[136:139], v[64:67]
  s_add_u32 m0, s69, 65536
  v_mul_f32 v34, v34, v246
  v_mfma_f32_16x16x32_bf16 v[72:75], a[24:27], a[140:143], v[72:75]
  buffer_load_dwordx4 v227, s[36:39], s72 offen offset:3072 lds
  v_mfma_f32_16x16x32_bf16 v[68:71], a[28:31], a[136:139], v[68:71]
  v_mul_f32 v35, v35, v246
  v_mul_f32 v36, v36, v246
  v_mfma_f32_16x16x32_bf16 v[76:79], a[28:31], a[140:143], v[76:79]
  buffer_store_dwordx4 v[212:215], v250, s[48:51], s5 offen offset:1024 sc1
  buffer_load_dword v217, v216, s[48:51], s97 offen sc1
  s_waitcnt lgkmcnt(8)
  v_mfma_f32_16x16x32_bf16 v[64:67], a[32:35], a[144:147], v[64:67]
  s_waitcnt vmcnt(21)
  s_waitcnt lgkmcnt(0)
  s_barrier
  ds_read_b64_tr_b16 a[0:1], v240 offset:14336
  v_mfma_f32_16x16x32_bf16 v[72:75], a[32:35], a[148:151], v[72:75]
  ds_read_b64_tr_b16 a[2:3], v240 offset:15360
  v_mul_f32 v37, v37, v246
  v_mfma_f32_16x16x32_bf16 v[68:71], a[36:39], a[144:147], v[68:71]
  s_add_u32 s72, s80, 229376
  s_add_u32 m0, s69, 98304
  ds_read_b64_tr_b16 a[4:5], v241 offset:14336
  ds_read_b64_tr_b16 a[6:7], v241 offset:15360
  v_mfma_f32_16x16x32_bf16 v[76:79], a[36:39], a[148:151], v[76:79]
  buffer_load_dwordx4 v224, s[36:39], s72 offen offset:0 lds
  v_mfma_f32_16x16x32_bf16 v[64:67], a[40:43], a[152:155], v[64:67]
  ds_read_b64_tr_b16 a[8:9], v240 offset:0
  v_mul_f32 v38, v38, v246
  v_mfma_f32_16x16x32_bf16 v[72:75], a[40:43], a[156:159], v[72:75]
  ds_read_b64_tr_b16 a[10:11], v240 offset:1024
  v_mul_f32 v39, v39, v246
  v_mfma_f32_16x16x32_bf16 v[68:71], a[44:47], a[152:155], v[68:71]
  s_add_u32 m0, s69, 114688
  ds_read_b64_tr_b16 a[12:13], v241 offset:0
  ds_read_b64_tr_b16 a[14:15], v241 offset:1024
  v_mfma_f32_16x16x32_bf16 v[76:79], a[44:47], a[156:159], v[76:79]
  buffer_load_dwordx4 v228, s[36:39], s72 offen offset:0 lds
  v_mfma_f32_16x16x32_bf16 v[64:67], a[48:51], a[160:163], v[64:67]
  ds_read_b64_tr_b16 a[16:17], v240 offset:2048
  v_mul_f32 v40, v40, v247
  v_mul_f32 v41, v41, v247
  v_mfma_f32_16x16x32_bf16 v[72:75], a[48:51], a[164:167], v[72:75]
  ds_read_b64_tr_b16 a[18:19], v240 offset:3072
  v_mul_f32 v42, v42, v247
  v_mul_f32 v43, v43, v247
  v_mfma_f32_16x16x32_bf16 v[68:71], a[52:55], a[160:163], v[68:71]
  ds_read_b64_tr_b16 a[20:21], v241 offset:2048
  ds_read_b64_tr_b16 a[22:23], v241 offset:3072
  v_mfma_f32_16x16x32_bf16 v[76:79], a[52:55], a[164:167], v[76:79]
  buffer_load_dwordx4 v229, s[36:39], s72 offen offset:1024 lds
  v_mfma_f32_16x16x32_bf16 v[64:67], a[56:59], a[168:171], v[64:67]
  ds_read_b64_tr_b16 a[24:25], v240 offset:4096
  v_mul_f32 v44, v44, v247
  v_mul_f32 v45, v45, v247
  v_mfma_f32_16x16x32_bf16 v[72:75], a[56:59], a[172:175], v[72:75]
  ds_read_b64_tr_b16 a[26:27], v240 offset:5120
  v_mul_f32 v46, v46, v247
  v_mul_f32 v47, v47, v247
  v_mfma_f32_16x16x32_bf16 v[68:71], a[60:63], a[168:171], v[68:71]
  s_add_u32 m0, s69, 98304
  ds_read_b64_tr_b16 a[28:29], v241 offset:4096
  ds_read_b64_tr_b16 a[30:31], v241 offset:5120
  v_mfma_f32_16x16x32_bf16 v[76:79], a[60:63], a[172:175], v[76:79]
  buffer_load_dwordx4 v225, s[36:39], s72 offen offset:1024 lds
  s_waitcnt lgkmcnt(8)
  v_mfma_f32_16x16x32_bf16 v[48:51], a[0:3], v[0:3], 0
  ds_read_b64_tr_b16 a[32:33], v240 offset:6144
  ds_read_b64_tr_b16 a[34:35], v240 offset:7168
  v_mfma_f32_16x16x32_bf16 v[56:59], a[0:3], v[4:7], 0
  ds_read_b64_tr_b16 a[36:37], v241 offset:6144
  ds_read_b64_tr_b16 a[38:39], v241 offset:7168
  v_mfma_f32_16x16x32_bf16 v[52:55], a[4:7], v[0:3], 0
  ds_read_b64_tr_b16 a[40:41], v240 offset:8192
  ds_read_b64_tr_b16 a[42:43], v240 offset:9216
  v_mfma_f32_16x16x32_bf16 v[60:63], a[4:7], v[4:7], 0
  buffer_load_dwordx4 v226, s[36:39], s72 offen offset:2048 lds
  v_mfma_f32_16x16x32_bf16 v[48:51], a[8:11], v[96:99], v[48:51]
  ds_read_b64_tr_b16 a[44:45], v241 offset:8192
  ds_read_b64_tr_b16 a[46:47], v241 offset:9216
  v_fmac_f32 v32, v64, v244
  v_mfma_f32_16x16x32_bf16 v[56:59], a[8:11], v[100:103], v[56:59]
  ds_read_b64_tr_b16 a[48:49], v240 offset:10240
  ds_read_b64_tr_b16 a[50:51], v240 offset:11264
  v_fmac_f32 v33, v65, v244
  v_mfma_f32_16x16x32_bf16 v[52:55], a[12:15], v[96:99], v[52:55]
  s_add_u32 m0, s69, 114688
  ds_read_b64_tr_b16 a[52:53], v241 offset:10240
  ds_read_b64_tr_b16 a[54:55], v241 offset:11264
  v_mfma_f32_16x16x32_bf16 v[60:63], a[12:15], v[100:103], v[60:63]
  buffer_load_dwordx4 v230, s[36:39], s72 offen offset:2048 lds
  s_waitcnt lgkmcnt(12)
  v_mfma_f32_16x16x32_bf16 v[48:51], a[16:19], v[112:115], v[48:51]
  ds_read_b64_tr_b16 a[56:57], v240 offset:12288
  ds_read_b64_tr_b16 a[58:59], v240 offset:13312
  v_fmac_f32 v34, v66, v244
  v_mfma_f32_16x16x32_bf16 v[56:59], a[16:19], v[116:119], v[56:59]
  ds_read_b64_tr_b16 a[60:61], v241 offset:12288
  ds_read_b64_tr_b16 a[62:63], v241 offset:13312
  v_fmac_f32 v35, v67, v244
  v_fmac_f32 v36, v68, v244
  v_mfma_f32_16x16x32_bf16 v[52:55], a[20:23], v[112:115], v[52:55]
  v_fmac_f32 v37, v69, v244
  v_fmac_f32 v38, v70, v244
  v_fmac_f32 v39, v71, v244
  v_cvt_pk_bf16_f32 v208, v32, v33
  v_mfma_f32_16x16x32_bf16 v[60:63], a[20:23], v[116:119], v[60:63]
  buffer_load_dwordx4 v231, s[36:39], s72 offen offset:3072 lds
  v_mfma_f32_16x16x32_bf16 v[48:51], a[24:27], v[128:131], v[48:51]
  s_add_u32 m0, s69, 98304
  v_cvt_pk_bf16_f32 v209, v34, v35
  v_cvt_pk_bf16_f32 v210, v36, v37
  v_cvt_pk_bf16_f32 v211, v38, v39
  v_mfma_f32_16x16x32_bf16 v[56:59], a[24:27], v[132:135], v[56:59]
  buffer_load_dwordx4 v227, s[36:39], s72 offen offset:3072 lds
  v_mfma_f32_16x16x32_bf16 v[52:55], a[28:31], v[128:131], v[52:55]
  v_mfma_f32_16x16x32_bf16 v[60:63], a[28:31], v[132:135], v[60:63]
  buffer_store_dwordx4 v[208:211], v250, s[48:51], s6 offen offset:0 sc1
  s_waitcnt lgkmcnt(8)
  v_mfma_f32_16x16x32_bf16 v[48:51], a[32:35], v[144:147], v[48:51]
  s_waitcnt vmcnt(20)
  s_waitcnt lgkmcnt(0)
  s_barrier
  ds_read_b64_tr_b16 a[0:1], v240 offset:47104
  v_mfma_f32_16x16x32_bf16 v[56:59], a[32:35], v[148:151], v[56:59]
  ds_read_b64_tr_b16 a[2:3], v240 offset:48128
  v_fmac_f32 v40, v72, v245
  v_mfma_f32_16x16x32_bf16 v[52:55], a[36:39], v[144:147], v[52:55]
  s_add_u32 s72, s81, 0
  s_add_u32 m0, s69, 0
  ds_read_b64_tr_b16 a[4:5], v241 offset:47104
  ds_read_b64_tr_b16 a[6:7], v241 offset:48128
  v_mfma_f32_16x16x32_bf16 v[60:63], a[36:39], v[148:151], v[60:63]
  buffer_load_dwordx4 v224, s[36:39], s72 offen offset:0 lds
  v_mfma_f32_16x16x32_bf16 v[48:51], a[40:43], v[160:163], v[48:51]
  ds_read_b64_tr_b16 a[8:9], v240 offset:32768
  v_fmac_f32 v41, v73, v245
  v_mfma_f32_16x16x32_bf16 v[56:59], a[40:43], v[164:167], v[56:59]
  ds_read_b64_tr_b16 a[10:11], v240 offset:33792
  v_fmac_f32 v42, v74, v245
  v_fmac_f32 v43, v75, v245
  v_mfma_f32_16x16x32_bf16 v[52:55], a[44:47], v[160:163], v[52:55]
  s_add_u32 m0, s69, 16384
  ds_read_b64_tr_b16 a[12:13], v241 offset:32768
  ds_read_b64_tr_b16 a[14:15], v241 offset:33792
  v_mfma_f32_16x16x32_bf16 v[60:63], a[44:47], v[164:167], v[60:63]
  buffer_load_dwordx4 v228, s[36:39], s72 offen offset:0 lds
  v_mfma_f32_16x16x32_bf16 v[48:51], a[48:51], v[176:179], v[48:51]
  ds_read_b64_tr_b16 a[16:17], v240 offset:34816
  v_fmac_f32 v44, v76, v245
  v_fmac_f32 v45, v77, v245
  v_mfma_f32_16x16x32_bf16 v[56:59], a[48:51], v[180:183], v[56:59]
  ds_read_b64_tr_b16 a[18:19], v240 offset:35840
  v_fmac_f32 v46, v78, v245
  v_fmac_f32 v47, v79, v245
  v_mfma_f32_16x16x32_bf16 v[52:55], a[52:55], v[176:179], v[52:55]
  ds_read_b64_tr_b16 a[20:21], v241 offset:34816
  ds_read_b64_tr_b16 a[22:23], v241 offset:35840
  v_mfma_f32_16x16x32_bf16 v[60:63], a[52:55], v[180:183], v[60:63]
  buffer_load_dwordx4 v229, s[36:39], s72 offen offset:1024 lds
  v_mfma_f32_16x16x32_bf16 v[48:51], a[56:59], v[192:195], v[48:51]
  ds_read_b64_tr_b16 a[24:25], v240 offset:36864
  v_cvt_pk_bf16_f32 v212, v40, v41
  v_cvt_pk_bf16_f32 v213, v42, v43
  v_mfma_f32_16x16x32_bf16 v[56:59], a[56:59], v[196:199], v[56:59]
  ds_read_b64_tr_b16 a[26:27], v240 offset:37888
  v_cvt_pk_bf16_f32 v214, v44, v45
  v_cvt_pk_bf16_f32 v215, v46, v47
  v_mfma_f32_16x16x32_bf16 v[52:55], a[60:63], v[192:195], v[52:55]
  s_add_u32 m0, s69, 0
  ds_read_b64_tr_b16 a[28:29], v241 offset:36864
  ds_read_b64_tr_b16 a[30:31], v241 offset:37888
  v_mfma_f32_16x16x32_bf16 v[60:63], a[60:63], v[196:199], v[60:63]
  buffer_load_dwordx4 v225, s[36:39], s72 offen offset:1024 lds
  s_waitcnt lgkmcnt(8)
  v_mfma_f32_16x16x32_bf16 v[80:83], a[0:3], a[112:115], 0
  ds_read_b64_tr_b16 a[32:33], v240 offset:38912
  ds_read_b64_tr_b16 a[34:35], v240 offset:39936
  v_mfma_f32_16x16x32_bf16 v[88:91], a[0:3], a[116:119], 0
  ds_read_b64_tr_b16 a[36:37], v241 offset:38912
  ds_read_b64_tr_b16 a[38:39], v241 offset:39936
  v_mfma_f32_16x16x32_bf16 v[84:87], a[4:7], a[112:115], 0
  ds_read_b64_tr_b16 a[40:41], v240 offset:40960
  ds_read_b64_tr_b16 a[42:43], v240 offset:41984
  v_mfma_f32_16x16x32_bf16 v[92:95], a[4:7], a[116:119], 0
  buffer_load_dwordx4 v226, s[36:39], s72 offen offset:2048 lds
  v_mfma_f32_16x16x32_bf16 v[80:83], a[8:11], a[120:123], v[80:83]
  ds_read_b64_tr_b16 a[44:45], v241 offset:40960
  ds_read_b64_tr_b16 a[46:47], v241 offset:41984
  v_mfma_f32_16x16x32_bf16 v[88:91], a[8:11], a[124:127], v[88:91]
  ds_read_b64_tr_b16 a[48:49], v240 offset:43008
  ds_read_b64_tr_b16 a[50:51], v240 offset:44032
  v_mfma_f32_16x16x32_bf16 v[84:87], a[12:15], a[120:123], v[84:87]
  s_add_u32 m0, s69, 16384
  ds_read_b64_tr_b16 a[52:53], v241 offset:43008
  ds_read_b64_tr_b16 a[54:55], v241 offset:44032
  v_mfma_f32_16x16x32_bf16 v[92:95], a[12:15], a[124:127], v[92:95]
  buffer_load_dwordx4 v230, s[36:39], s72 offen offset:2048 lds
  s_waitcnt lgkmcnt(12)
  v_mfma_f32_16x16x32_bf16 v[80:83], a[16:19], a[128:131], v[80:83]
  ds_read_b64_tr_b16 a[56:57], v240 offset:45056
  ds_read_b64_tr_b16 a[58:59], v240 offset:46080
  v_mfma_f32_16x16x32_bf16 v[88:91], a[16:19], a[132:135], v[88:91]
  ds_read_b64_tr_b16 a[60:61], v241 offset:45056
  ds_read_b64_tr_b16 a[62:63], v241 offset:46080
  v_mfma_f32_16x16x32_bf16 v[84:87], a[20:23], a[128:131], v[84:87]
  v_mul_f32 v48, v48, v246
  v_mul_f32 v49, v49, v246
  v_mfma_f32_16x16x32_bf16 v[92:95], a[20:23], a[132:135], v[92:95]
  buffer_load_dwordx4 v231, s[36:39], s72 offen offset:3072 lds
  v_mfma_f32_16x16x32_bf16 v[80:83], a[24:27], a[136:139], v[80:83]
  s_add_u32 m0, s69, 0
  v_mul_f32 v50, v50, v246
  v_mfma_f32_16x16x32_bf16 v[88:91], a[24:27], a[140:143], v[88:91]
  buffer_load_dwordx4 v227, s[36:39], s72 offen offset:3072 lds
  v_mfma_f32_16x16x32_bf16 v[84:87], a[28:31], a[136:139], v[84:87]
  v_mul_f32 v51, v51, v246
  v_mul_f32 v52, v52, v246
  v_mfma_f32_16x16x32_bf16 v[92:95], a[28:31], a[140:143], v[92:95]
  buffer_store_dwordx4 v[212:215], v250, s[48:51], s6 offen offset:1024 sc1
  s_waitcnt lgkmcnt(8)
  v_mfma_f32_16x16x32_bf16 v[80:83], a[32:35], a[144:147], v[80:83]
  s_waitcnt vmcnt(20)
  s_waitcnt lgkmcnt(0)
  s_barrier
  ds_read_b64_tr_b16 a[0:1], v236 offset:14336
  v_mfma_f32_16x16x32_bf16 v[88:91], a[32:35], a[148:151], v[88:91]
  ds_read_b64_tr_b16 a[2:3], v236 offset:15360
  v_mul_f32 v53, v53, v246
  v_mfma_f32_16x16x32_bf16 v[84:87], a[36:39], a[144:147], v[84:87]
  s_add_u32 s72, s81, 229376
  s_add_u32 m0, s69, 32768
  ds_read_b64_tr_b16 a[4:5], v237 offset:14336
  ds_read_b64_tr_b16 a[6:7], v237 offset:15360
  v_mfma_f32_16x16x32_bf16 v[92:95], a[36:39], a[148:151], v[92:95]
  buffer_load_dwordx4 v224, s[36:39], s72 offen offset:0 lds
  v_mfma_f32_16x16x32_bf16 v[80:83], a[40:43], a[152:155], v[80:83]
  ds_read_b64_tr_b16 a[8:9], v236 offset:0
  v_mul_f32 v54, v54, v246
  v_mfma_f32_16x16x32_bf16 v[88:91], a[40:43], a[156:159], v[88:91]
  ds_read_b64_tr_b16 a[10:11], v236 offset:1024
  v_mul_f32 v55, v55, v246
  v_mfma_f32_16x16x32_bf16 v[84:87], a[44:47], a[152:155], v[84:87]
  s_add_u32 m0, s69, 49152
  ds_read_b64_tr_b16 a[12:13], v237 offset:0
  ds_read_b64_tr_b16 a[14:15], v237 offset:1024
  v_mfma_f32_16x16x32_bf16 v[92:95], a[44:47], a[156:159], v[92:95]
  buffer_load_dwordx4 v228, s[36:39], s72 offen offset:0 lds
  v_mfma_f32_16x16x32_bf16 v[80:83], a[48:51], a[160:163], v[80:83]
  ds_read_b64_tr_b16 a[16:17], v236 offset:2048
  v_mul_f32 v56, v56, v247
  v_mul_f32 v57, v57, v247
  v_mfma_f32_16x16x32_bf16 v[88:91], a[48:51], a[164:167], v[88:91]
  ds_read_b64_tr_b16 a[18:19], v236 offset:3072
  v_mul_f32 v58, v58, v247
  v_mul_f32 v59, v59, v247
  v_mfma_f32_16x16x32_bf16 v[84:87], a[52:55], a[160:163], v[84:87]
  ds_read_b64_tr_b16 a[20:21], v237 offset:2048
  ds_read_b64_tr_b16 a[22:23], v237 offset:3072
  v_mfma_f32_16x16x32_bf16 v[92:95], a[52:55], a[164:167], v[92:95]
  buffer_load_dwordx4 v229, s[36:39], s72 offen offset:1024 lds
  v_mfma_f32_16x16x32_bf16 v[80:83], a[56:59], a[168:171], v[80:83]
  ds_read_b64_tr_b16 a[24:25], v236 offset:4096
  v_mul_f32 v60, v60, v247
  v_mul_f32 v61, v61, v247
  v_mfma_f32_16x16x32_bf16 v[88:91], a[56:59], a[172:175], v[88:91]
  ds_read_b64_tr_b16 a[26:27], v236 offset:5120
  v_mul_f32 v62, v62, v247
  v_mul_f32 v63, v63, v247
  v_mfma_f32_16x16x32_bf16 v[84:87], a[60:63], a[168:171], v[84:87]
  s_add_u32 m0, s69, 32768
  ds_read_b64_tr_b16 a[28:29], v237 offset:4096
  ds_read_b64_tr_b16 a[30:31], v237 offset:5120
  v_mfma_f32_16x16x32_bf16 v[92:95], a[60:63], a[172:175], v[92:95]
  buffer_load_dwordx4 v225, s[36:39], s72 offen offset:1024 lds
  s_waitcnt lgkmcnt(8)
  v_mfma_f32_16x16x32_bf16 v[32:35], a[0:3], v[0:3], 0
  ds_read_b64_tr_b16 a[32:33], v236 offset:6144
  ds_read_b64_tr_b16 a[34:35], v236 offset:7168
  v_mfma_f32_16x16x32_bf16 v[40:43], a[0:3], v[4:7], 0
  ds_read_b64_tr_b16 a[36:37], v237 offset:6144
  ds_read_b64_tr_b16 a[38:39], v237 offset:7168
  v_mfma_f32_16x16x32_bf16 v[36:39], a[4:7], v[0:3], 0
  ds_read_b64_tr_b16 a[40:41], v236 offset:8192
  ds_read_b64_tr_b16 a[42:43], v236 offset:9216
  v_mfma_f32_16x16x32_bf16 v[44:47], a[4:7], v[4:7], 0
  buffer_load_dwordx4 v226, s[36:39], s72 offen offset:2048 lds
  v_mfma_f32_16x16x32_bf16 v[32:35], a[8:11], v[96:99], v[32:35]
  ds_read_b64_tr_b16 a[44:45], v237 offset:8192
  ds_read_b64_tr_b16 a[46:47], v237 offset:9216
  v_fmac_f32 v48, v80, v244
  v_mfma_f32_16x16x32_bf16 v[40:43], a[8:11], v[100:103], v[40:43]
  ds_read_b64_tr_b16 a[48:49], v236 offset:10240
  ds_read_b64_tr_b16 a[50:51], v236 offset:11264
  v_fmac_f32 v49, v81, v244
  v_mfma_f32_16x16x32_bf16 v[36:39], a[12:15], v[96:99], v[36:39]
  s_add_u32 m0, s69, 49152
  ds_read_b64_tr_b16 a[52:53], v237 offset:10240
  ds_read_b64_tr_b16 a[54:55], v237 offset:11264
  v_mfma_f32_16x16x32_bf16 v[44:47], a[12:15], v[100:103], v[44:47]
  buffer_load_dwordx4 v230, s[36:39], s72 offen offset:2048 lds
  s_waitcnt lgkmcnt(12)
  v_mfma_f32_16x16x32_bf16 v[32:35], a[16:19], v[112:115], v[32:35]
  ds_read_b64_tr_b16 a[56:57], v236 offset:12288
  ds_read_b64_tr_b16 a[58:59], v236 offset:13312
  v_fmac_f32 v50, v82, v244
  v_mfma_f32_16x16x32_bf16 v[40:43], a[16:19], v[116:119], v[40:43]
  ds_read_b64_tr_b16 a[60:61], v237 offset:12288
  ds_read_b64_tr_b16 a[62:63], v237 offset:13312
  v_fmac_f32 v51, v83, v244
  v_fmac_f32 v52, v84, v244
  v_mfma_f32_16x16x32_bf16 v[36:39], a[20:23], v[112:115], v[36:39]
  v_fmac_f32 v53, v85, v244
  v_fmac_f32 v54, v86, v244
  v_fmac_f32 v55, v87, v244
  v_cvt_pk_bf16_f32 v208, v48, v49
  v_mfma_f32_16x16x32_bf16 v[44:47], a[20:23], v[116:119], v[44:47]
  buffer_load_dwordx4 v231, s[36:39], s72 offen offset:3072 lds
  v_mfma_f32_16x16x32_bf16 v[32:35], a[24:27], v[128:131], v[32:35]
  s_add_u32 m0, s69, 32768
  v_cvt_pk_bf16_f32 v209, v50, v51
  v_cvt_pk_bf16_f32 v210, v52, v53
  v_cvt_pk_bf16_f32 v211, v54, v55
  v_mfma_f32_16x16x32_bf16 v[40:43], a[24:27], v[132:135], v[40:43]
  buffer_load_dwordx4 v227, s[36:39], s72 offen offset:3072 lds
  v_mfma_f32_16x16x32_bf16 v[36:39], a[28:31], v[128:131], v[36:39]
  v_mfma_f32_16x16x32_bf16 v[44:47], a[28:31], v[132:135], v[44:47]
  buffer_store_dwordx4 v[208:211], v250, s[48:51], s7 offen offset:0 sc1
  s_waitcnt lgkmcnt(8)
  v_mfma_f32_16x16x32_bf16 v[32:35], a[32:35], v[144:147], v[32:35]
  s_waitcnt vmcnt(19)
  s_waitcnt lgkmcnt(0)
  s_barrier
  ds_read_b64_tr_b16 a[0:1], v236 offset:47104
  v_mfma_f32_16x16x32_bf16 v[40:43], a[32:35], v[148:151], v[40:43]
  ds_read_b64_tr_b16 a[2:3], v236 offset:48128
  v_fmac_f32 v56, v88, v245
  v_mfma_f32_16x16x32_bf16 v[36:39], a[36:39], v[144:147], v[36:39]
  s_add_u32 s72, s82, 0
  s_add_u32 m0, s69, 65536
  ds_read_b64_tr_b16 a[4:5], v237 offset:47104
  ds_read_b64_tr_b16 a[6:7], v237 offset:48128
  v_mfma_f32_16x16x32_bf16 v[44:47], a[36:39], v[148:151], v[44:47]
  buffer_load_dwordx4 v224, s[36:39], s72 offen offset:0 lds
  v_mfma_f32_16x16x32_bf16 v[32:35], a[40:43], v[160:163], v[32:35]
  ds_read_b64_tr_b16 a[8:9], v236 offset:32768
  v_fmac_f32 v57, v89, v245
  v_mfma_f32_16x16x32_bf16 v[40:43], a[40:43], v[164:167], v[40:43]
  ds_read_b64_tr_b16 a[10:11], v236 offset:33792
  v_fmac_f32 v58, v90, v245
  v_fmac_f32 v59, v91, v245
  v_mfma_f32_16x16x32_bf16 v[36:39], a[44:47], v[160:163], v[36:39]
  s_add_u32 m0, s69, 81920
  ds_read_b64_tr_b16 a[12:13], v237 offset:32768
  ds_read_b64_tr_b16 a[14:15], v237 offset:33792
  v_mfma_f32_16x16x32_bf16 v[44:47], a[44:47], v[164:167], v[44:47]
  buffer_load_dwordx4 v228, s[36:39], s72 offen offset:0 lds
  v_mfma_f32_16x16x32_bf16 v[32:35], a[48:51], v[176:179], v[32:35]
  ds_read_b64_tr_b16 a[16:17], v236 offset:34816
  v_fmac_f32 v60, v92, v245
  v_fmac_f32 v61, v93, v245
  v_mfma_f32_16x16x32_bf16 v[40:43], a[48:51], v[180:183], v[40:43]
  ds_read_b64_tr_b16 a[18:19], v236 offset:35840
  v_fmac_f32 v62, v94, v245
  v_fmac_f32 v63, v95, v245
  v_mfma_f32_16x16x32_bf16 v[36:39], a[52:55], v[176:179], v[36:39]
  ds_read_b64_tr_b16 a[20:21], v237 offset:34816
  ds_read_b64_tr_b16 a[22:23], v237 offset:35840
  v_mfma_f32_16x16x32_bf16 v[44:47], a[52:55], v[180:183], v[44:47]
  buffer_load_dwordx4 v229, s[36:39], s72 offen offset:1024 lds
  v_mfma_f32_16x16x32_bf16 v[32:35], a[56:59], v[192:195], v[32:35]
  ds_read_b64_tr_b16 a[24:25], v236 offset:36864
  v_cvt_pk_bf16_f32 v212, v56, v57
  v_cvt_pk_bf16_f32 v213, v58, v59
  v_mfma_f32_16x16x32_bf16 v[40:43], a[56:59], v[196:199], v[40:43]
  ds_read_b64_tr_b16 a[26:27], v236 offset:37888
  v_cvt_pk_bf16_f32 v214, v60, v61
  v_cvt_pk_bf16_f32 v215, v62, v63
  v_mfma_f32_16x16x32_bf16 v[36:39], a[60:63], v[192:195], v[36:39]
  s_add_u32 m0, s69, 65536
  ds_read_b64_tr_b16 a[28:29], v237 offset:36864
  ds_read_b64_tr_b16 a[30:31], v237 offset:37888
  v_mfma_f32_16x16x32_bf16 v[44:47], a[60:63], v[196:199], v[44:47]
  buffer_load_dwordx4 v225, s[36:39], s72 offen offset:1024 lds
  s_waitcnt lgkmcnt(8)
  v_mfma_f32_16x16x32_bf16 v[64:67], a[0:3], a[112:115], 0
  ds_read_b64_tr_b16 a[32:33], v236 offset:38912
  ds_read_b64_tr_b16 a[34:35], v236 offset:39936
  v_mfma_f32_16x16x32_bf16 v[72:75], a[0:3], a[116:119], 0
  ds_read_b64_tr_b16 a[36:37], v237 offset:38912
  ds_read_b64_tr_b16 a[38:39], v237 offset:39936
  v_mfma_f32_16x16x32_bf16 v[68:71], a[4:7], a[112:115], 0
  ds_read_b64_tr_b16 a[40:41], v236 offset:40960
  ds_read_b64_tr_b16 a[42:43], v236 offset:41984
  v_mfma_f32_16x16x32_bf16 v[76:79], a[4:7], a[116:119], 0
  buffer_load_dwordx4 v226, s[36:39], s72 offen offset:2048 lds
  v_mfma_f32_16x16x32_bf16 v[64:67], a[8:11], a[120:123], v[64:67]
  ds_read_b64_tr_b16 a[44:45], v237 offset:40960
  ds_read_b64_tr_b16 a[46:47], v237 offset:41984
  v_mfma_f32_16x16x32_bf16 v[72:75], a[8:11], a[124:127], v[72:75]
  ds_read_b64_tr_b16 a[48:49], v236 offset:43008
  ds_read_b64_tr_b16 a[50:51], v236 offset:44032
  v_mfma_f32_16x16x32_bf16 v[68:71], a[12:15], a[120:123], v[68:71]
  s_add_u32 m0, s69, 81920
  ds_read_b64_tr_b16 a[52:53], v237 offset:43008
  ds_read_b64_tr_b16 a[54:55], v237 offset:44032
  v_mfma_f32_16x16x32_bf16 v[76:79], a[12:15], a[124:127], v[76:79]
  buffer_load_dwordx4 v230, s[36:39], s72 offen offset:2048 lds
  s_waitcnt lgkmcnt(12)
  v_mfma_f32_16x16x32_bf16 v[64:67], a[16:19], a[128:131], v[64:67]
  ds_read_b64_tr_b16 a[56:57], v236 offset:45056
  ds_read_b64_tr_b16 a[58:59], v236 offset:46080
  v_mfma_f32_16x16x32_bf16 v[72:75], a[16:19], a[132:135], v[72:75]
  ds_read_b64_tr_b16 a[60:61], v237 offset:45056
  ds_read_b64_tr_b16 a[62:63], v237 offset:46080
  v_mfma_f32_16x16x32_bf16 v[68:71], a[20:23], a[128:131], v[68:71]
  v_mul_f32 v32, v32, v246
  v_mul_f32 v33, v33, v246
  v_mfma_f32_16x16x32_bf16 v[76:79], a[20:23], a[132:135], v[76:79]
  buffer_load_dwordx4 v231, s[36:39], s72 offen offset:3072 lds
  v_mfma_f32_16x16x32_bf16 v[64:67], a[24:27], a[136:139], v[64:67]
  s_add_u32 m0, s69, 65536
  v_mul_f32 v34, v34, v246
  v_mfma_f32_16x16x32_bf16 v[72:75], a[24:27], a[140:143], v[72:75]
  buffer_load_dwordx4 v227, s[36:39], s72 offen offset:3072 lds
  v_cmp_ne_u32_e64 s[90:91], s96, v217
  v_mfma_f32_16x16x32_bf16 v[68:71], a[28:31], a[136:139], v[68:71]
  v_mul_f32 v35, v35, v246
  v_mul_f32 v36, v36, v246
  v_mfma_f32_16x16x32_bf16 v[76:79], a[28:31], a[140:143], v[76:79]
  s_cmp_lg_u64 s[90:91], 0
  s_cbranch_scc1 L_spin2
L_spin2r:
  buffer_store_dwordx4 v[212:215], v250, s[48:51], s7 offen offset:1024 sc1
  s_waitcnt lgkmcnt(8)
  v_mfma_f32_16x16x32_bf16 v[64:67], a[32:35], a[144:147], v[64:67]
  s_waitcnt vmcnt(19)
  s_waitcnt lgkmcnt(0)
  s_barrier
  ds_read_b64_tr_b16 a[0:1], v240 offset:14336
  v_mfma_f32_16x16x32_bf16 v[72:75], a[32:35], a[148:151], v[72:75]
  ds_read_b64_tr_b16 a[2:3], v240 offset:15360
  v_mul_f32 v37, v37, v246
  v_mfma_f32_16x16x32_bf16 v[68:71], a[36:39], a[144:147], v[68:71]
  s_add_u32 s72, s82, 229376
  s_add_u32 m0, s69, 98304
  ds_read_b64_tr_b16 a[4:5], v241 offset:14336
  ds_read_b64_tr_b16 a[6:7], v241 offset:15360
  v_mfma_f32_16x16x32_bf16 v[76:79], a[36:39], a[148:151], v[76:79]
  buffer_load_dwordx4 v224, s[36:39], s72 offen offset:0 lds
  v_mfma_f32_16x16x32_bf16 v[64:67], a[40:43], a[152:155], v[64:67]
  ds_read_b64_tr_b16 a[8:9], v240 offset:0
  v_mul_f32 v38, v38, v246
  v_mfma_f32_16x16x32_bf16 v[72:75], a[40:43], a[156:159], v[72:75]
  ds_read_b64_tr_b16 a[10:11], v240 offset:1024
  v_mul_f32 v39, v39, v246
  v_mfma_f32_16x16x32_bf16 v[68:71], a[44:47], a[152:155], v[68:71]
  s_add_u32 m0, s69, 114688
  ds_read_b64_tr_b16 a[12:13], v241 offset:0
  ds_read_b64_tr_b16 a[14:15], v241 offset:1024
  v_mfma_f32_16x16x32_bf16 v[76:79], a[44:47], a[156:159], v[76:79]
  buffer_load_dwordx4 v228, s[36:39], s72 offen offset:0 lds
  v_mfma_f32_16x16x32_bf16 v[64:67], a[48:51], a[160:163], v[64:67]
  ds_read_b64_tr_b16 a[16:17], v240 offset:2048
  v_mul_f32 v40, v40, v247
  v_mul_f32 v41, v41, v247
  v_mfma_f32_16x16x32_bf16 v[72:75], a[48:51], a[164:167], v[72:75]
  ds_read_b64_tr_b16 a[18:19], v240 offset:3072
  v_mul_f32 v42, v42, v247
  v_mul_f32 v43, v43, v247
  v_mfma_f32_16x16x32_bf16 v[68:71], a[52:55], a[160:163], v[68:71]
  ds_read_b64_tr_b16 a[20:21], v241 offset:2048
  ds_read_b64_tr_b16 a[22:23], v241 offset:3072
  v_mfma_f32_16x16x32_bf16 v[76:79], a[52:55], a[164:167], v[76:79]
  buffer_load_dwordx4 v229, s[36:39], s72 offen offset:1024 lds
  v_mfma_f32_16x16x32_bf16 v[64:67], a[56:59], a[168:171], v[64:67]
  ds_read_b64_tr_b16 a[24:25], v240 offset:4096
  v_mul_f32 v44, v44, v247
  v_mul_f32 v45, v45, v247
  v_mfma_f32_16x16x32_bf16 v[72:75], a[56:59], a[172:175], v[72:75]
  ds_read_b64_tr_b16 a[26:27], v240 offset:5120
  v_mul_f32 v46, v46, v247
  v_mul_f32 v47, v47, v247
  v_mfma_f32_16x16x32_bf16 v[68:71], a[60:63], a[168:171], v[68:71]
  s_add_u32 m0, s69, 98304
  ds_read_b64_tr_b16 a[28:29], v241 offset:4096
  ds_read_b64_tr_b16 a[30:31], v241 offset:5120
  v_mfma_f32_16x16x32_bf16 v[76:79], a[60:63], a[172:175], v[76:79]
  buffer_load_dwordx4 v225, s[36:39], s72 offen offset:1024 lds
  s_waitcnt lgkmcnt(8)
  v_mfma_f32_16x16x32_bf16 v[48:51], a[0:3], v[0:3], 0
  ds_read_b64_tr_b16 a[32:33], v240 offset:6144
  ds_read_b64_tr_b16 a[34:35], v240 offset:7168
  v_mfma_f32_16x16x32_bf16 v[56:59], a[0:3], v[4:7], 0
  ds_read_b64_tr_b16 a[36:37], v241 offset:6144
  ds_read_b64_tr_b16 a[38:39], v241 offset:7168
  v_mfma_f32_16x16x32_bf16 v[52:55], a[4:7], v[0:3], 0
  ds_read_b64_tr_b16 a[40:41], v240 offset:8192
  ds_read_b64_tr_b16 a[42:43], v240 offset:9216
  v_mfma_f32_16x16x32_bf16 v[60:63], a[4:7], v[4:7], 0
  buffer_load_dwordx4 v226, s[36:39], s72 offen offset:2048 lds
  v_mfma_f32_16x16x32_bf16 v[48:51], a[8:11], v[96:99], v[48:51]
  ds_read_b64_tr_b16 a[44:45], v241 offset:8192
  ds_read_b64_tr_b16 a[46:47], v241 offset:9216
  v_fmac_f32 v32, v64, v244
  v_mfma_f32_16x16x32_bf16 v[56:59], a[8:11], v[100:103], v[56:59]
  ds_read_b64_tr_b16 a[48:49], v240 offset:10240
  ds_read_b64_tr_b16 a[50:51], v240 offset:11264
  v_fmac_f32 v33, v65, v244
  v_mfma_f32_16x16x32_bf16 v[52:55], a[12:15], v[96:99], v[52:55]
  s_add_u32 m0, s69, 114688
  ds_read_b64_tr_b16 a[52:53], v241 offset:10240
  ds_read_b64_tr_b16 a[54:55], v241 offset:11264
  v_mfma_f32_16x16x32_bf16 v[60:63], a[12:15], v[100:103], v[60:63]
  buffer_load_dwordx4 v230, s[36:39], s72 offen offset:2048 lds
  s_waitcnt lgkmcnt(12)
  v_mfma_f32_16x16x32_bf16 v[48:51], a[16:19], v[112:115], v[48:51]
  ds_read_b64_tr_b16 a[56:57], v240 offset:12288
  ds_read_b64_tr_b16 a[58:59], v240 offset:13312
  v_fmac_f32 v34, v66, v244
  v_mfma_f32_16x16x32_bf16 v[56:59], a[16:19], v[116:119], v[56:59]
  ds_read_b64_tr_b16 a[60:61], v241 offset:12288
  ds_read_b64_tr_b16 a[62:63], v241 offset:13312
  v_fmac_f32 v35, v67, v244
  v_fmac_f32 v36, v68, v244
  v_mfma_f32_16x16x32_bf16 v[52:55], a[20:23], v[112:115], v[52:55]
  v_fmac_f32 v37, v69, v244
  v_fmac_f32 v38, v70, v244
  v_fmac_f32 v39, v71, v244
  v_cvt_pk_bf16_f32 v208, v32, v33
  v_mfma_f32_16x16x32_bf16 v[60:63], a[20:23], v[116:119], v[60:63]
  buffer_load_dwordx4 v231, s[36:39], s72 offen offset:3072 lds
  v_mfma_f32_16x16x32_bf16 v[48:51], a[24:27], v[128:131], v[48:51]
  s_add_u32 m0, s69, 98304
  v_cvt_pk_bf16_f32 v209, v34, v35
  v_cvt_pk_bf16_f32 v210, v36, v37
  v_cvt_pk_bf16_f32 v211, v38, v39
  v_mfma_f32_16x16x32_bf16 v[56:59], a[24:27], v[132:135], v[56:59]
  buffer_load_dwordx4 v227, s[36:39], s72 offen offset:3072 lds
  v_mfma_f32_16x16x32_bf16 v[52:55], a[28:31], v[128:131], v[52:55]
  v_mfma_f32_16x16x32_bf16 v[60:63], a[28:31], v[132:135], v[60:63]
  buffer_store_dwordx4 v[208:211], v250, s[48:51], s8 offen offset:0 sc1
  s_waitcnt lgkmcnt(8)
  v_mfma_f32_16x16x32_bf16 v[48:51], a[32:35], v[144:147], v[48:51]
  s_waitcnt vmcnt(19)
  s_barrier
  ds_read_b64_tr_b16 a[0:1], v240 offset:47104
  v_mfma_f32_16x16x32_bf16 v[56:59], a[32:35], v[148:151], v[56:59]
  ds_read_b64_tr_b16 a[2:3], v240 offset:48128
  v_fmac_f32 v40, v72, v245
  v_fmac_f32 v41, v73, v245
  v_mfma_f32_16x16x32_bf16 v[52:55], a[36:39], v[144:147], v[52:55]
  ds_read_b64_tr_b16 a[4:5], v241 offset:47104
  v_fmac_f32 v42, v74, v245
  v_fmac_f32 v43, v75, v245
  v_mfma_f32_16x16x32_bf16 v[60:63], a[36:39], v[148:151], v[60:63]
  ds_read_b64_tr_b16 a[6:7], v241 offset:48128
  v_fmac_f32 v44, v76, v245
  v_fmac_f32 v45, v77, v245
  s_cmp_lg_u32 s14, 0
  s_cbranch_scc1 L_ys1
L_ys1r:
  v_mfma_f32_16x16x32_bf16 v[48:51], a[40:43], v[160:163], v[48:51]
  ds_read_b64_tr_b16 a[8:9], v240 offset:32768
  ds_read_b64_tr_b16 a[10:11], v240 offset:33792
  v_fmac_f32 v46, v78, v245
  v_fmac_f32 v47, v79, v245
  v_mfma_f32_16x16x32_bf16 v[56:59], a[40:43], v[164:167], v[56:59]
  v_cvt_pk_bf16_f32 v212, v40, v41
  v_cvt_pk_bf16_f32 v213, v42, v43
  s_add_u32 s87, s83, 0
  buffer_load_dwordx4 v[104:107], v250, s[48:51], s87 offen offset:0 sc1
  v_mfma_f32_16x16x32_bf16 v[52:55], a[44:47], v[160:163], v[52:55]
  ds_read_b64_tr_b16 a[12:13], v241 offset:32768
  v_cvt_pk_bf16_f32 v214, v44, v45
  v_cvt_pk_bf16_f32 v215, v46, v47
  v_mfma_f32_16x16x32_bf16 v[60:63], a[44:47], v[164:167], v[60:63]
  ds_read_b64_tr_b16 a[14:15], v241 offset:33792
  s_waitcnt lgkmcnt(8)
  v_mfma_f32_16x16x32_bf16 v[48:51], a[48:51], v[176:179], v[48:51]
  ds_read_b64_tr_b16 a[16:17], v240 offset:34816
  ds_read_b64_tr_b16 a[18:19], v240 offset:35840
  v_mfma_f32_16x16x32_bf16 v[56:59], a[48:51], v[180:183], v[56:59]
  buffer_store_dwordx4 v[212:215], v250, s[48:51], s8 offen offset:1024 sc1
  v_mfma_f32_16x16x32_bf16 v[52:55], a[52:55], v[176:179], v[52:55]
  ds_read_b64_tr_b16 a[20:21], v241 offset:34816
  ds_read_b64_tr_b16 a[22:23], v241 offset:35840
  v_mfma_f32_16x16x32_bf16 v[60:63], a[52:55], v[180:183], v[60:63]
  s_add_u32 s87, s83, 0
  buffer_load_dwordx4 v[108:111], v250, s[48:51], s87 offen offset:1024 sc1
  v_mfma_f32_16x16x32_bf16 v[48:51], a[56:59], v[192:195], v[48:51]
  ds_read_b64_tr_b16 a[24:25], v240 offset:36864
  v_mfma_f32_16x16x32_bf16 v[56:59], a[56:59], v[196:199], v[56:59]
  ds_read_b64_tr_b16 a[26:27], v240 offset:37888
  v_mfma_f32_16x16x32_bf16 v[52:55], a[60:63], v[192:195], v[52:55]
  ds_read_b64_tr_b16 a[28:29], v241 offset:36864
  v_mfma_f32_16x16x32_bf16 v[60:63], a[60:63], v[196:199], v[60:63]
  ds_read_b64_tr_b16 a[30:31], v241 offset:37888
  s_waitcnt lgkmcnt(8)
  v_mfma_f32_16x16x32_bf16 v[80:83], a[0:3], a[112:115], 0
  ds_read_b64_tr_b16 a[32:33], v240 offset:38912
  ds_read_b64_tr_b16 a[34:35], v240 offset:39936
  ds_read_b64_tr_b16 a[36:37], v241 offset:38912
  ds_read_b64_tr_b16 a[38:39], v241 offset:39936
  v_mfma_f32_16x16x32_bf16 v[88:91], a[0:3], a[116:119], 0
  s_add_u32 s87, s83, 0
  buffer_load_dwordx4 v[120:123], v250, s[48:51], s87 offen offset:2048 sc1
  v_mfma_f32_16x16x32_bf16 v[84:87], a[4:7], a[112:115], 0
  ds_read_b64_tr_b16 a[40:41], v240 offset:40960
  v_accvgpr_read_b32 v8, a224
  v_and_b32 v218, 15, v251
  v_mfma_f32_16x16x32_bf16 v[92:95], a[4:7], a[116:119], 0
  ds_read_b64_tr_b16 a[42:43], v240 offset:41984
  v_accvgpr_read_b32 v9, a225
  v_lshrrev_b32 v219, 4, v251
  v_mfma_f32_16x16x32_bf16 v[80:83], a[8:11], a[120:123], v[80:83]
  ds_read_b64_tr_b16 a[44:45], v241 offset:40960
  ds_read_b64_tr_b16 a[46:47], v241 offset:41984
  v_lshlrev_b32 v219, 2, v219
  v_mfma_f32_16x16x32_bf16 v[88:91], a[8:11], a[124:127], v[88:91]
  ds_read_b64_tr_b16 a[48:49], v240 offset:43008
  ds_read_b64_tr_b16 a[50:51], v240 offset:44032
  v_sub_u32 v218, v218, v219
  v_mfma_f32_16x16x32_bf16 v[84:87], a[12:15], a[120:123], v[84:87]
  ds_read_b64_tr_b16 a[52:53], v241 offset:43008
  ds_read_b64_tr_b16 a[54:55], v241 offset:44032
  v_mul_f32 v48, v48, v246
  v_mfma_f32_16x16x32_bf16 v[92:95], a[12:15], a[124:127], v[92:95]
  s_add_u32 s87, s83, 0
  buffer_load_dwordx4 v[124:127], v250, s[48:51], s87 offen offset:3072 sc1
  s_waitcnt lgkmcnt(12)
  v_mfma_f32_16x16x32_bf16 v[80:83], a[16:19], a[128:131], v[80:83]
  ds_read_b64_tr_b16 a[56:57], v240 offset:45056
  ds_read_b64_tr_b16 a[58:59], v240 offset:46080
  v_mov_b32 v220, 0x3f80
  v_mfma_f32_16x16x32_bf16 v[88:91], a[16:19], a[132:135], v[88:91]
  ds_read_b64_tr_b16 a[60:61], v241 offset:45056
  ds_read_b64_tr_b16 a[62:63], v241 offset:46080
  v_mov_b32 v221, 0x3f800000
  v_mfma_f32_16x16x32_bf16 v[84:87], a[20:23], a[128:131], v[84:87]
  v_mul_f32 v49, v49, v246
  v_mul_f32 v50, v50, v246
  v_cmp_eq_u32_e64 s[94:95], 0, v218
  v_mfma_f32_16x16x32_bf16 v[92:95], a[20:23], a[132:135], v[92:95]
  v_mul_f32 v51, v51, v246
  v_mul_f32 v52, v52, v246
  v_cmp_eq_u32_e64 s[92:93], 1, v218
  v_mfma_f32_16x16x32_bf16 v[80:83], a[24:27], a[136:139], v[80:83]
  v_mul_f32 v53, v53, v246
  v_mul_f32 v54, v54, v246
  v_accvgpr_write_b32 a176, 0
  v_mfma_f32_16x16x32_bf16 v[88:91], a[24:27], a[140:143], v[88:91]
  v_mul_f32 v55, v55, v246
  v_mul_f32 v56, v56, v247
  v_accvgpr_write_b32 a180, 0
  v_mfma_f32_16x16x32_bf16 v[84:87], a[28:31], a[136:139], v[84:87]
  v_mul_f32 v57, v57, v247
  v_mul_f32 v58, v58, v247
  v_cndmask_b32_e64 v219, 0, v220, s[94:95]
  v_mfma_f32_16x16x32_bf16 v[92:95], a[28:31], a[140:143], v[92:95]
  v_mul_f32 v59, v59, v247
  v_cndmask_b32_e64 v219, v219, v221, s[92:93]
  s_waitcnt lgkmcnt(8)
  v_mfma_f32_16x16x32_bf16 v[80:83], a[32:35], a[144:147], v[80:83]
  s_waitcnt vmcnt(15)
  s_barrier
  ds_read_b64_tr_b16 a[0:1], v236 offset:14336
  ds_read_b64_tr_b16 a[2:3], v236 offset:15360
  v_mfma_f32_16x16x32_bf16 v[88:91], a[32:35], a[148:151], v[88:91]
  v_mul_f32 v60, v60, v247
  s_add_u32 s87, s83, 4096
  buffer_load_dwordx4 v[136:139], v250, s[48:51], s87 offen offset:0 sc1
  v_mfma_f32_16x16x32_bf16 v[84:87], a[36:39], a[144:147], v[84:87]
  ds_read_b64_tr_b16 a[4:5], v237 offset:14336
  v_mul_f32 v61, v61, v247
  v_accvgpr_write_b32 a178, v219
  v_mfma_f32_16x16x32_bf16 v[92:95], a[36:39], a[148:151], v[92:95]
  ds_read_b64_tr_b16 a[6:7], v237 offset:15360
  v_mul_f32 v62, v62, v247
  v_cmp_eq_u32_e64 s[94:95], 2, v218
  v_mfma_f32_16x16x32_bf16 v[80:83], a[40:43], a[152:155], v[80:83]
  ds_read_b64_tr_b16 a[8:9], v236 offset:0
  v_mul_f32 v63, v63, v247
  v_cmp_eq_u32_e64 s[92:93], 3, v218
  v_mfma_f32_16x16x32_bf16 v[88:91], a[40:43], a[156:159], v[88:91]
  ds_read_b64_tr_b16 a[10:11], v236 offset:1024
  v_accvgpr_read_b32 v10, a226
  v_accvgpr_write_b32 a177, 0
  v_mfma_f32_16x16x32_bf16 v[84:87], a[44:47], a[152:155], v[84:87]
  ds_read_b64_tr_b16 a[12:13], v237 offset:0
  ds_read_b64_tr_b16 a[14:15], v237 offset:1024
  v_accvgpr_write_b32 a181, 0
  v_mfma_f32_16x16x32_bf16 v[92:95], a[44:47], a[156:159], v[92:95]
  s_add_u32 s87, s83, 4096
  buffer_load_dwordx4 v[140:143], v250, s[48:51], s87 offen offset:1024 sc1
  s_waitcnt lgkmcnt(8)
  v_mfma_f32_16x16x32_bf16 v[80:83], a[48:51], a[160:163], v[80:83]
  ds_read_b64_tr_b16 a[16:17], v236 offset:2048
  v_accvgpr_read_b32 v11, a227
  v_cndmask_b32_e64 v219, 0, v220, s[94:95]
  v_mfma_f32_16x16x32_bf16 v[88:91], a[48:51], a[164:167], v[88:91]
  ds_read_b64_tr_b16 a[18:19], v236 offset:3072
  v_accvgpr_read_b32 v12, a228
  v_mfma_f32_16x16x32_bf16 v[84:87], a[52:55], a[160:163], v[84:87]
  ds_read_b64_tr_b16 a[20:21], v237 offset:2048
  v_accvgpr_read_b32 v13, a229
  v_mfma_f32_16x16x32_bf16 v[92:95], a[52:55], a[164:167], v[92:95]
  ds_read_b64_tr_b16 a[22:23], v237 offset:3072
  v_accvgpr_read_b32 v14, a230
  v_mfma_f32_16x16x32_bf16 v[80:83], a[56:59], a[168:171], v[80:83]
  ds_read_b64_tr_b16 a[24:25], v236 offset:4096
  v_accvgpr_read_b32 v15, a231
  v_mfma_f32_16x16x32_bf16 v[88:91], a[56:59], a[172:175], v[88:91]
  ds_read_b64_tr_b16 a[26:27], v236 offset:5120
  v_cndmask_b32_e64 v219, v219, v221, s[92:93]
  v_mfma_f32_16x16x32_bf16 v[84:87], a[60:63], a[168:171], v[84:87]
  ds_read_b64_tr_b16 a[28:29], v237 offset:4096
  v_accvgpr_write_b32 a179, v219
  v_mfma_f32_16x16x32_bf16 v[92:95], a[60:63], a[172:175], v[92:95]
  ds_read_b64_tr_b16 a[30:31], v237 offset:5120
  s_waitcnt lgkmcnt(8)
  v_mfma_f32_16x16x32_bf16 v[32:35], a[0:3], v[0:3], 0
  ds_read_b64_tr_b16 a[32:33], v236 offset:6144
  ds_read_b64_tr_b16 a[34:35], v236 offset:7168
  v_mfma_f32_16x16x32_bf16 v[40:43], a[0:3], v[4:7], 0
  ds_read_b64_tr_b16 a[36:37], v237 offset:6144
  ds_read_b64_tr_b16 a[38:39], v237 offset:7168
  v_mfma_f32_16x16x32_bf16 v[36:39], a[4:7], v[0:3], 0
  ds_read_b64_tr_b16 a[40:41], v236 offset:8192
  v_fmac_f32 v48, v80, v244
  v_fmac_f32 v49, v81, v244
  v_mfma_f32_16x16x32_bf16 v[44:47], a[4:7], v[4:7], 0
  ds_read_b64_tr_b16 a[42:43], v236 offset:9216
  v_fmac_f32 v50, v82, v244
  v_fmac_f32 v51, v83, v244
  v_mfma_f32_16x16x32_bf16 v[32:35], a[8:11], v[96:99], v[32:35]
  ds_read_b64_tr_b16 a[44:45], v237 offset:8192
  ds_read_b64_tr_b16 a[46:47], v237 offset:9216
  v_mfma_f32_16x16x32_bf16 v[40:43], a[8:11], v[100:103], v[40:43]
  ds_read_b64_tr_b16 a[48:49], v236 offset:10240
  ds_read_b64_tr_b16 a[50:51], v236 offset:11264
  v_mfma_f32_16x16x32_bf16 v[36:39], a[12:15], v[96:99], v[36:39]
  ds_read_b64_tr_b16 a[52:53], v237 offset:10240
  v_fmac_f32 v52, v84, v244
  v_fmac_f32 v53, v85, v244
  v_mfma_f32_16x16x32_bf16 v[44:47], a[12:15], v[100:103], v[44:47]
  ds_read_b64_tr_b16 a[54:55], v237 offset:11264
  s_waitcnt lgkmcnt(12)
  v_mfma_f32_16x16x32_bf16 v[32:35], a[16:19], v[112:115], v[32:35]
  ds_read_b64_tr_b16 a[56:57], v236 offset:12288
  ds_read_b64_tr_b16 a[58:59], v236 offset:13312
  v_mfma_f32_16x16x32_bf16 v[40:43], a[16:19], v[116:119], v[40:43]
  ds_read_b64_tr_b16 a[60:61], v237 offset:12288
  ds_read_b64_tr_b16 a[62:63], v237 offset:13312
  v_mfma_f32_16x16x32_bf16 v[36:39], a[20:23], v[112:115], v[36:39]
  v_fmac_f32 v54, v86, v244
  v_fmac_f32 v55, v87, v244
  v_cvt_pk_bf16_f32 v208, v48, v49
  v_mfma_f32_16x16x32_bf16 v[44:47], a[20:23], v[116:119], v[44:47]
  v_cvt_pk_bf16_f32 v209, v50, v51
  v_cvt_pk_bf16_f32 v210, v52, v53
  v_cvt_pk_bf16_f32 v211, v54, v55
  v_mfma_f32_16x16x32_bf16 v[32:35], a[24:27], v[128:131], v[32:35]
  buffer_store_dwordx4 v[208:211], v250, s[48:51], s9 offen offset:0 sc1
  v_mfma_f32_16x16x32_bf16 v[40:43], a[24:27], v[132:135], v[40:43]
  v_fmac_f32 v56, v88, v245
  v_fmac_f32 v57, v89, v245
  v_fmac_f32 v58, v90, v245
  v_mfma_f32_16x16x32_bf16 v[36:39], a[28:31], v[128:131], v[36:39]
  v_fmac_f32 v59, v91, v245
  v_fmac_f32 v60, v92, v245
  v_fmac_f32 v61, v93, v245
  v_mfma_f32_16x16x32_bf16 v[44:47], a[28:31], v[132:135], v[44:47]
  v_fmac_f32 v62, v94, v245
  v_fmac_f32 v63, v95, v245
  s_waitcnt lgkmcnt(8)
  v_mfma_f32_16x16x32_bf16 v[32:35], a[32:35], v[144:147], v[32:35]
  s_waitcnt vmcnt(9)
  s_barrier
  ds_read_b64_tr_b16 a[0:1], v236 offset:47104
  v_mfma_f32_16x16x32_bf16 v[40:43], a[32:35], v[148:151], v[40:43]
  ds_read_b64_tr_b16 a[2:3], v236 offset:48128
  v_cvt_pk_bf16_f32 v212, v56, v57
  v_cvt_pk_bf16_f32 v213, v58, v59
  v_mfma_f32_16x16x32_bf16 v[36:39], a[36:39], v[144:147], v[36:39]
  ds_read_b64_tr_b16 a[4:5], v237 offset:47104
  v_cvt_pk_bf16_f32 v214, v60, v61
  v_cvt_pk_bf16_f32 v215, v62, v63
  v_mfma_f32_16x16x32_bf16 v[44:47], a[36:39], v[148:151], v[44:47]
  ds_read_b64_tr_b16 a[6:7], v237 offset:48128
  buffer_store_dwordx4 v[212:215], v250, s[48:51], s9 offen offset:1024 sc1
  v_mfma_f32_16x16x32_bf16 v[32:35], a[40:43], v[160:163], v[32:35]
  ds_read_b64_tr_b16 a[8:9], v236 offset:32768
  ds_read_b64_tr_b16 a[10:11], v236 offset:33792
  v_accvgpr_read_b32 v220, a254
  v_accvgpr_read_b32 v221, a255
  v_mfma_f32_16x16x32_bf16 v[40:43], a[40:43], v[164:167], v[40:43]
  s_add_u32 s87, s83, 4096
  buffer_load_dwordx4 v[152:155], v250, s[48:51], s87 offen offset:2048 sc1
  v_mfma_f32_16x16x32_bf16 v[36:39], a[44:47], v[160:163], v[36:39]
  ds_read_b64_tr_b16 a[12:13], v237 offset:32768
  v_mul_f32 v218, 0x41317218, v238
  v_mul_f32 v219, 0x41317218, v239
  v_mul_f32 v220, 0x41317218, v220
  v_mfma_f32_16x16x32_bf16 v[44:47], a[44:47], v[164:167], v[44:47]
  ds_read_b64_tr_b16 a[14:15], v237 offset:33792
  v_mul_f32 v221, 0x41317218, v221
  v_lshlrev_b32 v48, 16, v8
  s_waitcnt lgkmcnt(8)
  v_mfma_f32_16x16x32_bf16 v[32:35], a[48:51], v[176:179], v[32:35]
  ds_read_b64_tr_b16 a[16:17], v236 offset:34816
  v_and_b32 v49, 0xffff0000, v8
  v_fma_f32 v80, v48, v218, v219
  v_fma_f32 v81, v49, v218, v219
  v_mfma_f32_16x16x32_bf16 v[40:43], a[48:51], v[180:183], v[40:43]
  ds_read_b64_tr_b16 a[18:19], v236 offset:35840
  v_lshlrev_b32 v50, 16, v9
  v_and_b32 v51, 0xffff0000, v9
  v_fma_f32 v82, v50, v218, v219
  v_mfma_f32_16x16x32_bf16 v[36:39], a[52:55], v[176:179], v[36:39]
  ds_read_b64_tr_b16 a[20:21], v237 offset:34816
  ds_read_b64_tr_b16 a[22:23], v237 offset:35840
  v_fma_f32 v83, v51, v218, v219
  v_lshlrev_b32 v52, 16, v10
  v_mfma_f32_16x16x32_bf16 v[44:47], a[52:55], v[180:183], v[44:47]
  s_add_u32 s87, s83, 4096
  buffer_load_dwordx4 v[156:159], v250, s[48:51], s87 offen offset:3072 sc1
  v_mfma_f32_16x16x32_bf16 v[32:35], a[56:59], v[192:195], v[32:35]
  ds_read_b64_tr_b16 a[24:25], v236 offset:36864
  v_and_b32 v53, 0xffff0000, v10
  v_fma_f32 v84, v52, v218, v219
  v_fma_f32 v85, v53, v218, v219
  v_lshlrev_b32 v54, 16, v11
  v_mfma_f32_16x16x32_bf16 v[40:43], a[56:59], v[196:199], v[40:43]
  ds_read_b64_tr_b16 a[26:27], v236 offset:37888
  v_and_b32 v55, 0xffff0000, v11
  v_fma_f32 v86, v54, v218, v219
  v_fma_f32 v87, v55, v218, v219
  v_lshlrev_b32 v56, 16, v12
  v_mfma_f32_16x16x32_bf16 v[36:39], a[60:63], v[192:195], v[36:39]
  ds_read_b64_tr_b16 a[28:29], v237 offset:36864
  v_and_b32 v57, 0xffff0000, v12
  v_fma_f32 v88, v56, v220, v221
  v_fma_f32 v89, v57, v220, v221
  v_lshlrev_b32 v58, 16, v13
  v_mfma_f32_16x16x32_bf16 v[44:47], a[60:63], v[196:199], v[44:47]
  ds_read_b64_tr_b16 a[30:31], v237 offset:37888
  v_and_b32 v59, 0xffff0000, v13
  v_fma_f32 v90, v58, v220, v221
  v_fma_f32 v91, v59, v220, v221
  s_waitcnt lgkmcnt(8)
  v_mfma_f32_16x16x32_bf16 v[64:67], a[0:3], a[112:115], 0
  ds_read_b64_tr_b16 a[32:33], v236 offset:38912
  ds_read_b64_tr_b16 a[34:35], v236 offset:39936
  ds_read_b64_tr_b16 a[36:37], v237 offset:38912
  ds_read_b64_tr_b16 a[38:39], v237 offset:39936
  v_mfma_f32_16x16x32_bf16 v[72:75], a[0:3], a[116:119], 0
  s_add_u32 s87, s83, 8192
  buffer_load_dwordx4 v[168:171], v250, s[48:51], s87 offen offset:0 sc1
  v_mfma_f32_16x16x32_bf16 v[68:71], a[4:7], a[112:115], 0
  ds_read_b64_tr_b16 a[40:41], v236 offset:40960
  v_lshlrev_b32 v60, 16, v14
  v_and_b32 v61, 0xffff0000, v14
  v_fma_f32 v92, v60, v220, v221
  v_fma_f32 v93, v61, v220, v221
  v_mfma_f32_16x16x32_bf16 v[76:79], a[4:7], a[116:119], 0
  ds_read_b64_tr_b16 a[42:43], v236 offset:41984
  v_lshlrev_b32 v62, 16, v15
  v_and_b32 v63, 0xffff0000, v15
  v_fma_f32 v94, v62, v220, v221
  v_fma_f32 v95, v63, v220, v221
  v_mfma_f32_16x16x32_bf16 v[64:67], a[8:11], a[120:123], v[64:67]
  ds_read_b64_tr_b16 a[44:45], v237 offset:40960
  ds_read_b64_tr_b16 a[46:47], v237 offset:41984
  ds_read_b64_tr_b16 a[48:49], v236 offset:43008
  ds_read_b64_tr_b16 a[50:51], v236 offset:44032
  v_mfma_f32_16x16x32_bf16 v[72:75], a[8:11], a[124:127], v[72:75]
  s_add_u32 s87, s83, 8192
  buffer_load_dwordx4 v[172:175], v250, s[48:51], s87 offen offset:1024 sc1
  v_mfma_f32_16x16x32_bf16 v[68:71], a[12:15], a[120:123], v[68:71]
  ds_read_b64_tr_b16 a[52:53], v237 offset:43008
  v_mfma_f32_16x16x32_bf16 v[76:79], a[12:15], a[124:127], v[76:79]
  ds_read_b64_tr_b16 a[54:55], v237 offset:44032
  s_cmp_lg_u32 s14, 0
  s_cbranch_scc1 L_ys2
L_ys2r:
  s_waitcnt lgkmcnt(12)
  v_mfma_f32_16x16x32_bf16 v[64:67], a[16:19], a[128:131], v[64:67]
  ds_read_b64_tr_b16 a[56:57], v236 offset:45056
  ds_read_b64_tr_b16 a[58:59], v236 offset:46080
  v_mul_f32 v16, 0xbfb8aa3b, v80
  v_mfma_f32_16x16x32_bf16 v[72:75], a[16:19], a[132:135], v[72:75]
  ds_read_b64_tr_b16 a[60:61], v237 offset:45056
  ds_read_b64_tr_b16 a[62:63], v237 offset:46080
  v_mul_f32 v17, 0xbfb8aa3b, v81
  v_mfma_f32_16x16x32_bf16 v[68:71], a[20:23], a[128:131], v[68:71]
  v_mul_f32 v32, v32, v246
  v_mul_f32 v18, 0xbfb8aa3b, v82
  v_mul_f32 v19, 0xbfb8aa3b, v83
  v_mfma_f32_16x16x32_bf16 v[76:79], a[20:23], a[132:135], v[76:79]
  v_mul_f32 v33, v33, v246
  s_add_u32 s87, s83, 12288
  buffer_load_dwordx4 v[200:203], v250, s[48:51], s87 offen offset:0 sc1
  v_mfma_f32_16x16x32_bf16 v[64:67], a[24:27], a[136:139], v[64:67]
  v_mul_f32 v34, v34, v246
  v_exp_f32 v16, v16
  v_mfma_f32_16x16x32_bf16 v[72:75], a[24:27], a[140:143], v[72:75]
  v_mul_f32 v35, v35, v246
  v_exp_f32 v17, v17
  v_mfma_f32_16x16x32_bf16 v[68:71], a[28:31], a[136:139], v[68:71]
  v_mul_f32 v36, v36, v246
  v_exp_f32 v18, v18
  v_mfma_f32_16x16x32_bf16 v[76:79], a[28:31], a[140:143], v[76:79]
  s_add_u32 s87, s83, 12288
  buffer_load_dwordx4 v[204:207], v250, s[48:51], s87 offen offset:1024 sc1
  s_waitcnt lgkmcnt(8)
  v_mfma_f32_16x16x32_bf16 v[64:67], a[32:35], a[144:147], v[64:67]
  v_mul_f32 v37, v37, v246
  v_exp_f32 v19, v19
  v_mfma_f32_16x16x32_bf16 v[72:75], a[32:35], a[148:151], v[72:75]
  v_mul_f32 v38, v38, v246
  v_add_f32 v16, 1.0, v16
  v_add_f32 v17, 1.0, v17
  v_mfma_f32_16x16x32_bf16 v[68:71], a[36:39], a[144:147], v[68:71]
  v_mul_f32 v39, v39, v246
  v_add_f32 v18, 1.0, v18
  v_add_f32 v19, 1.0, v19
  v_mfma_f32_16x16x32_bf16 v[76:79], a[36:39], a[148:151], v[76:79]
  v_mul_f32 v40, v40, v247
  v_rcp_f32 v16, v16
  v_mfma_f32_16x16x32_bf16 v[64:67], a[40:43], a[152:155], v[64:67]
  v_mul_f32 v41, v41, v247
  v_rcp_f32 v17, v17
  v_mfma_f32_16x16x32_bf16 v[72:75], a[40:43], a[156:159], v[72:75]
  v_mul_f32 v42, v42, v247
  v_rcp_f32 v18, v18
  v_mfma_f32_16x16x32_bf16 v[68:71], a[44:47], a[152:155], v[68:71]
  v_mul_f32 v43, v43, v247
  v_rcp_f32 v19, v19
  v_mfma_f32_16x16x32_bf16 v[76:79], a[44:47], a[156:159], v[76:79]
  v_mul_f32 v80, v80, v16
  s_waitcnt lgkmcnt(0)
  v_mfma_f32_16x16x32_bf16 v[64:67], a[48:51], a[160:163], v[64:67]
  v_mul_f32 v44, v44, v247
  v_mul_f32 v81, v81, v17
  v_mul_f32 v82, v82, v18
  v_mfma_f32_16x16x32_bf16 v[72:75], a[48:51], a[164:167], v[72:75]
  v_mul_f32 v45, v45, v247
  s_add_u32 s87, s83, 8192
  buffer_load_dwordx4 v[184:187], v250, s[48:51], s87 offen offset:2048 sc1
  v_mfma_f32_16x16x32_bf16 v[68:71], a[52:55], a[160:163], v[68:71]
  v_mul_f32 v46, v46, v247
  v_mul_f32 v83, v83, v19
  v_mul_f32 v20, 0xbfb8aa3b, v84
  v_mfma_f32_16x16x32_bf16 v[76:79], a[52:55], a[164:167], v[76:79]
  v_mul_f32 v47, v47, v247
  v_mul_f32 v21, 0xbfb8aa3b, v85
  v_mul_f32 v22, 0xbfb8aa3b, v86
  v_mfma_f32_16x16x32_bf16 v[64:67], a[56:59], a[168:171], v[64:67]
  v_mul_f32 v23, 0xbfb8aa3b, v87
  v_exp_f32 v20, v20
  v_mfma_f32_16x16x32_bf16 v[72:75], a[56:59], a[172:175], v[72:75]
  s_add_u32 s87, s83, 8192
  buffer_load_dwordx4 v[188:191], v250, s[48:51], s87 offen offset:3072 sc1
  v_mfma_f32_16x16x32_bf16 v[68:71], a[60:63], a[168:171], v[68:71]
  v_exp_f32 v21, v21
  v_exp_f32 v22, v22
  v_mfma_f32_16x16x32_bf16 v[76:79], a[60:63], a[172:175], v[76:79]
  v_exp_f32 v23, v23
  v_add_f32 v20, 1.0, v20
  v_add_f32 v21, 1.0, v21
L_tail:
  s_cmp_eq_u32 s70, 7
  s_cbranch_scc1 L_tail7
  v_fmac_f32 v32, v64, v244
  v_fmac_f32 v33, v65, v244
  v_fmac_f32 v34, v66, v244
  v_fmac_f32 v35, v67, v244
  v_fmac_f32 v36, v68, v244
  v_fmac_f32 v37, v69, v244
  v_fmac_f32 v38, v70, v244
  v_fmac_f32 v39, v71, v244
  v_fmac_f32 v40, v72, v245
  v_fmac_f32 v41, v73, v245
  v_fmac_f32 v42, v74, v245
  v_fmac_f32 v43, v75, v245
  v_fmac_f32 v44, v76, v245
  v_fmac_f32 v45, v77, v245
  v_fmac_f32 v46, v78, v245
  v_fmac_f32 v47, v79, v245
  s_waitcnt vmcnt(14)
  v_max_u32 v216, v104, v108
  s_waitcnt vmcnt(12)
  v_max3_u32 v216, v216, v120, v124
  s_waitcnt vmcnt(10)
  v_max3_u32 v216, v216, v136, v140
  v_cmp_eq_u32 vcc, -1, v216
  s_nop 0
  s_cbranch_vccnz L_re0
L_re0r:
  v_mfma_f32_16x16x32_bf16 v[32:35], a[178:181], v[104:107], v[32:35]
  v_add_f32 v22, 1.0, v22
  v_add_f32 v23, 1.0, v23
  v_mfma_f32_16x16x32_bf16 v[36:39], a[176:179], v[104:107], v[36:39]
  v_rcp_f32 v20, v20
  v_rcp_f32 v21, v21
  v_rcp_f32 v22, v22
  v_mfma_f32_16x16x32_bf16 v[40:43], a[178:181], v[108:111], v[40:43]
  v_rcp_f32 v23, v23
  v_mul_f32 v84, v84, v20
  v_mfma_f32_16x16x32_bf16 v[44:47], a[176:179], v[108:111], v[44:47]
  v_mul_f32 v85, v85, v21
  v_mul_f32 v86, v86, v22
  v_mul_f32 v87, v87, v23
  v_mfma_f32_16x16x32_bf16 v[32:35], a[178:181], v[120:123], v[32:35]
  s_add_u32 s87, s83, 8192
  buffer_load_dwordx4 v[96:99], v250, s[48:51], s87 offen offset:2048 sc1
  v_mul_f32 v16, 0xbfb8aa3b, v88
  v_mul_f32 v17, 0xbfb8aa3b, v89
  v_mfma_f32_16x16x32_bf16 v[36:39], a[176:179], v[120:123], v[36:39]
  buffer_load_dwordx4 v[100:103], v250, s[48:51], s87 offen offset:3072 sc1
  v_mul_f32 v18, 0xbfb8aa3b, v90
  v_mul_f32 v19, 0xbfb8aa3b, v91
  v_exp_f32 v16, v16
  v_mfma_f32_16x16x32_bf16 v[40:43], a[178:181], v[124:127], v[40:43]
  v_exp_f32 v17, v17
  v_exp_f32 v18, v18
  v_mfma_f32_16x16x32_bf16 v[44:47], a[176:179], v[124:127], v[44:47]
  v_exp_f32 v19, v19
  v_add_f32 v16, 1.0, v16
  v_add_f32 v17, 1.0, v17
  v_mfma_f32_16x16x32_bf16 v[32:35], a[178:181], v[136:139], v[32:35]
  v_add_f32 v18, 1.0, v18
  v_add_f32 v19, 1.0, v19
  v_mfma_f32_16x16x32_bf16 v[36:39], a[176:179], v[136:139], v[36:39]
  v_rcp_f32 v16, v16
  v_rcp_f32 v17, v17
  v_rcp_f32 v18, v18
  v_mfma_f32_16x16x32_bf16 v[40:43], a[178:181], v[140:143], v[40:43]
  v_rcp_f32 v19, v19
  v_mul_f32 v88, v88, v16
  v_mfma_f32_16x16x32_bf16 v[44:47], a[176:179], v[140:143], v[44:47]
  v_mul_f32 v89, v89, v17
  v_mul_f32 v90, v90, v18
  v_mul_f32 v91, v91, v19
  s_waitcnt vmcnt(8)
  v_max_u32 v216, v152, v156
  s_waitcnt vmcnt(6)
  v_max3_u32 v216, v216, v168, v172
  v_cmp_eq_u32 vcc, -1, v216
  s_nop 0
  s_cbranch_vccnz L_re1
L_re1r:
  v_mfma_f32_16x16x32_bf16 v[32:35], a[178:181], v[152:155], v[32:35]
  v_mul_f32 v20, 0xbfb8aa3b, v92
  v_mul_f32 v21, 0xbfb8aa3b, v93
  v_mfma_f32_16x16x32_bf16 v[36:39], a[176:179], v[152:155], v[36:39]
  v_mul_f32 v22, 0xbfb8aa3b, v94
  v_mul_f32 v23, 0xbfb8aa3b, v95
  v_exp_f32 v20, v20
  v_mfma_f32_16x16x32_bf16 v[40:43], a[178:181], v[156:159], v[40:43]
  v_exp_f32 v21, v21
  v_exp_f32 v22, v22
  v_mfma_f32_16x16x32_bf16 v[44:47], a[176:179], v[156:159], v[44:47]
  v_exp_f32 v23, v23
  v_add_f32 v20, 1.0, v20
  v_add_f32 v21, 1.0, v21
  v_mfma_f32_16x16x32_bf16 v[32:35], a[178:181], v[168:171], v[32:35]
  s_add_u32 s87, s83, 8192
  buffer_load_dwordx4 v[112:115], v250, s[48:51], s87 offen offset:2048 sc1
  v_add_f32 v22, 1.0, v22
  v_add_f32 v23, 1.0, v23
  v_mfma_f32_16x16x32_bf16 v[36:39], a[176:179], v[168:171], v[36:39]
  buffer_load_dwordx4 v[116:119], v250, s[48:51], s87 offen offset:3072 sc1
  v_rcp_f32 v20, v20
  v_rcp_f32 v21, v21
  v_rcp_f32 v22, v22
  v_mfma_f32_16x16x32_bf16 v[40:43], a[178:181], v[172:175], v[40:43]
  v_rcp_f32 v23, v23
  v_mul_f32 v92, v92, v20
  v_mfma_f32_16x16x32_bf16 v[44:47], a[176:179], v[172:175], v[44:47]
  v_mul_f32 v93, v93, v21
  v_mul_f32 v94, v94, v22
  v_mul_f32 v95, v95, v23
  s_waitcnt vmcnt(6)
  v_max_u32 v216, v200, v204
  v_cmp_eq_u32 vcc, -1, v216
  s_nop 0
  s_cbranch_vccnz L_re2
L_re2r:
  v_mfma_f32_16x16x32_bf16 v[32:35], a[178:181], v[200:203], v[32:35]
  v_mfma_f32_16x16x32_bf16 v[36:39], a[176:179], v[200:203], v[36:39]
  v_mfma_f32_16x16x32_bf16 v[40:43], a[178:181], v[204:207], v[40:43]
  v_mfma_f32_16x16x32_bf16 v[44:47], a[176:179], v[204:207], v[44:47]
  s_waitcnt vmcnt(4)
  v_max_u32 v216, v184, v188
  v_cmp_eq_u32 vcc, -1, v216
  s_nop 0
  s_cbranch_vccnz L_re3
L_re3r:
  v_mfma_f32_16x16x32_bf16 v[32:35], a[178:181], v[184:187], v[32:35]
  v_mfma_f32_16x16x32_bf16 v[36:39], a[176:179], v[184:187], v[36:39]
  v_mfma_f32_16x16x32_bf16 v[40:43], a[178:181], v[188:191], v[40:43]
  v_mfma_f32_16x16x32_bf16 v[44:47], a[176:179], v[188:191], v[44:47]
  v_fma_f32 v48, v32, v80, v48
  v_fma_f32 v49, v33, v81, v49
  v_cvt_pk_bf16_f32 v208, v48, v49
  v_fma_f32 v50, v34, v82, v50
  v_fma_f32 v51, v35, v83, v51
  v_cvt_pk_bf16_f32 v209, v50, v51
  v_fma_f32 v52, v36, v84, v52
  v_fma_f32 v53, v37, v85, v53
  v_cvt_pk_bf16_f32 v210, v52, v53
  s_nop 1
  v_permlane16_swap_b32 v208, v210
  v_fma_f32 v54, v38, v86, v54
  v_fma_f32 v55, v39, v87, v55
  v_cvt_pk_bf16_f32 v211, v54, v55
  s_nop 1
  v_permlane16_swap_b32 v209, v211
  buffer_store_dwordx4 v[208:211], v254, s[16:19], s15 offen nt
  v_fma_f32 v56, v40, v88, v56
  v_fma_f32 v57, v41, v89, v57
  v_cvt_pk_bf16_f32 v212, v56, v57
  v_fma_f32 v58, v42, v90, v58
  v_fma_f32 v59, v43, v91, v59
  v_cvt_pk_bf16_f32 v213, v58, v59
  v_fma_f32 v60, v44, v92, v60
  v_fma_f32 v61, v45, v93, v61
  v_cvt_pk_bf16_f32 v214, v60, v61
  s_nop 1
  v_permlane16_swap_b32 v212, v214
  v_fma_f32 v62, v46, v94, v62
  v_fma_f32 v63, v47, v95, v63
  v_cvt_pk_bf16_f32 v215, v62, v63
  s_nop 1
  v_permlane16_swap_b32 v213, v215
  buffer_store_dwordx4 v[212:215], v254, s[16:19], s11 offen nt
L_fin:
L_end:
  s_endpgm
L_g4b:
  s_waitcnt lgkmcnt(8)
  v_mfma_f32_16x16x32_bf16 v[32:35], a[0:3], a[112:115], 0
  ds_read_b64_tr_b16 a[32:33], v236 offset:6144
  ds_read_b64_tr_b16 a[34:35], v236 offset:7168
  s_bfe_u32 s87, s87, 393221
  v_mfma_f32_16x16x32_bf16 v[40:43], a[0:3], a[116:119], 0
  ds_read_b64_tr_b16 a[36:37], v237 offset:6144
  ds_read_b64_tr_b16 a[38:39], v237 offset:7168
  s_not_b32 s88, s86
  v_mfma_f32_16x16x32_bf16 v[36:39], a[4:7], a[112:115], 0
  ds_read_b64_tr_b16 a[40:41], v236 offset:8192
  ds_read_b64_tr_b16 a[42:43], v236 offset:9216
  s_bfe_u32 s88, s88, 393221
  v_mfma_f32_16x16x32_bf16 v[44:47], a[4:7], a[116:119], 0
  buffer_load_dwordx4 v226, s[36:39], s72 offen offset:2048 lds
  v_mfma_f32_16x16x32_bf16 v[32:35], a[8:11], a[120:123], v[32:35]
  ds_read_b64_tr_b16 a[44:45], v237 offset:8192
  ds_read_b64_tr_b16 a[46:47], v237 offset:9216
  v_fmac_f32 v48, v80, v244
  v_mfma_f32_16x16x32_bf16 v[40:43], a[8:11], a[124:127], v[40:43]
  ds_read_b64_tr_b16 a[48:49], v236 offset:10240
  ds_read_b64_tr_b16 a[50:51], v236 offset:11264
  v_fmac_f32 v49, v81, v244
  v_mfma_f32_16x16x32_bf16 v[36:39], a[12:15], a[120:123], v[36:39]
  s_add_u32 m0, s69, 49152
  ds_read_b64_tr_b16 a[52:53], v237 offset:10240
  ds_read_b64_tr_b16 a[54:55], v237 offset:11264
  v_mfma_f32_16x16x32_bf16 v[44:47], a[12:15], a[124:127], v[44:47]
  buffer_load_dwordx4 v230, s[36:39], s72 offen offset:2048 lds
  s_waitcnt lgkmcnt(12)
  v_mfma_f32_16x16x32_bf16 v[32:35], a[16:19], a[128:131], v[32:35]
  ds_read_b64_tr_b16 a[56:57], v236 offset:12288
  ds_read_b64_tr_b16 a[58:59], v236 offset:13312
  v_fmac_f32 v50, v82, v244
  v_mfma_f32_16x16x32_bf16 v[40:43], a[16:19], a[132:135], v[40:43]
  ds_read_b64_tr_b16 a[60:61], v237 offset:12288
  ds_read_b64_tr_b16 a[62:63], v237 offset:13312
  v_fmac_f32 v51, v83, v244
  v_fmac_f32 v52, v84, v244
  v_mfma_f32_16x16x32_bf16 v[36:39], a[20:23], a[128:131], v[36:39]
  v_fmac_f32 v53, v85, v244
  v_fmac_f32 v54, v86, v244
  v_fmac_f32 v55, v87, v244
  v_cvt_pk_bf16_f32 v208, v48, v49
  v_mfma_f32_16x16x32_bf16 v[44:47], a[20:23], a[132:135], v[44:47]
  buffer_load_dwordx4 v231, s[36:39], s72 offen offset:3072 lds
  v_mfma_f32_16x16x32_bf16 v[32:35], a[24:27], a[136:139], v[32:35]
  s_add_u32 m0, s69, 32768
  v_cvt_pk_bf16_f32 v209, v50, v51
  v_cvt_pk_bf16_f32 v210, v52, v53
  v_cvt_pk_bf16_f32 v211, v54, v55
  v_mfma_f32_16x16x32_bf16 v[40:43], a[24:27], a[140:143], v[40:43]
  buffer_load_dwordx4 v227, s[36:39], s72 offen offset:3072 lds
  v_mfma_f32_16x16x32_bf16 v[36:39], a[28:31], a[136:139], v[36:39]
  s_bitcmp0_b32 s85, 4
  s_cselect_b32 s92, 2, 1
  s_bitcmp0_b32 s86, 4
  s_cselect_b32 s93, 2, 1
  v_mfma_f32_16x16x32_bf16 v[44:47], a[28:31], a[140:143], v[44:47]
  buffer_store_dwordx4 v[208:211], v250, s[48:51], s5 offen offset:0 sc1
  s_waitcnt lgkmcnt(8)
  v_mfma_f32_16x16x32_bf16 v[32:35], a[32:35], a[144:147], v[32:35]
  s_waitcnt vmcnt(19)
  s_waitcnt lgkmcnt(0)
  s_barrier
  ds_read_b64_tr_b16 a[0:1], v236 offset:47104
  v_mfma_f32_16x16x32_bf16 v[40:43], a[32:35], a[148:151], v[40:43]
  ds_read_b64_tr_b16 a[2:3], v236 offset:48128
  v_fmac_f32 v56, v88, v245
  s_cmp_eq_u32 s87, s89
  s_cselect_b32 s14, s92, 0
  v_mfma_f32_16x16x32_bf16 v[36:39], a[36:39], a[144:147], v[36:39]
  s_add_u32 s72, s80, 0
  s_add_u32 m0, s69, 65536
  ds_read_b64_tr_b16 a[4:5], v237 offset:47104
  ds_read_b64_tr_b16 a[6:7], v237 offset:48128
  v_mfma_f32_16x16x32_bf16 v[44:47], a[36:39], a[148:151], v[44:47]
  buffer_load_dwordx4 v224, s[36:39], s72 offen offset:0 lds
  v_mfma_f32_16x16x32_bf16 v[32:35], a[40:43], a[152:155], v[32:35]
  ds_read_b64_tr_b16 a[8:9], v236 offset:32768
  v_fmac_f32 v57, v89, v245
  s_cmp_eq_u32 s88, s89
  s_cselect_b32 s93, s93, 0
  v_mfma_f32_16x16x32_bf16 v[40:43], a[40:43], a[156:159], v[40:43]
  ds_read_b64_tr_b16 a[10:11], v236 offset:33792
  v_fmac_f32 v58, v90, v245
  v_fmac_f32 v59, v91, v245
  v_mfma_f32_16x16x32_bf16 v[36:39], a[44:47], a[152:155], v[36:39]
  s_add_u32 m0, s69, 81920
  ds_read_b64_tr_b16 a[12:13], v237 offset:32768
  ds_read_b64_tr_b16 a[14:15], v237 offset:33792
  v_mfma_f32_16x16x32_bf16 v[44:47], a[44:47], a[156:159], v[44:47]
  buffer_load_dwordx4 v228, s[36:39], s72 offen offset:0 lds
  v_mfma_f32_16x16x32_bf16 v[32:35], a[48:51], a[160:163], v[32:35]
  ds_read_b64_tr_b16 a[16:17], v236 offset:34816
  v_fmac_f32 v60, v92, v245
  v_fmac_f32 v61, v93, v245
  v_mfma_f32_16x16x32_bf16 v[40:43], a[48:51], a[164:167], v[40:43]
  ds_read_b64_tr_b16 a[18:19], v236 offset:35840
  v_fmac_f32 v62, v94, v245
  v_fmac_f32 v63, v95, v245
  v_mfma_f32_16x16x32_bf16 v[36:39], a[52:55], a[160:163], v[36:39]
  ds_read_b64_tr_b16 a[20:21], v237 offset:34816
  ds_read_b64_tr_b16 a[22:23], v237 offset:35840
  s_or_b32 s14, s14, s93
  v_mfma_f32_16x16x32_bf16 v[44:47], a[52:55], a[164:167], v[44:47]
  buffer_load_dwordx4 v229, s[36:39], s72 offen offset:1024 lds
  v_mfma_f32_16x16x32_bf16 v[32:35], a[56:59], a[168:171], v[32:35]
  ds_read_b64_tr_b16 a[24:25], v236 offset:36864
  v_cvt_pk_bf16_f32 v212, v56, v57
  v_cvt_pk_bf16_f32 v213, v58, v59
  v_mfma_f32_16x16x32_bf16 v[40:43], a[56:59], a[172:175], v[40:43]
  ds_read_b64_tr_b16 a[26:27], v236 offset:37888
  v_cvt_pk_bf16_f32 v214, v60, v61
  v_cvt_pk_bf16_f32 v215, v62, v63
  v_mfma_f32_16x16x32_bf16 v[36:39], a[60:63], a[168:171], v[36:39]
  s_add_u32 m0, s69, 65536
  ds_read_b64_tr_b16 a[28:29], v237 offset:36864
  ds_read_b64_tr_b16 a[30:31], v237 offset:37888
  v_mfma_f32_16x16x32_bf16 v[44:47], a[60:63], a[172:175], v[44:47]
  buffer_load_dwordx4 v225, s[36:39], s72 offen offset:1024 lds
  s_waitcnt lgkmcnt(8)
  v_mfma_f32_16x16x32_bf16 v[64:67], a[0:3], v[0:3], 0
  ds_read_b64_tr_b16 a[32:33], v236 offset:38912
  ds_read_b64_tr_b16 a[34:35], v236 offset:39936
  s_cmp_eq_u32 s70, 7
  s_cselect_b32 s14, 0, s14
  v_mfma_f32_16x16x32_bf16 v[72:75], a[0:3], v[4:7], 0
  ds_read_b64_tr_b16 a[36:37], v237 offset:38912
  ds_read_b64_tr_b16 a[38:39], v237 offset:39936
  v_mfma_f32_16x16x32_bf16 v[68:71], a[4:7], v[0:3], 0
  ds_read_b64_tr_b16 a[40:41], v236 offset:40960
  ds_read_b64_tr_b16 a[42:43], v236 offset:41984
  v_mfma_f32_16x16x32_bf16 v[76:79], a[4:7], v[4:7], 0
  buffer_load_dwordx4 v226, s[36:39], s72 offen offset:2048 lds
  v_mfma_f32_16x16x32_bf16 v[64:67], a[8:11], v[96:99], v[64:67]
  ds_read_b64_tr_b16 a[44:45], v237 offset:40960
  ds_read_b64_tr_b16 a[46:47], v237 offset:41984
  v_mfma_f32_16x16x32_bf16 v[72:75], a[8:11], v[100:103], v[72:75]
  ds_read_b64_tr_b16 a[48:49], v236 offset:43008
  ds_read_b64_tr_b16 a[50:51], v236 offset:44032
  v_mfma_f32_16x16x32_bf16 v[68:71], a[12:15], v[96:99], v[68:71]
  s_add_u32 m0, s69, 81920
  ds_read_b64_tr_b16 a[52:53], v237 offset:43008
  ds_read_b64_tr_b16 a[54:55], v237 offset:44032
  v_mfma_f32_16x16x32_bf16 v[76:79], a[12:15], v[100:103], v[76:79]
  buffer_load_dwordx4 v230, s[36:39], s72 offen offset:2048 lds
  s_waitcnt lgkmcnt(12)
  v_mfma_f32_16x16x32_bf16 v[64:67], a[16:19], v[112:115], v[64:67]
  ds_read_b64_tr_b16 a[56:57], v236 offset:45056
  ds_read_b64_tr_b16 a[58:59], v236 offset:46080
  v_mfma_f32_16x16x32_bf16 v[72:75], a[16:19], v[116:119], v[72:75]
  ds_read_b64_tr_b16 a[60:61], v237 offset:45056
  ds_read_b64_tr_b16 a[62:63], v237 offset:46080
  v_mfma_f32_16x16x32_bf16 v[68:71], a[20:23], v[112:115], v[68:71]
  v_mul_f32 v32, v32, v244
  v_mul_f32 v33, v33, v244
  v_mfma_f32_16x16x32_bf16 v[76:79], a[20:23], v[116:119], v[76:79]
  buffer_load_dwordx4 v231, s[36:39], s72 offen offset:3072 lds
  v_mfma_f32_16x16x32_bf16 v[64:67], a[24:27], v[128:131], v[64:67]
  s_add_u32 m0, s69, 65536
  v_mul_f32 v34, v34, v244
  v_mfma_f32_16x16x32_bf16 v[72:75], a[24:27], v[132:135], v[72:75]
  buffer_load_dwordx4 v227, s[36:39], s72 offen offset:3072 lds
  v_mfma_f32_16x16x32_bf16 v[68:71], a[28:31], v[128:131], v[68:71]
  v_mul_f32 v35, v35, v244
  v_mul_f32 v36, v36, v244
  v_mfma_f32_16x16x32_bf16 v[76:79], a[28:31], v[132:135], v[76:79]
  buffer_store_dwordx4 v[212:215], v250, s[48:51], s5 offen offset:1024 sc1
  buffer_load_dword v217, v216, s[48:51], s97 offen sc1
  s_waitcnt lgkmcnt(8)
  v_mfma_f32_16x16x32_bf16 v[64:67], a[32:35], v[144:147], v[64:67]
  s_waitcnt vmcnt(21)
  s_waitcnt lgkmcnt(0)
  s_barrier
  ds_read_b64_tr_b16 a[0:1], v240 offset:14336
  v_mfma_f32_16x16x32_bf16 v[72:75], a[32:35], v[148:151], v[72:75]
  ds_read_b64_tr_b16 a[2:3], v240 offset:15360
  v_mul_f32 v37, v37, v244
  v_mfma_f32_16x16x32_bf16 v[68:71], a[36:39], v[144:147], v[68:71]
  s_add_u32 s72, s80, 229376
  s_add_u32 m0, s69, 98304
  ds_read_b64_tr_b16 a[4:5], v241 offset:14336
  ds_read_b64_tr_b16 a[6:7], v241 offset:15360
  v_mfma_f32_16x16x32_bf16 v[76:79], a[36:39], v[148:151], v[76:79]
  buffer_load_dwordx4 v224, s[36:39], s72 offen offset:0 lds
  v_mfma_f32_16x16x32_bf16 v[64:67], a[40:43], v[160:163], v[64:67]
  ds_read_b64_tr_b16 a[8:9], v240 offset:0
  v_mul_f32 v38, v38, v244
  v_mfma_f32_16x16x32_bf16 v[72:75], a[40:43], v[164:167], v[72:75]
  ds_read_b64_tr_b16 a[10:11], v240 offset:1024
  v_mul_f32 v39, v39, v244
  v_mfma_f32_16x16x32_bf16 v[68:71], a[44:47], v[160:163], v[68:71]
  s_add_u32 m0, s69, 114688
  ds_read_b64_tr_b16 a[12:13], v241 offset:0
  ds_read_b64_tr_b16 a[14:15], v241 offset:1024
  v_mfma_f32_16x16x32_bf16 v[76:79], a[44:47], v[164:167], v[76:79]
  buffer_load_dwordx4 v228, s[36:39], s72 offen offset:0 lds
  v_mfma_f32_16x16x32_bf16 v[64:67], a[48:51], v[176:179], v[64:67]
  ds_read_b64_tr_b16 a[16:17], v240 offset:2048
  v_mul_f32 v40, v40, v245
  v_mul_f32 v41, v41, v245
  v_mfma_f32_16x16x32_bf16 v[72:75], a[48:51], v[180:183], v[72:75]
  ds_read_b64_tr_b16 a[18:19], v240 offset:3072
  v_mul_f32 v42, v42, v245
  v_mul_f32 v43, v43, v245
  v_mfma_f32_16x16x32_bf16 v[68:71], a[52:55], v[176:179], v[68:71]
  ds_read_b64_tr_b16 a[20:21], v241 offset:2048
  ds_read_b64_tr_b16 a[22:23], v241 offset:3072
  v_mfma_f32_16x16x32_bf16 v[76:79], a[52:55], v[180:183], v[76:79]
  buffer_load_dwordx4 v229, s[36:39], s72 offen offset:1024 lds
  v_mfma_f32_16x16x32_bf16 v[64:67], a[56:59], v[192:195], v[64:67]
  ds_read_b64_tr_b16 a[24:25], v240 offset:4096
  v_mul_f32 v44, v44, v245
  v_mul_f32 v45, v45, v245
  v_mfma_f32_16x16x32_bf16 v[72:75], a[56:59], v[196:199], v[72:75]
  ds_read_b64_tr_b16 a[26:27], v240 offset:5120
  v_mul_f32 v46, v46, v245
  v_mul_f32 v47, v47, v245
  v_mfma_f32_16x16x32_bf16 v[68:71], a[60:63], v[192:195], v[68:71]
  s_add_u32 m0, s69, 98304
  ds_read_b64_tr_b16 a[28:29], v241 offset:4096
  ds_read_b64_tr_b16 a[30:31], v241 offset:5120
  v_mfma_f32_16x16x32_bf16 v[76:79], a[60:63], v[196:199], v[76:79]
  buffer_load_dwordx4 v225, s[36:39], s72 offen offset:1024 lds
  s_waitcnt lgkmcnt(8)
  v_mfma_f32_16x16x32_bf16 v[48:51], a[0:3], a[112:115], 0
  ds_read_b64_tr_b16 a[32:33], v240 offset:6144
  ds_read_b64_tr_b16 a[34:35], v240 offset:7168
  v_mfma_f32_16x16x32_bf16 v[56:59], a[0:3], a[116:119], 0
  ds_read_b64_tr_b16 a[36:37], v241 offset:6144
  ds_read_b64_tr_b16 a[38:39], v241 offset:7168
  v_mfma_f32_16x16x32_bf16 v[52:55], a[4:7], a[112:115], 0
  ds_read_b64_tr_b16 a[40:41], v240 offset:8192
  ds_read_b64_tr_b16 a[42:43], v240 offset:9216
  v_mfma_f32_16x16x32_bf16 v[60:63], a[4:7], a[116:119], 0
  buffer_load_dwordx4 v226, s[36:39], s72 offen offset:2048 lds
  v_mfma_f32_16x16x32_bf16 v[48:51], a[8:11], a[120:123], v[48:51]
  ds_read_b64_tr_b16 a[44:45], v241 offset:8192
  ds_read_b64_tr_b16 a[46:47], v241 offset:9216
  v_fmac_f32 v32, v64, v246
  v_mfma_f32_16x16x32_bf16 v[56:59], a[8:11], a[124:127], v[56:59]
  ds_read_b64_tr_b16 a[48:49], v240 offset:10240
  ds_read_b64_tr_b16 a[50:51], v240 offset:11264
  v_fmac_f32 v33, v65, v246
  v_mfma_f32_16x16x32_bf16 v[52:55], a[12:15], a[120:123], v[52:55]
  s_add_u32 m0, s69, 114688
  ds_read_b64_tr_b16 a[52:53], v241 offset:10240
  ds_read_b64_tr_b16 a[54:55], v241 offset:11264
  v_mfma_f32_16x16x32_bf16 v[60:63], a[12:15], a[124:127], v[60:63]
  buffer_load_dwordx4 v230, s[36:39], s72 offen offset:2048 lds
  s_waitcnt lgkmcnt(12)
  v_mfma_f32_16x16x32_bf16 v[48:51], a[16:19], a[128:131], v[48:51]
  ds_read_b64_tr_b16 a[56:57], v240 offset:12288
  ds_read_b64_tr_b16 a[58:59], v240 offset:13312
  v_fmac_f32 v34, v66, v246
  v_mfma_f32_16x16x32_bf16 v[56:59], a[16:19], a[132:135], v[56:59]
  ds_read_b64_tr_b16 a[60:61], v241 offset:12288
  ds_read_b64_tr_b16 a[62:63], v241 offset:13312
  v_fmac_f32 v35, v67, v246
  v_fmac_f32 v36, v68, v246
  v_mfma_f32_16x16x32_bf16 v[52:55], a[20:23], a[128:131], v[52:55]
  v_fmac_f32 v37, v69, v246
  v_fmac_f32 v38, v70, v246
  v_fmac_f32 v39, v71, v246
  v_cvt_pk_bf16_f32 v208, v32, v33
  v_mfma_f32_16x16x32_bf16 v[60:63], a[20:23], a[132:135], v[60:63]
  buffer_load_dwordx4 v231, s[36:39], s72 offen offset:3072 lds
  v_mfma_f32_16x16x32_bf16 v[48:51], a[24:27], a[136:139], v[48:51]
  s_add_u32 m0, s69, 98304
  v_cvt_pk_bf16_f32 v209, v34, v35
  v_cvt_pk_bf16_f32 v210, v36, v37
  v_cvt_pk_bf16_f32 v211, v38, v39
  v_mfma_f32_16x16x32_bf16 v[56:59], a[24:27], a[140:143], v[56:59]
  buffer_load_dwordx4 v227, s[36:39], s72 offen offset:3072 lds
  v_mfma_f32_16x16x32_bf16 v[52:55], a[28:31], a[136:139], v[52:55]
  v_mfma_f32_16x16x32_bf16 v[60:63], a[28:31], a[140:143], v[60:63]
  buffer_store_dwordx4 v[208:211], v250, s[48:51], s6 offen offset:0 sc1
  s_waitcnt lgkmcnt(8)
  v_mfma_f32_16x16x32_bf16 v[48:51], a[32:35], a[144:147], v[48:51]
  s_waitcnt vmcnt(20)
  s_waitcnt lgkmcnt(0)
  s_barrier
  ds_read_b64_tr_b16 a[0:1], v240 offset:47104
  v_mfma_f32_16x16x32_bf16 v[56:59], a[32:35], a[148:151], v[56:59]
  ds_read_b64_tr_b16 a[2:3], v240 offset:48128
  v_fmac_f32 v40, v72, v247
  v_mfma_f32_16x16x32_bf16 v[52:55], a[36:39], a[144:147], v[52:55]
  s_add_u32 s72, s81, 0
  s_add_u32 m0, s69, 0
  ds_read_b64_tr_b16 a[4:5], v241 offset:47104
  ds_read_b64_tr_b16 a[6:7], v241 offset:48128
  v_mfma_f32_16x16x32_bf16 v[60:63], a[36:39], a[148:151], v[60:63]
  buffer_load_dwordx4 v224, s[36:39], s72 offen offset:0 lds
  v_mfma_f32_16x16x32_bf16 v[48:51], a[40:43], a[152:155], v[48:51]
  ds_read_b64_tr_b16 a[8:9], v240 offset:32768
  v_fmac_f32 v41, v73, v247
  v_mfma_f32_16x16x32_bf16 v[56:59], a[40:43], a[156:159], v[56:59]
  ds_read_b64_tr_b16 a[10:11], v240 offset:33792
  v_fmac_f32 v42, v74, v247
  v_fmac_f32 v43, v75, v247
  v_mfma_f32_16x16x32_bf16 v[52:55], a[44:47], a[152:155], v[52:55]
  s_add_u32 m0, s69, 16384
  ds_read_b64_tr_b16 a[12:13], v241 offset:32768
  ds_read_b64_tr_b16 a[14:15], v241 offset:33792
  v_mfma_f32_16x16x32_bf16 v[60:63], a[44:47], a[156:159], v[60:63]
  buffer_load_dwordx4 v228, s[36:39], s72 offen offset:0 lds
  v_mfma_f32_16x16x32_bf16 v[48:51], a[48:51], a[160:163], v[48:51]
  ds_read_b64_tr_b16 a[16:17], v240 offset:34816
  v_fmac_f32 v44, v76, v247
  v_fmac_f32 v45, v77, v247
  v_mfma_f32_16x16x32_bf16 v[56:59], a[48:51], a[164:167], v[56:59]
  ds_read_b64_tr_b16 a[18:19], v240 offset:35840
  v_fmac_f32 v46, v78, v247
  v_fmac_f32 v47, v79, v247
  v_mfma_f32_16x16x32_bf16 v[52:55], a[52:55], a[160:163], v[52:55]
  ds_read_b64_tr_b16 a[20:21], v241 offset:34816
  ds_read_b64_tr_b16 a[22:23], v241 offset:35840
  v_mfma_f32_16x16x32_bf16 v[60:63], a[52:55], a[164:167], v[60:63]
  buffer_load_dwordx4 v229, s[36:39], s72 offen offset:1024 lds
  v_mfma_f32_16x16x32_bf16 v[48:51], a[56:59], a[168:171], v[48:51]
  ds_read_b64_tr_b16 a[24:25], v240 offset:36864
  v_cvt_pk_bf16_f32 v212, v40, v41
  v_cvt_pk_bf16_f32 v213, v42, v43
  v_mfma_f32_16x16x32_bf16 v[56:59], a[56:59], a[172:175], v[56:59]
  ds_read_b64_tr_b16 a[26:27], v240 offset:37888
  v_cvt_pk_bf16_f32 v214, v44, v45
  v_cvt_pk_bf16_f32 v215, v46, v47
  v_mfma_f32_16x16x32_bf16 v[52:55], a[60:63], a[168:171], v[52:55]
  s_add_u32 m0, s69, 0
  ds_read_b64_tr_b16 a[28:29], v241 offset:36864
  ds_read_b64_tr_b16 a[30:31], v241 offset:37888
  v_mfma_f32_16x16x32_bf16 v[60:63], a[60:63], a[172:175], v[60:63]
  buffer_load_dwordx4 v225, s[36:39], s72 offen offset:1024 lds
  s_waitcnt lgkmcnt(8)
  v_mfma_f32_16x16x32_bf16 v[80:83], a[0:3], v[0:3], 0
  ds_read_b64_tr_b16 a[32:33], v240 offset:38912
  ds_read_b64_tr_b16 a[34:35], v240 offset:39936
  v_mfma_f32_16x16x32_bf16 v[88:91], a[0:3], v[4:7], 0
  ds_read_b64_tr_b16 a[36:37], v241 offset:38912
  ds_read_b64_tr_b16 a[38:39], v241 offset:39936
  v_mfma_f32_16x16x32_bf16 v[84:87], a[4:7], v[0:3], 0
  ds_read_b64_tr_b16 a[40:41], v240 offset:40960
  ds_read_b64_tr_b16 a[42:43], v240 offset:41984
  v_mfma_f32_16x16x32_bf16 v[92:95], a[4:7], v[4:7], 0
  buffer_load_dwordx4 v226, s[36:39], s72 offen offset:2048 lds
  v_mfma_f32_16x16x32_bf16 v[80:83], a[8:11], v[96:99], v[80:83]
  ds_read_b64_tr_b16 a[44:45], v241 offset:40960
  ds_read_b64_tr_b16 a[46:47], v241 offset:41984
  v_mfma_f32_16x16x32_bf16 v[88:91], a[8:11], v[100:103], v[88:91]
  ds_read_b64_tr_b16 a[48:49], v240 offset:43008
  ds_read_b64_tr_b16 a[50:51], v240 offset:44032
  v_mfma_f32_16x16x32_bf16 v[84:87], a[12:15], v[96:99], v[84:87]
  s_add_u32 m0, s69, 16384
  ds_read_b64_tr_b16 a[52:53], v241 offset:43008
  ds_read_b64_tr_b16 a[54:55], v241 offset:44032
  v_mfma_f32_16x16x32_bf16 v[92:95], a[12:15], v[100:103], v[92:95]
  buffer_load_dwordx4 v230, s[36:39], s72 offen offset:2048 lds
  s_waitcnt lgkmcnt(12)
  v_mfma_f32_16x16x32_bf16 v[80:83], a[16:19], v[112:115], v[80:83]
  ds_read_b64_tr_b16 a[56:57], v240 offset:45056
  ds_read_b64_tr_b16 a[58:59], v240 offset:46080
  v_mfma_f32_16x16x32_bf16 v[88:91], a[16:19], v[116:119], v[88:91]
  ds_read_b64_tr_b16 a[60:61], v241 offset:45056
  ds_read_b64_tr_b16 a[62:63], v241 offset:46080
  v_mfma_f32_16x16x32_bf16 v[84:87], a[20:23], v[112:115], v[84:87]
  v_mul_f32 v48, v48, v244
  v_mul_f32 v49, v49, v244
  v_mfma_f32_16x16x32_bf16 v[92:95], a[20:23], v[116:119], v[92:95]
  buffer_load_dwordx4 v231, s[36:39], s72 offen offset:3072 lds
  v_mfma_f32_16x16x32_bf16 v[80:83], a[24:27], v[128:131], v[80:83]
  s_add_u32 m0, s69, 0
  v_mul_f32 v50, v50, v244
  v_mfma_f32_16x16x32_bf16 v[88:91], a[24:27], v[132:135], v[88:91]
  buffer_load_dwordx4 v227, s[36:39], s72 offen offset:3072 lds
  v_mfma_f32_16x16x32_bf16 v[84:87], a[28:31], v[128:131], v[84:87]
  v_mul_f32 v51, v51, v244
  v_mul_f32 v52, v52, v244
  v_mfma_f32_16x16x32_bf16 v[92:95], a[28:31], v[132:135], v[92:95]
  buffer_store_dwordx4 v[212:215], v250, s[48:51], s6 offen offset:1024 sc1
  s_waitcnt lgkmcnt(8)
  v_mfma_f32_16x16x32_bf16 v[80:83], a[32:35], v[144:147], v[80:83]
  s_waitcnt vmcnt(20)
  s_waitcnt lgkmcnt(0)
  s_barrier
  ds_read_b64_tr_b16 a[0:1], v236 offset:14336
  v_mfma_f32_16x16x32_bf16 v[88:91], a[32:35], v[148:151], v[88:91]
  ds_read_b64_tr_b16 a[2:3], v236 offset:15360
  v_mul_f32 v53, v53, v244
  v_mfma_f32_16x16x32_bf16 v[84:87], a[36:39], v[144:147], v[84:87]
  s_add_u32 s72, s81, 229376
  s_add_u32 m0, s69, 32768
  ds_read_b64_tr_b16 a[4:5], v237 offset:14336
  ds_read_b64_tr_b16 a[6:7], v237 offset:15360
  v_mfma_f32_16x16x32_bf16 v[92:95], a[36:39], v[148:151], v[92:95]
  buffer_load_dwordx4 v224, s[36:39], s72 offen offset:0 lds
  v_mfma_f32_16x16x32_bf16 v[80:83], a[40:43], v[160:163], v[80:83]
  ds_read_b64_tr_b16 a[8:9], v236 offset:0
  v_mul_f32 v54, v54, v244
  v_mfma_f32_16x16x32_bf16 v[88:91], a[40:43], v[164:167], v[88:91]
  ds_read_b64_tr_b16 a[10:11], v236 offset:1024
  v_mul_f32 v55, v55, v244
  v_mfma_f32_16x16x32_bf16 v[84:87], a[44:47], v[160:163], v[84:87]
  s_add_u32 m0, s69, 49152
  ds_read_b64_tr_b16 a[12:13], v237 offset:0
  ds_read_b64_tr_b16 a[14:15], v237 offset:1024
  v_mfma_f32_16x16x32_bf16 v[92:95], a[44:47], v[164:167], v[92:95]
  buffer_load_dwordx4 v228, s[36:39], s72 offen offset:0 lds
  v_mfma_f32_16x16x32_bf16 v[80:83], a[48:51], v[176:179], v[80:83]
  ds_read_b64_tr_b16 a[16:17], v236 offset:2048
  v_mul_f32 v56, v56, v245
  v_mul_f32 v57, v57, v245
  v_mfma_f32_16x16x32_bf16 v[88:91], a[48:51], v[180:183], v[88:91]
  ds_read_b64_tr_b16 a[18:19], v236 offset:3072
  v_mul_f32 v58, v58, v245
  v_mul_f32 v59, v59, v245
  v_mfma_f32_16x16x32_bf16 v[84:87], a[52:55], v[176:179], v[84:87]
  ds_read_b64_tr_b16 a[20:21], v237 offset:2048
  ds_read_b64_tr_b16 a[22:23], v237 offset:3072
  v_mfma_f32_16x16x32_bf16 v[92:95], a[52:55], v[180:183], v[92:95]
  buffer_load_dwordx4 v229, s[36:39], s72 offen offset:1024 lds
  v_mfma_f32_16x16x32_bf16 v[80:83], a[56:59], v[192:195], v[80:83]
  ds_read_b64_tr_b16 a[24:25], v236 offset:4096
  v_mul_f32 v60, v60, v245
  v_mul_f32 v61, v61, v245
  v_mfma_f32_16x16x32_bf16 v[88:91], a[56:59], v[196:199], v[88:91]
  ds_read_b64_tr_b16 a[26:27], v236 offset:5120
  v_mul_f32 v62, v62, v245
  v_mul_f32 v63, v63, v245
  v_mfma_f32_16x16x32_bf16 v[84:87], a[60:63], v[192:195], v[84:87]
  s_add_u32 m0, s69, 32768
  ds_read_b64_tr_b16 a[28:29], v237 offset:4096
  ds_read_b64_tr_b16 a[30:31], v237 offset:5120
  v_mfma_f32_16x16x32_bf16 v[92:95], a[60:63], v[196:199], v[92:95]
  buffer_load_dwordx4 v225, s[36:39], s72 offen offset:1024 lds
  s_waitcnt lgkmcnt(8)
  v_mfma_f32_16x16x32_bf16 v[32:35], a[0:3], a[112:115], 0
  ds_read_b64_tr_b16 a[32:33], v236 offset:6144
  ds_read_b64_tr_b16 a[34:35], v236 offset:7168
  v_mfma_f32_16x16x32_bf16 v[40:43], a[0:3], a[116:119], 0
  ds_read_b64_tr_b16 a[36:37], v237 offset:6144
  ds_read_b64_tr_b16 a[38:39], v237 offset:7168
  v_mfma_f32_16x16x32_bf16 v[36:39], a[4:7], a[112:115], 0
  ds_read_b64_tr_b16 a[40:41], v236 offset:8192
  ds_read_b64_tr_b16 a[42:43], v236 offset:9216
  v_mfma_f32_16x16x32_bf16 v[44:47], a[4:7], a[116:119], 0
  buffer_load_dwordx4 v226, s[36:39], s72 offen offset:2048 lds
  v_mfma_f32_16x16x32_bf16 v[32:35], a[8:11], a[120:123], v[32:35]
  ds_read_b64_tr_b16 a[44:45], v237 offset:8192
  ds_read_b64_tr_b16 a[46:47], v237 offset:9216
  v_fmac_f32 v48, v80, v246
  v_mfma_f32_16x16x32_bf16 v[40:43], a[8:11], a[124:127], v[40:43]
  ds_read_b64_tr_b16 a[48:49], v236 offset:10240
  ds_read_b64_tr_b16 a[50:51], v236 offset:11264
  v_fmac_f32 v49, v81, v246
  v_mfma_f32_16x16x32_bf16 v[36:39], a[12:15], a[120:123], v[36:39]
  s_add_u32 m0, s69, 49152
  ds_read_b64_tr_b16 a[52:53], v237 offset:10240
  ds_read_b64_tr_b16 a[54:55], v237 offset:11264
  v_mfma_f32_16x16x32_bf16 v[44:47], a[12:15], a[124:127], v[44:47]
  buffer_load_dwordx4 v230, s[36:39], s72 offen offset:2048 lds
  s_waitcnt lgkmcnt(12)
  v_mfma_f32_16x16x32_bf16 v[32:35], a[16:19], a[128:131], v[32:35]
  ds_read_b64_tr_b16 a[56:57], v236 offset:12288
  ds_read_b64_tr_b16 a[58:59], v236 offset:13312
  v_fmac_f32 v50, v82, v246
  v_mfma_f32_16x16x32_bf16 v[40:43], a[16:19], a[132:135], v[40:43]
  ds_read_b64_tr_b16 a[60:61], v237 offset:12288
  ds_read_b64_tr_b16 a[62:63], v237 offset:13312
  v_fmac_f32 v51, v83, v246
  v_fmac_f32 v52, v84, v246
  v_mfma_f32_16x16x32_bf16 v[36:39], a[20:23], a[128:131], v[36:39]
  v_fmac_f32 v53, v85, v246
  v_fmac_f32 v54, v86, v246
  v_fmac_f32 v55, v87, v246
  v_cvt_pk_bf16_f32 v208, v48, v49
  v_mfma_f32_16x16x32_bf16 v[44:47], a[20:23], a[132:135], v[44:47]
  buffer_load_dwordx4 v231, s[36:39], s72 offen offset:3072 lds
  v_mfma_f32_16x16x32_bf16 v[32:35], a[24:27], a[136:139], v[32:35]
  s_add_u32 m0, s69, 32768
  v_cvt_pk_bf16_f32 v209, v50, v51
  v_cvt_pk_bf16_f32 v210, v52, v53
  v_cvt_pk_bf16_f32 v211, v54, v55
  v_mfma_f32_16x16x32_bf16 v[40:43], a[24:27], a[140:143], v[40:43]
  buffer_load_dwordx4 v227, s[36:39], s72 offen offset:3072 lds
  v_mfma_f32_16x16x32_bf16 v[36:39], a[28:31], a[136:139], v[36:39]
  v_mfma_f32_16x16x32_bf16 v[44:47], a[28:31], a[140:143], v[44:47]
  buffer_store_dwordx4 v[208:211], v250, s[48:51], s7 offen offset:0 sc1
  s_waitcnt lgkmcnt(8)
  v_mfma_f32_16x16x32_bf16 v[32:35], a[32:35], a[144:147], v[32:35]
  s_waitcnt vmcnt(19)
  s_waitcnt lgkmcnt(0)
  s_barrier
  ds_read_b64_tr_b16 a[0:1], v236 offset:47104
  v_mfma_f32_16x16x32_bf16 v[40:43], a[32:35], a[148:151], v[40:43]
  ds_read_b64_tr_b16 a[2:3], v236 offset:48128
  v_fmac_f32 v56, v88, v247
  v_mfma_f32_16x16x32_bf16 v[36:39], a[36:39], a[144:147], v[36:39]
  s_add_u32 s72, s82, 0
  s_add_u32 m0, s69, 65536
  ds_read_b64_tr_b16 a[4:5], v237 offset:47104
  ds_read_b64_tr_b16 a[6:7], v237 offset:48128
  v_mfma_f32_16x16x32_bf16 v[44:47], a[36:39], a[148:151], v[44:47]
  buffer_load_dwordx4 v224, s[36:39], s72 offen offset:0 lds
  v_mfma_f32_16x16x32_bf16 v[32:35], a[40:43], a[152:155], v[32:35]
  ds_read_b64_tr_b16 a[8:9], v236 offset:32768
  v_fmac_f32 v57, v89, v247
  v_mfma_f32_16x16x32_bf16 v[40:43], a[40:43], a[156:159], v[40:43]
  ds_read_b64_tr_b16 a[10:11], v236 offset:33792
  v_fmac_f32 v58, v90, v247
  v_fmac_f32 v59, v91, v247
  v_mfma_f32_16x16x32_bf16 v[36:39], a[44:47], a[152:155], v[36:39]
  s_add_u32 m0, s69, 81920
  ds_read_b64_tr_b16 a[12:13], v237 offset:32768
  ds_read_b64_tr_b16 a[14:15], v237 offset:33792
  v_mfma_f32_16x16x32_bf16 v[44:47], a[44:47], a[156:159], v[44:47]
  buffer_load_dwordx4 v228, s[36:39], s72 offen offset:0 lds
  v_mfma_f32_16x16x32_bf16 v[32:35], a[48:51], a[160:163], v[32:35]
  ds_read_b64_tr_b16 a[16:17], v236 offset:34816
  v_fmac_f32 v60, v92, v247
  v_fmac_f32 v61, v93, v247
  v_mfma_f32_16x16x32_bf16 v[40:43], a[48:51], a[164:167], v[40:43]
  ds_read_b64_tr_b16 a[18:19], v236 offset:35840
  v_fmac_f32 v62, v94, v247
  v_fmac_f32 v63, v95, v247
  v_mfma_f32_16x16x32_bf16 v[36:39], a[52:55], a[160:163], v[36:39]
  ds_read_b64_tr_b16 a[20:21], v237 offset:34816
  ds_read_b64_tr_b16 a[22:23], v237 offset:35840
  v_mfma_f32_16x16x32_bf16 v[44:47], a[52:55], a[164:167], v[44:47]
  buffer_load_dwordx4 v229, s[36:39], s72 offen offset:1024 lds
  v_mfma_f32_16x16x32_bf16 v[32:35], a[56:59], a[168:171], v[32:35]
  ds_read_b64_tr_b16 a[24:25], v236 offset:36864
  v_cvt_pk_bf16_f32 v212, v56, v57
  v_cvt_pk_bf16_f32 v213, v58, v59
  v_mfma_f32_16x16x32_bf16 v[40:43], a[56:59], a[172:175], v[40:43]
  ds_read_b64_tr_b16 a[26:27], v236 offset:37888
  v_cvt_pk_bf16_f32 v214, v60, v61
  v_cvt_pk_bf16_f32 v215, v62, v63
  v_mfma_f32_16x16x32_bf16 v[36:39], a[60:63], a[168:171], v[36:39]
  s_add_u32 m0, s69, 65536
  ds_read_b64_tr_b16 a[28:29], v237 offset:36864
  ds_read_b64_tr_b16 a[30:31], v237 offset:37888
  v_mfma_f32_16x16x32_bf16 v[44:47], a[60:63], a[172:175], v[44:47]
  buffer_load_dwordx4 v225, s[36:39], s72 offen offset:1024 lds
  s_waitcnt lgkmcnt(8)
  v_mfma_f32_16x16x32_bf16 v[64:67], a[0:3], v[0:3], 0
  ds_read_b64_tr_b16 a[32:33], v236 offset:38912
  ds_read_b64_tr_b16 a[34:35], v236 offset:39936
  v_mfma_f32_16x16x32_bf16 v[72:75], a[0:3], v[4:7], 0
  ds_read_b64_tr_b16 a[36:37], v237 offset:38912
  ds_read_b64_tr_b16 a[38:39], v237 offset:39936
  v_mfma_f32_16x16x32_bf16 v[68:71], a[4:7], v[0:3], 0
  ds_read_b64_tr_b16 a[40:41], v236 offset:40960
  ds_read_b64_tr_b16 a[42:43], v236 offset:41984
  v_mfma_f32_16x16x32_bf16 v[76:79], a[4:7], v[4:7], 0
  buffer_load_dwordx4 v226, s[36:39], s72 offen offset:2048 lds
  v_mfma_f32_16x16x32_bf16 v[64:67], a[8:11], v[96:99], v[64:67]
  ds_read_b64_tr_b16 a[44:45], v237 offset:40960
  ds_read_b64_tr_b16 a[46:47], v237 offset:41984
  v_mfma_f32_16x16x32_bf16 v[72:75], a[8:11], v[100:103], v[72:75]
  ds_read_b64_tr_b16 a[48:49], v236 offset:43008
  ds_read_b64_tr_b16 a[50:51], v236 offset:44032
  v_mfma_f32_16x16x32_bf16 v[68:71], a[12:15], v[96:99], v[68:71]
  s_add_u32 m0, s69, 81920
  ds_read_b64_tr_b16 a[52:53], v237 offset:43008
  ds_read_b64_tr_b16 a[54:55], v237 offset:44032
  v_mfma_f32_16x16x32_bf16 v[76:79], a[12:15], v[100:103], v[76:79]
  buffer_load_dwordx4 v230, s[36:39], s72 offen offset:2048 lds
  s_waitcnt lgkmcnt(12)
  v_mfma_f32_16x16x32_bf16 v[64:67], a[16:19], v[112:115], v[64:67]
  ds_read_b64_tr_b16 a[56:57], v236 offset:45056
  ds_read_b64_tr_b16 a[58:59], v236 offset:46080
  v_mfma_f32_16x16x32_bf16 v[72:75], a[16:19], v[116:119], v[72:75]
  ds_read_b64_tr_b16 a[60:61], v237 offset:45056
  ds_read_b64_tr_b16 a[62:63], v237 offset:46080
  v_mfma_f32_16x16x32_bf16 v[68:71], a[20:23], v[112:115], v[68:71]
  v_mul_f32 v32, v32, v244
  v_mul_f32 v33, v33, v244
  v_mfma_f32_16x16x32_bf16 v[76:79], a[20:23], v[116:119], v[76:79]
  buffer_load_dwordx4 v231, s[36:39], s72 offen offset:3072 lds
  v_mfma_f32_16x16x32_bf16 v[64:67], a[24:27], v[128:131], v[64:67]
  s_add_u32 m0, s69, 65536
  v_mul_f32 v34, v34, v244
  v_mfma_f32_16x16x32_bf16 v[72:75], a[24:27], v[132:135], v[72:75]
  buffer_load_dwordx4 v227, s[36:39], s72 offen offset:3072 lds
  v_cmp_ne_u32_e64 s[90:91], s96, v217
  v_mfma_f32_16x16x32_bf16 v[68:71], a[28:31], v[128:131], v[68:71]
  v_mul_f32 v35, v35, v244
  v_mul_f32 v36, v36, v244
  v_mfma_f32_16x16x32_bf16 v[76:79], a[28:31], v[132:135], v[76:79]
  s_cmp_lg_u64 s[90:91], 0
  s_cbranch_scc1 L_spin2b
L_spin2rb:
  buffer_store_dwordx4 v[212:215], v250, s[48:51], s7 offen offset:1024 sc1
  s_waitcnt lgkmcnt(8)
  v_mfma_f32_16x16x32_bf16 v[64:67], a[32:35], v[144:147], v[64:67]
  s_waitcnt vmcnt(19)
  s_waitcnt lgkmcnt(0)
  s_barrier
  ds_read_b64_tr_b16 a[0:1], v240 offset:14336
  v_mfma_f32_16x16x32_bf16 v[72:75], a[32:35], v[148:151], v[72:75]
  ds_read_b64_tr_b16 a[2:3], v240 offset:15360
  v_mul_f32 v37, v37, v244
  v_mfma_f32_16x16x32_bf16 v[68:71], a[36:39], v[144:147], v[68:71]
  s_add_u32 s72, s82, 229376
  s_add_u32 m0, s69, 98304
  ds_read_b64_tr_b16 a[4:5], v241 offset:14336
  ds_read_b64_tr_b16 a[6:7], v241 offset:15360
  v_mfma_f32_16x16x32_bf16 v[76:79], a[36:39], v[148:151], v[76:79]
  buffer_load_dwordx4 v224, s[36:39], s72 offen offset:0 lds
  v_mfma_f32_16x16x32_bf16 v[64:67], a[40:43], v[160:163], v[64:67]
  ds_read_b64_tr_b16 a[8:9], v240 offset:0
  v_mul_f32 v38, v38, v244
  v_mfma_f32_16x16x32_bf16 v[72:75], a[40:43], v[164:167], v[72:75]
  ds_read_b64_tr_b16 a[10:11], v240 offset:1024
  v_mul_f32 v39, v39, v244
  v_mfma_f32_16x16x32_bf16 v[68:71], a[44:47], v[160:163], v[68:71]
  s_add_u32 m0, s69, 114688
  ds_read_b64_tr_b16 a[12:13], v241 offset:0
  ds_read_b64_tr_b16 a[14:15], v241 offset:1024
  v_mfma_f32_16x16x32_bf16 v[76:79], a[44:47], v[164:167], v[76:79]
  buffer_load_dwordx4 v228, s[36:39], s72 offen offset:0 lds
  v_mfma_f32_16x16x32_bf16 v[64:67], a[48:51], v[176:179], v[64:67]
  ds_read_b64_tr_b16 a[16:17], v240 offset:2048
  v_mul_f32 v40, v40, v245
  v_mul_f32 v41, v41, v245
  v_mfma_f32_16x16x32_bf16 v[72:75], a[48:51], v[180:183], v[72:75]
  ds_read_b64_tr_b16 a[18:19], v240 offset:3072
  v_mul_f32 v42, v42, v245
  v_mul_f32 v43, v43, v245
  v_mfma_f32_16x16x32_bf16 v[68:71], a[52:55], v[176:179], v[68:71]
  ds_read_b64_tr_b16 a[20:21], v241 offset:2048
  ds_read_b64_tr_b16 a[22:23], v241 offset:3072
  v_mfma_f32_16x16x32_bf16 v[76:79], a[52:55], v[180:183], v[76:79]
  buffer_load_dwordx4 v229, s[36:39], s72 offen offset:1024 lds
  v_mfma_f32_16x16x32_bf16 v[64:67], a[56:59], v[192:195], v[64:67]
  ds_read_b64_tr_b16 a[24:25], v240 offset:4096
  v_mul_f32 v44, v44, v245
  v_mul_f32 v45, v45, v245
  v_mfma_f32_16x16x32_bf16 v[72:75], a[56:59], v[196:199], v[72:75]
  ds_read_b64_tr_b16 a[26:27], v240 offset:5120
  v_mul_f32 v46, v46, v245
  v_mul_f32 v47, v47, v245
  v_mfma_f32_16x16x32_bf16 v[68:71], a[60:63], v[192:195], v[68:71]
  s_add_u32 m0, s69, 98304
  ds_read_b64_tr_b16 a[28:29], v241 offset:4096
  ds_read_b64_tr_b16 a[30:31], v241 offset:5120
  v_mfma_f32_16x16x32_bf16 v[76:79], a[60:63], v[196:199], v[76:79]
  buffer_load_dwordx4 v225, s[36:39], s72 offen offset:1024 lds
  s_waitcnt lgkmcnt(8)
  v_mfma_f32_16x16x32_bf16 v[48:51], a[0:3], a[112:115], 0
  ds_read_b64_tr_b16 a[32:33], v240 offset:6144
  ds_read_b64_tr_b16 a[34:35], v240 offset:7168
  v_mfma_f32_16x16x32_bf16 v[56:59], a[0:3], a[116:119], 0
  ds_read_b64_tr_b16 a[36:37], v241 offset:6144
  ds_read_b64_tr_b16 a[38:39], v241 offset:7168
  v_mfma_f32_16x16x32_bf16 v[52:55], a[4:7], a[112:115], 0
  ds_read_b64_tr_b16 a[40:41], v240 offset:8192
  ds_read_b64_tr_b16 a[42:43], v240 offset:9216
  v_mfma_f32_16x16x32_bf16 v[60:63], a[4:7], a[116:119], 0
  buffer_load_dwordx4 v226, s[36:39], s72 offen offset:2048 lds
  v_mfma_f32_16x16x32_bf16 v[48:51], a[8:11], a[120:123], v[48:51]
  ds_read_b64_tr_b16 a[44:45], v241 offset:8192
  ds_read_b64_tr_b16 a[46:47], v241 offset:9216
  v_fmac_f32 v32, v64, v246
  v_mfma_f32_16x16x32_bf16 v[56:59], a[8:11], a[124:127], v[56:59]
  ds_read_b64_tr_b16 a[48:49], v240 offset:10240
  ds_read_b64_tr_b16 a[50:51], v240 offset:11264
  v_fmac_f32 v33, v65, v246
  v_mfma_f32_16x16x32_bf16 v[52:55], a[12:15], a[120:123], v[52:55]
  s_add_u32 m0, s69, 114688
  ds_read_b64_tr_b16 a[52:53], v241 offset:10240
  ds_read_b64_tr_b16 a[54:55], v241 offset:11264
  v_mfma_f32_16x16x32_bf16 v[60:63], a[12:15], a[124:127], v[60:63]
  buffer_load_dwordx4 v230, s[36:39], s72 offen offset:2048 lds
  s_waitcnt lgkmcnt(12)
  v_mfma_f32_16x16x32_bf16 v[48:51], a[16:19], a[128:131], v[48:51]
  ds_read_b64_tr_b16 a[56:57], v240 offset:12288
  ds_read_b64_tr_b16 a[58:59], v240 offset:13312
  v_fmac_f32 v34, v66, v246
  v_mfma_f32_16x16x32_bf16 v[56:59], a[16:19], a[132:135], v[56:59]
  ds_read_b64_tr_b16 a[60:61], v241 offset:12288
  ds_read_b64_tr_b16 a[62:63], v241 offset:13312
  v_fmac_f32 v35, v67, v246
  v_fmac_f32 v36, v68, v246
  v_mfma_f32_16x16x32_bf16 v[52:55], a[20:23], a[128:131], v[52:55]
  v_fmac_f32 v37, v69, v246
  v_fmac_f32 v38, v70, v246
  v_fmac_f32 v39, v71, v246
  v_cvt_pk_bf16_f32 v208, v32, v33
  v_mfma_f32_16x16x32_bf16 v[60:63], a[20:23], a[132:135], v[60:63]
  buffer_load_dwordx4 v231, s[36:39], s72 offen offset:3072 lds
  v_mfma_f32_16x16x32_bf16 v[48:51], a[24:27], a[136:139], v[48:51]
  s_add_u32 m0, s69, 98304
  v_cvt_pk_bf16_f32 v209, v34, v35
  v_cvt_pk_bf16_f32 v210, v36, v37
  v_cvt_pk_bf16_f32 v211, v38, v39
  v_mfma_f32_16x16x32_bf16 v[56:59], a[24:27], a[140:143], v[56:59]
  buffer_load_dwordx4 v227, s[36:39], s72 offen offset:3072 lds
  v_mfma_f32_16x16x32_bf16 v[52:55], a[28:31], a[136:139], v[52:55]
  v_mfma_f32_16x16x32_bf16 v[60:63], a[28:31], a[140:143], v[60:63]
  buffer_store_dwordx4 v[208:211], v250, s[48:51], s8 offen offset:0 sc1
  s_waitcnt lgkmcnt(8)
  v_mfma_f32_16x16x32_bf16 v[48:51], a[32:35], a[144:147], v[48:51]
  s_waitcnt vmcnt(19)
  s_barrier
  ds_read_b64_tr_b16 a[0:1], v240 offset:47104
  v_mfma_f32_16x16x32_bf16 v[56:59], a[32:35], a[148:151], v[56:59]
  ds_read_b64_tr_b16 a[2:3], v240 offset:48128
  v_fmac_f32 v40, v72, v247
  v_fmac_f32 v41, v73, v247
  v_mfma_f32_16x16x32_bf16 v[52:55], a[36:39], a[144:147], v[52:55]
  ds_read_b64_tr_b16 a[4:5], v241 offset:47104
  v_fmac_f32 v42, v74, v247
  v_fmac_f32 v43, v75, v247
  v_mfma_f32_16x16x32_bf16 v[60:63], a[36:39], a[148:151], v[60:63]
  ds_read_b64_tr_b16 a[6:7], v241 offset:48128
  v_fmac_f32 v44, v76, v247
  v_fmac_f32 v45, v77, v247
  s_cmp_lg_u32 s14, 0
  s_cbranch_scc1 L_ys1b
L_ys1rb:
  v_mfma_f32_16x16x32_bf16 v[48:51], a[40:43], a[152:155], v[48:51]
  ds_read_b64_tr_b16 a[8:9], v240 offset:32768
  ds_read_b64_tr_b16 a[10:11], v240 offset:33792
  v_fmac_f32 v46, v78, v247
  v_fmac_f32 v47, v79, v247
  v_mfma_f32_16x16x32_bf16 v[56:59], a[40:43], a[156:159], v[56:59]
  v_cvt_pk_bf16_f32 v212, v40, v41
  v_cvt_pk_bf16_f32 v213, v42, v43
  s_add_u32 s87, s83, 0
  buffer_load_dwordx4 v[104:107], v250, s[48:51], s87 offen offset:0 sc1
  v_mfma_f32_16x16x32_bf16 v[52:55], a[44:47], a[152:155], v[52:55]
  ds_read_b64_tr_b16 a[12:13], v241 offset:32768
  v_cvt_pk_bf16_f32 v214, v44, v45
  v_cvt_pk_bf16_f32 v215, v46, v47
  v_mfma_f32_16x16x32_bf16 v[60:63], a[44:47], a[156:159], v[60:63]
  ds_read_b64_tr_b16 a[14:15], v241 offset:33792
  s_waitcnt lgkmcnt(8)
  v_mfma_f32_16x16x32_bf16 v[48:51], a[48:51], a[160:163], v[48:51]
  ds_read_b64_tr_b16 a[16:17], v240 offset:34816
  ds_read_b64_tr_b16 a[18:19], v240 offset:35840
  v_mfma_f32_16x16x32_bf16 v[56:59], a[48:51], a[164:167], v[56:59]
  buffer_store_dwordx4 v[212:215], v250, s[48:51], s8 offen offset:1024 sc1
  v_mfma_f32_16x16x32_bf16 v[52:55], a[52:55], a[160:163], v[52:55]
  ds_read_b64_tr_b16 a[20:21], v241 offset:34816
  ds_read_b64_tr_b16 a[22:23], v241 offset:35840
  v_mfma_f32_16x16x32_bf16 v[60:63], a[52:55], a[164:167], v[60:63]
  s_add_u32 s87, s83, 0
  buffer_load_dwordx4 v[108:111], v250, s[48:51], s87 offen offset:1024 sc1
  v_mfma_f32_16x16x32_bf16 v[48:51], a[56:59], a[168:171], v[48:51]
  ds_read_b64_tr_b16 a[24:25], v240 offset:36864
  v_mfma_f32_16x16x32_bf16 v[56:59], a[56:59], a[172:175], v[56:59]
  ds_read_b64_tr_b16 a[26:27], v240 offset:37888
  v_mfma_f32_16x16x32_bf16 v[52:55], a[60:63], a[168:171], v[52:55]
  ds_read_b64_tr_b16 a[28:29], v241 offset:36864
  v_mfma_f32_16x16x32_bf16 v[60:63], a[60:63], a[172:175], v[60:63]
  ds_read_b64_tr_b16 a[30:31], v241 offset:37888
  s_waitcnt lgkmcnt(8)
  v_mfma_f32_16x16x32_bf16 v[80:83], a[0:3], v[0:3], 0
  ds_read_b64_tr_b16 a[32:33], v240 offset:38912
  ds_read_b64_tr_b16 a[34:35], v240 offset:39936
  ds_read_b64_tr_b16 a[36:37], v241 offset:38912
  ds_read_b64_tr_b16 a[38:39], v241 offset:39936
  v_mfma_f32_16x16x32_bf16 v[88:91], a[0:3], v[4:7], 0
  s_add_u32 s87, s83, 0
  buffer_load_dwordx4 v[120:123], v250, s[48:51], s87 offen offset:2048 sc1
  v_mfma_f32_16x16x32_bf16 v[84:87], a[4:7], v[0:3], 0
  ds_read_b64_tr_b16 a[40:41], v240 offset:40960
  v_accvgpr_read_b32 v8, a224
  v_and_b32 v218, 15, v251
  v_mfma_f32_16x16x32_bf16 v[92:95], a[4:7], v[4:7], 0
  ds_read_b64_tr_b16 a[42:43], v240 offset:41984
  v_accvgpr_read_b32 v9, a225
  v_lshrrev_b32 v219, 4, v251
  v_mfma_f32_16x16x32_bf16 v[80:83], a[8:11], v[96:99], v[80:83]
  ds_read_b64_tr_b16 a[44:45], v241 offset:40960
  ds_read_b64_tr_b16 a[46:47], v241 offset:41984
  v_lshlrev_b32 v219, 2, v219
  v_mfma_f32_16x16x32_bf16 v[88:91], a[8:11], v[100:103], v[88:91]
  ds_read_b64_tr_b16 a[48:49], v240 offset:43008
  ds_read_b64_tr_b16 a[50:51], v240 offset:44032
  v_sub_u32 v218, v218, v219
  v_mfma_f32_16x16x32_bf16 v[84:87], a[12:15], v[96:99], v[84:87]
  ds_read_b64_tr_b16 a[52:53], v241 offset:43008
  ds_read_b64_tr_b16 a[54:55], v241 offset:44032
  v_mul_f32 v48, v48, v244
  v_mfma_f32_16x16x32_bf16 v[92:95], a[12:15], v[100:103], v[92:95]
  s_add_u32 s87, s83, 0
  buffer_load_dwordx4 v[124:127], v250, s[48:51], s87 offen offset:3072 sc1
  s_waitcnt lgkmcnt(12)
  v_mfma_f32_16x16x32_bf16 v[80:83], a[16:19], v[112:115], v[80:83]
  ds_read_b64_tr_b16 a[56:57], v240 offset:45056
  ds_read_b64_tr_b16 a[58:59], v240 offset:46080
  v_mov_b32 v220, 0x3f80
  v_mfma_f32_16x16x32_bf16 v[88:91], a[16:19], v[116:119], v[88:91]
  ds_read_b64_tr_b16 a[60:61], v241 offset:45056
  ds_read_b64_tr_b16 a[62:63], v241 offset:46080
  v_mov_b32 v221, 0x3f800000
  v_mfma_f32_16x16x32_bf16 v[84:87], a[20:23], v[112:115], v[84:87]
  v_mul_f32 v49, v49, v244
  v_mul_f32 v50, v50, v244
  v_cmp_eq_u32_e64 s[94:95], 0, v218
  v_mfma_f32_16x16x32_bf16 v[92:95], a[20:23], v[116:119], v[92:95]
  v_mul_f32 v51, v51, v244
  v_mul_f32 v52, v52, v244
  v_cmp_eq_u32_e64 s[92:93], 1, v218
  v_mfma_f32_16x16x32_bf16 v[80:83], a[24:27], v[128:131], v[80:83]
  v_mul_f32 v53, v53, v244
  v_mul_f32 v54, v54, v244
  v_accvgpr_write_b32 a176, 0
  v_mfma_f32_16x16x32_bf16 v[88:91], a[24:27], v[132:135], v[88:91]
  v_mul_f32 v55, v55, v244
  v_mul_f32 v56, v56, v245
  v_accvgpr_write_b32 a180, 0
  v_mfma_f32_16x16x32_bf16 v[84:87], a[28:31], v[128:131], v[84:87]
  v_mul_f32 v57, v57, v245
  v_mul_f32 v58, v58, v245
  v_cndmask_b32_e64 v219, 0, v220, s[94:95]
  v_mfma_f32_16x16x32_bf16 v[92:95], a[28:31], v[132:135], v[92:95]
  v_mul_f32 v59, v59, v245
  v_cndmask_b32_e64 v219, v219, v221, s[92:93]
  s_waitcnt lgkmcnt(8)
  v_mfma_f32_16x16x32_bf16 v[80:83], a[32:35], v[144:147], v[80:83]
  s_waitcnt vmcnt(15)
  s_barrier
  ds_read_b64_tr_b16 a[0:1], v236 offset:14336
  ds_read_b64_tr_b16 a[2:3], v236 offset:15360
  v_mfma_f32_16x16x32_bf16 v[88:91], a[32:35], v[148:151], v[88:91]
  v_mul_f32 v60, v60, v245
  s_add_u32 s87, s83, 4096
  buffer_load_dwordx4 v[136:139], v250, s[48:51], s87 offen offset:0 sc1
  v_mfma_f32_16x16x32_bf16 v[84:87], a[36:39], v[144:147], v[84:87]
  ds_read_b64_tr_b16 a[4:5], v237 offset:14336
  v_mul_f32 v61, v61, v245
  v_accvgpr_write_b32 a178, v219
  v_mfma_f32_16x16x32_bf16 v[92:95], a[36:39], v[148:151], v[92:95]
  ds_read_b64_tr_b16 a[6:7], v237 offset:15360
  v_mul_f32 v62, v62, v245
  v_cmp_eq_u32_e64 s[94:95], 2, v218
  v_mfma_f32_16x16x32_bf16 v[80:83], a[40:43], v[160:163], v[80:83]
  ds_read_b64_tr_b16 a[8:9], v236 offset:0
  v_mul_f32 v63, v63, v245
  v_cmp_eq_u32_e64 s[92:93], 3, v218
  v_mfma_f32_16x16x32_bf16 v[88:91], a[40:43], v[164:167], v[88:91]
  ds_read_b64_tr_b16 a[10:11], v236 offset:1024
  v_accvgpr_read_b32 v10, a226
  v_accvgpr_write_b32 a177, 0
  v_mfma_f32_16x16x32_bf16 v[84:87], a[44:47], v[160:163], v[84:87]
  ds_read_b64_tr_b16 a[12:13], v237 offset:0
  ds_read_b64_tr_b16 a[14:15], v237 offset:1024
  v_accvgpr_write_b32 a181, 0
  v_mfma_f32_16x16x32_bf16 v[92:95], a[44:47], v[164:167], v[92:95]
  s_add_u32 s87, s83, 4096
  buffer_load_dwordx4 v[140:143], v250, s[48:51], s87 offen offset:1024 sc1
  s_waitcnt lgkmcnt(8)
  v_mfma_f32_16x16x32_bf16 v[80:83], a[48:51], v[176:179], v[80:83]
  ds_read_b64_tr_b16 a[16:17], v236 offset:2048
  v_accvgpr_read_b32 v11, a227
  v_cndmask_b32_e64 v219, 0, v220, s[94:95]
  v_mfma_f32_16x16x32_bf16 v[88:91], a[48:51], v[180:183], v[88:91]
  ds_read_b64_tr_b16 a[18:19], v236 offset:3072
  v_accvgpr_read_b32 v12, a228
  v_mfma_f32_16x16x32_bf16 v[84:87], a[52:55], v[176:179], v[84:87]
  ds_read_b64_tr_b16 a[20:21], v237 offset:2048
  v_accvgpr_read_b32 v13, a229
  v_mfma_f32_16x16x32_bf16 v[92:95], a[52:55], v[180:183], v[92:95]
  ds_read_b64_tr_b16 a[22:23], v237 offset:3072
  v_accvgpr_read_b32 v14, a230
  v_mfma_f32_16x16x32_bf16 v[80:83], a[56:59], v[192:195], v[80:83]
  ds_read_b64_tr_b16 a[24:25], v236 offset:4096
  v_accvgpr_read_b32 v15, a231
  v_mfma_f32_16x16x32_bf16 v[88:91], a[56:59], v[196:199], v[88:91]
  ds_read_b64_tr_b16 a[26:27], v236 offset:5120
  v_cndmask_b32_e64 v219, v219, v221, s[92:93]
  v_mfma_f32_16x16x32_bf16 v[84:87], a[60:63], v[192:195], v[84:87]
  ds_read_b64_tr_b16 a[28:29], v237 offset:4096
  v_accvgpr_write_b32 a179, v219
  v_mfma_f32_16x16x32_bf16 v[92:95], a[60:63], v[196:199], v[92:95]
  ds_read_b64_tr_b16 a[30:31], v237 offset:5120
  s_waitcnt lgkmcnt(8)
  v_mfma_f32_16x16x32_bf16 v[32:35], a[0:3], a[112:115], 0
  ds_read_b64_tr_b16 a[32:33], v236 offset:6144
  ds_read_b64_tr_b16 a[34:35], v236 offset:7168
  v_mfma_f32_16x16x32_bf16 v[40:43], a[0:3], a[116:119], 0
  ds_read_b64_tr_b16 a[36:37], v237 offset:6144
  ds_read_b64_tr_b16 a[38:39], v237 offset:7168
  v_mfma_f32_16x16x32_bf16 v[36:39], a[4:7], a[112:115], 0
  ds_read_b64_tr_b16 a[40:41], v236 offset:8192
  v_fmac_f32 v48, v80, v246
  v_fmac_f32 v49, v81, v246
  v_mfma_f32_16x16x32_bf16 v[44:47], a[4:7], a[116:119], 0
  ds_read_b64_tr_b16 a[42:43], v236 offset:9216
  v_fmac_f32 v50, v82, v246
  v_fmac_f32 v51, v83, v246
  v_mfma_f32_16x16x32_bf16 v[32:35], a[8:11], a[120:123], v[32:35]
  ds_read_b64_tr_b16 a[44:45], v237 offset:8192
  ds_read_b64_tr_b16 a[46:47], v237 offset:9216
  v_mfma_f32_16x16x32_bf16 v[40:43], a[8:11], a[124:127], v[40:43]
  ds_read_b64_tr_b16 a[48:49], v236 offset:10240
  ds_read_b64_tr_b16 a[50:51], v236 offset:11264
  v_mfma_f32_16x16x32_bf16 v[36:39], a[12:15], a[120:123], v[36:39]
  ds_read_b64_tr_b16 a[52:53], v237 offset:10240
  v_fmac_f32 v52, v84, v246
  v_fmac_f32 v53, v85, v246
  v_mfma_f32_16x16x32_bf16 v[44:47], a[12:15], a[124:127], v[44:47]
  ds_read_b64_tr_b16 a[54:55], v237 offset:11264
  s_waitcnt lgkmcnt(12)
  v_mfma_f32_16x16x32_bf16 v[32:35], a[16:19], a[128:131], v[32:35]
  ds_read_b64_tr_b16 a[56:57], v236 offset:12288
  ds_read_b64_tr_b16 a[58:59], v236 offset:13312
  v_mfma_f32_16x16x32_bf16 v[40:43], a[16:19], a[132:135], v[40:43]
  ds_read_b64_tr_b16 a[60:61], v237 offset:12288
  ds_read_b64_tr_b16 a[62:63], v237 offset:13312
  v_mfma_f32_16x16x32_bf16 v[36:39], a[20:23], a[128:131], v[36:39]
  v_fmac_f32 v54, v86, v246
  v_fmac_f32 v55, v87, v246
  v_cvt_pk_bf16_f32 v208, v48, v49
  v_mfma_f32_16x16x32_bf16 v[44:47], a[20:23], a[132:135], v[44:47]
  v_cvt_pk_bf16_f32 v209, v50, v51
  v_cvt_pk_bf16_f32 v210, v52, v53
  v_cvt_pk_bf16_f32 v211, v54, v55
  v_mfma_f32_16x16x32_bf16 v[32:35], a[24:27], a[136:139], v[32:35]
  buffer_store_dwordx4 v[208:211], v250, s[48:51], s9 offen offset:0 sc1
  v_mfma_f32_16x16x32_bf16 v[40:43], a[24:27], a[140:143], v[40:43]
  v_fmac_f32 v56, v88, v247
  v_fmac_f32 v57, v89, v247
  v_fmac_f32 v58, v90, v247
  v_mfma_f32_16x16x32_bf16 v[36:39], a[28:31], a[136:139], v[36:39]
  v_fmac_f32 v59, v91, v247
  v_fmac_f32 v60, v92, v247
  v_fmac_f32 v61, v93, v247
  v_mfma_f32_16x16x32_bf16 v[44:47], a[28:31], a[140:143], v[44:47]
  v_fmac_f32 v62, v94, v247
  v_fmac_f32 v63, v95, v247
  s_waitcnt lgkmcnt(8)
  v_mfma_f32_16x16x32_bf16 v[32:35], a[32:35], a[144:147], v[32:35]
  s_waitcnt vmcnt(9)
  s_barrier
  ds_read_b64_tr_b16 a[0:1], v236 offset:47104
  v_mfma_f32_16x16x32_bf16 v[40:43], a[32:35], a[148:151], v[40:43]
  ds_read_b64_tr_b16 a[2:3], v236 offset:48128
  v_cvt_pk_bf16_f32 v212, v56, v57
  v_cvt_pk_bf16_f32 v213, v58, v59
  v_mfma_f32_16x16x32_bf16 v[36:39], a[36:39], a[144:147], v[36:39]
  ds_read_b64_tr_b16 a[4:5], v237 offset:47104
  v_cvt_pk_bf16_f32 v214, v60, v61
  v_cvt_pk_bf16_f32 v215, v62, v63
  v_mfma_f32_16x16x32_bf16 v[44:47], a[36:39], a[148:151], v[44:47]
  ds_read_b64_tr_b16 a[6:7], v237 offset:48128
  buffer_store_dwordx4 v[212:215], v250, s[48:51], s9 offen offset:1024 sc1
  v_mfma_f32_16x16x32_bf16 v[32:35], a[40:43], a[152:155], v[32:35]
  ds_read_b64_tr_b16 a[8:9], v236 offset:32768
  ds_read_b64_tr_b16 a[10:11], v236 offset:33792
  v_accvgpr_read_b32 v220, a254
  v_accvgpr_read_b32 v221, a255
  v_mfma_f32_16x16x32_bf16 v[40:43], a[40:43], a[156:159], v[40:43]
  s_add_u32 s87, s83, 4096
  buffer_load_dwordx4 v[152:155], v250, s[48:51], s87 offen offset:2048 sc1
  v_mfma_f32_16x16x32_bf16 v[36:39], a[44:47], a[152:155], v[36:39]
  ds_read_b64_tr_b16 a[12:13], v237 offset:32768
  v_mul_f32 v218, 0x41317218, v238
  v_mul_f32 v219, 0x41317218, v239
  v_mul_f32 v220, 0x41317218, v220
  v_mfma_f32_16x16x32_bf16 v[44:47], a[44:47], a[156:159], v[44:47]
  ds_read_b64_tr_b16 a[14:15], v237 offset:33792
  v_mul_f32 v221, 0x41317218, v221
  v_lshlrev_b32 v48, 16, v8
  s_waitcnt lgkmcnt(8)
  v_mfma_f32_16x16x32_bf16 v[32:35], a[48:51], a[160:163], v[32:35]
  ds_read_b64_tr_b16 a[16:17], v236 offset:34816
  v_and_b32 v49, 0xffff0000, v8
  v_fma_f32 v80, v48, v218, v219
  v_fma_f32 v81, v49, v218, v219
  v_mfma_f32_16x16x32_bf16 v[40:43], a[48:51], a[164:167], v[40:43]
  ds_read_b64_tr_b16 a[18:19], v236 offset:35840
  v_lshlrev_b32 v50, 16, v9
  v_and_b32 v51, 0xffff0000, v9
  v_fma_f32 v82, v50, v218, v219
  v_mfma_f32_16x16x32_bf16 v[36:39], a[52:55], a[160:163], v[36:39]
  ds_read_b64_tr_b16 a[20:21], v237 offset:34816
  ds_read_b64_tr_b16 a[22:23], v237 offset:35840
  v_fma_f32 v83, v51, v218, v219
  v_lshlrev_b32 v52, 16, v10
  v_mfma_f32_16x16x32_bf16 v[44:47], a[52:55], a[164:167], v[44:47]
  s_add_u32 s87, s83, 4096
  buffer_load_dwordx4 v[156:159], v250, s[48:51], s87 offen offset:3072 sc1
  v_mfma_f32_16x16x32_bf16 v[32:35], a[56:59], a[168:171], v[32:35]
  ds_read_b64_tr_b16 a[24:25], v236 offset:36864
  v_and_b32 v53, 0xffff0000, v10
  v_fma_f32 v84, v52, v218, v219
  v_fma_f32 v85, v53, v218, v219
  v_lshlrev_b32 v54, 16, v11
  v_mfma_f32_16x16x32_bf16 v[40:43], a[56:59], a[172:175], v[40:43]
  ds_read_b64_tr_b16 a[26:27], v236 offset:37888
  v_and_b32 v55, 0xffff0000, v11
  v_fma_f32 v86, v54, v218, v219
  v_fma_f32 v87, v55, v218, v219
  v_lshlrev_b32 v56, 16, v12
  v_mfma_f32_16x16x32_bf16 v[36:39], a[60:63], a[168:171], v[36:39]
  ds_read_b64_tr_b16 a[28:29], v237 offset:36864
  v_and_b32 v57, 0xffff0000, v12
  v_fma_f32 v88, v56, v220, v221
  v_fma_f32 v89, v57, v220, v221
  v_lshlrev_b32 v58, 16, v13
  v_mfma_f32_16x16x32_bf16 v[44:47], a[60:63], a[172:175], v[44:47]
  ds_read_b64_tr_b16 a[30:31], v237 offset:37888
  v_and_b32 v59, 0xffff0000, v13
  v_fma_f32 v90, v58, v220, v221
  v_fma_f32 v91, v59, v220, v221
  s_waitcnt lgkmcnt(8)
  v_mfma_f32_16x16x32_bf16 v[64:67], a[0:3], v[0:3], 0
  ds_read_b64_tr_b16 a[32:33], v236 offset:38912
  ds_read_b64_tr_b16 a[34:35], v236 offset:39936
  ds_read_b64_tr_b16 a[36:37], v237 offset:38912
  ds_read_b64_tr_b16 a[38:39], v237 offset:39936
  v_mfma_f32_16x16x32_bf16 v[72:75], a[0:3], v[4:7], 0
  s_add_u32 s87, s83, 8192
  buffer_load_dwordx4 v[168:171], v250, s[48:51], s87 offen offset:0 sc1
  v_mfma_f32_16x16x32_bf16 v[68:71], a[4:7], v[0:3], 0
  ds_read_b64_tr_b16 a[40:41], v236 offset:40960
  v_lshlrev_b32 v60, 16, v14
  v_and_b32 v61, 0xffff0000, v14
  v_fma_f32 v92, v60, v220, v221
  v_fma_f32 v93, v61, v220, v221
  v_mfma_f32_16x16x32_bf16 v[76:79], a[4:7], v[4:7], 0
  ds_read_b64_tr_b16 a[42:43], v236 offset:41984
  v_lshlrev_b32 v62, 16, v15
  v_and_b32 v63, 0xffff0000, v15
  v_fma_f32 v94, v62, v220, v221
  v_fma_f32 v95, v63, v220, v221
  v_mfma_f32_16x16x32_bf16 v[64:67], a[8:11], v[96:99], v[64:67]
  ds_read_b64_tr_b16 a[44:45], v237 offset:40960
  ds_read_b64_tr_b16 a[46:47], v237 offset:41984
  ds_read_b64_tr_b16 a[48:49], v236 offset:43008
  ds_read_b64_tr_b16 a[50:51], v236 offset:44032
  v_mfma_f32_16x16x32_bf16 v[72:75], a[8:11], v[100:103], v[72:75]
  s_add_u32 s87, s83, 8192
  buffer_load_dwordx4 v[172:175], v250, s[48:51], s87 offen offset:1024 sc1
  v_mfma_f32_16x16x32_bf16 v[68:71], a[12:15], v[96:99], v[68:71]
  ds_read_b64_tr_b16 a[52:53], v237 offset:43008
  v_mfma_f32_16x16x32_bf16 v[76:79], a[12:15], v[100:103], v[76:79]
  ds_read_b64_tr_b16 a[54:55], v237 offset:44032
  s_cmp_lg_u32 s14, 0
  s_cbranch_scc1 L_ys2b
L_ys2rb:
  s_waitcnt lgkmcnt(12)
  v_mfma_f32_16x16x32_bf16 v[64:67], a[16:19], v[112:115], v[64:67]
  ds_read_b64_tr_b16 a[56:57], v236 offset:45056
  ds_read_b64_tr_b16 a[58:59], v236 offset:46080
  v_mul_f32 v16, 0xbfb8aa3b, v80
  v_mfma_f32_16x16x32_bf16 v[72:75], a[16:19], v[116:119], v[72:75]
  ds_read_b64_tr_b16 a[60:61], v237 offset:45056
  ds_read_b64_tr_b16 a[62:63], v237 offset:46080
  v_mul_f32 v17, 0xbfb8aa3b, v81
  v_mfma_f32_16x16x32_bf16 v[68:71], a[20:23], v[112:115], v[68:71]
  v_mul_f32 v32, v32, v244
  v_mul_f32 v18, 0xbfb8aa3b, v82
  v_mul_f32 v19, 0xbfb8aa3b, v83
  v_mfma_f32_16x16x32_bf16 v[76:79], a[20:23], v[116:119], v[76:79]
  v_mul_f32 v33, v33, v244
  s_add_u32 s87, s83, 12288
  buffer_load_dwordx4 v[200:203], v250, s[48:51], s87 offen offset:0 sc1
  v_mfma_f32_16x16x32_bf16 v[64:67], a[24:27], v[128:131], v[64:67]
  v_mul_f32 v34, v34, v244
  v_exp_f32 v16, v16
  v_mfma_f32_16x16x32_bf16 v[72:75], a[24:27], v[132:135], v[72:75]
  v_mul_f32 v35, v35, v244
  v_exp_f32 v17, v17
  v_mfma_f32_16x16x32_bf16 v[68:71], a[28:31], v[128:131], v[68:71]
  v_mul_f32 v36, v36, v244
  v_exp_f32 v18, v18
  v_mfma_f32_16x16x32_bf16 v[76:79], a[28:31], v[132:135], v[76:79]
  s_add_u32 s87, s83, 12288
  buffer_load_dwordx4 v[204:207], v250, s[48:51], s87 offen offset:1024 sc1
  s_waitcnt lgkmcnt(8)
  v_mfma_f32_16x16x32_bf16 v[64:67], a[32:35], v[144:147], v[64:67]
  v_mul_f32 v37, v37, v244
  v_exp_f32 v19, v19
  v_mfma_f32_16x16x32_bf16 v[72:75], a[32:35], v[148:151], v[72:75]
  v_mul_f32 v38, v38, v244
  v_add_f32 v16, 1.0, v16
  v_add_f32 v17, 1.0, v17
  v_mfma_f32_16x16x32_bf16 v[68:71], a[36:39], v[144:147], v[68:71]
  v_mul_f32 v39, v39, v244
  v_add_f32 v18, 1.0, v18
  v_add_f32 v19, 1.0, v19
  v_mfma_f32_16x16x32_bf16 v[76:79], a[36:39], v[148:151], v[76:79]
  v_mul_f32 v40, v40, v245
  v_rcp_f32 v16, v16
  v_mfma_f32_16x16x32_bf16 v[64:67], a[40:43], v[160:163], v[64:67]
  v_mul_f32 v41, v41, v245
  v_rcp_f32 v17, v17
  v_mfma_f32_16x16x32_bf16 v[72:75], a[40:43], v[164:167], v[72:75]
  v_mul_f32 v42, v42, v245
  v_rcp_f32 v18, v18
  v_mfma_f32_16x16x32_bf16 v[68:71], a[44:47], v[160:163], v[68:71]
  v_mul_f32 v43, v43, v245
  v_rcp_f32 v19, v19
  v_mfma_f32_16x16x32_bf16 v[76:79], a[44:47], v[164:167], v[76:79]
  v_mul_f32 v80, v80, v16
  s_waitcnt lgkmcnt(0)
  v_mfma_f32_16x16x32_bf16 v[64:67], a[48:51], v[176:179], v[64:67]
  v_mul_f32 v44, v44, v245
  v_mul_f32 v81, v81, v17
  v_mul_f32 v82, v82, v18
  v_mfma_f32_16x16x32_bf16 v[72:75], a[48:51], v[180:183], v[72:75]
  v_mul_f32 v45, v45, v245
  s_add_u32 s87, s83, 8192
  buffer_load_dwordx4 v[184:187], v250, s[48:51], s87 offen offset:2048 sc1
  v_mfma_f32_16x16x32_bf16 v[68:71], a[52:55], v[176:179], v[68:71]
  v_mul_f32 v46, v46, v245
  v_mul_f32 v83, v83, v19
  v_mul_f32 v20, 0xbfb8aa3b, v84
  v_mfma_f32_16x16x32_bf16 v[76:79], a[52:55], v[180:183], v[76:79]
  v_mul_f32 v47, v47, v245
  v_mul_f32 v21, 0xbfb8aa3b, v85
  v_mul_f32 v22, 0xbfb8aa3b, v86
  v_mfma_f32_16x16x32_bf16 v[64:67], a[56:59], v[192:195], v[64:67]
  v_mul_f32 v23, 0xbfb8aa3b, v87
  v_exp_f32 v20, v20
  v_mfma_f32_16x16x32_bf16 v[72:75], a[56:59], v[196:199], v[72:75]
  s_add_u32 s87, s83, 8192
  buffer_load_dwordx4 v[188:191], v250, s[48:51], s87 offen offset:3072 sc1
  v_mfma_f32_16x16x32_bf16 v[68:71], a[60:63], v[192:195], v[68:71]
  v_exp_f32 v21, v21
  v_exp_f32 v22, v22
  v_mfma_f32_16x16x32_bf16 v[76:79], a[60:63], v[196:199], v[76:79]
  v_exp_f32 v23, v23
  v_add_f32 v20, 1.0, v20
  v_add_f32 v21, 1.0, v21
  v_mov_b64 v[244:245], v[246:247]
  s_branch L_tail
L_tail7:
  v_fmac_f32 v32, v64, v244
  v_fmac_f32 v33, v65, v244
  v_fmac_f32 v34, v66, v244
  v_fmac_f32 v35, v67, v244
  v_fmac_f32 v36, v68, v244
  v_fmac_f32 v37, v69, v244
  v_fmac_f32 v38, v70, v244
  v_fmac_f32 v39, v71, v244
  v_cvt_pk_bf16_f32 v208, v32, v33
  v_cvt_pk_bf16_f32 v209, v34, v35
  v_cvt_pk_bf16_f32 v210, v36, v37
  v_cvt_pk_bf16_f32 v211, v38, v39
  buffer_store_dwordx4 v[208:211], v250, s[48:51], s10 offen offset:0 sc1
  v_fmac_f32 v40, v72, v245
  v_fmac_f32 v41, v73, v245
  v_fmac_f32 v42, v74, v245
  v_fmac_f32 v43, v75, v245
  v_fmac_f32 v44, v76, v245
  v_fmac_f32 v45, v77, v245
  v_fmac_f32 v46, v78, v245
  v_fmac_f32 v47, v79, v245
  v_cvt_pk_bf16_f32 v212, v40, v41
  v_cvt_pk_bf16_f32 v213, v42, v43
  v_cvt_pk_bf16_f32 v214, v44, v45
  v_cvt_pk_bf16_f32 v215, v46, v47
  buffer_store_dwordx4 v[212:215], v250, s[48:51], s10 offen offset:1024 sc1
  s_branch L_fin
L_re3:
  s_waitcnt vmcnt(2)
  v_max_u32 v216, v96, v100
  v_cmp_eq_u32 vcc, -1, v216
  v_mov_b64 v[184:185], v[96:97]
  v_mov_b64 v[186:187], v[98:99]
  v_mov_b64 v[188:189], v[100:101]
  v_mov_b64 v[190:191], v[102:103]
  s_cbranch_vccz L_re3r
  s_waitcnt vmcnt(0)
  v_max_u32 v216, v112, v116
  v_cmp_eq_u32 vcc, -1, v216
  v_mov_b64 v[184:185], v[112:113]
  v_mov_b64 v[186:187], v[114:115]
  v_mov_b64 v[188:189], v[116:117]
  v_mov_b64 v[190:191], v[118:119]
  s_cbranch_vccz L_re3r
  s_mov_b32 s88, 0
L_re3l:
  s_add_u32 s87, s83, 8192
  buffer_load_dwordx4 v[184:187], v250, s[48:51], s87 offen offset:2048 sc1
  buffer_load_dwordx4 v[188:191], v250, s[48:51], s87 offen offset:3072 sc1
  s_add_u32 s88, s88, 1
  s_cmp_gt_u32 s88, 0x8000
  s_cbranch_scc1 L_re3r
  s_waitcnt vmcnt(0)
  v_max_u32 v216, v184, v188
  v_cmp_eq_u32 vcc, -1, v216
  s_nop 0
  s_cbranch_vccnz L_re3l
  s_branch L_re3r
L_re2:
  s_mov_b32 s88, 0
L_re2l:
  s_add_u32 s87, s83, 12288
  buffer_load_dwordx4 v[200:203], v250, s[48:51], s87 offen offset:0 sc1
  buffer_load_dwordx4 v[204:207], v250, s[48:51], s87 offen offset:1024 sc1
  s_add_u32 s88, s88, 1
  s_cmp_gt_u32 s88, 0x8000
  s_cbranch_scc1 L_re2r
  s_waitcnt vmcnt(0)
  v_max_u32 v216, v200, v204
  v_cmp_eq_u32 vcc, -1, v216
  s_nop 0
  s_cbranch_vccnz L_re2l
  s_branch L_re2r
L_re1:
  s_mov_b32 s88, 0
L_re1l:
  s_add_u32 s87, s83, 4096
  buffer_load_dwordx4 v[152:155], v250, s[48:51], s87 offen offset:2048 sc1
  buffer_load_dwordx4 v[156:159], v250, s[48:51], s87 offen offset:3072 sc1
  s_add_u32 s87, s83, 8192
  buffer_load_dwordx4 v[168:171], v250, s[48:51], s87 offen offset:0 sc1
  buffer_load_dwordx4 v[172:175], v250, s[48:51], s87 offen offset:1024 sc1
  s_add_u32 s88, s88, 1
  s_cmp_gt_u32 s88, 0x8000
  s_cbranch_scc1 L_re1r
  s_waitcnt vmcnt(2)
  v_max_u32 v216, v152, v156
  s_waitcnt vmcnt(0)
  v_max3_u32 v216, v216, v168, v172
  v_cmp_eq_u32 vcc, -1, v216
  s_nop 0
  s_cbranch_vccnz L_re1l
  s_branch L_re1r
L_re0:
  s_mov_b32 s88, 0
L_re0l:
  s_add_u32 s87, s83, 0
  buffer_load_dwordx4 v[104:107], v250, s[48:51], s87 offen offset:0 sc1
  buffer_load_dwordx4 v[108:111], v250, s[48:51], s87 offen offset:1024 sc1
  buffer_load_dwordx4 v[120:123], v250, s[48:51], s87 offen offset:2048 sc1
  buffer_load_dwordx4 v[124:127], v250, s[48:51], s87 offen offset:3072 sc1
  s_add_u32 s87, s83, 4096
  buffer_load_dwordx4 v[136:139], v250, s[48:51], s87 offen offset:0 sc1
  buffer_load_dwordx4 v[140:143], v250, s[48:51], s87 offen offset:1024 sc1
  s_add_u32 s88, s88, 1
  s_cmp_gt_u32 s88, 0x8000
  s_cbranch_scc1 L_re0r
  s_waitcnt vmcnt(4)
  v_max_u32 v216, v104, v108
  s_waitcnt vmcnt(2)
  v_max3_u32 v216, v216, v120, v124
  s_waitcnt vmcnt(0)
  v_max3_u32 v216, v216, v136, v140
  v_cmp_eq_u32 vcc, -1, v216
  s_nop 0
  s_cbranch_vccnz L_re0l
  s_branch L_re0r
L_pub0:
  v_mov_b64 v[16:17], 0
  v_mov_b64 v[18:19], 0
  s_lshl_b32 s87, s3, 10
  s_add_u32 s87, s87, 16777216
  s_cmp_lt_u32 s71, 4
  s_cselect_b32 s87, s87, 2146435072
  buffer_store_dwordx4 v[16:19], v250, s[48:51], s87 offen sc1
  s_branch L_pub0r
L_pub1:
  s_lshl_b32 s87, s71, 9
  s_add_u32 s87, s87, 16842752
  v_lshlrev_b32 v254, 3, v30
  buffer_store_dwordx2 v[16:17], v254, s[48:51], s87 offen sc1
  s_branch L_pub1r
L_pub2:
  v_add_u32 v254, 145408, v250
  ds_read_b32 v253, v254 offset:8
  s_lshl_b32 s87, s71, 6
  s_sub_u32 s87, 0xffff, s87
  v_sub_u32 v252, s87, v251
  s_waitcnt lgkmcnt(0)
  v_cvt_pk_bf16_f32 v253, 0, v253
  v_ashrrev_i32 v254, 31, v253
  v_or_b32 v254, 0x80000000, v254
  v_xor_b32 v253, v253, v254
  v_and_b32 v253, 0xffff0000, v253
  v_or_b32 v253, v253, v252
  v_mov_b32 v252, v253
  s_nop 1
  v_max_u32_dpp v252, v252, v252 quad_perm:[1,0,3,2] row_mask:0xf bank_mask:0xf
  s_nop 1
  v_max_u32_dpp v252, v252, v252 quad_perm:[2,3,0,1] row_mask:0xf bank_mask:0xf
  s_nop 1
  v_max_u32_dpp v252, v252, v252 row_half_mirror row_mask:0xf bank_mask:0xf
  s_nop 1
  v_max_u32_dpp v252, v252, v252 row_mirror row_mask:0xf bank_mask:0xf
  v_mov_b32 v254, v252
  s_nop 1
  v_permlane16_swap_b32 v252, v254
  v_max_u32 v252, v252, v254
  v_mov_b32 v254, v252
  s_nop 1
  v_permlane32_swap_b32 v252, v254
  v_max_u32 v252, v252, v254
  v_cmp_eq_u32_e64 s[90:91], v252, v253
  s_nop 1
  v_cndmask_b32_e64 v253, v253, 0, s[90:91]
  s_nop 1
  v_max_u32_dpp v253, v253, v253 quad_perm:[1,0,3,2] row_mask:0xf bank_mask:0xf
  s_nop 1
  v_max_u32_dpp v253, v253, v253 quad_perm:[2,3,0,1] row_mask:0xf bank_mask:0xf
  s_nop 1
  v_max_u32_dpp v253, v253, v253 row_half_mirror row_mask:0xf bank_mask:0xf
  s_nop 1
  v_max_u32_dpp v253, v253, v253 row_mirror row_mask:0xf bank_mask:0xf
  v_mov_b32 v254, v253
  s_nop 1
  v_permlane16_swap_b32 v253, v254
  v_max_u32 v253, v253, v254
  v_mov_b32 v254, v253
  s_nop 1
  v_permlane32_swap_b32 v253, v254
  v_max_u32 v253, v253, v254
  s_lshl_b32 s87, s71, 3
  v_lshlrev_b32 v254, 20, v251
  buffer_store_dwordx2 v[252:253], v254, s[56:59], s87 offen sc1
  s_branch L_pub2r
L_st15:
  s_call_b64 s[98:99], L_fix0
  s_branch L_rt15
L_st17:
  s_call_b64 s[98:99], L_fixa
  s_branch L_rt17
L_st19:
  s_call_b64 s[98:99], L_fixb
  s_branch L_rt19
L_st21:
  s_call_b64 s[98:99], L_fixa
  s_branch L_rt21
L_st23:
  s_call_b64 s[98:99], L_fixb
  s_branch L_rt23
L_st25:
  s_call_b64 s[98:99], L_fixa
  s_branch L_rt25
L_st27:
  s_call_b64 s[98:99], L_fixb
  s_branch L_rt27
L_st29:
  s_call_b64 s[98:99], L_fixa
  s_branch L_rt29
L_st31:
  s_call_b64 s[98:99], L_fixb
  s_branch L_rt31
L_st33:
  s_call_b64 s[98:99], L_fixa
  s_branch L_rt33
L_st35:
  s_call_b64 s[98:99], L_fixb
  s_branch L_rt35
L_st37:
  s_call_b64 s[98:99], L_fixa
  s_branch L_rt37
L_st39:
  s_call_b64 s[98:99], L_fixb
  s_branch L_rt39
L_st41:
  s_call_b64 s[98:99], L_fixa
  s_branch L_rt41
L_st43:
  s_call_b64 s[98:99], L_fixb
  s_branch L_rt43
L_st44:
  s_call_b64 s[98:99], L_fixl
  s_branch L_rt44
L_spin1:
  s_mov_b32 s87, 0
L_spin1l:
  s_sleep 2
  buffer_load_dword v208, v209, s[56:59], 0 offen sc1
  s_add_u32 s87, s87, 1
  s_cmp_gt_u32 s87, 0x10000
  s_cbranch_scc1 L_spin1r
  s_waitcnt vmcnt(0)
  v_cmp_eq_u32_e64 s[90:91], 0, v208
  s_nop 0
  s_cmp_lg_u64 s[90:91], 0
  s_cbranch_scc1 L_spin1l
  s_branch L_spin1r
L_spin2:
  s_mov_b32 s87, 0
L_spin2l:
  s_sleep 2
  buffer_load_dword v217, v216, s[48:51], s97 offen sc1
  s_add_u32 s87, s87, 1
  s_cmp_gt_u32 s87, 0x10000
  s_cbranch_scc1 L_spin2r
  s_waitcnt vmcnt(0)
  v_cmp_ne_u32_e64 s[90:91], s96, v217
  s_nop 0
  s_cmp_lg_u64 s[90:91], 0
  s_cbranch_scc1 L_spin2l
  s_branch L_spin2r
L_spin2b:
  s_mov_b32 s87, 0
L_spin2lb:
  s_sleep 2
  buffer_load_dword v217, v216, s[48:51], s97 offen sc1
  s_add_u32 s87, s87, 1
  s_cmp_gt_u32 s87, 0x10000
  s_cbranch_scc1 L_spin2rb
  s_waitcnt vmcnt(0)
  v_cmp_ne_u32_e64 s[90:91], s96, v217
  s_nop 0
  s_cmp_lg_u64 s[90:91], 0
  s_cbranch_scc1 L_spin2lb
  s_branch L_spin2rb
L_ys1:
  v_bfe_u32 v217, v251, 2, 2
  v_lshl_add_u32 v217, v217, 12, v253
  v_bfe_u32 v216, v251, 1, 1
  v_lshl_add_u32 v217, v216, 5, v217
  v_and_b32 v216, 1, v251
  v_mul_u32_u24 v216, 896, v216
  v_add_u32 v217, v217, v216
  s_add_u32 s87, s15, 16777216
  buffer_load_dwordx2 v[24:25], v217, s[48:51], s87 offen offset:0 sc1
  buffer_load_dwordx2 v[26:27], v217, s[48:51], s87 offen offset:1792 sc1
  s_ashr_i32 s90, s85, 31
  s_ashr_i32 s96, s86, 31
  s_orn2_b32 s90, 0x80000000, s90
  s_orn2_b32 s96, 0x80000000, s96
  s_xor_b32 s90, s90, s85
  s_xor_b32 s96, s96, s86
  s_and_b32 s90, s90, 0xffff0000
  s_and_b32 s96, s96, 0xffff0000
  v_mov_b32 v222, 0xbfb8aa3b
  v_mov_b32 v223, 0xbfb8aa3b
  v_mul_f32 v222, s90, v222
  v_mul_f32 v223, s96, v223
  s_andn2_b32 s90, 2031, s85
  s_andn2_b32 s96, 2031, s86
  v_exp_f32 v222, v222
  v_exp_f32 v223, v223
  v_cmp_eq_u32_e64 s[90:91], s90, v252
  v_cmp_eq_u32_e64 s[96:97], s96, v252
  v_add_f32 v222, 1.0, v222
  v_add_f32 v223, 1.0, v223
  v_rcp_f32 v222, v222
  v_rcp_f32 v223, v223
  v_cvt_pk_bf16_f32 v222, 0, v222
  v_cvt_pk_bf16_f32 v223, 0, v223
  v_cndmask_b32_e64 v222, 0, v222, s[90:91]
  v_cndmask_b32_e64 v223, 0, v223, s[96:97]
  s_branch L_ys1r
L_ys1b:
  v_bfe_u32 v217, v251, 2, 2
  v_lshl_add_u32 v217, v217, 12, v253
  v_bfe_u32 v216, v251, 1, 1
  v_lshl_add_u32 v217, v216, 5, v217
  v_and_b32 v216, 1, v251
  v_mul_u32_u24 v216, 896, v216
  v_add_u32 v217, v217, v216
  s_add_u32 s87, s15, 16777216
  buffer_load_dwordx2 v[24:25], v217, s[48:51], s87 offen offset:0 sc1
  buffer_load_dwordx2 v[26:27], v217, s[48:51], s87 offen offset:1792 sc1
  s_ashr_i32 s90, s85, 31
  s_ashr_i32 s96, s86, 31
  s_orn2_b32 s90, 0x80000000, s90
  s_orn2_b32 s96, 0x80000000, s96
  s_xor_b32 s90, s90, s85
  s_xor_b32 s96, s96, s86
  s_and_b32 s90, s90, 0xffff0000
  s_and_b32 s96, s96, 0xffff0000
  v_mov_b32 v222, 0xbfb8aa3b
  v_mov_b32 v223, 0xbfb8aa3b
  v_mul_f32 v222, s90, v222
  v_mul_f32 v223, s96, v223
  s_andn2_b32 s90, 2031, s85
  s_andn2_b32 s96, 2031, s86
  v_exp_f32 v222, v222
  v_exp_f32 v223, v223
  v_cmp_eq_u32_e64 s[90:91], s90, v252
  v_cmp_eq_u32_e64 s[96:97], s96, v252
  v_add_f32 v222, 1.0, v222
  v_add_f32 v223, 1.0, v223
  v_rcp_f32 v222, v222
  v_rcp_f32 v223, v223
  v_cvt_pk_bf16_f32 v222, 0, v222
  v_cvt_pk_bf16_f32 v223, 0, v223
  v_cndmask_b32_e64 v222, 0, v222, s[90:91]
  v_cndmask_b32_e64 v223, 0, v223, s[96:97]
  s_branch L_ys1rb
L_ys2:
  v_add_f32_dpp v24, v24, v24 row_ror:4 row_mask:0xf bank_mask:0xf
  v_add_f32_dpp v25, v25, v25 row_ror:4 row_mask:0xf bank_mask:0xf
  s_waitcnt vmcnt(13)
  v_add_f32_dpp v26, v26, v26 row_ror:4 row_mask:0xf bank_mask:0xf
  v_add_f32_dpp v27, v27, v27 row_ror:4 row_mask:0xf bank_mask:0xf
  v_add_f32_dpp v24, v24, v24 row_ror:8 row_mask:0xf bank_mask:0xf
  v_add_f32_dpp v25, v25, v25 row_ror:8 row_mask:0xf bank_mask:0xf
  v_add_f32_dpp v26, v26, v26 row_ror:8 row_mask:0xf bank_mask:0xf
  v_add_f32_dpp v27, v27, v27 row_ror:8 row_mask:0xf bank_mask:0xf
  s_bitcmp0_b32 s85, 4
  s_cbranch_scc1 L_yc0a
  v_fmac_f32_dpp v80, v24, v222 quad_perm:[0,0,0,0] row_mask:0xf bank_mask:0xf
  v_fmac_f32_dpp v81, v24, v222 quad_perm:[1,1,1,1] row_mask:0xf bank_mask:0xf
  v_fmac_f32_dpp v82, v25, v222 quad_perm:[0,0,0,0] row_mask:0xf bank_mask:0xf
  v_fmac_f32_dpp v83, v25, v222 quad_perm:[1,1,1,1] row_mask:0xf bank_mask:0xf
  v_fmac_f32_dpp v84, v24, v222 quad_perm:[2,2,2,2] row_mask:0xf bank_mask:0xf
  v_fmac_f32_dpp v85, v24, v222 quad_perm:[3,3,3,3] row_mask:0xf bank_mask:0xf
  v_fmac_f32_dpp v86, v25, v222 quad_perm:[2,2,2,2] row_mask:0xf bank_mask:0xf
  v_fmac_f32_dpp v87, v25, v222 quad_perm:[3,3,3,3] row_mask:0xf bank_mask:0xf
  s_branch L_yd0a
L_yc0a:
  v_fmac_f32_dpp v88, v24, v222 quad_perm:[0,0,0,0] row_mask:0xf bank_mask:0xf
  v_fmac_f32_dpp v89, v24, v222 quad_perm:[1,1,1,1] row_mask:0xf bank_mask:0xf
  v_fmac_f32_dpp v90, v25, v222 quad_perm:[0,0,0,0] row_mask:0xf bank_mask:0xf
  v_fmac_f32_dpp v91, v25, v222 quad_perm:[1,1,1,1] row_mask:0xf bank_mask:0xf
  v_fmac_f32_dpp v92, v24, v222 quad_perm:[2,2,2,2] row_mask:0xf bank_mask:0xf
  v_fmac_f32_dpp v93, v24, v222 quad_perm:[3,3,3,3] row_mask:0xf bank_mask:0xf
  v_fmac_f32_dpp v94, v25, v222 quad_perm:[2,2,2,2] row_mask:0xf bank_mask:0xf
  v_fmac_f32_dpp v95, v25, v222 quad_perm:[3,3,3,3] row_mask:0xf bank_mask:0xf
L_yd0a:
  s_bitcmp0_b32 s86, 4
  s_cbranch_scc1 L_yc1a
  v_fmac_f32_dpp v80, v26, v223 quad_perm:[0,0,0,0] row_mask:0xf bank_mask:0xf
  v_fmac_f32_dpp v81, v26, v223 quad_perm:[1,1,1,1] row_mask:0xf bank_mask:0xf
  v_fmac_f32_dpp v82, v27, v223 quad_perm:[0,0,0,0] row_mask:0xf bank_mask:0xf
  v_fmac_f32_dpp v83, v27, v223 quad_perm:[1,1,1,1] row_mask:0xf bank_mask:0xf
  v_fmac_f32_dpp v84, v26, v223 quad_perm:[2,2,2,2] row_mask:0xf bank_mask:0xf
  v_fmac_f32_dpp v85, v26, v223 quad_perm:[3,3,3,3] row_mask:0xf bank_mask:0xf
  v_fmac_f32_dpp v86, v27, v223 quad_perm:[2,2,2,2] row_mask:0xf bank_mask:0xf
  v_fmac_f32_dpp v87, v27, v223 quad_perm:[3,3,3,3] row_mask:0xf bank_mask:0xf
  s_branch L_yd1a
L_yc1a:
  v_fmac_f32_dpp v88, v26, v223 quad_perm:[0,0,0,0] row_mask:0xf bank_mask:0xf
  v_fmac_f32_dpp v89, v26, v223 quad_perm:[1,1,1,1] row_mask:0xf bank_mask:0xf
  v_fmac_f32_dpp v90, v27, v223 quad_perm:[0,0,0,0] row_mask:0xf bank_mask:0xf
  v_fmac_f32_dpp v91, v27, v223 quad_perm:[1,1,1,1] row_mask:0xf bank_mask:0xf
  v_fmac_f32_dpp v92, v26, v223 quad_perm:[2,2,2,2] row_mask:0xf bank_mask:0xf
  v_fmac_f32_dpp v93, v26, v223 quad_perm:[3,3,3,3] row_mask:0xf bank_mask:0xf
  v_fmac_f32_dpp v94, v27, v223 quad_perm:[2,2,2,2] row_mask:0xf bank_mask:0xf
  v_fmac_f32_dpp v95, v27, v223 quad_perm:[3,3,3,3] row_mask:0xf bank_mask:0xf
L_yd1a:
  s_branch L_ys2r
L_ys2b:
  v_add_f32_dpp v24, v24, v24 row_ror:4 row_mask:0xf bank_mask:0xf
  v_add_f32_dpp v25, v25, v25 row_ror:4 row_mask:0xf bank_mask:0xf
  s_waitcnt vmcnt(13)
  v_add_f32_dpp v26, v26, v26 row_ror:4 row_mask:0xf bank_mask:0xf
  v_add_f32_dpp v27, v27, v27 row_ror:4 row_mask:0xf bank_mask:0xf
  v_add_f32_dpp v24, v24, v24 row_ror:8 row_mask:0xf bank_mask:0xf
  v_add_f32_dpp v25, v25, v25 row_ror:8 row_mask:0xf bank_mask:0xf
  v_add_f32_dpp v26, v26, v26 row_ror:8 row_mask:0xf bank_mask:0xf
  v_add_f32_dpp v27, v27, v27 row_ror:8 row_mask:0xf bank_mask:0xf
  s_bitcmp0_b32 s85, 4
  s_cbranch_scc1 L_yc0b
  v_fmac_f32_dpp v80, v24, v222 quad_perm:[0,0,0,0] row_mask:0xf bank_mask:0xf
  v_fmac_f32_dpp v81, v24, v222 quad_perm:[1,1,1,1] row_mask:0xf bank_mask:0xf
  v_fmac_f32_dpp v82, v25, v222 quad_perm:[0,0,0,0] row_mask:0xf bank_mask:0xf
  v_fmac_f32_dpp v83, v25, v222 quad_perm:[1,1,1,1] row_mask:0xf bank_mask:0xf
  v_fmac_f32_dpp v84, v24, v222 quad_perm:[2,2,2,2] row_mask:0xf bank_mask:0xf
  v_fmac_f32_dpp v85, v24, v222 quad_perm:[3,3,3,3] row_mask:0xf bank_mask:0xf
  v_fmac_f32_dpp v86, v25, v222 quad_perm:[2,2,2,2] row_mask:0xf bank_mask:0xf
  v_fmac_f32_dpp v87, v25, v222 quad_perm:[3,3,3,3] row_mask:0xf bank_mask:0xf
  s_branch L_yd0b
L_yc0b:
  v_fmac_f32_dpp v88, v24, v222 quad_perm:[0,0,0,0] row_mask:0xf bank_mask:0xf
  v_fmac_f32_dpp v89, v24, v222 quad_perm:[1,1,1,1] row_mask:0xf bank_mask:0xf
  v_fmac_f32_dpp v90, v25, v222 quad_perm:[0,0,0,0] row_mask:0xf bank_mask:0xf
  v_fmac_f32_dpp v91, v25, v222 quad_perm:[1,1,1,1] row_mask:0xf bank_mask:0xf
  v_fmac_f32_dpp v92, v24, v222 quad_perm:[2,2,2,2] row_mask:0xf bank_mask:0xf
  v_fmac_f32_dpp v93, v24, v222 quad_perm:[3,3,3,3] row_mask:0xf bank_mask:0xf
  v_fmac_f32_dpp v94, v25, v222 quad_perm:[2,2,2,2] row_mask:0xf bank_mask:0xf
  v_fmac_f32_dpp v95, v25, v222 quad_perm:[3,3,3,3] row_mask:0xf bank_mask:0xf
L_yd0b:
  s_bitcmp0_b32 s86, 4
  s_cbranch_scc1 L_yc1b
  v_fmac_f32_dpp v80, v26, v223 quad_perm:[0,0,0,0] row_mask:0xf bank_mask:0xf
  v_fmac_f32_dpp v81, v26, v223 quad_perm:[1,1,1,1] row_mask:0xf bank_mask:0xf
  v_fmac_f32_dpp v82, v27, v223 quad_perm:[0,0,0,0] row_mask:0xf bank_mask:0xf
  v_fmac_f32_dpp v83, v27, v223 quad_perm:[1,1,1,1] row_mask:0xf bank_mask:0xf
  v_fmac_f32_dpp v84, v26, v223 quad_perm:[2,2,2,2] row_mask:0xf bank_mask:0xf
  v_fmac_f32_dpp v85, v26, v223 quad_perm:[3,3,3,3] row_mask:0xf bank_mask:0xf
  v_fmac_f32_dpp v86, v27, v223 quad_perm:[2,2,2,2] row_mask:0xf bank_mask:0xf
  v_fmac_f32_dpp v87, v27, v223 quad_perm:[3,3,3,3] row_mask:0xf bank_mask:0xf
  s_branch L_yd1b
L_yc1b:
  v_fmac_f32_dpp v88, v26, v223 quad_perm:[0,0,0,0] row_mask:0xf bank_mask:0xf
  v_fmac_f32_dpp v89, v26, v223 quad_perm:[1,1,1,1] row_mask:0xf bank_mask:0xf
  v_fmac_f32_dpp v90, v27, v223 quad_perm:[0,0,0,0] row_mask:0xf bank_mask:0xf
  v_fmac_f32_dpp v91, v27, v223 quad_perm:[1,1,1,1] row_mask:0xf bank_mask:0xf
  v_fmac_f32_dpp v92, v26, v223 quad_perm:[2,2,2,2] row_mask:0xf bank_mask:0xf
  v_fmac_f32_dpp v93, v26, v223 quad_perm:[3,3,3,3] row_mask:0xf bank_mask:0xf
  v_fmac_f32_dpp v94, v27, v223 quad_perm:[2,2,2,2] row_mask:0xf bank_mask:0xf
  v_fmac_f32_dpp v95, v27, v223 quad_perm:[3,3,3,3] row_mask:0xf bank_mask:0xf
L_yd1b:
  s_branch L_ys2rb
L_codeend:
L_fix0:
  s_nop 15
  v_max3_f32 v248, v32, v33, v34
  v_max3_f32 v248, v248, v35, v36
  v_max3_f32 v248, v248, v37, v38
  v_max_f32 v248, v248, v39
  v_max3_f32 v74, v40, v41, v42
  v_max3_f32 v74, v74, v43, v44
  v_max3_f32 v74, v74, v45, v46
  v_max_f32 v74, v74, v47
  v_mov_b32 v252, v248
  s_nop 1
  v_permlane16_swap_b32 v248, v252
  v_max_f32 v248, v248, v252
  v_mov_b32 v252, v248
  s_nop 1
  v_permlane32_swap_b32 v248, v252
  v_max_f32 v248, v248, v252
  v_mov_b32 v252, v74
  s_nop 1
  v_permlane16_swap_b32 v74, v252
  v_max_f32 v74, v74, v252
  v_mov_b32 v252, v74
  s_nop 1
  v_permlane32_swap_b32 v74, v252
  v_max_f32 v74, v74, v252
  v_sub_f32 v64, v64, v248
  v_sub_f32 v32, v32, v248
  v_sub_f32 v48, v48, v248
  v_sub_f32 v65, v65, v248
  v_sub_f32 v33, v33, v248
  v_sub_f32 v49, v49, v248
  v_sub_f32 v66, v66, v248
  v_sub_f32 v34, v34, v248
  v_sub_f32 v50, v50, v248
  v_sub_f32 v67, v67, v248
  v_sub_f32 v35, v35, v248
  v_sub_f32 v51, v51, v248
  v_sub_f32 v68, v68, v74
  v_sub_f32 v36, v36, v248
  v_sub_f32 v52, v52, v248
  v_sub_f32 v69, v69, v74
  v_sub_f32 v37, v37, v248
  v_sub_f32 v53, v53, v248
  v_sub_f32 v70, v70, v74
  v_sub_f32 v38, v38, v248
  v_sub_f32 v54, v54, v248
  v_sub_f32 v71, v71, v74
  v_sub_f32 v39, v39, v248
  v_sub_f32 v55, v55, v248
  v_sub_f32 v40, v40, v74
  v_sub_f32 v56, v56, v74
  v_sub_f32 v41, v41, v74
  v_sub_f32 v57, v57, v74
  v_sub_f32 v42, v42, v74
  v_sub_f32 v58, v58, v74
  v_sub_f32 v43, v43, v74
  v_sub_f32 v59, v59, v74
  v_sub_f32 v44, v44, v74
  v_sub_f32 v60, v60, v74
  v_sub_f32 v45, v45, v74
  v_sub_f32 v61, v61, v74
  v_sub_f32 v46, v46, v74
  v_sub_f32 v62, v62, v74
  v_sub_f32 v47, v47, v74
  v_sub_f32 v63, v63, v74
  v_exp_f32 v242, v32
  v_exp_f32 v243, v33
  v_exp_f32 v244, v34
  v_add_f32 v72, v242, v243
  v_exp_f32 v245, v35
  v_cvt_pk_bf16_f32 v80, v242, v243
  v_exp_f32 v242, v36
  v_add_f32 v72, v72, v244
  v_add_f32 v72, v72, v245
  v_exp_f32 v243, v37
  v_cvt_pk_bf16_f32 v81, v244, v245
  v_exp_f32 v244, v38
  v_add_f32 v72, v72, v242
  v_add_f32 v72, v72, v243
  v_exp_f32 v245, v39
  v_cvt_pk_bf16_f32 v82, v242, v243
  v_exp_f32 v242, v40
  v_add_f32 v72, v72, v244
  v_add_f32 v72, v72, v245
  v_exp_f32 v243, v41
  v_cvt_pk_bf16_f32 v83, v244, v245
  v_exp_f32 v244, v42
  v_add_f32 v73, v242, v243
  v_exp_f32 v245, v43
  v_cvt_pk_bf16_f32 v84, v242, v243
  v_exp_f32 v242, v44
  v_add_f32 v73, v73, v244
  v_add_f32 v73, v73, v245
  v_exp_f32 v243, v45
  v_cvt_pk_bf16_f32 v85, v244, v245
  v_exp_f32 v244, v46
  v_add_f32 v73, v73, v242
  v_add_f32 v73, v73, v243
  v_exp_f32 v245, v47
  v_cvt_pk_bf16_f32 v86, v242, v243
  v_add_f32 v73, v73, v244
  v_add_f32 v73, v73, v245
  v_cvt_pk_bf16_f32 v87, v244, v245
  s_nop 3
  s_setpc_b64 s[98:99]
L_fixa:
  s_nop 15
  v_max3_f32 v248, v48, v49, v50
  v_max3_f32 v248, v248, v51, v52
  v_max3_f32 v248, v248, v53, v54
  v_max_f32 v248, v248, v55
  v_max3_f32 v74, v56, v57, v58
  v_max3_f32 v74, v74, v59, v60
  v_max3_f32 v74, v74, v61, v62
  v_max_f32 v74, v74, v63
  v_mov_b32 v252, v248
  s_nop 1
  v_permlane16_swap_b32 v248, v252
  v_max_f32 v248, v248, v252
  v_mov_b32 v252, v248
  s_nop 1
  v_permlane32_swap_b32 v248, v252
  v_max_f32 v248, v248, v252
  v_mov_b32 v252, v74
  s_nop 1
  v_permlane16_swap_b32 v74, v252
  v_max_f32 v74, v74, v252
  v_mov_b32 v252, v74
  s_nop 1
  v_permlane32_swap_b32 v74, v252
  v_max_f32 v74, v74, v252
  v_max_f32 v248, 0, v248
  v_exp_f32 v242, -v248
  v_max_f32 v74, 0, v74
  v_exp_f32 v243, -v74
  v_mul_f32 v96, v96, v242
  v_mul_f32 v97, v97, v242
  v_mul_f32 v98, v98, v242
  v_mul_f32 v99, v99, v242
  v_mul_f32 v100, v100, v242
  v_mul_f32 v101, v101, v242
  v_mul_f32 v102, v102, v242
  v_mul_f32 v103, v103, v242
  v_mul_f32 v104, v104, v243
  v_mul_f32 v105, v105, v243
  v_mul_f32 v106, v106, v243
  v_mul_f32 v107, v107, v243
  v_mul_f32 v108, v108, v243
  v_mul_f32 v109, v109, v243
  v_mul_f32 v110, v110, v243
  v_mul_f32 v111, v111, v243
  v_mul_f32 v112, v112, v242
  v_mul_f32 v113, v113, v242
  v_mul_f32 v114, v114, v242
  v_mul_f32 v115, v115, v242
  v_mul_f32 v116, v116, v242
  v_mul_f32 v117, v117, v242
  v_mul_f32 v118, v118, v242
  v_mul_f32 v119, v119, v242
  v_mul_f32 v120, v120, v243
  v_mul_f32 v121, v121, v243
  v_mul_f32 v122, v122, v243
  v_mul_f32 v123, v123, v243
  v_mul_f32 v124, v124, v243
  v_mul_f32 v125, v125, v243
  v_mul_f32 v126, v126, v243
  v_mul_f32 v127, v127, v243
  v_mul_f32 v128, v128, v242
  v_mul_f32 v129, v129, v242
  v_mul_f32 v130, v130, v242
  v_mul_f32 v131, v131, v242
  v_mul_f32 v132, v132, v242
  v_mul_f32 v133, v133, v242
  v_mul_f32 v134, v134, v242
  v_mul_f32 v135, v135, v242
  v_mul_f32 v136, v136, v243
  v_mul_f32 v137, v137, v243
  v_mul_f32 v138, v138, v243
  v_mul_f32 v139, v139, v243
  v_mul_f32 v140, v140, v243
  v_mul_f32 v141, v141, v243
  v_mul_f32 v142, v142, v243
  v_mul_f32 v143, v143, v243
  v_mul_f32 v144, v144, v242
  v_mul_f32 v145, v145, v242
  v_mul_f32 v146, v146, v242
  v_mul_f32 v147, v147, v242
  v_mul_f32 v148, v148, v242
  v_mul_f32 v149, v149, v242
  v_mul_f32 v150, v150, v242
  v_mul_f32 v151, v151, v242
  v_mul_f32 v152, v152, v243
  v_mul_f32 v153, v153, v243
  v_mul_f32 v154, v154, v243
  v_mul_f32 v155, v155, v243
  v_mul_f32 v156, v156, v243
  v_mul_f32 v157, v157, v243
  v_mul_f32 v158, v158, v243
  v_mul_f32 v159, v159, v243
  v_mul_f32 v160, v160, v242
  v_mul_f32 v161, v161, v242
  v_mul_f32 v162, v162, v242
  v_mul_f32 v163, v163, v242
  v_mul_f32 v164, v164, v242
  v_mul_f32 v165, v165, v242
  v_mul_f32 v166, v166, v242
  v_mul_f32 v167, v167, v242
  v_mul_f32 v168, v168, v243
  v_mul_f32 v169, v169, v243
  v_mul_f32 v170, v170, v243
  v_mul_f32 v171, v171, v243
  v_mul_f32 v172, v172, v243
  v_mul_f32 v173, v173, v243
  v_mul_f32 v174, v174, v243
  v_mul_f32 v175, v175, v243
  v_mul_f32 v176, v176, v242
  v_mul_f32 v177, v177, v242
  v_mul_f32 v178, v178, v242
  v_mul_f32 v179, v179, v242
  v_mul_f32 v180, v180, v242
  v_mul_f32 v181, v181, v242
  v_mul_f32 v182, v182, v242
  v_mul_f32 v183, v183, v242
  v_mul_f32 v184, v184, v243
  v_mul_f32 v185, v185, v243
  v_mul_f32 v186, v186, v243
  v_mul_f32 v187, v187, v243
  v_mul_f32 v188, v188, v243
  v_mul_f32 v189, v189, v243
  v_mul_f32 v190, v190, v243
  v_mul_f32 v191, v191, v243
  v_mul_f32 v192, v192, v242
  v_mul_f32 v193, v193, v242
  v_mul_f32 v194, v194, v242
  v_mul_f32 v195, v195, v242
  v_mul_f32 v196, v196, v242
  v_mul_f32 v197, v197, v242
  v_mul_f32 v198, v198, v242
  v_mul_f32 v199, v199, v242
  v_mul_f32 v200, v200, v243
  v_mul_f32 v201, v201, v243
  v_mul_f32 v202, v202, v243
  v_mul_f32 v203, v203, v243
  v_mul_f32 v204, v204, v243
  v_mul_f32 v205, v205, v243
  v_mul_f32 v206, v206, v243
  v_mul_f32 v207, v207, v243
  v_accvgpr_read_b32 v253, a96
  v_mul_f32 v253, v253, v242
  v_accvgpr_write_b32 a96, v253
  v_accvgpr_read_b32 v253, a97
  v_mul_f32 v253, v253, v242
  v_accvgpr_write_b32 a97, v253
  v_accvgpr_read_b32 v253, a98
  v_mul_f32 v253, v253, v242
  v_accvgpr_write_b32 a98, v253
  v_accvgpr_read_b32 v253, a99
  v_mul_f32 v253, v253, v242
  v_accvgpr_write_b32 a99, v253
  v_accvgpr_read_b32 v253, a100
  v_mul_f32 v253, v253, v242
  v_accvgpr_write_b32 a100, v253
  v_accvgpr_read_b32 v253, a101
  v_mul_f32 v253, v253, v242
  v_accvgpr_write_b32 a101, v253
  v_accvgpr_read_b32 v253, a102
  v_mul_f32 v253, v253, v242
  v_accvgpr_write_b32 a102, v253
  v_accvgpr_read_b32 v253, a103
  v_mul_f32 v253, v253, v242
  v_accvgpr_write_b32 a103, v253
  v_accvgpr_read_b32 v253, a104
  v_mul_f32 v253, v253, v243
  v_accvgpr_write_b32 a104, v253
  v_accvgpr_read_b32 v253, a105
  v_mul_f32 v253, v253, v243
  v_accvgpr_write_b32 a105, v253
  v_accvgpr_read_b32 v253, a106
  v_mul_f32 v253, v253, v243
  v_accvgpr_write_b32 a106, v253
  v_accvgpr_read_b32 v253, a107
  v_mul_f32 v253, v253, v243
  v_accvgpr_write_b32 a107, v253
  v_accvgpr_read_b32 v253, a108
  v_mul_f32 v253, v253, v243
  v_accvgpr_write_b32 a108, v253
  v_accvgpr_read_b32 v253, a109
  v_mul_f32 v253, v253, v243
  v_accvgpr_write_b32 a109, v253
  v_accvgpr_read_b32 v253, a110
  v_mul_f32 v253, v253, v243
  v_accvgpr_write_b32 a110, v253
  v_accvgpr_read_b32 v253, a111
  v_mul_f32 v253, v253, v243
  v_accvgpr_write_b32 a111, v253
  v_mul_f32 v246, v246, v242
  v_mul_f32 v247, v247, v243
  v_sub_f32 v64, v64, v248
  v_sub_f32 v48, v48, v248
  v_sub_f32 v32, v32, v248
  v_sub_f32 v65, v65, v248
  v_sub_f32 v49, v49, v248
  v_sub_f32 v33, v33, v248
  v_sub_f32 v66, v66, v248
  v_sub_f32 v50, v50, v248
  v_sub_f32 v34, v34, v248
  v_sub_f32 v67, v67, v248
  v_sub_f32 v51, v51, v248
  v_sub_f32 v35, v35, v248
  v_sub_f32 v68, v68, v74
  v_sub_f32 v52, v52, v248
  v_sub_f32 v36, v36, v248
  v_sub_f32 v69, v69, v74
  v_sub_f32 v53, v53, v248
  v_sub_f32 v37, v37, v248
  v_sub_f32 v70, v70, v74
  v_sub_f32 v54, v54, v248
  v_sub_f32 v38, v38, v248
  v_sub_f32 v71, v71, v74
  v_sub_f32 v55, v55, v248
  v_sub_f32 v39, v39, v248
  v_sub_f32 v56, v56, v74
  v_sub_f32 v40, v40, v74
  v_sub_f32 v57, v57, v74
  v_sub_f32 v41, v41, v74
  v_sub_f32 v58, v58, v74
  v_sub_f32 v42, v42, v74
  v_sub_f32 v59, v59, v74
  v_sub_f32 v43, v43, v74
  v_sub_f32 v60, v60, v74
  v_sub_f32 v44, v44, v74
  v_sub_f32 v61, v61, v74
  v_sub_f32 v45, v45, v74
  v_sub_f32 v62, v62, v74
  v_sub_f32 v46, v46, v74
  v_sub_f32 v63, v63, v74
  v_sub_f32 v47, v47, v74
  v_exp_f32 v242, v48
  v_exp_f32 v243, v49
  v_exp_f32 v244, v50
  v_add_f32 v72, v242, v243
  v_exp_f32 v245, v51
  v_cvt_pk_bf16_f32 v88, v242, v243
  v_exp_f32 v242, v52
  v_add_f32 v72, v72, v244
  v_add_f32 v72, v72, v245
  v_exp_f32 v243, v53
  v_cvt_pk_bf16_f32 v89, v244, v245
  v_exp_f32 v244, v54
  v_add_f32 v72, v72, v242
  v_add_f32 v72, v72, v243
  v_exp_f32 v245, v55
  v_cvt_pk_bf16_f32 v90, v242, v243
  v_exp_f32 v242, v56
  v_add_f32 v72, v72, v244
  v_add_f32 v72, v72, v245
  v_exp_f32 v243, v57
  v_cvt_pk_bf16_f32 v91, v244, v245
  v_exp_f32 v244, v58
  v_add_f32 v73, v242, v243
  v_exp_f32 v245, v59
  v_cvt_pk_bf16_f32 v92, v242, v243
  v_exp_f32 v242, v60
  v_add_f32 v73, v73, v244
  v_add_f32 v73, v73, v245
  v_exp_f32 v243, v61
  v_cvt_pk_bf16_f32 v93, v244, v245
  v_exp_f32 v244, v62
  v_add_f32 v73, v73, v242
  v_add_f32 v73, v73, v243
  v_exp_f32 v245, v63
  v_cvt_pk_bf16_f32 v94, v242, v243
  v_add_f32 v73, v73, v244
  v_add_f32 v73, v73, v245
  v_cvt_pk_bf16_f32 v95, v244, v245
  s_nop 3
  s_setpc_b64 s[98:99]
L_fixb:
  s_nop 15
  v_max3_f32 v248, v32, v33, v34
  v_max3_f32 v248, v248, v35, v36
  v_max3_f32 v248, v248, v37, v38
  v_max_f32 v248, v248, v39
  v_max3_f32 v74, v40, v41, v42
  v_max3_f32 v74, v74, v43, v44
  v_max3_f32 v74, v74, v45, v46
  v_max_f32 v74, v74, v47
  v_mov_b32 v252, v248
  s_nop 1
  v_permlane16_swap_b32 v248, v252
  v_max_f32 v248, v248, v252
  v_mov_b32 v252, v248
  s_nop 1
  v_permlane32_swap_b32 v248, v252
  v_max_f32 v248, v248, v252
  v_mov_b32 v252, v74
  s_nop 1
  v_permlane16_swap_b32 v74, v252
  v_max_f32 v74, v74, v252
  v_mov_b32 v252, v74
  s_nop 1
  v_permlane32_swap_b32 v74, v252
  v_max_f32 v74, v74, v252
  v_max_f32 v248, 0, v248
  v_exp_f32 v242, -v248
  v_max_f32 v74, 0, v74
  v_exp_f32 v243, -v74
  v_mul_f32 v96, v96, v242
  v_mul_f32 v97, v97, v242
  v_mul_f32 v98, v98, v242
  v_mul_f32 v99, v99, v242
  v_mul_f32 v100, v100, v242
  v_mul_f32 v101, v101, v242
  v_mul_f32 v102, v102, v242
  v_mul_f32 v103, v103, v242
  v_mul_f32 v104, v104, v243
  v_mul_f32 v105, v105, v243
  v_mul_f32 v106, v106, v243
  v_mul_f32 v107, v107, v243
  v_mul_f32 v108, v108, v243
  v_mul_f32 v109, v109, v243
  v_mul_f32 v110, v110, v243
  v_mul_f32 v111, v111, v243
  v_mul_f32 v112, v112, v242
  v_mul_f32 v113, v113, v242
  v_mul_f32 v114, v114, v242
  v_mul_f32 v115, v115, v242
  v_mul_f32 v116, v116, v242
  v_mul_f32 v117, v117, v242
  v_mul_f32 v118, v118, v242
  v_mul_f32 v119, v119, v242
  v_mul_f32 v120, v120, v243
  v_mul_f32 v121, v121, v243
  v_mul_f32 v122, v122, v243
  v_mul_f32 v123, v123, v243
  v_mul_f32 v124, v124, v243
  v_mul_f32 v125, v125, v243
  v_mul_f32 v126, v126, v243
  v_mul_f32 v127, v127, v243
  v_mul_f32 v128, v128, v242
  v_mul_f32 v129, v129, v242
  v_mul_f32 v130, v130, v242
  v_mul_f32 v131, v131, v242
  v_mul_f32 v132, v132, v242
  v_mul_f32 v133, v133, v242
  v_mul_f32 v134, v134, v242
  v_mul_f32 v135, v135, v242
  v_mul_f32 v136, v136, v243
  v_mul_f32 v137, v137, v243
  v_mul_f32 v138, v138, v243
  v_mul_f32 v139, v139, v243
  v_mul_f32 v140, v140, v243
  v_mul_f32 v141, v141, v243
  v_mul_f32 v142, v142, v243
  v_mul_f32 v143, v143, v243
  v_mul_f32 v144, v144, v242
  v_mul_f32 v145, v145, v242
  v_mul_f32 v146, v146, v242
  v_mul_f32 v147, v147, v242
  v_mul_f32 v148, v148, v242
  v_mul_f32 v149, v149, v242
  v_mul_f32 v150, v150, v242
  v_mul_f32 v151, v151, v242
  v_mul_f32 v152, v152, v243
  v_mul_f32 v153, v153, v243
  v_mul_f32 v154, v154, v243
  v_mul_f32 v155, v155, v243
  v_mul_f32 v156, v156, v243
  v_mul_f32 v157, v157, v243
  v_mul_f32 v158, v158, v243
  v_mul_f32 v159, v159, v243
  v_mul_f32 v160, v160, v242
  v_mul_f32 v161, v161, v242
  v_mul_f32 v162, v162, v242
  v_mul_f32 v163, v163, v242
  v_mul_f32 v164, v164, v242
  v_mul_f32 v165, v165, v242
  v_mul_f32 v166, v166, v242
  v_mul_f32 v167, v167, v242
  v_mul_f32 v168, v168, v243
  v_mul_f32 v169, v169, v243
  v_mul_f32 v170, v170, v243
  v_mul_f32 v171, v171, v243
  v_mul_f32 v172, v172, v243
  v_mul_f32 v173, v173, v243
  v_mul_f32 v174, v174, v243
  v_mul_f32 v175, v175, v243
  v_mul_f32 v176, v176, v242
  v_mul_f32 v177, v177, v242
  v_mul_f32 v178, v178, v242
  v_mul_f32 v179, v179, v242
  v_mul_f32 v180, v180, v242
  v_mul_f32 v181, v181, v242
  v_mul_f32 v182, v182, v242
  v_mul_f32 v183, v183, v242
  v_mul_f32 v184, v184, v243
  v_mul_f32 v185, v185, v243
  v_mul_f32 v186, v186, v243
  v_mul_f32 v187, v187, v243
  v_mul_f32 v188, v188, v243
  v_mul_f32 v189, v189, v243
  v_mul_f32 v190, v190, v243
  v_mul_f32 v191, v191, v243
  v_mul_f32 v192, v192, v242
  v_mul_f32 v193, v193, v242
  v_mul_f32 v194, v194, v242
  v_mul_f32 v195, v195, v242
  v_mul_f32 v196, v196, v242
  v_mul_f32 v197, v197, v242
  v_mul_f32 v198, v198, v242
  v_mul_f32 v199, v199, v242
  v_mul_f32 v200, v200, v243
  v_mul_f32 v201, v201, v243
  v_mul_f32 v202, v202, v243
  v_mul_f32 v203, v203, v243
  v_mul_f32 v204, v204, v243
  v_mul_f32 v205, v205, v243
  v_mul_f32 v206, v206, v243
  v_mul_f32 v207, v207, v243
  v_accvgpr_read_b32 v253, a96
  v_mul_f32 v253, v253, v242
  v_accvgpr_write_b32 a96, v253
  v_accvgpr_read_b32 v253, a97
  v_mul_f32 v253, v253, v242
  v_accvgpr_write_b32 a97, v253
  v_accvgpr_read_b32 v253, a98
  v_mul_f32 v253, v253, v242
  v_accvgpr_write_b32 a98, v253
  v_accvgpr_read_b32 v253, a99
  v_mul_f32 v253, v253, v242
  v_accvgpr_write_b32 a99, v253
  v_accvgpr_read_b32 v253, a100
  v_mul_f32 v253, v253, v242
  v_accvgpr_write_b32 a100, v253
  v_accvgpr_read_b32 v253, a101
  v_mul_f32 v253, v253, v242
  v_accvgpr_write_b32 a101, v253
  v_accvgpr_read_b32 v253, a102
  v_mul_f32 v253, v253, v242
  v_accvgpr_write_b32 a102, v253
  v_accvgpr_read_b32 v253, a103
  v_mul_f32 v253, v253, v242
  v_accvgpr_write_b32 a103, v253
  v_accvgpr_read_b32 v253, a104
  v_mul_f32 v253, v253, v243
  v_accvgpr_write_b32 a104, v253
  v_accvgpr_read_b32 v253, a105
  v_mul_f32 v253, v253, v243
  v_accvgpr_write_b32 a105, v253
  v_accvgpr_read_b32 v253, a106
  v_mul_f32 v253, v253, v243
  v_accvgpr_write_b32 a106, v253
  v_accvgpr_read_b32 v253, a107
  v_mul_f32 v253, v253, v243
  v_accvgpr_write_b32 a107, v253
  v_accvgpr_read_b32 v253, a108
  v_mul_f32 v253, v253, v243
  v_accvgpr_write_b32 a108, v253
  v_accvgpr_read_b32 v253, a109
  v_mul_f32 v253, v253, v243
  v_accvgpr_write_b32 a109, v253
  v_accvgpr_read_b32 v253, a110
  v_mul_f32 v253, v253, v243
  v_accvgpr_write_b32 a110, v253
  v_accvgpr_read_b32 v253, a111
  v_mul_f32 v253, v253, v243
  v_accvgpr_write_b32 a111, v253
  v_mul_f32 v246, v246, v242
  v_mul_f32 v247, v247, v243
  v_sub_f32 v64, v64, v248
  v_sub_f32 v32, v32, v248
  v_sub_f32 v48, v48, v248
  v_sub_f32 v65, v65, v248
  v_sub_f32 v33, v33, v248
  v_sub_f32 v49, v49, v248
  v_sub_f32 v66, v66, v248
  v_sub_f32 v34, v34, v248
  v_sub_f32 v50, v50, v248
  v_sub_f32 v67, v67, v248
  v_sub_f32 v35, v35, v248
  v_sub_f32 v51, v51, v248
  v_sub_f32 v68, v68, v74
  v_sub_f32 v36, v36, v248
  v_sub_f32 v52, v52, v248
  v_sub_f32 v69, v69, v74
  v_sub_f32 v37, v37, v248
  v_sub_f32 v53, v53, v248
  v_sub_f32 v70, v70, v74
  v_sub_f32 v38, v38, v248
  v_sub_f32 v54, v54, v248
  v_sub_f32 v71, v71, v74
  v_sub_f32 v39, v39, v248
  v_sub_f32 v55, v55, v248
  v_sub_f32 v40, v40, v74
  v_sub_f32 v56, v56, v74
  v_sub_f32 v41, v41, v74
  v_sub_f32 v57, v57, v74
  v_sub_f32 v42, v42, v74
  v_sub_f32 v58, v58, v74
  v_sub_f32 v43, v43, v74
  v_sub_f32 v59, v59, v74
  v_sub_f32 v44, v44, v74
  v_sub_f32 v60, v60, v74
  v_sub_f32 v45, v45, v74
  v_sub_f32 v61, v61, v74
  v_sub_f32 v46, v46, v74
  v_sub_f32 v62, v62, v74
  v_sub_f32 v47, v47, v74
  v_sub_f32 v63, v63, v74
  v_exp_f32 v242, v32
  v_exp_f32 v243, v33
  v_exp_f32 v244, v34
  v_add_f32 v72, v242, v243
  v_exp_f32 v245, v35
  v_cvt_pk_bf16_f32 v80, v242, v243
  v_exp_f32 v242, v36
  v_add_f32 v72, v72, v244
  v_add_f32 v72, v72, v245
  v_exp_f32 v243, v37
  v_cvt_pk_bf16_f32 v81, v244, v245
  v_exp_f32 v244, v38
  v_add_f32 v72, v72, v242
  v_add_f32 v72, v72, v243
  v_exp_f32 v245, v39
  v_cvt_pk_bf16_f32 v82, v242, v243
  v_exp_f32 v242, v40
  v_add_f32 v72, v72, v244
  v_add_f32 v72, v72, v245
  v_exp_f32 v243, v41
  v_cvt_pk_bf16_f32 v83, v244, v245
  v_exp_f32 v244, v42
  v_add_f32 v73, v242, v243
  v_exp_f32 v245, v43
  v_cvt_pk_bf16_f32 v84, v242, v243
  v_exp_f32 v242, v44
  v_add_f32 v73, v73, v244
  v_add_f32 v73, v73, v245
  v_exp_f32 v243, v45
  v_cvt_pk_bf16_f32 v85, v244, v245
  v_exp_f32 v244, v46
  v_add_f32 v73, v73, v242
  v_add_f32 v73, v73, v243
  v_exp_f32 v245, v47
  v_cvt_pk_bf16_f32 v86, v242, v243
  v_add_f32 v73, v73, v244
  v_add_f32 v73, v73, v245
  v_cvt_pk_bf16_f32 v87, v244, v245
  s_nop 3
  s_setpc_b64 s[98:99]
L_fixl:
  s_nop 15
  v_max3_f32 v248, v48, v49, v50
  v_max3_f32 v248, v248, v51, v52
  v_max3_f32 v248, v248, v53, v54
  v_max_f32 v248, v248, v55
  v_max3_f32 v74, v56, v57, v58
  v_max3_f32 v74, v74, v59, v60
  v_max3_f32 v74, v74, v61, v62
  v_max_f32 v74, v74, v63
  v_mov_b32 v252, v248
  s_nop 1
  v_permlane16_swap_b32 v248, v252
  v_max_f32 v248, v248, v252
  v_mov_b32 v252, v248
  s_nop 1
  v_permlane32_swap_b32 v248, v252
  v_max_f32 v248, v248, v252
  v_mov_b32 v252, v74
  s_nop 1
  v_permlane16_swap_b32 v74, v252
  v_max_f32 v74, v74, v252
  v_mov_b32 v252, v74
  s_nop 1
  v_permlane32_swap_b32 v74, v252
  v_max_f32 v74, v74, v252
  v_max_f32 v248, 0, v248
  v_exp_f32 v242, -v248
  v_max_f32 v74, 0, v74
  v_exp_f32 v243, -v74
  v_mul_f32 v96, v96, v242
  v_mul_f32 v97, v97, v242
  v_mul_f32 v98, v98, v242
  v_mul_f32 v99, v99, v242
  v_mul_f32 v100, v100, v242
  v_mul_f32 v101, v101, v242
  v_mul_f32 v102, v102, v242
  v_mul_f32 v103, v103, v242
  v_mul_f32 v104, v104, v243
  v_mul_f32 v105, v105, v243
  v_mul_f32 v106, v106, v243
  v_mul_f32 v107, v107, v243
  v_mul_f32 v108, v108, v243
  v_mul_f32 v109, v109, v243
  v_mul_f32 v110, v110, v243
  v_mul_f32 v111, v111, v243
  v_mul_f32 v112, v112, v242
  v_mul_f32 v113, v113, v242
  v_mul_f32 v114, v114, v242
  v_mul_f32 v115, v115, v242
  v_mul_f32 v116, v116, v242
  v_mul_f32 v117, v117, v242
  v_mul_f32 v118, v118, v242
  v_mul_f32 v119, v119, v242
  v_mul_f32 v120, v120, v243
  v_mul_f32 v121, v121, v243
  v_mul_f32 v122, v122, v243
  v_mul_f32 v123, v123, v243
  v_mul_f32 v124, v124, v243
  v_mul_f32 v125, v125, v243
  v_mul_f32 v126, v126, v243
  v_mul_f32 v127, v127, v243
  v_mul_f32 v128, v128, v242
  v_mul_f32 v129, v129, v242
  v_mul_f32 v130, v130, v242
  v_mul_f32 v131, v131, v242
  v_mul_f32 v132, v132, v242
  v_mul_f32 v133, v133, v242
  v_mul_f32 v134, v134, v242
  v_mul_f32 v135, v135, v242
  v_mul_f32 v136, v136, v243
  v_mul_f32 v137, v137, v243
  v_mul_f32 v138, v138, v243
  v_mul_f32 v139, v139, v243
  v_mul_f32 v140, v140, v243
  v_mul_f32 v141, v141, v243
  v_mul_f32 v142, v142, v243
  v_mul_f32 v143, v143, v243
  v_mul_f32 v144, v144, v242
  v_mul_f32 v145, v145, v242
  v_mul_f32 v146, v146, v242
  v_mul_f32 v147, v147, v242
  v_mul_f32 v148, v148, v242
  v_mul_f32 v149, v149, v242
  v_mul_f32 v150, v150, v242
  v_mul_f32 v151, v151, v242
  v_mul_f32 v152, v152, v243
  v_mul_f32 v153, v153, v243
  v_mul_f32 v154, v154, v243
  v_mul_f32 v155, v155, v243
  v_mul_f32 v156, v156, v243
  v_mul_f32 v157, v157, v243
  v_mul_f32 v158, v158, v243
  v_mul_f32 v159, v159, v243
  v_mul_f32 v160, v160, v242
  v_mul_f32 v161, v161, v242
  v_mul_f32 v162, v162, v242
  v_mul_f32 v163, v163, v242
  v_mul_f32 v164, v164, v242
  v_mul_f32 v165, v165, v242
  v_mul_f32 v166, v166, v242
  v_mul_f32 v167, v167, v242
  v_mul_f32 v168, v168, v243
  v_mul_f32 v169, v169, v243
  v_mul_f32 v170, v170, v243
  v_mul_f32 v171, v171, v243
  v_mul_f32 v172, v172, v243
  v_mul_f32 v173, v173, v243
  v_mul_f32 v174, v174, v243
  v_mul_f32 v175, v175, v243
  v_mul_f32 v176, v176, v242
  v_mul_f32 v177, v177, v242
  v_mul_f32 v178, v178, v242
  v_mul_f32 v179, v179, v242
  v_mul_f32 v180, v180, v242
  v_mul_f32 v181, v181, v242
  v_mul_f32 v182, v182, v242
  v_mul_f32 v183, v183, v242
  v_mul_f32 v184, v184, v243
  v_mul_f32 v185, v185, v243
  v_mul_f32 v186, v186, v243
  v_mul_f32 v187, v187, v243
  v_mul_f32 v188, v188, v243
  v_mul_f32 v189, v189, v243
  v_mul_f32 v190, v190, v243
  v_mul_f32 v191, v191, v243
  v_mul_f32 v192, v192, v242
  v_mul_f32 v193, v193, v242
  v_mul_f32 v194, v194, v242
  v_mul_f32 v195, v195, v242
  v_mul_f32 v196, v196, v242
  v_mul_f32 v197, v197, v242
  v_mul_f32 v198, v198, v242
  v_mul_f32 v199, v199, v242
  v_mul_f32 v200, v200, v243
  v_mul_f32 v201, v201, v243
  v_mul_f32 v202, v202, v243
  v_mul_f32 v203, v203, v243
  v_mul_f32 v204, v204, v243
  v_mul_f32 v205, v205, v243
  v_mul_f32 v206, v206, v243
  v_mul_f32 v207, v207, v243
  v_accvgpr_read_b32 v253, a96
  v_mul_f32 v253, v253, v242
  v_accvgpr_write_b32 a96, v253
  v_accvgpr_read_b32 v253, a97
  v_mul_f32 v253, v253, v242
  v_accvgpr_write_b32 a97, v253
  v_accvgpr_read_b32 v253, a98
  v_mul_f32 v253, v253, v242
  v_accvgpr_write_b32 a98, v253
  v_accvgpr_read_b32 v253, a99
  v_mul_f32 v253, v253, v242
  v_accvgpr_write_b32 a99, v253
  v_accvgpr_read_b32 v253, a100
  v_mul_f32 v253, v253, v242
  v_accvgpr_write_b32 a100, v253
  v_accvgpr_read_b32 v253, a101
  v_mul_f32 v253, v253, v242
  v_accvgpr_write_b32 a101, v253
  v_accvgpr_read_b32 v253, a102
  v_mul_f32 v253, v253, v242
  v_accvgpr_write_b32 a102, v253
  v_accvgpr_read_b32 v253, a103
  v_mul_f32 v253, v253, v242
  v_accvgpr_write_b32 a103, v253
  v_accvgpr_read_b32 v253, a104
  v_mul_f32 v253, v253, v243
  v_accvgpr_write_b32 a104, v253
  v_accvgpr_read_b32 v253, a105
  v_mul_f32 v253, v253, v243
  v_accvgpr_write_b32 a105, v253
  v_accvgpr_read_b32 v253, a106
  v_mul_f32 v253, v253, v243
  v_accvgpr_write_b32 a106, v253
  v_accvgpr_read_b32 v253, a107
  v_mul_f32 v253, v253, v243
  v_accvgpr_write_b32 a107, v253
  v_accvgpr_read_b32 v253, a108
  v_mul_f32 v253, v253, v243
  v_accvgpr_write_b32 a108, v253
  v_accvgpr_read_b32 v253, a109
  v_mul_f32 v253, v253, v243
  v_accvgpr_write_b32 a109, v253
  v_accvgpr_read_b32 v253, a110
  v_mul_f32 v253, v253, v243
  v_accvgpr_write_b32 a110, v253
  v_accvgpr_read_b32 v253, a111
  v_mul_f32 v253, v253, v243
  v_accvgpr_write_b32 a111, v253
  v_mul_f32 v246, v246, v242
  v_mul_f32 v247, v247, v243
  v_sub_f32 v64, v64, v248
  v_sub_f32 v48, v48, v248
  v_sub_f32 v65, v65, v248
  v_sub_f32 v49, v49, v248
  v_sub_f32 v66, v66, v248
  v_sub_f32 v50, v50, v248
  v_sub_f32 v67, v67, v248
  v_sub_f32 v51, v51, v248
  v_sub_f32 v68, v68, v74
  v_sub_f32 v52, v52, v248
  v_sub_f32 v69, v69, v74
  v_sub_f32 v53, v53, v248
  v_sub_f32 v70, v70, v74
  v_sub_f32 v54, v54, v248
  v_sub_f32 v71, v71, v74
  v_sub_f32 v55, v55, v248
  v_sub_f32 v56, v56, v74
  v_sub_f32 v57, v57, v74
  v_sub_f32 v58, v58, v74
  v_sub_f32 v59, v59, v74
  v_sub_f32 v60, v60, v74
  v_sub_f32 v61, v61, v74
  v_sub_f32 v62, v62, v74
  v_sub_f32 v63, v63, v74
  v_exp_f32 v242, v48
  v_exp_f32 v243, v49
  v_exp_f32 v244, v50
  v_add_f32 v72, v242, v243
  v_exp_f32 v245, v51
  v_cvt_pk_bf16_f32 v88, v242, v243
  v_exp_f32 v242, v52
  v_add_f32 v72, v72, v244
  v_add_f32 v72, v72, v245
  v_exp_f32 v243, v53
  v_cvt_pk_bf16_f32 v89, v244, v245
  v_exp_f32 v244, v54
  v_add_f32 v72, v72, v242
  v_add_f32 v72, v72, v243
  v_exp_f32 v245, v55
  v_cvt_pk_bf16_f32 v90, v242, v243
  v_exp_f32 v242, v56
  v_add_f32 v72, v72, v244
  v_add_f32 v72, v72, v245
  v_exp_f32 v243, v57
  v_cvt_pk_bf16_f32 v91, v244, v245
  v_exp_f32 v244, v58
  v_add_f32 v73, v242, v243
  v_exp_f32 v245, v59
  v_cvt_pk_bf16_f32 v92, v242, v243
  v_exp_f32 v242, v60
  v_add_f32 v73, v73, v244
  v_add_f32 v73, v73, v245
  v_exp_f32 v243, v61
  v_cvt_pk_bf16_f32 v93, v244, v245
  v_exp_f32 v244, v62
  v_add_f32 v73, v73, v242
  v_add_f32 v73, v73, v243
  v_exp_f32 v245, v63
  v_cvt_pk_bf16_f32 v94, v242, v243
  v_add_f32 v73, v73, v244
  v_add_f32 v73, v73, v245
  v_cvt_pk_bf16_f32 v95, v244, v245
  s_nop 3
  s_setpc_b64 s[98:99]

.section .rodata,"a"
.p2align 6
.amdhsa_kernel main_kernel
  .amdhsa_next_free_vgpr 512
  .amdhsa_next_free_sgpr 102
  .amdhsa_accum_offset 256
  .amdhsa_group_segment_fixed_size 0
  .amdhsa_kernarg_size 104
  .amdhsa_user_sgpr_count 2
  .amdhsa_user_sgpr_kernarg_segment_ptr 1
  .amdhsa_system_sgpr_workgroup_id_x 1
.end_amdhsa_kernel
```
